```python
import torch

def _softmax(x, axis=-1):
    return torch.softmax(x, dim=axis)
def _gelu(x):
    return torch.nn.functional.gelu(x, approximate="tanh")
def _silu(x):
    return torch.nn.functional.silu(x)
def _sigmoid(x):
    return torch.sigmoid(x)
def _layernorm(x, axis=-1, eps=1e-5):
    m = x.mean(dim=axis, keepdim=True)
    v = x.var(dim=axis, keepdim=True, unbiased=False)
    return (x - m) / torch.sqrt(v + eps)
def _scatter_add(tgt, idx, src, axis=0):
    return tgt.clone().index_add_(axis, idx, src)
def _segment_sum(src, seg, n):
    out = torch.zeros((n,) + src.shape[1:], dtype=src.dtype)
    return out.index_add_(0, seg, src)
def _pad(x, pw):
    flat = tuple(v for pair in reversed(pw) for v in pair)
    return torch.nn.functional.pad(x, flat)

kernel_name = 'parallel_sum__linear_kernel_hedgehog__dense_activation_silu__prompt'

def setup_inputs():

    _w = (lambda a: (lambda t: t.to(torch.bfloat16) if t.is_floating_point() else t)(torch.as_tensor(a)))
    def _A_setup():
        B, S, D, H = 1, 2048, 576, 32
        Dh = D // H
        return {
            "x": _w((lambda *s: torch.randn(*s, dtype=torch.bfloat16) * 0.05)(B, S, D)),
            "wqkv": _w((lambda *s: torch.randn(*s, dtype=torch.bfloat16) * 0.2)(D, 3 * D)),
            "w_phi": _w((lambda *s: torch.randn(*s, dtype=torch.bfloat16) * 0.2)(H, Dh, Dh) * (Dh ** -0.5)),
            "wo": _w((lambda *s: torch.randn(*s, dtype=torch.bfloat16) * 0.05)(D, D)),
        }
    _A_in = _A_setup()

    def _B_setup():
        B, S, D, F = 1, 2048, 576, 4608
        return {
            "x": _w((lambda *s: torch.randn(*s, dtype=torch.bfloat16) * 0.05)(B, S, D)),
            "w1": _w((lambda *s: torch.randn(*s, dtype=torch.bfloat16) * 1.6)(D, F) * (D ** -0.5)),
            "w2": _w((lambda *s: torch.randn(*s, dtype=torch.bfloat16) * 0.1)(F, D) * (F ** -0.5)),
        }
    _B_in = _B_setup()

    return {
        "A_x": _A_in["x"],
        "A_wqkv": _A_in["wqkv"],
        "A_w_phi": _A_in["w_phi"],
        "A_wo": _A_in["wo"],
        "B_x": _B_in["x"],
        "B_w1": _B_in["w1"],
        "B_w2": _B_in["w2"],
    }

def reference(A_x, A_wqkv, A_w_phi, A_wo, B_x, B_w1, B_w2):
    def _A_ref(x, wqkv, w_phi, wo):
        B, S, D = x.shape
        H = 32; Dh = D // H
        qkv = (lambda x, *d: x.permute(*d))((x @ wqkv).reshape(B, S, 3, H, Dh), 2, 0, 3, 1, 4)
        q, k, v = qkv[0], qkv[1], qkv[2]
        pq = torch.einsum("bhsd,hdf->bhsf", q, w_phi)
        pk = torch.einsum("bhsd,hdf->bhsf", k, w_phi)
        phi_q = torch.concatenate([_softmax(pq, axis=-1), _softmax(-pq, axis=-1)], axis=-1)
        phi_k = torch.concatenate([_softmax(pk, axis=-1), _softmax(-pk, axis=-1)], axis=-1)
        kv = torch.einsum("bhsf,bhsd->bhfd", phi_k, v)
        z  = torch.einsum("bhsf->bhf", phi_k)
        num = torch.einsum("bhqf,bhfd->bhqd", phi_q, kv)
        den = torch.einsum("bhqf,bhf->bhq", phi_q, z)[..., None] + 1e-6
        o = num / den
        return (lambda x, *d: x.permute(*d))(o, 0, 2, 1, 3).reshape(B, S, D) @ wo

    def _B_ref(x, w1, w2):
        h = torch.einsum("bsd,df->bsf", x, w1)
        h = _silu(h)
        out = torch.einsum("bsf,fd->bsd", h, w2)
        return out

    x = A_x
    xn = _layernorm(x, axis=-1)
    return x + _A_ref(xn, A_wqkv, A_w_phi, A_wo) + _B_ref(xn, B_w1, B_w2)
```

```asm
; @launch kernel=k1_ln_gemm1_kernel grid=(256,1,1) block=(256,1,1) lds=131072
; @launch kernel=k2_attn_out_kernel grid=(256,1,1) block=(256,1,1) lds=6144
; @launch kernel=k3_gemm2_kernel grid=(256,1,1) block=(256,1,1) lds=122880
; @launch kernel=k4_reduce_kernel grid=(576,1,1) block=(256,1,1) lds=0
.amdgcn_target "amdgcn-amd-amdhsa--gfx950"
.text
.globl k1_ln_gemm1_kernel
.p2align 8
.type k1_ln_gemm1_kernel,@function
k1_ln_gemm1_kernel:
    s_load_dwordx2 s[4:5], s[0:1], 0
    s_load_dwordx2 s[6:7], s[0:1], 8
    s_load_dwordx2 s[8:9], s[0:1], 16
    s_load_dwordx2 s[10:11], s[0:1], 40
    s_load_dwordx2 s[12:13], s[0:1], 72
    s_cmp_ge_u32 s2, 256
    s_cbranch_scc1 L_k1_ln_gemm1_kernel_end
    s_lshr_b32 s44, s2, 4
    s_and_b32 s45, s2, 15
    v_and_b32 v1, 63, v0
    v_lshrrev_b32 v4, 6, v0
    v_lshrrev_b32 v2, 4, v1
    v_and_b32 v3, 15, v1
    v_readfirstlane_b32 s46, v4
    s_waitcnt lgkmcnt(0)
    s_mov_b32 s16, s4
    s_mov_b32 s17, s5
    s_mov_b32 s18, 2359296
    s_mov_b32 s19, 0x00020000
    s_mov_b32 s20, s10
    s_mov_b32 s21, s11
    s_mov_b32 s22, 5308416
    s_mov_b32 s23, 0x00020000
    s_mov_b32 s24, s6
    s_mov_b32 s25, s7
    s_mov_b32 s26, 1990656
    s_mov_b32 s27, 0x00020000
    s_mov_b32 s28, s12
    s_mov_b32 s29, s13
    s_mov_b32 s30, 21233664
    s_mov_b32 s31, 0x00020000
    s_add_u32 s32, s12, 25165824
    s_addc_u32 s33, s13, 0
    s_mov_b32 s34, 4718592
    s_mov_b32 s35, 0x00020000
    s_add_u32 s36, s12, 33554432
    s_addc_u32 s37, s13, 0
    s_mov_b32 s38, 3145728
    s_mov_b32 s39, 0x00020000
    s_lshl_b32 s53, s44, 7
    s_lshl_b32 s54, s46, 5
    s_add_u32 s53, s53, s54
    v_add_u32 v5, s53, v3
    v_mul_u32_u24 v10, 1152, v5
    v_lshlrev_b32 v6, 4, v2
    v_add_u32 v10, v10, v6
    v_add_u32 v11, 18432, v10
    s_lshl_b32 s53, s44, 6
    buffer_load_dwordx4 v[72:75], v10, s[16:19], s53 offen
    buffer_load_dwordx4 v[144:147], v11, s[16:19], s53 offen
    s_add_u32 s53, s53, 64
    s_cmp_eq_u32 s53, 1152
    s_cselect_b32 s53, 0, s53
    buffer_load_dwordx4 v[76:79], v10, s[16:19], s53 offen
    buffer_load_dwordx4 v[148:151], v11, s[16:19], s53 offen
    s_add_u32 s53, s53, 64
    s_cmp_eq_u32 s53, 1152
    s_cselect_b32 s53, 0, s53
    buffer_load_dwordx4 v[80:83], v10, s[16:19], s53 offen
    buffer_load_dwordx4 v[152:155], v11, s[16:19], s53 offen
    s_add_u32 s53, s53, 64
    s_cmp_eq_u32 s53, 1152
    s_cselect_b32 s53, 0, s53
    buffer_load_dwordx4 v[84:87], v10, s[16:19], s53 offen
    buffer_load_dwordx4 v[156:159], v11, s[16:19], s53 offen
    s_add_u32 s53, s53, 64
    s_cmp_eq_u32 s53, 1152
    s_cselect_b32 s53, 0, s53
    buffer_load_dwordx4 v[88:91], v10, s[16:19], s53 offen
    buffer_load_dwordx4 v[160:163], v11, s[16:19], s53 offen
    s_add_u32 s53, s53, 64
    s_cmp_eq_u32 s53, 1152
    s_cselect_b32 s53, 0, s53
    buffer_load_dwordx4 v[92:95], v10, s[16:19], s53 offen
    buffer_load_dwordx4 v[164:167], v11, s[16:19], s53 offen
    s_add_u32 s53, s53, 64
    s_cmp_eq_u32 s53, 1152
    s_cselect_b32 s53, 0, s53
    buffer_load_dwordx4 v[96:99], v10, s[16:19], s53 offen
    buffer_load_dwordx4 v[168:171], v11, s[16:19], s53 offen
    s_add_u32 s53, s53, 64
    s_cmp_eq_u32 s53, 1152
    s_cselect_b32 s53, 0, s53
    buffer_load_dwordx4 v[100:103], v10, s[16:19], s53 offen
    buffer_load_dwordx4 v[172:175], v11, s[16:19], s53 offen
    s_add_u32 s53, s53, 64
    s_cmp_eq_u32 s53, 1152
    s_cselect_b32 s53, 0, s53
    buffer_load_dwordx4 v[104:107], v10, s[16:19], s53 offen
    buffer_load_dwordx4 v[176:179], v11, s[16:19], s53 offen
    s_add_u32 s53, s53, 64
    s_cmp_eq_u32 s53, 1152
    s_cselect_b32 s53, 0, s53
    buffer_load_dwordx4 v[108:111], v10, s[16:19], s53 offen
    buffer_load_dwordx4 v[180:183], v11, s[16:19], s53 offen
    s_add_u32 s53, s53, 64
    s_cmp_eq_u32 s53, 1152
    s_cselect_b32 s53, 0, s53
    buffer_load_dwordx4 v[112:115], v10, s[16:19], s53 offen
    buffer_load_dwordx4 v[184:187], v11, s[16:19], s53 offen
    s_add_u32 s53, s53, 64
    s_cmp_eq_u32 s53, 1152
    s_cselect_b32 s53, 0, s53
    buffer_load_dwordx4 v[116:119], v10, s[16:19], s53 offen
    buffer_load_dwordx4 v[188:191], v11, s[16:19], s53 offen
    s_add_u32 s53, s53, 64
    s_cmp_eq_u32 s53, 1152
    s_cselect_b32 s53, 0, s53
    buffer_load_dwordx4 v[120:123], v10, s[16:19], s53 offen
    buffer_load_dwordx4 v[192:195], v11, s[16:19], s53 offen
    s_add_u32 s53, s53, 64
    s_cmp_eq_u32 s53, 1152
    s_cselect_b32 s53, 0, s53
    buffer_load_dwordx4 v[124:127], v10, s[16:19], s53 offen
    buffer_load_dwordx4 v[196:199], v11, s[16:19], s53 offen
    s_add_u32 s53, s53, 64
    s_cmp_eq_u32 s53, 1152
    s_cselect_b32 s53, 0, s53
    buffer_load_dwordx4 v[128:131], v10, s[16:19], s53 offen
    buffer_load_dwordx4 v[200:203], v11, s[16:19], s53 offen
    s_add_u32 s53, s53, 64
    s_cmp_eq_u32 s53, 1152
    s_cselect_b32 s53, 0, s53
    buffer_load_dwordx4 v[132:135], v10, s[16:19], s53 offen
    buffer_load_dwordx4 v[204:207], v11, s[16:19], s53 offen
    s_add_u32 s53, s53, 64
    s_cmp_eq_u32 s53, 1152
    s_cselect_b32 s53, 0, s53
    buffer_load_dwordx4 v[136:139], v10, s[16:19], s53 offen
    buffer_load_dwordx4 v[208:211], v11, s[16:19], s53 offen
    s_add_u32 s53, s53, 64
    s_cmp_eq_u32 s53, 1152
    s_cselect_b32 s53, 0, s53
    buffer_load_dwordx4 v[140:143], v10, s[16:19], s53 offen
    buffer_load_dwordx4 v[212:215], v11, s[16:19], s53 offen
    s_add_u32 s53, s53, 64
    s_cmp_eq_u32 s53, 1152
    s_cselect_b32 s53, 0, s53
    s_mul_i32 s55, s45, 576
    s_mul_i32 s56, s45, 72
    s_lshl_b32 s53, s46, 6
    s_add_u32 s53, s53, 0
    v_add_u32 v4, s53, v1
    v_mul_u32_u24 v5, 1821, v4
    v_lshrrev_b32 v5, 16, v5
    v_mul_u32_u24 v6, 36, v5
    v_sub_u32 v6, v4, v6
    v_lshrrev_b32 v7, 1, v6
    v_bfe_u32 v8, v5, 3, 1
    v_xor_b32 v7, v7, v8
    v_and_b32 v6, 1, v6
    v_lshlrev_b32 v7, 5, v7
    v_lshl_add_u32 v7, v6, 4, v7
    v_mul_u32_u24 v5, 9216, v5
    v_add3_u32 v12, v5, v7, s55
    s_lshl_b32 s53, s46, 6
    s_add_u32 s53, s53, 256
    v_add_u32 v4, s53, v1
    v_mul_u32_u24 v5, 1821, v4
    v_lshrrev_b32 v5, 16, v5
    v_mul_u32_u24 v6, 36, v5
    v_sub_u32 v6, v4, v6
    v_lshrrev_b32 v7, 1, v6
    v_bfe_u32 v8, v5, 3, 1
    v_xor_b32 v7, v7, v8
    v_and_b32 v6, 1, v6
    v_lshlrev_b32 v7, 5, v7
    v_lshl_add_u32 v7, v6, 4, v7
    v_mul_u32_u24 v5, 9216, v5
    v_add3_u32 v13, v5, v7, s55
    s_lshl_b32 s53, s46, 6
    s_add_u32 s53, s53, 512
    v_add_u32 v4, s53, v1
    v_mul_u32_u24 v5, 1821, v4
    v_lshrrev_b32 v5, 16, v5
    v_mul_u32_u24 v6, 36, v5
    v_sub_u32 v6, v4, v6
    v_lshrrev_b32 v7, 1, v6
    v_bfe_u32 v8, v5, 3, 1
    v_xor_b32 v7, v7, v8
    v_and_b32 v6, 1, v6
    v_lshlrev_b32 v7, 5, v7
    v_lshl_add_u32 v7, v6, 4, v7
    v_mul_u32_u24 v5, 9216, v5
    v_add3_u32 v14, v5, v7, s55
    s_lshl_b32 s53, s46, 6
    s_add_u32 s53, s53, 768
    v_add_u32 v4, s53, v1
    v_mul_u32_u24 v5, 1821, v4
    v_lshrrev_b32 v5, 16, v5
    v_mul_u32_u24 v6, 36, v5
    v_sub_u32 v6, v4, v6
    v_lshrrev_b32 v7, 1, v6
    v_bfe_u32 v8, v5, 3, 1
    v_xor_b32 v7, v7, v8
    v_and_b32 v6, 1, v6
    v_lshlrev_b32 v7, 5, v7
    v_lshl_add_u32 v7, v6, 4, v7
    v_mul_u32_u24 v5, 9216, v5
    v_add3_u32 v15, v5, v7, s55
    s_lshl_b32 s53, s46, 6
    s_add_u32 s53, s53, 1024
    v_add_u32 v4, s53, v1
    v_mul_u32_u24 v5, 1821, v4
    v_lshrrev_b32 v5, 16, v5
    v_mul_u32_u24 v6, 36, v5
    v_sub_u32 v6, v4, v6
    v_lshrrev_b32 v7, 1, v6
    v_bfe_u32 v8, v5, 3, 1
    v_xor_b32 v7, v7, v8
    v_and_b32 v6, 1, v6
    v_lshlrev_b32 v7, 5, v7
    v_lshl_add_u32 v7, v6, 4, v7
    v_mul_u32_u24 v5, 9216, v5
    v_add3_u32 v16, v5, v7, s55
    s_lshl_b32 s53, s46, 6
    s_add_u32 s53, s53, 0
    v_add_u32 v4, s53, v1
    v_lshrrev_b32 v5, 4, v4
    v_and_b32 v6, 15, v4
    v_lshrrev_b32 v7, 1, v6
    v_and_b32 v8, 3, v5
    v_bfe_u32 v9, v5, 3, 1
    v_lshl_or_b32 v8, v9, 2, v8
    v_xor_b32 v7, v7, v8
    v_and_b32 v6, 1, v6
    v_lshl_add_u32 v7, v7, 1, v6
    v_mul_u32_u24 v8, 205, v7
    v_lshrrev_b32 v8, 10, v8
    v_mul_u32_u24 v9, 5, v8
    v_sub_u32 v9, v7, v9
    v_mul_u32_u24 v8, 1152, v8
    v_lshl_add_u32 v8, v9, 4, v8
    v_mul_u32_u24 v5, 3456, v5
    v_add3_u32 v5, v5, v8, s56
    v_cmp_eq_u32 vcc, 15, v7
    v_mov_b32 v8, 0x80000000
    s_nop 1
    v_cndmask_b32 v17, v5, v8, vcc
    s_lshl_b32 s53, s46, 6
    s_add_u32 s53, s53, 256
    v_add_u32 v4, s53, v1
    v_lshrrev_b32 v5, 4, v4
    v_and_b32 v6, 15, v4
    v_lshrrev_b32 v7, 1, v6
    v_and_b32 v8, 3, v5
    v_bfe_u32 v9, v5, 3, 1
    v_lshl_or_b32 v8, v9, 2, v8
    v_xor_b32 v7, v7, v8
    v_and_b32 v6, 1, v6
    v_lshl_add_u32 v7, v7, 1, v6
    v_mul_u32_u24 v8, 205, v7
    v_lshrrev_b32 v8, 10, v8
    v_mul_u32_u24 v9, 5, v8
    v_sub_u32 v9, v7, v9
    v_mul_u32_u24 v8, 1152, v8
    v_lshl_add_u32 v8, v9, 4, v8
    v_mul_u32_u24 v5, 3456, v5
    v_add3_u32 v5, v5, v8, s56
    v_cmp_eq_u32 vcc, 15, v7
    v_mov_b32 v8, 0x80000000
    s_nop 1
    v_cndmask_b32 v18, v5, v8, vcc
    s_lshl_b32 s57, s46, 10
    s_add_u32 s57, s57, 40960
    s_lshl_b32 s58, s46, 10
    s_add_u32 s58, s58, 0
    s_cmp_lt_u32 s46, 2
    s_cselect_b32 s42, s22, 0
    s_mov_b32 s40, s20
    s_mov_b32 s41, s21
    s_mov_b32 s43, 0x00020000
    s_mov_b32 s53, 10240
    s_cselect_b32 s50, 18432, s53
    s_add_u32 s53, s57, 16384
    s_lshl_b32 s54, s46, 10
    s_add_u32 s54, s54, 6144
    s_cmp_lt_u32 s46, 2
    s_cselect_b32 s49, s53, s54
    s_mul_i32 s47, s44, 294912
    s_mul_i32 s48, s44, 110592
    s_add_u32 m0, s57, 0
    s_nop 0
    buffer_load_dwordx4 v12, s[20:23], s47 offen lds
    s_add_u32 m0, s57, 4096
    s_nop 0
    buffer_load_dwordx4 v13, s[20:23], s47 offen lds
    s_add_u32 m0, s57, 8192
    s_nop 0
    buffer_load_dwordx4 v14, s[20:23], s47 offen lds
    s_add_u32 m0, s57, 12288
    s_nop 0
    buffer_load_dwordx4 v15, s[20:23], s47 offen lds
    s_mul_i32 s53, s50, 0
    s_add_u32 m0, s49, s53
    s_nop 0
    buffer_load_dwordx4 v16, s[40:43], s47 offen lds
    s_add_u32 m0, s58, 0
    s_nop 0
    buffer_load_dwordx4 v17, s[24:27], s48 offen lds
    s_add_u32 m0, s58, 4096
    s_nop 0
    buffer_load_dwordx4 v18, s[24:27], s48 offen lds
    s_add_u32 s47, s47, 294912
    s_cmp_eq_u32 s47, 5308416
    s_cselect_b32 s47, 0, s47
    s_add_u32 s48, s48, 110592
    s_cmp_eq_u32 s48, 1990656
    s_cselect_b32 s48, 0, s48
    s_add_u32 m0, s57, 18432
    s_nop 0
    buffer_load_dwordx4 v12, s[20:23], s47 offen lds
    s_add_u32 m0, s57, 22528
    s_nop 0
    buffer_load_dwordx4 v13, s[20:23], s47 offen lds
    s_add_u32 m0, s57, 26624
    s_nop 0
    buffer_load_dwordx4 v14, s[20:23], s47 offen lds
    s_add_u32 m0, s57, 30720
    s_nop 0
    buffer_load_dwordx4 v15, s[20:23], s47 offen lds
    s_mul_i32 s53, s50, 1
    s_add_u32 m0, s49, s53
    s_nop 0
    buffer_load_dwordx4 v16, s[40:43], s47 offen lds
    s_add_u32 m0, s58, 10240
    s_nop 0
    buffer_load_dwordx4 v17, s[24:27], s48 offen lds
    s_add_u32 m0, s58, 14336
    s_nop 0
    buffer_load_dwordx4 v18, s[24:27], s48 offen lds
    s_add_u32 s47, s47, 294912
    s_cmp_eq_u32 s47, 5308416
    s_cselect_b32 s47, 0, s47
    s_add_u32 s48, s48, 110592
    s_cmp_eq_u32 s48, 1990656
    s_cselect_b32 s48, 0, s48
    v_lshrrev_b32 v4, 2, v3
    v_lshl_add_u32 v4, v2, 3, v4
    v_and_b32 v5, 3, v3
    v_and_b32 v6, 1, v2
    v_mul_u32_u24 v7, 576, v4
    v_lshl_add_u32 v7, v5, 3, v7
    v_add_u32 v7, 40960, v7
    v_lshlrev_b32 v8, 5, v6
    v_add_u32 v19, v7, v8
    v_sub_u32 v20, v7, v8
    v_and_b32 v7, 3, v4
    v_lshl_or_b32 v7, v6, 2, v7
    v_lshlrev_b32 v8, 2, v5
    v_add_u32 v8, 0, v8
    v_mul_u32_u24 v9, 57, v8
    v_lshrrev_b32 v9, 11, v9
    v_lshlrev_b32 v28, 2, v9
    v_add_u32 v8, v8, v28
    v_lshrrev_b32 v9, 4, v8
    v_xor_b32 v9, v9, v7
    v_and_b32 v8, 15, v8
    v_lshlrev_b32 v8, 1, v8
    v_lshl_add_u32 v8, v9, 5, v8
    v_lshl_add_u32 v21, v4, 8, v8
    v_lshlrev_b32 v8, 2, v5
    v_add_u32 v8, 16, v8
    v_mul_u32_u24 v9, 57, v8
    v_lshrrev_b32 v9, 11, v9
    v_lshlrev_b32 v28, 2, v9
    v_add_u32 v8, v8, v28
    v_lshrrev_b32 v9, 4, v8
    v_xor_b32 v9, v9, v7
    v_and_b32 v8, 15, v8
    v_lshlrev_b32 v8, 1, v8
    v_lshl_add_u32 v8, v9, 5, v8
    v_lshl_add_u32 v22, v4, 8, v8
    v_lshlrev_b32 v8, 2, v5
    v_add_u32 v8, 32, v8
    v_mul_u32_u24 v9, 57, v8
    v_lshrrev_b32 v9, 11, v9
    v_lshlrev_b32 v28, 2, v9
    v_add_u32 v8, v8, v28
    v_lshrrev_b32 v9, 4, v8
    v_xor_b32 v9, v9, v7
    v_and_b32 v8, 15, v8
    v_lshlrev_b32 v8, 1, v8
    v_lshl_add_u32 v8, v9, 5, v8
    v_lshl_add_u32 v23, v4, 8, v8
    v_lshlrev_b32 v8, 2, v5
    v_add_u32 v8, 48, v8
    v_mul_u32_u24 v9, 57, v8
    v_lshrrev_b32 v9, 11, v9
    v_lshlrev_b32 v28, 2, v9
    v_add_u32 v8, v8, v28
    v_lshrrev_b32 v9, 4, v8
    v_xor_b32 v9, v9, v7
    v_and_b32 v8, 15, v8
    v_lshlrev_b32 v8, 1, v8
    v_lshl_add_u32 v8, v9, 5, v8
    v_lshl_add_u32 v24, v4, 8, v8
    v_lshlrev_b32 v8, 2, v5
    v_add_u32 v8, 64, v8
    v_mul_u32_u24 v9, 57, v8
    v_lshrrev_b32 v9, 11, v9
    v_lshlrev_b32 v28, 2, v9
    v_add_u32 v8, v8, v28
    v_lshrrev_b32 v9, 4, v8
    v_xor_b32 v9, v9, v7
    v_and_b32 v8, 15, v8
    v_lshlrev_b32 v8, 1, v8
    v_lshl_add_u32 v8, v9, 5, v8
    v_lshl_add_u32 v25, v4, 8, v8
    v_lshlrev_b32 v8, 2, v5
    v_add_u32 v8, 80, v8
    v_mul_u32_u24 v9, 57, v8
    v_lshrrev_b32 v9, 11, v9
    v_lshlrev_b32 v28, 2, v9
    v_add_u32 v8, v8, v28
    v_lshrrev_b32 v9, 4, v8
    v_xor_b32 v9, v9, v7
    v_and_b32 v8, 15, v8
    v_lshlrev_b32 v8, 1, v8
    v_lshl_add_u32 v8, v9, 5, v8
    v_lshl_add_u32 v26, v4, 8, v8
    v_lshlrev_b32 v8, 2, v5
    v_add_u32 v8, 96, v8
    v_mul_u32_u24 v9, 57, v8
    v_lshrrev_b32 v9, 11, v9
    v_lshlrev_b32 v28, 2, v9
    v_add_u32 v8, v8, v28
    v_lshrrev_b32 v9, 4, v8
    v_xor_b32 v9, v9, v7
    v_and_b32 v8, 15, v8
    v_lshlrev_b32 v8, 1, v8
    v_lshl_add_u32 v8, v9, 5, v8
    v_lshl_add_u32 v27, v4, 8, v8
    v_and_b32 v4, 1, v2
    v_lshrrev_b32 v5, 1, v2
    v_lshl_or_b32 v4, v4, 1, v5
    v_lshl_add_u32 v4, v4, 4, v3
    v_lshlrev_b32 v39, 4, v4
    s_lshl_b32 s53, s44, 3
    s_lshl_b32 s54, s46, 1
    s_add_u32 s53, s53, s54
    s_mul_i32 s53, s53, 165888
    s_mul_i32 s54, s45, 9216
    s_add_u32 s53, s53, s54
    s_add_u32 s53, s53, 18432
    v_add_u32 v39, s53, v39
    v_lshlrev_b32 v4, 4, v0
    v_add_u32 v4, 114688, v4
    v_mov_b32 v28, 0
    v_mov_b32 v29, 0
    v_mov_b32 v30, 0
    v_mov_b32 v31, 0
    ds_write_b128 v4, v[28:31] offset:0
    ds_write_b128 v4, v[28:31] offset:4096
    ds_write_b128 v4, v[28:31] offset:8192
    ds_write_b128 v4, v[28:31] offset:12288
    s_mul_i32 s53, s45, 1296
    s_add_u32 s54, s8, s53
    s_addc_u32 s55, s9, 0
    s_mov_b32 s60, s54
    s_mov_b32 s61, s55
    s_mov_b32 s62, 1296
    s_mov_b32 s63, 0x00020000
    v_add_u32 v4, 0, v0
    v_mul_u32_u24 v5, 1619, v4
    v_lshrrev_b32 v5, 19, v5
    v_mul_u32_u24 v6, 324, v5
    v_sub_u32 v6, v4, v6
    v_mul_u32_u24 v7, 57, v6
    v_lshrrev_b32 v7, 10, v7
    v_mul_u32_u24 v8, 18, v7
    v_sub_u32 v8, v6, v8
    v_and_b32 v9, 1, v5
    v_mul_u32_u24 v9, 324, v9
    v_add_lshl_u32 v9, v9, v6, 1
    v_cmp_gt_u32 vcc, 1296, v4
    v_mov_b32 v28, 0x80000000
    s_nop 1
    v_cndmask_b32 v9, v28, v9, vcc
    buffer_load_ushort v216, v9, s[60:63], 0 offen
    v_mul_u32_u24 v5, 18, v5
    v_add_u32 v8, v8, v5
    v_add_u32 v7, v7, v5
    v_mul_u32_u24 v8, 192, v8
    v_lshl_add_u32 v8, v7, 1, v8
    v_add_u32 v8, 114688, v8
    v_mov_b32 v28, 131068
    s_nop 1
    v_cndmask_b32 v222, v28, v8, vcc
    v_add_u32 v4, 256, v0
    v_mul_u32_u24 v5, 1619, v4
    v_lshrrev_b32 v5, 19, v5
    v_mul_u32_u24 v6, 324, v5
    v_sub_u32 v6, v4, v6
    v_mul_u32_u24 v7, 57, v6
    v_lshrrev_b32 v7, 10, v7
    v_mul_u32_u24 v8, 18, v7
    v_sub_u32 v8, v6, v8
    v_and_b32 v9, 1, v5
    v_mul_u32_u24 v9, 324, v9
    v_add_lshl_u32 v9, v9, v6, 1
    v_cmp_gt_u32 vcc, 1296, v4
    v_mov_b32 v28, 0x80000000
    s_nop 1
    v_cndmask_b32 v9, v28, v9, vcc
    buffer_load_ushort v217, v9, s[60:63], 0 offen
    v_mul_u32_u24 v5, 18, v5
    v_add_u32 v8, v8, v5
    v_add_u32 v7, v7, v5
    v_mul_u32_u24 v8, 192, v8
    v_lshl_add_u32 v8, v7, 1, v8
    v_add_u32 v8, 114688, v8
    v_mov_b32 v28, 131068
    s_nop 1
    v_cndmask_b32 v223, v28, v8, vcc
    v_add_u32 v4, 512, v0
    v_mul_u32_u24 v5, 1619, v4
    v_lshrrev_b32 v5, 19, v5
    v_mul_u32_u24 v6, 324, v5
    v_sub_u32 v6, v4, v6
    v_mul_u32_u24 v7, 57, v6
    v_lshrrev_b32 v7, 10, v7
    v_mul_u32_u24 v8, 18, v7
    v_sub_u32 v8, v6, v8
    v_and_b32 v9, 1, v5
    v_mul_u32_u24 v9, 324, v9
    v_add_lshl_u32 v9, v9, v6, 1
    v_cmp_gt_u32 vcc, 1296, v4
    v_mov_b32 v28, 0x80000000
    s_nop 1
    v_cndmask_b32 v9, v28, v9, vcc
    buffer_load_ushort v218, v9, s[60:63], 0 offen
    v_mul_u32_u24 v5, 18, v5
    v_add_u32 v8, v8, v5
    v_add_u32 v7, v7, v5
    v_mul_u32_u24 v8, 192, v8
    v_lshl_add_u32 v8, v7, 1, v8
    v_add_u32 v8, 114688, v8
    v_mov_b32 v28, 131068
    s_nop 1
    v_cndmask_b32 v224, v28, v8, vcc
    v_add_u32 v4, 768, v0
    v_mul_u32_u24 v5, 1619, v4
    v_lshrrev_b32 v5, 19, v5
    v_mul_u32_u24 v6, 324, v5
    v_sub_u32 v6, v4, v6
    v_mul_u32_u24 v7, 57, v6
    v_lshrrev_b32 v7, 10, v7
    v_mul_u32_u24 v8, 18, v7
    v_sub_u32 v8, v6, v8
    v_and_b32 v9, 1, v5
    v_mul_u32_u24 v9, 324, v9
    v_add_lshl_u32 v9, v9, v6, 1
    v_cmp_gt_u32 vcc, 1296, v4
    v_mov_b32 v28, 0x80000000
    s_nop 1
    v_cndmask_b32 v9, v28, v9, vcc
    buffer_load_ushort v219, v9, s[60:63], 0 offen
    v_mul_u32_u24 v5, 18, v5
    v_add_u32 v8, v8, v5
    v_add_u32 v7, v7, v5
    v_mul_u32_u24 v8, 192, v8
    v_lshl_add_u32 v8, v7, 1, v8
    v_add_u32 v8, 114688, v8
    v_mov_b32 v28, 131068
    s_nop 1
    v_cndmask_b32 v225, v28, v8, vcc
    v_add_u32 v4, 1024, v0
    v_mul_u32_u24 v5, 1619, v4
    v_lshrrev_b32 v5, 19, v5
    v_mul_u32_u24 v6, 324, v5
    v_sub_u32 v6, v4, v6
    v_mul_u32_u24 v7, 57, v6
    v_lshrrev_b32 v7, 10, v7
    v_mul_u32_u24 v8, 18, v7
    v_sub_u32 v8, v6, v8
    v_and_b32 v9, 1, v5
    v_mul_u32_u24 v9, 324, v9
    v_add_lshl_u32 v9, v9, v6, 1
    v_cmp_gt_u32 vcc, 1296, v4
    v_mov_b32 v28, 0x80000000
    s_nop 1
    v_cndmask_b32 v9, v28, v9, vcc
    buffer_load_ushort v220, v9, s[60:63], 0 offen
    v_mul_u32_u24 v5, 18, v5
    v_add_u32 v8, v8, v5
    v_add_u32 v7, v7, v5
    v_mul_u32_u24 v8, 192, v8
    v_lshl_add_u32 v8, v7, 1, v8
    v_add_u32 v8, 114688, v8
    v_mov_b32 v28, 131068
    s_nop 1
    v_cndmask_b32 v226, v28, v8, vcc
    v_add_u32 v4, 1280, v0
    v_mul_u32_u24 v5, 1619, v4
    v_lshrrev_b32 v5, 19, v5
    v_mul_u32_u24 v6, 324, v5
    v_sub_u32 v6, v4, v6
    v_mul_u32_u24 v7, 57, v6
    v_lshrrev_b32 v7, 10, v7
    v_mul_u32_u24 v8, 18, v7
    v_sub_u32 v8, v6, v8
    v_and_b32 v9, 1, v5
    v_mul_u32_u24 v9, 324, v9
    v_add_lshl_u32 v9, v9, v6, 1
    v_cmp_gt_u32 vcc, 1296, v4
    v_mov_b32 v28, 0x80000000
    s_nop 1
    v_cndmask_b32 v9, v28, v9, vcc
    buffer_load_ushort v221, v9, s[60:63], 0 offen
    v_mul_u32_u24 v5, 18, v5
    v_add_u32 v8, v8, v5
    v_add_u32 v7, v7, v5
    v_mul_u32_u24 v8, 192, v8
    v_lshl_add_u32 v8, v7, 1, v8
    v_add_u32 v8, 114688, v8
    v_mov_b32 v28, 131068
    s_nop 1
    v_cndmask_b32 v227, v28, v8, vcc
    s_waitcnt lgkmcnt(0)
    s_barrier
    s_waitcnt vmcnt(20)
    v_mov_b32 v28, 0x3f803f80
    v_mov_b32 v29, 0
    v_mov_b32 v30, 0
    v_mov_b32 v31, 0
    v_mov_b32 v32, 0
    v_mov_b32 v33, 0
    v_mov_b32 v34, 0
    v_mov_b32 v35, 0
    v_mov_b32 v36, 0
    v_dot2_f32_bf16 v29, v72, v28, v29
    v_dot2_f32_bf16 v30, v72, v72, v30
    v_dot2_f32_bf16 v31, v73, v28, v31
    v_dot2_f32_bf16 v32, v73, v73, v32
    v_dot2_f32_bf16 v29, v74, v28, v29
    v_dot2_f32_bf16 v30, v74, v74, v30
    v_dot2_f32_bf16 v31, v75, v28, v31
    v_dot2_f32_bf16 v32, v75, v75, v32
    v_dot2_f32_bf16 v29, v76, v28, v29
    v_dot2_f32_bf16 v30, v76, v76, v30
    v_dot2_f32_bf16 v31, v77, v28, v31
    v_dot2_f32_bf16 v32, v77, v77, v32
    v_dot2_f32_bf16 v29, v78, v28, v29
    v_dot2_f32_bf16 v30, v78, v78, v30
    v_dot2_f32_bf16 v31, v79, v28, v31
    v_dot2_f32_bf16 v32, v79, v79, v32
    v_dot2_f32_bf16 v29, v80, v28, v29
    v_dot2_f32_bf16 v30, v80, v80, v30
    v_dot2_f32_bf16 v31, v81, v28, v31
    v_dot2_f32_bf16 v32, v81, v81, v32
    v_dot2_f32_bf16 v29, v82, v28, v29
    v_dot2_f32_bf16 v30, v82, v82, v30
    v_dot2_f32_bf16 v31, v83, v28, v31
    v_dot2_f32_bf16 v32, v83, v83, v32
    v_dot2_f32_bf16 v29, v84, v28, v29
    v_dot2_f32_bf16 v30, v84, v84, v30
    v_dot2_f32_bf16 v31, v85, v28, v31
    v_dot2_f32_bf16 v32, v85, v85, v32
    v_dot2_f32_bf16 v29, v86, v28, v29
    v_dot2_f32_bf16 v30, v86, v86, v30
    v_dot2_f32_bf16 v31, v87, v28, v31
    v_dot2_f32_bf16 v32, v87, v87, v32
    v_dot2_f32_bf16 v29, v88, v28, v29
    v_dot2_f32_bf16 v30, v88, v88, v30
    v_dot2_f32_bf16 v31, v89, v28, v31
    v_dot2_f32_bf16 v32, v89, v89, v32
    v_dot2_f32_bf16 v29, v90, v28, v29
    v_dot2_f32_bf16 v30, v90, v90, v30
    v_dot2_f32_bf16 v31, v91, v28, v31
    v_dot2_f32_bf16 v32, v91, v91, v32
    v_dot2_f32_bf16 v29, v92, v28, v29
    v_dot2_f32_bf16 v30, v92, v92, v30
    v_dot2_f32_bf16 v31, v93, v28, v31
    v_dot2_f32_bf16 v32, v93, v93, v32
    v_dot2_f32_bf16 v29, v94, v28, v29
    v_dot2_f32_bf16 v30, v94, v94, v30
    v_dot2_f32_bf16 v31, v95, v28, v31
    v_dot2_f32_bf16 v32, v95, v95, v32
    v_dot2_f32_bf16 v29, v96, v28, v29
    v_dot2_f32_bf16 v30, v96, v96, v30
    v_dot2_f32_bf16 v31, v97, v28, v31
    v_dot2_f32_bf16 v32, v97, v97, v32
    v_dot2_f32_bf16 v29, v98, v28, v29
    v_dot2_f32_bf16 v30, v98, v98, v30
    v_dot2_f32_bf16 v31, v99, v28, v31
    v_dot2_f32_bf16 v32, v99, v99, v32
    v_dot2_f32_bf16 v29, v100, v28, v29
    v_dot2_f32_bf16 v30, v100, v100, v30
    v_dot2_f32_bf16 v31, v101, v28, v31
    v_dot2_f32_bf16 v32, v101, v101, v32
    v_dot2_f32_bf16 v29, v102, v28, v29
    v_dot2_f32_bf16 v30, v102, v102, v30
    v_dot2_f32_bf16 v31, v103, v28, v31
    v_dot2_f32_bf16 v32, v103, v103, v32
    v_dot2_f32_bf16 v29, v104, v28, v29
    v_dot2_f32_bf16 v30, v104, v104, v30
    v_dot2_f32_bf16 v31, v105, v28, v31
    v_dot2_f32_bf16 v32, v105, v105, v32
    v_dot2_f32_bf16 v29, v106, v28, v29
    v_dot2_f32_bf16 v30, v106, v106, v30
    v_dot2_f32_bf16 v31, v107, v28, v31
    v_dot2_f32_bf16 v32, v107, v107, v32
    v_dot2_f32_bf16 v29, v108, v28, v29
    v_dot2_f32_bf16 v30, v108, v108, v30
    v_dot2_f32_bf16 v31, v109, v28, v31
    v_dot2_f32_bf16 v32, v109, v109, v32
    v_dot2_f32_bf16 v29, v110, v28, v29
    v_dot2_f32_bf16 v30, v110, v110, v30
    v_dot2_f32_bf16 v31, v111, v28, v31
    v_dot2_f32_bf16 v32, v111, v111, v32
    v_dot2_f32_bf16 v29, v112, v28, v29
    v_dot2_f32_bf16 v30, v112, v112, v30
    v_dot2_f32_bf16 v31, v113, v28, v31
    v_dot2_f32_bf16 v32, v113, v113, v32
    v_dot2_f32_bf16 v29, v114, v28, v29
    v_dot2_f32_bf16 v30, v114, v114, v30
    v_dot2_f32_bf16 v31, v115, v28, v31
    v_dot2_f32_bf16 v32, v115, v115, v32
    v_dot2_f32_bf16 v29, v116, v28, v29
    v_dot2_f32_bf16 v30, v116, v116, v30
    v_dot2_f32_bf16 v31, v117, v28, v31
    v_dot2_f32_bf16 v32, v117, v117, v32
    v_dot2_f32_bf16 v29, v118, v28, v29
    v_dot2_f32_bf16 v30, v118, v118, v30
    v_dot2_f32_bf16 v31, v119, v28, v31
    v_dot2_f32_bf16 v32, v119, v119, v32
    v_dot2_f32_bf16 v29, v120, v28, v29
    v_dot2_f32_bf16 v30, v120, v120, v30
    v_dot2_f32_bf16 v31, v121, v28, v31
    v_dot2_f32_bf16 v32, v121, v121, v32
    v_dot2_f32_bf16 v29, v122, v28, v29
    v_dot2_f32_bf16 v30, v122, v122, v30
    v_dot2_f32_bf16 v31, v123, v28, v31
    v_dot2_f32_bf16 v32, v123, v123, v32
    v_dot2_f32_bf16 v29, v124, v28, v29
    v_dot2_f32_bf16 v30, v124, v124, v30
    v_dot2_f32_bf16 v31, v125, v28, v31
    v_dot2_f32_bf16 v32, v125, v125, v32
    v_dot2_f32_bf16 v29, v126, v28, v29
    v_dot2_f32_bf16 v30, v126, v126, v30
    v_dot2_f32_bf16 v31, v127, v28, v31
    v_dot2_f32_bf16 v32, v127, v127, v32
    v_dot2_f32_bf16 v29, v128, v28, v29
    v_dot2_f32_bf16 v30, v128, v128, v30
    v_dot2_f32_bf16 v31, v129, v28, v31
    v_dot2_f32_bf16 v32, v129, v129, v32
    v_dot2_f32_bf16 v29, v130, v28, v29
    v_dot2_f32_bf16 v30, v130, v130, v30
    v_dot2_f32_bf16 v31, v131, v28, v31
    v_dot2_f32_bf16 v32, v131, v131, v32
    v_dot2_f32_bf16 v29, v132, v28, v29
    v_dot2_f32_bf16 v30, v132, v132, v30
    v_dot2_f32_bf16 v31, v133, v28, v31
    v_dot2_f32_bf16 v32, v133, v133, v32
    v_dot2_f32_bf16 v29, v134, v28, v29
    v_dot2_f32_bf16 v30, v134, v134, v30
    v_dot2_f32_bf16 v31, v135, v28, v31
    v_dot2_f32_bf16 v32, v135, v135, v32
    v_dot2_f32_bf16 v29, v136, v28, v29
    v_dot2_f32_bf16 v30, v136, v136, v30
    v_dot2_f32_bf16 v31, v137, v28, v31
    v_dot2_f32_bf16 v32, v137, v137, v32
    v_dot2_f32_bf16 v29, v138, v28, v29
    v_dot2_f32_bf16 v30, v138, v138, v30
    v_dot2_f32_bf16 v31, v139, v28, v31
    v_dot2_f32_bf16 v32, v139, v139, v32
    v_dot2_f32_bf16 v29, v140, v28, v29
    v_dot2_f32_bf16 v30, v140, v140, v30
    v_dot2_f32_bf16 v31, v141, v28, v31
    v_dot2_f32_bf16 v32, v141, v141, v32
    v_dot2_f32_bf16 v29, v142, v28, v29
    v_dot2_f32_bf16 v30, v142, v142, v30
    v_dot2_f32_bf16 v31, v143, v28, v31
    v_dot2_f32_bf16 v32, v143, v143, v32
    v_dot2_f32_bf16 v33, v144, v28, v33
    v_dot2_f32_bf16 v34, v144, v144, v34
    v_dot2_f32_bf16 v35, v145, v28, v35
    v_dot2_f32_bf16 v36, v145, v145, v36
    v_dot2_f32_bf16 v33, v146, v28, v33
    v_dot2_f32_bf16 v34, v146, v146, v34
    v_dot2_f32_bf16 v35, v147, v28, v35
    v_dot2_f32_bf16 v36, v147, v147, v36
    v_dot2_f32_bf16 v33, v148, v28, v33
    v_dot2_f32_bf16 v34, v148, v148, v34
    v_dot2_f32_bf16 v35, v149, v28, v35
    v_dot2_f32_bf16 v36, v149, v149, v36
    v_dot2_f32_bf16 v33, v150, v28, v33
    v_dot2_f32_bf16 v34, v150, v150, v34
    v_dot2_f32_bf16 v35, v151, v28, v35
    v_dot2_f32_bf16 v36, v151, v151, v36
    v_dot2_f32_bf16 v33, v152, v28, v33
    v_dot2_f32_bf16 v34, v152, v152, v34
    v_dot2_f32_bf16 v35, v153, v28, v35
    v_dot2_f32_bf16 v36, v153, v153, v36
    v_dot2_f32_bf16 v33, v154, v28, v33
    v_dot2_f32_bf16 v34, v154, v154, v34
    v_dot2_f32_bf16 v35, v155, v28, v35
    v_dot2_f32_bf16 v36, v155, v155, v36
    v_dot2_f32_bf16 v33, v156, v28, v33
    v_dot2_f32_bf16 v34, v156, v156, v34
    v_dot2_f32_bf16 v35, v157, v28, v35
    v_dot2_f32_bf16 v36, v157, v157, v36
    v_dot2_f32_bf16 v33, v158, v28, v33
    v_dot2_f32_bf16 v34, v158, v158, v34
    v_dot2_f32_bf16 v35, v159, v28, v35
    v_dot2_f32_bf16 v36, v159, v159, v36
    v_dot2_f32_bf16 v33, v160, v28, v33
    v_dot2_f32_bf16 v34, v160, v160, v34
    v_dot2_f32_bf16 v35, v161, v28, v35
    v_dot2_f32_bf16 v36, v161, v161, v36
    v_dot2_f32_bf16 v33, v162, v28, v33
    v_dot2_f32_bf16 v34, v162, v162, v34
    v_dot2_f32_bf16 v35, v163, v28, v35
    v_dot2_f32_bf16 v36, v163, v163, v36
    v_dot2_f32_bf16 v33, v164, v28, v33
    v_dot2_f32_bf16 v34, v164, v164, v34
    v_dot2_f32_bf16 v35, v165, v28, v35
    v_dot2_f32_bf16 v36, v165, v165, v36
    v_dot2_f32_bf16 v33, v166, v28, v33
    v_dot2_f32_bf16 v34, v166, v166, v34
    v_dot2_f32_bf16 v35, v167, v28, v35
    v_dot2_f32_bf16 v36, v167, v167, v36
    v_dot2_f32_bf16 v33, v168, v28, v33
    v_dot2_f32_bf16 v34, v168, v168, v34
    v_dot2_f32_bf16 v35, v169, v28, v35
    v_dot2_f32_bf16 v36, v169, v169, v36
    v_dot2_f32_bf16 v33, v170, v28, v33
    v_dot2_f32_bf16 v34, v170, v170, v34
    v_dot2_f32_bf16 v35, v171, v28, v35
    v_dot2_f32_bf16 v36, v171, v171, v36
    v_dot2_f32_bf16 v33, v172, v28, v33
    v_dot2_f32_bf16 v34, v172, v172, v34
    v_dot2_f32_bf16 v35, v173, v28, v35
    v_dot2_f32_bf16 v36, v173, v173, v36
    v_dot2_f32_bf16 v33, v174, v28, v33
    v_dot2_f32_bf16 v34, v174, v174, v34
    v_dot2_f32_bf16 v35, v175, v28, v35
    v_dot2_f32_bf16 v36, v175, v175, v36
    v_dot2_f32_bf16 v33, v176, v28, v33
    v_dot2_f32_bf16 v34, v176, v176, v34
    v_dot2_f32_bf16 v35, v177, v28, v35
    v_dot2_f32_bf16 v36, v177, v177, v36
    v_dot2_f32_bf16 v33, v178, v28, v33
    v_dot2_f32_bf16 v34, v178, v178, v34
    v_dot2_f32_bf16 v35, v179, v28, v35
    v_dot2_f32_bf16 v36, v179, v179, v36
    v_dot2_f32_bf16 v33, v180, v28, v33
    v_dot2_f32_bf16 v34, v180, v180, v34
    v_dot2_f32_bf16 v35, v181, v28, v35
    v_dot2_f32_bf16 v36, v181, v181, v36
    v_dot2_f32_bf16 v33, v182, v28, v33
    v_dot2_f32_bf16 v34, v182, v182, v34
    v_dot2_f32_bf16 v35, v183, v28, v35
    v_dot2_f32_bf16 v36, v183, v183, v36
    v_dot2_f32_bf16 v33, v184, v28, v33
    v_dot2_f32_bf16 v34, v184, v184, v34
    v_dot2_f32_bf16 v35, v185, v28, v35
    v_dot2_f32_bf16 v36, v185, v185, v36
    v_dot2_f32_bf16 v33, v186, v28, v33
    v_dot2_f32_bf16 v34, v186, v186, v34
    v_dot2_f32_bf16 v35, v187, v28, v35
    v_dot2_f32_bf16 v36, v187, v187, v36
    v_dot2_f32_bf16 v33, v188, v28, v33
    v_dot2_f32_bf16 v34, v188, v188, v34
    v_dot2_f32_bf16 v35, v189, v28, v35
    v_dot2_f32_bf16 v36, v189, v189, v36
    v_dot2_f32_bf16 v33, v190, v28, v33
    v_dot2_f32_bf16 v34, v190, v190, v34
    v_dot2_f32_bf16 v35, v191, v28, v35
    v_dot2_f32_bf16 v36, v191, v191, v36
    v_dot2_f32_bf16 v33, v192, v28, v33
    v_dot2_f32_bf16 v34, v192, v192, v34
    v_dot2_f32_bf16 v35, v193, v28, v35
    v_dot2_f32_bf16 v36, v193, v193, v36
    v_dot2_f32_bf16 v33, v194, v28, v33
    v_dot2_f32_bf16 v34, v194, v194, v34
    v_dot2_f32_bf16 v35, v195, v28, v35
    v_dot2_f32_bf16 v36, v195, v195, v36
    v_dot2_f32_bf16 v33, v196, v28, v33
    v_dot2_f32_bf16 v34, v196, v196, v34
    v_dot2_f32_bf16 v35, v197, v28, v35
    v_dot2_f32_bf16 v36, v197, v197, v36
    v_dot2_f32_bf16 v33, v198, v28, v33
    v_dot2_f32_bf16 v34, v198, v198, v34
    v_dot2_f32_bf16 v35, v199, v28, v35
    v_dot2_f32_bf16 v36, v199, v199, v36
    v_dot2_f32_bf16 v33, v200, v28, v33
    v_dot2_f32_bf16 v34, v200, v200, v34
    v_dot2_f32_bf16 v35, v201, v28, v35
    v_dot2_f32_bf16 v36, v201, v201, v36
    v_dot2_f32_bf16 v33, v202, v28, v33
    v_dot2_f32_bf16 v34, v202, v202, v34
    v_dot2_f32_bf16 v35, v203, v28, v35
    v_dot2_f32_bf16 v36, v203, v203, v36
    v_dot2_f32_bf16 v33, v204, v28, v33
    v_dot2_f32_bf16 v34, v204, v204, v34
    v_dot2_f32_bf16 v35, v205, v28, v35
    v_dot2_f32_bf16 v36, v205, v205, v36
    v_dot2_f32_bf16 v33, v206, v28, v33
    v_dot2_f32_bf16 v34, v206, v206, v34
    v_dot2_f32_bf16 v35, v207, v28, v35
    v_dot2_f32_bf16 v36, v207, v207, v36
    v_dot2_f32_bf16 v33, v208, v28, v33
    v_dot2_f32_bf16 v34, v208, v208, v34
    v_dot2_f32_bf16 v35, v209, v28, v35
    v_dot2_f32_bf16 v36, v209, v209, v36
    v_dot2_f32_bf16 v33, v210, v28, v33
    v_dot2_f32_bf16 v34, v210, v210, v34
    v_dot2_f32_bf16 v35, v211, v28, v35
    v_dot2_f32_bf16 v36, v211, v211, v36
    v_dot2_f32_bf16 v33, v212, v28, v33
    v_dot2_f32_bf16 v34, v212, v212, v34
    v_dot2_f32_bf16 v35, v213, v28, v35
    v_dot2_f32_bf16 v36, v213, v213, v36
    v_dot2_f32_bf16 v33, v214, v28, v33
    v_dot2_f32_bf16 v34, v214, v214, v34
    v_dot2_f32_bf16 v35, v215, v28, v35
    v_dot2_f32_bf16 v36, v215, v215, v36
    s_nop 3
    v_add_f32 v29, v29, v31
    v_add_f32 v30, v30, v32
    v_add_f32 v33, v33, v35
    v_add_f32 v34, v34, v36
    v_mov_b32 v31, v29
    s_nop 1
    v_permlane16_swap_b32 v29, v31
    s_nop 1
    v_add_f32 v29, v29, v31
    v_mov_b32 v31, v30
    s_nop 1
    v_permlane16_swap_b32 v30, v31
    s_nop 1
    v_add_f32 v30, v30, v31
    v_mov_b32 v31, v33
    s_nop 1
    v_permlane16_swap_b32 v33, v31
    s_nop 1
    v_add_f32 v33, v33, v31
    v_mov_b32 v31, v34
    s_nop 1
    v_permlane16_swap_b32 v34, v31
    s_nop 1
    v_add_f32 v34, v34, v31
    v_mov_b32 v31, v29
    s_nop 1
    v_permlane32_swap_b32 v29, v31
    s_nop 1
    v_add_f32 v29, v29, v31
    v_mov_b32 v31, v30
    s_nop 1
    v_permlane32_swap_b32 v30, v31
    s_nop 1
    v_add_f32 v30, v30, v31
    v_mov_b32 v31, v33
    s_nop 1
    v_permlane32_swap_b32 v33, v31
    s_nop 1
    v_add_f32 v33, v33, v31
    v_mov_b32 v31, v34
    s_nop 1
    v_permlane32_swap_b32 v34, v31
    s_nop 1
    v_add_f32 v34, v34, v31
    v_mul_f32 v29, 0x3ae38e39, v29
    v_mul_f32 v30, 0x3ae38e39, v30
    v_fma_f32 v30, -v29, v29, v30
    v_max_f32 v30, 0, v30
    v_cvt_pk_bf16_f32 v29, v29, v29
    v_lshlrev_b32 v29, 16, v29
    v_cvt_pk_bf16_f32 v30, v30, v30
    v_lshlrev_b32 v30, 16, v30
    v_add_f32 v30, 0x3727c5ac, v30
    v_cvt_pk_bf16_f32 v30, v30, v30
    v_lshlrev_b32 v30, 16, v30
    v_sqrt_f32 v30, v30
    s_nop 0
    v_cvt_pk_bf16_f32 v30, v30, v30
    v_lshlrev_b32 v30, 16, v30
    v_rcp_f32 v228, v30
    s_nop 0
    v_mul_f32 v230, v29, v228
    v_sub_f32 v230, 0, v230
    v_mul_f32 v33, 0x3ae38e39, v33
    v_mul_f32 v34, 0x3ae38e39, v34
    v_fma_f32 v34, -v33, v33, v34
    v_max_f32 v34, 0, v34
    v_cvt_pk_bf16_f32 v33, v33, v33
    v_lshlrev_b32 v33, 16, v33
    v_cvt_pk_bf16_f32 v34, v34, v34
    v_lshlrev_b32 v34, 16, v34
    v_add_f32 v34, 0x3727c5ac, v34
    v_cvt_pk_bf16_f32 v34, v34, v34
    v_lshlrev_b32 v34, 16, v34
    v_sqrt_f32 v34, v34
    s_nop 0
    v_cvt_pk_bf16_f32 v34, v34, v34
    v_lshlrev_b32 v34, 16, v34
    v_rcp_f32 v229, v34
    s_nop 0
    v_mul_f32 v231, v33, v229
    v_sub_f32 v231, 0, v231
    v_lshlrev_b32 v4, 16, v72
    v_and_b32 v5, 0xffff0000, v72
    v_fma_f32 v4, v4, v228, v230
    v_fma_f32 v5, v5, v228, v230
    v_cvt_pk_bf16_f32 v72, v4, v5
    v_lshlrev_b32 v6, 16, v73
    v_and_b32 v7, 0xffff0000, v73
    v_fma_f32 v6, v6, v228, v230
    v_fma_f32 v7, v7, v228, v230
    v_cvt_pk_bf16_f32 v73, v6, v7
    v_lshlrev_b32 v4, 16, v74
    v_and_b32 v5, 0xffff0000, v74
    v_fma_f32 v4, v4, v228, v230
    v_fma_f32 v5, v5, v228, v230
    v_cvt_pk_bf16_f32 v74, v4, v5
    v_lshlrev_b32 v6, 16, v75
    v_and_b32 v7, 0xffff0000, v75
    v_fma_f32 v6, v6, v228, v230
    v_fma_f32 v7, v7, v228, v230
    v_cvt_pk_bf16_f32 v75, v6, v7
    v_lshlrev_b32 v4, 16, v76
    v_and_b32 v5, 0xffff0000, v76
    v_fma_f32 v4, v4, v228, v230
    v_fma_f32 v5, v5, v228, v230
    v_cvt_pk_bf16_f32 v76, v4, v5
    v_lshlrev_b32 v6, 16, v77
    v_and_b32 v7, 0xffff0000, v77
    v_fma_f32 v6, v6, v228, v230
    v_fma_f32 v7, v7, v228, v230
    v_cvt_pk_bf16_f32 v77, v6, v7
    v_lshlrev_b32 v4, 16, v78
    v_and_b32 v5, 0xffff0000, v78
    v_fma_f32 v4, v4, v228, v230
    v_fma_f32 v5, v5, v228, v230
    v_cvt_pk_bf16_f32 v78, v4, v5
    v_lshlrev_b32 v6, 16, v79
    v_and_b32 v7, 0xffff0000, v79
    v_fma_f32 v6, v6, v228, v230
    v_fma_f32 v7, v7, v228, v230
    v_cvt_pk_bf16_f32 v79, v6, v7
    v_lshlrev_b32 v4, 16, v80
    v_and_b32 v5, 0xffff0000, v80
    v_fma_f32 v4, v4, v228, v230
    v_fma_f32 v5, v5, v228, v230
    v_cvt_pk_bf16_f32 v80, v4, v5
    v_lshlrev_b32 v6, 16, v81
    v_and_b32 v7, 0xffff0000, v81
    v_fma_f32 v6, v6, v228, v230
    v_fma_f32 v7, v7, v228, v230
    v_cvt_pk_bf16_f32 v81, v6, v7
    v_lshlrev_b32 v4, 16, v82
    v_and_b32 v5, 0xffff0000, v82
    v_fma_f32 v4, v4, v228, v230
    v_fma_f32 v5, v5, v228, v230
    v_cvt_pk_bf16_f32 v82, v4, v5
    v_lshlrev_b32 v6, 16, v83
    v_and_b32 v7, 0xffff0000, v83
    v_fma_f32 v6, v6, v228, v230
    v_fma_f32 v7, v7, v228, v230
    v_cvt_pk_bf16_f32 v83, v6, v7
    v_lshlrev_b32 v4, 16, v84
    v_and_b32 v5, 0xffff0000, v84
    v_fma_f32 v4, v4, v228, v230
    v_fma_f32 v5, v5, v228, v230
    v_cvt_pk_bf16_f32 v84, v4, v5
    v_lshlrev_b32 v6, 16, v85
    v_and_b32 v7, 0xffff0000, v85
    v_fma_f32 v6, v6, v228, v230
    v_fma_f32 v7, v7, v228, v230
    v_cvt_pk_bf16_f32 v85, v6, v7
    v_lshlrev_b32 v4, 16, v86
    v_and_b32 v5, 0xffff0000, v86
    v_fma_f32 v4, v4, v228, v230
    v_fma_f32 v5, v5, v228, v230
    v_cvt_pk_bf16_f32 v86, v4, v5
    v_lshlrev_b32 v6, 16, v87
    v_and_b32 v7, 0xffff0000, v87
    v_fma_f32 v6, v6, v228, v230
    v_fma_f32 v7, v7, v228, v230
    v_cvt_pk_bf16_f32 v87, v6, v7
    v_lshlrev_b32 v4, 16, v88
    v_and_b32 v5, 0xffff0000, v88
    v_fma_f32 v4, v4, v228, v230
    v_fma_f32 v5, v5, v228, v230
    v_cvt_pk_bf16_f32 v88, v4, v5
    v_lshlrev_b32 v6, 16, v89
    v_and_b32 v7, 0xffff0000, v89
    v_fma_f32 v6, v6, v228, v230
    v_fma_f32 v7, v7, v228, v230
    v_cvt_pk_bf16_f32 v89, v6, v7
    v_lshlrev_b32 v4, 16, v90
    v_and_b32 v5, 0xffff0000, v90
    v_fma_f32 v4, v4, v228, v230
    v_fma_f32 v5, v5, v228, v230
    v_cvt_pk_bf16_f32 v90, v4, v5
    v_lshlrev_b32 v6, 16, v91
    v_and_b32 v7, 0xffff0000, v91
    v_fma_f32 v6, v6, v228, v230
    v_fma_f32 v7, v7, v228, v230
    v_cvt_pk_bf16_f32 v91, v6, v7
    v_lshlrev_b32 v4, 16, v92
    v_and_b32 v5, 0xffff0000, v92
    v_fma_f32 v4, v4, v228, v230
    v_fma_f32 v5, v5, v228, v230
    v_cvt_pk_bf16_f32 v92, v4, v5
    v_lshlrev_b32 v6, 16, v93
    v_and_b32 v7, 0xffff0000, v93
    v_fma_f32 v6, v6, v228, v230
    v_fma_f32 v7, v7, v228, v230
    v_cvt_pk_bf16_f32 v93, v6, v7
    v_lshlrev_b32 v4, 16, v94
    v_and_b32 v5, 0xffff0000, v94
    v_fma_f32 v4, v4, v228, v230
    v_fma_f32 v5, v5, v228, v230
    v_cvt_pk_bf16_f32 v94, v4, v5
    v_lshlrev_b32 v6, 16, v95
    v_and_b32 v7, 0xffff0000, v95
    v_fma_f32 v6, v6, v228, v230
    v_fma_f32 v7, v7, v228, v230
    v_cvt_pk_bf16_f32 v95, v6, v7
    v_lshlrev_b32 v4, 16, v96
    v_and_b32 v5, 0xffff0000, v96
    v_fma_f32 v4, v4, v228, v230
    v_fma_f32 v5, v5, v228, v230
    v_cvt_pk_bf16_f32 v96, v4, v5
    v_lshlrev_b32 v6, 16, v97
    v_and_b32 v7, 0xffff0000, v97
    v_fma_f32 v6, v6, v228, v230
    v_fma_f32 v7, v7, v228, v230
    v_cvt_pk_bf16_f32 v97, v6, v7
    v_lshlrev_b32 v4, 16, v98
    v_and_b32 v5, 0xffff0000, v98
    v_fma_f32 v4, v4, v228, v230
    v_fma_f32 v5, v5, v228, v230
    v_cvt_pk_bf16_f32 v98, v4, v5
    v_lshlrev_b32 v6, 16, v99
    v_and_b32 v7, 0xffff0000, v99
    v_fma_f32 v6, v6, v228, v230
    v_fma_f32 v7, v7, v228, v230
    v_cvt_pk_bf16_f32 v99, v6, v7
    v_lshlrev_b32 v4, 16, v100
    v_and_b32 v5, 0xffff0000, v100
    v_fma_f32 v4, v4, v228, v230
    v_fma_f32 v5, v5, v228, v230
    v_cvt_pk_bf16_f32 v100, v4, v5
    v_lshlrev_b32 v6, 16, v101
    v_and_b32 v7, 0xffff0000, v101
    v_fma_f32 v6, v6, v228, v230
    v_fma_f32 v7, v7, v228, v230
    v_cvt_pk_bf16_f32 v101, v6, v7
    v_lshlrev_b32 v4, 16, v102
    v_and_b32 v5, 0xffff0000, v102
    v_fma_f32 v4, v4, v228, v230
    v_fma_f32 v5, v5, v228, v230
    v_cvt_pk_bf16_f32 v102, v4, v5
    v_lshlrev_b32 v6, 16, v103
    v_and_b32 v7, 0xffff0000, v103
    v_fma_f32 v6, v6, v228, v230
    v_fma_f32 v7, v7, v228, v230
    v_cvt_pk_bf16_f32 v103, v6, v7
    v_lshlrev_b32 v4, 16, v104
    v_and_b32 v5, 0xffff0000, v104
    v_fma_f32 v4, v4, v228, v230
    v_fma_f32 v5, v5, v228, v230
    v_cvt_pk_bf16_f32 v104, v4, v5
    v_lshlrev_b32 v6, 16, v105
    v_and_b32 v7, 0xffff0000, v105
    v_fma_f32 v6, v6, v228, v230
    v_fma_f32 v7, v7, v228, v230
    v_cvt_pk_bf16_f32 v105, v6, v7
    v_lshlrev_b32 v4, 16, v106
    v_and_b32 v5, 0xffff0000, v106
    v_fma_f32 v4, v4, v228, v230
    v_fma_f32 v5, v5, v228, v230
    v_cvt_pk_bf16_f32 v106, v4, v5
    v_lshlrev_b32 v6, 16, v107
    v_and_b32 v7, 0xffff0000, v107
    v_fma_f32 v6, v6, v228, v230
    v_fma_f32 v7, v7, v228, v230
    v_cvt_pk_bf16_f32 v107, v6, v7
    v_lshlrev_b32 v4, 16, v108
    v_and_b32 v5, 0xffff0000, v108
    v_fma_f32 v4, v4, v228, v230
    v_fma_f32 v5, v5, v228, v230
    v_cvt_pk_bf16_f32 v108, v4, v5
    v_lshlrev_b32 v6, 16, v109
    v_and_b32 v7, 0xffff0000, v109
    v_fma_f32 v6, v6, v228, v230
    v_fma_f32 v7, v7, v228, v230
    v_cvt_pk_bf16_f32 v109, v6, v7
    v_lshlrev_b32 v4, 16, v110
    v_and_b32 v5, 0xffff0000, v110
    v_fma_f32 v4, v4, v228, v230
    v_fma_f32 v5, v5, v228, v230
    v_cvt_pk_bf16_f32 v110, v4, v5
    v_lshlrev_b32 v6, 16, v111
    v_and_b32 v7, 0xffff0000, v111
    v_fma_f32 v6, v6, v228, v230
    v_fma_f32 v7, v7, v228, v230
    v_cvt_pk_bf16_f32 v111, v6, v7
    v_lshlrev_b32 v4, 16, v112
    v_and_b32 v5, 0xffff0000, v112
    v_fma_f32 v4, v4, v228, v230
    v_fma_f32 v5, v5, v228, v230
    v_cvt_pk_bf16_f32 v112, v4, v5
    v_lshlrev_b32 v6, 16, v113
    v_and_b32 v7, 0xffff0000, v113
    v_fma_f32 v6, v6, v228, v230
    v_fma_f32 v7, v7, v228, v230
    v_cvt_pk_bf16_f32 v113, v6, v7
    v_lshlrev_b32 v4, 16, v114
    v_and_b32 v5, 0xffff0000, v114
    v_fma_f32 v4, v4, v228, v230
    v_fma_f32 v5, v5, v228, v230
    v_cvt_pk_bf16_f32 v114, v4, v5
    v_lshlrev_b32 v6, 16, v115
    v_and_b32 v7, 0xffff0000, v115
    v_fma_f32 v6, v6, v228, v230
    v_fma_f32 v7, v7, v228, v230
    v_cvt_pk_bf16_f32 v115, v6, v7
    v_lshlrev_b32 v4, 16, v116
    v_and_b32 v5, 0xffff0000, v116
    v_fma_f32 v4, v4, v228, v230
    v_fma_f32 v5, v5, v228, v230
    v_cvt_pk_bf16_f32 v116, v4, v5
    v_lshlrev_b32 v6, 16, v117
    v_and_b32 v7, 0xffff0000, v117
    v_fma_f32 v6, v6, v228, v230
    v_fma_f32 v7, v7, v228, v230
    v_cvt_pk_bf16_f32 v117, v6, v7
    v_lshlrev_b32 v4, 16, v118
    v_and_b32 v5, 0xffff0000, v118
    v_fma_f32 v4, v4, v228, v230
    v_fma_f32 v5, v5, v228, v230
    v_cvt_pk_bf16_f32 v118, v4, v5
    v_lshlrev_b32 v6, 16, v119
    v_and_b32 v7, 0xffff0000, v119
    v_fma_f32 v6, v6, v228, v230
    v_fma_f32 v7, v7, v228, v230
    v_cvt_pk_bf16_f32 v119, v6, v7
    v_lshlrev_b32 v4, 16, v120
    v_and_b32 v5, 0xffff0000, v120
    v_fma_f32 v4, v4, v228, v230
    v_fma_f32 v5, v5, v228, v230
    v_cvt_pk_bf16_f32 v120, v4, v5
    v_lshlrev_b32 v6, 16, v121
    v_and_b32 v7, 0xffff0000, v121
    v_fma_f32 v6, v6, v228, v230
    v_fma_f32 v7, v7, v228, v230
    v_cvt_pk_bf16_f32 v121, v6, v7
    v_lshlrev_b32 v4, 16, v122
    v_and_b32 v5, 0xffff0000, v122
    v_fma_f32 v4, v4, v228, v230
    v_fma_f32 v5, v5, v228, v230
    v_cvt_pk_bf16_f32 v122, v4, v5
    v_lshlrev_b32 v6, 16, v123
    v_and_b32 v7, 0xffff0000, v123
    v_fma_f32 v6, v6, v228, v230
    v_fma_f32 v7, v7, v228, v230
    v_cvt_pk_bf16_f32 v123, v6, v7
    v_lshlrev_b32 v4, 16, v124
    v_and_b32 v5, 0xffff0000, v124
    v_fma_f32 v4, v4, v228, v230
    v_fma_f32 v5, v5, v228, v230
    v_cvt_pk_bf16_f32 v124, v4, v5
    v_lshlrev_b32 v6, 16, v125
    v_and_b32 v7, 0xffff0000, v125
    v_fma_f32 v6, v6, v228, v230
    v_fma_f32 v7, v7, v228, v230
    v_cvt_pk_bf16_f32 v125, v6, v7
    v_lshlrev_b32 v4, 16, v126
    v_and_b32 v5, 0xffff0000, v126
    v_fma_f32 v4, v4, v228, v230
    v_fma_f32 v5, v5, v228, v230
    v_cvt_pk_bf16_f32 v126, v4, v5
    v_lshlrev_b32 v6, 16, v127
    v_and_b32 v7, 0xffff0000, v127
    v_fma_f32 v6, v6, v228, v230
    v_fma_f32 v7, v7, v228, v230
    v_cvt_pk_bf16_f32 v127, v6, v7
    v_lshlrev_b32 v4, 16, v128
    v_and_b32 v5, 0xffff0000, v128
    v_fma_f32 v4, v4, v228, v230
    v_fma_f32 v5, v5, v228, v230
    v_cvt_pk_bf16_f32 v128, v4, v5
    v_lshlrev_b32 v6, 16, v129
    v_and_b32 v7, 0xffff0000, v129
    v_fma_f32 v6, v6, v228, v230
    v_fma_f32 v7, v7, v228, v230
    v_cvt_pk_bf16_f32 v129, v6, v7
    v_lshlrev_b32 v4, 16, v130
    v_and_b32 v5, 0xffff0000, v130
    v_fma_f32 v4, v4, v228, v230
    v_fma_f32 v5, v5, v228, v230
    v_cvt_pk_bf16_f32 v130, v4, v5
    v_lshlrev_b32 v6, 16, v131
    v_and_b32 v7, 0xffff0000, v131
    v_fma_f32 v6, v6, v228, v230
    v_fma_f32 v7, v7, v228, v230
    v_cvt_pk_bf16_f32 v131, v6, v7
    v_lshlrev_b32 v4, 16, v132
    v_and_b32 v5, 0xffff0000, v132
    v_fma_f32 v4, v4, v228, v230
    v_fma_f32 v5, v5, v228, v230
    v_cvt_pk_bf16_f32 v132, v4, v5
    v_lshlrev_b32 v6, 16, v133
    v_and_b32 v7, 0xffff0000, v133
    v_fma_f32 v6, v6, v228, v230
    v_fma_f32 v7, v7, v228, v230
    v_cvt_pk_bf16_f32 v133, v6, v7
    v_lshlrev_b32 v4, 16, v134
    v_and_b32 v5, 0xffff0000, v134
    v_fma_f32 v4, v4, v228, v230
    v_fma_f32 v5, v5, v228, v230
    v_cvt_pk_bf16_f32 v134, v4, v5
    v_lshlrev_b32 v6, 16, v135
    v_and_b32 v7, 0xffff0000, v135
    v_fma_f32 v6, v6, v228, v230
    v_fma_f32 v7, v7, v228, v230
    v_cvt_pk_bf16_f32 v135, v6, v7
    v_lshlrev_b32 v4, 16, v136
    v_and_b32 v5, 0xffff0000, v136
    v_fma_f32 v4, v4, v228, v230
    v_fma_f32 v5, v5, v228, v230
    v_cvt_pk_bf16_f32 v136, v4, v5
    v_lshlrev_b32 v6, 16, v137
    v_and_b32 v7, 0xffff0000, v137
    v_fma_f32 v6, v6, v228, v230
    v_fma_f32 v7, v7, v228, v230
    v_cvt_pk_bf16_f32 v137, v6, v7
    v_lshlrev_b32 v4, 16, v138
    v_and_b32 v5, 0xffff0000, v138
    v_fma_f32 v4, v4, v228, v230
    v_fma_f32 v5, v5, v228, v230
    v_cvt_pk_bf16_f32 v138, v4, v5
    v_lshlrev_b32 v6, 16, v139
    v_and_b32 v7, 0xffff0000, v139
    v_fma_f32 v6, v6, v228, v230
    v_fma_f32 v7, v7, v228, v230
    v_cvt_pk_bf16_f32 v139, v6, v7
    v_lshlrev_b32 v4, 16, v140
    v_and_b32 v5, 0xffff0000, v140
    v_fma_f32 v4, v4, v228, v230
    v_fma_f32 v5, v5, v228, v230
    v_cvt_pk_bf16_f32 v140, v4, v5
    v_lshlrev_b32 v6, 16, v141
    v_and_b32 v7, 0xffff0000, v141
    v_fma_f32 v6, v6, v228, v230
    v_fma_f32 v7, v7, v228, v230
    v_cvt_pk_bf16_f32 v141, v6, v7
    v_lshlrev_b32 v4, 16, v142
    v_and_b32 v5, 0xffff0000, v142
    v_fma_f32 v4, v4, v228, v230
    v_fma_f32 v5, v5, v228, v230
    v_cvt_pk_bf16_f32 v142, v4, v5
    v_lshlrev_b32 v6, 16, v143
    v_and_b32 v7, 0xffff0000, v143
    v_fma_f32 v6, v6, v228, v230
    v_fma_f32 v7, v7, v228, v230
    v_cvt_pk_bf16_f32 v143, v6, v7
    v_lshlrev_b32 v4, 16, v144
    v_and_b32 v5, 0xffff0000, v144
    v_fma_f32 v4, v4, v229, v231
    v_fma_f32 v5, v5, v229, v231
    v_cvt_pk_bf16_f32 v144, v4, v5
    v_lshlrev_b32 v6, 16, v145
    v_and_b32 v7, 0xffff0000, v145
    v_fma_f32 v6, v6, v229, v231
    v_fma_f32 v7, v7, v229, v231
    v_cvt_pk_bf16_f32 v145, v6, v7
    v_lshlrev_b32 v4, 16, v146
    v_and_b32 v5, 0xffff0000, v146
    v_fma_f32 v4, v4, v229, v231
    v_fma_f32 v5, v5, v229, v231
    v_cvt_pk_bf16_f32 v146, v4, v5
    v_lshlrev_b32 v6, 16, v147
    v_and_b32 v7, 0xffff0000, v147
    v_fma_f32 v6, v6, v229, v231
    v_fma_f32 v7, v7, v229, v231
    v_cvt_pk_bf16_f32 v147, v6, v7
    v_lshlrev_b32 v4, 16, v148
    v_and_b32 v5, 0xffff0000, v148
    v_fma_f32 v4, v4, v229, v231
    v_fma_f32 v5, v5, v229, v231
    v_cvt_pk_bf16_f32 v148, v4, v5
    v_lshlrev_b32 v6, 16, v149
    v_and_b32 v7, 0xffff0000, v149
    v_fma_f32 v6, v6, v229, v231
    v_fma_f32 v7, v7, v229, v231
    v_cvt_pk_bf16_f32 v149, v6, v7
    v_lshlrev_b32 v4, 16, v150
    v_and_b32 v5, 0xffff0000, v150
    v_fma_f32 v4, v4, v229, v231
    v_fma_f32 v5, v5, v229, v231
    v_cvt_pk_bf16_f32 v150, v4, v5
    v_lshlrev_b32 v6, 16, v151
    v_and_b32 v7, 0xffff0000, v151
    v_fma_f32 v6, v6, v229, v231
    v_fma_f32 v7, v7, v229, v231
    v_cvt_pk_bf16_f32 v151, v6, v7
    v_lshlrev_b32 v4, 16, v152
    v_and_b32 v5, 0xffff0000, v152
    v_fma_f32 v4, v4, v229, v231
    v_fma_f32 v5, v5, v229, v231
    v_cvt_pk_bf16_f32 v152, v4, v5
    v_lshlrev_b32 v6, 16, v153
    v_and_b32 v7, 0xffff0000, v153
    v_fma_f32 v6, v6, v229, v231
    v_fma_f32 v7, v7, v229, v231
    v_cvt_pk_bf16_f32 v153, v6, v7
    v_lshlrev_b32 v4, 16, v154
    v_and_b32 v5, 0xffff0000, v154
    v_fma_f32 v4, v4, v229, v231
    v_fma_f32 v5, v5, v229, v231
    v_cvt_pk_bf16_f32 v154, v4, v5
    v_lshlrev_b32 v6, 16, v155
    v_and_b32 v7, 0xffff0000, v155
    v_fma_f32 v6, v6, v229, v231
    v_fma_f32 v7, v7, v229, v231
    v_cvt_pk_bf16_f32 v155, v6, v7
    v_lshlrev_b32 v4, 16, v156
    v_and_b32 v5, 0xffff0000, v156
    v_fma_f32 v4, v4, v229, v231
    v_fma_f32 v5, v5, v229, v231
    v_cvt_pk_bf16_f32 v156, v4, v5
    v_lshlrev_b32 v6, 16, v157
    v_and_b32 v7, 0xffff0000, v157
    v_fma_f32 v6, v6, v229, v231
    v_fma_f32 v7, v7, v229, v231
    v_cvt_pk_bf16_f32 v157, v6, v7
    v_lshlrev_b32 v4, 16, v158
    v_and_b32 v5, 0xffff0000, v158
    v_fma_f32 v4, v4, v229, v231
    v_fma_f32 v5, v5, v229, v231
    v_cvt_pk_bf16_f32 v158, v4, v5
    v_lshlrev_b32 v6, 16, v159
    v_and_b32 v7, 0xffff0000, v159
    v_fma_f32 v6, v6, v229, v231
    v_fma_f32 v7, v7, v229, v231
    v_cvt_pk_bf16_f32 v159, v6, v7
    v_lshlrev_b32 v4, 16, v160
    v_and_b32 v5, 0xffff0000, v160
    v_fma_f32 v4, v4, v229, v231
    v_fma_f32 v5, v5, v229, v231
    v_cvt_pk_bf16_f32 v160, v4, v5
    v_lshlrev_b32 v6, 16, v161
    v_and_b32 v7, 0xffff0000, v161
    v_fma_f32 v6, v6, v229, v231
    v_fma_f32 v7, v7, v229, v231
    v_cvt_pk_bf16_f32 v161, v6, v7
    v_lshlrev_b32 v4, 16, v162
    v_and_b32 v5, 0xffff0000, v162
    v_fma_f32 v4, v4, v229, v231
    v_fma_f32 v5, v5, v229, v231
    v_cvt_pk_bf16_f32 v162, v4, v5
    v_lshlrev_b32 v6, 16, v163
    v_and_b32 v7, 0xffff0000, v163
    v_fma_f32 v6, v6, v229, v231
    v_fma_f32 v7, v7, v229, v231
    v_cvt_pk_bf16_f32 v163, v6, v7
    v_lshlrev_b32 v4, 16, v164
    v_and_b32 v5, 0xffff0000, v164
    v_fma_f32 v4, v4, v229, v231
    v_fma_f32 v5, v5, v229, v231
    v_cvt_pk_bf16_f32 v164, v4, v5
    v_lshlrev_b32 v6, 16, v165
    v_and_b32 v7, 0xffff0000, v165
    v_fma_f32 v6, v6, v229, v231
    v_fma_f32 v7, v7, v229, v231
    v_cvt_pk_bf16_f32 v165, v6, v7
    v_lshlrev_b32 v4, 16, v166
    v_and_b32 v5, 0xffff0000, v166
    v_fma_f32 v4, v4, v229, v231
    v_fma_f32 v5, v5, v229, v231
    v_cvt_pk_bf16_f32 v166, v4, v5
    v_lshlrev_b32 v6, 16, v167
    v_and_b32 v7, 0xffff0000, v167
    v_fma_f32 v6, v6, v229, v231
    v_fma_f32 v7, v7, v229, v231
    v_cvt_pk_bf16_f32 v167, v6, v7
    v_lshlrev_b32 v4, 16, v168
    v_and_b32 v5, 0xffff0000, v168
    v_fma_f32 v4, v4, v229, v231
    v_fma_f32 v5, v5, v229, v231
    v_cvt_pk_bf16_f32 v168, v4, v5
    v_lshlrev_b32 v6, 16, v169
    v_and_b32 v7, 0xffff0000, v169
    v_fma_f32 v6, v6, v229, v231
    v_fma_f32 v7, v7, v229, v231
    v_cvt_pk_bf16_f32 v169, v6, v7
    v_lshlrev_b32 v4, 16, v170
    v_and_b32 v5, 0xffff0000, v170
    v_fma_f32 v4, v4, v229, v231
    v_fma_f32 v5, v5, v229, v231
    v_cvt_pk_bf16_f32 v170, v4, v5
    v_lshlrev_b32 v6, 16, v171
    v_and_b32 v7, 0xffff0000, v171
    v_fma_f32 v6, v6, v229, v231
    v_fma_f32 v7, v7, v229, v231
    v_cvt_pk_bf16_f32 v171, v6, v7
    v_lshlrev_b32 v4, 16, v172
    v_and_b32 v5, 0xffff0000, v172
    v_fma_f32 v4, v4, v229, v231
    v_fma_f32 v5, v5, v229, v231
    v_cvt_pk_bf16_f32 v172, v4, v5
    v_lshlrev_b32 v6, 16, v173
    v_and_b32 v7, 0xffff0000, v173
    v_fma_f32 v6, v6, v229, v231
    v_fma_f32 v7, v7, v229, v231
    v_cvt_pk_bf16_f32 v173, v6, v7
    v_lshlrev_b32 v4, 16, v174
    v_and_b32 v5, 0xffff0000, v174
    v_fma_f32 v4, v4, v229, v231
    v_fma_f32 v5, v5, v229, v231
    v_cvt_pk_bf16_f32 v174, v4, v5
    v_lshlrev_b32 v6, 16, v175
    v_and_b32 v7, 0xffff0000, v175
    v_fma_f32 v6, v6, v229, v231
    v_fma_f32 v7, v7, v229, v231
    v_cvt_pk_bf16_f32 v175, v6, v7
    v_lshlrev_b32 v4, 16, v176
    v_and_b32 v5, 0xffff0000, v176
    v_fma_f32 v4, v4, v229, v231
    v_fma_f32 v5, v5, v229, v231
    v_cvt_pk_bf16_f32 v176, v4, v5
    v_lshlrev_b32 v6, 16, v177
    v_and_b32 v7, 0xffff0000, v177
    v_fma_f32 v6, v6, v229, v231
    v_fma_f32 v7, v7, v229, v231
    v_cvt_pk_bf16_f32 v177, v6, v7
    v_lshlrev_b32 v4, 16, v178
    v_and_b32 v5, 0xffff0000, v178
    v_fma_f32 v4, v4, v229, v231
    v_fma_f32 v5, v5, v229, v231
    v_cvt_pk_bf16_f32 v178, v4, v5
    v_lshlrev_b32 v6, 16, v179
    v_and_b32 v7, 0xffff0000, v179
    v_fma_f32 v6, v6, v229, v231
    v_fma_f32 v7, v7, v229, v231
    v_cvt_pk_bf16_f32 v179, v6, v7
    v_lshlrev_b32 v4, 16, v180
    v_and_b32 v5, 0xffff0000, v180
    v_fma_f32 v4, v4, v229, v231
    v_fma_f32 v5, v5, v229, v231
    v_cvt_pk_bf16_f32 v180, v4, v5
    v_lshlrev_b32 v6, 16, v181
    v_and_b32 v7, 0xffff0000, v181
    v_fma_f32 v6, v6, v229, v231
    v_fma_f32 v7, v7, v229, v231
    v_cvt_pk_bf16_f32 v181, v6, v7
    v_lshlrev_b32 v4, 16, v182
    v_and_b32 v5, 0xffff0000, v182
    v_fma_f32 v4, v4, v229, v231
    v_fma_f32 v5, v5, v229, v231
    v_cvt_pk_bf16_f32 v182, v4, v5
    v_lshlrev_b32 v6, 16, v183
    v_and_b32 v7, 0xffff0000, v183
    v_fma_f32 v6, v6, v229, v231
    v_fma_f32 v7, v7, v229, v231
    v_cvt_pk_bf16_f32 v183, v6, v7
    v_lshlrev_b32 v4, 16, v184
    v_and_b32 v5, 0xffff0000, v184
    v_fma_f32 v4, v4, v229, v231
    v_fma_f32 v5, v5, v229, v231
    v_cvt_pk_bf16_f32 v184, v4, v5
    v_lshlrev_b32 v6, 16, v185
    v_and_b32 v7, 0xffff0000, v185
    v_fma_f32 v6, v6, v229, v231
    v_fma_f32 v7, v7, v229, v231
    v_cvt_pk_bf16_f32 v185, v6, v7
    v_lshlrev_b32 v4, 16, v186
    v_and_b32 v5, 0xffff0000, v186
    v_fma_f32 v4, v4, v229, v231
    v_fma_f32 v5, v5, v229, v231
    v_cvt_pk_bf16_f32 v186, v4, v5
    v_lshlrev_b32 v6, 16, v187
    v_and_b32 v7, 0xffff0000, v187
    v_fma_f32 v6, v6, v229, v231
    v_fma_f32 v7, v7, v229, v231
    v_cvt_pk_bf16_f32 v187, v6, v7
    v_lshlrev_b32 v4, 16, v188
    v_and_b32 v5, 0xffff0000, v188
    v_fma_f32 v4, v4, v229, v231
    v_fma_f32 v5, v5, v229, v231
    v_cvt_pk_bf16_f32 v188, v4, v5
    v_lshlrev_b32 v6, 16, v189
    v_and_b32 v7, 0xffff0000, v189
    v_fma_f32 v6, v6, v229, v231
    v_fma_f32 v7, v7, v229, v231
    v_cvt_pk_bf16_f32 v189, v6, v7
    v_lshlrev_b32 v4, 16, v190
    v_and_b32 v5, 0xffff0000, v190
    v_fma_f32 v4, v4, v229, v231
    v_fma_f32 v5, v5, v229, v231
    v_cvt_pk_bf16_f32 v190, v4, v5
    v_lshlrev_b32 v6, 16, v191
    v_and_b32 v7, 0xffff0000, v191
    v_fma_f32 v6, v6, v229, v231
    v_fma_f32 v7, v7, v229, v231
    v_cvt_pk_bf16_f32 v191, v6, v7
    v_lshlrev_b32 v4, 16, v192
    v_and_b32 v5, 0xffff0000, v192
    v_fma_f32 v4, v4, v229, v231
    v_fma_f32 v5, v5, v229, v231
    v_cvt_pk_bf16_f32 v192, v4, v5
    v_lshlrev_b32 v6, 16, v193
    v_and_b32 v7, 0xffff0000, v193
    v_fma_f32 v6, v6, v229, v231
    v_fma_f32 v7, v7, v229, v231
    v_cvt_pk_bf16_f32 v193, v6, v7
    v_lshlrev_b32 v4, 16, v194
    v_and_b32 v5, 0xffff0000, v194
    v_fma_f32 v4, v4, v229, v231
    v_fma_f32 v5, v5, v229, v231
    v_cvt_pk_bf16_f32 v194, v4, v5
    v_lshlrev_b32 v6, 16, v195
    v_and_b32 v7, 0xffff0000, v195
    v_fma_f32 v6, v6, v229, v231
    v_fma_f32 v7, v7, v229, v231
    v_cvt_pk_bf16_f32 v195, v6, v7
    v_lshlrev_b32 v4, 16, v196
    v_and_b32 v5, 0xffff0000, v196
    v_fma_f32 v4, v4, v229, v231
    v_fma_f32 v5, v5, v229, v231
    v_cvt_pk_bf16_f32 v196, v4, v5
    v_lshlrev_b32 v6, 16, v197
    v_and_b32 v7, 0xffff0000, v197
    v_fma_f32 v6, v6, v229, v231
    v_fma_f32 v7, v7, v229, v231
    v_cvt_pk_bf16_f32 v197, v6, v7
    v_lshlrev_b32 v4, 16, v198
    v_and_b32 v5, 0xffff0000, v198
    v_fma_f32 v4, v4, v229, v231
    v_fma_f32 v5, v5, v229, v231
    v_cvt_pk_bf16_f32 v198, v4, v5
    v_lshlrev_b32 v6, 16, v199
    v_and_b32 v7, 0xffff0000, v199
    v_fma_f32 v6, v6, v229, v231
    v_fma_f32 v7, v7, v229, v231
    v_cvt_pk_bf16_f32 v199, v6, v7
    v_lshlrev_b32 v4, 16, v200
    v_and_b32 v5, 0xffff0000, v200
    v_fma_f32 v4, v4, v229, v231
    v_fma_f32 v5, v5, v229, v231
    v_cvt_pk_bf16_f32 v200, v4, v5
    v_lshlrev_b32 v6, 16, v201
    v_and_b32 v7, 0xffff0000, v201
    v_fma_f32 v6, v6, v229, v231
    v_fma_f32 v7, v7, v229, v231
    v_cvt_pk_bf16_f32 v201, v6, v7
    v_lshlrev_b32 v4, 16, v202
    v_and_b32 v5, 0xffff0000, v202
    v_fma_f32 v4, v4, v229, v231
    v_fma_f32 v5, v5, v229, v231
    v_cvt_pk_bf16_f32 v202, v4, v5
    v_lshlrev_b32 v6, 16, v203
    v_and_b32 v7, 0xffff0000, v203
    v_fma_f32 v6, v6, v229, v231
    v_fma_f32 v7, v7, v229, v231
    v_cvt_pk_bf16_f32 v203, v6, v7
    v_lshlrev_b32 v4, 16, v204
    v_and_b32 v5, 0xffff0000, v204
    v_fma_f32 v4, v4, v229, v231
    v_fma_f32 v5, v5, v229, v231
    v_cvt_pk_bf16_f32 v204, v4, v5
    v_lshlrev_b32 v6, 16, v205
    v_and_b32 v7, 0xffff0000, v205
    v_fma_f32 v6, v6, v229, v231
    v_fma_f32 v7, v7, v229, v231
    v_cvt_pk_bf16_f32 v205, v6, v7
    v_lshlrev_b32 v4, 16, v206
    v_and_b32 v5, 0xffff0000, v206
    v_fma_f32 v4, v4, v229, v231
    v_fma_f32 v5, v5, v229, v231
    v_cvt_pk_bf16_f32 v206, v4, v5
    v_lshlrev_b32 v6, 16, v207
    v_and_b32 v7, 0xffff0000, v207
    v_fma_f32 v6, v6, v229, v231
    v_fma_f32 v7, v7, v229, v231
    v_cvt_pk_bf16_f32 v207, v6, v7
    v_lshlrev_b32 v4, 16, v208
    v_and_b32 v5, 0xffff0000, v208
    v_fma_f32 v4, v4, v229, v231
    v_fma_f32 v5, v5, v229, v231
    v_cvt_pk_bf16_f32 v208, v4, v5
    v_lshlrev_b32 v6, 16, v209
    v_and_b32 v7, 0xffff0000, v209
    v_fma_f32 v6, v6, v229, v231
    v_fma_f32 v7, v7, v229, v231
    v_cvt_pk_bf16_f32 v209, v6, v7
    v_lshlrev_b32 v4, 16, v210
    v_and_b32 v5, 0xffff0000, v210
    v_fma_f32 v4, v4, v229, v231
    v_fma_f32 v5, v5, v229, v231
    v_cvt_pk_bf16_f32 v210, v4, v5
    v_lshlrev_b32 v6, 16, v211
    v_and_b32 v7, 0xffff0000, v211
    v_fma_f32 v6, v6, v229, v231
    v_fma_f32 v7, v7, v229, v231
    v_cvt_pk_bf16_f32 v211, v6, v7
    v_lshlrev_b32 v4, 16, v212
    v_and_b32 v5, 0xffff0000, v212
    v_fma_f32 v4, v4, v229, v231
    v_fma_f32 v5, v5, v229, v231
    v_cvt_pk_bf16_f32 v212, v4, v5
    v_lshlrev_b32 v6, 16, v213
    v_and_b32 v7, 0xffff0000, v213
    v_fma_f32 v6, v6, v229, v231
    v_fma_f32 v7, v7, v229, v231
    v_cvt_pk_bf16_f32 v213, v6, v7
    v_lshlrev_b32 v4, 16, v214
    v_and_b32 v5, 0xffff0000, v214
    v_fma_f32 v4, v4, v229, v231
    v_fma_f32 v5, v5, v229, v231
    v_cvt_pk_bf16_f32 v214, v4, v5
    v_lshlrev_b32 v6, 16, v215
    v_and_b32 v7, 0xffff0000, v215
    v_fma_f32 v6, v6, v229, v231
    v_fma_f32 v7, v7, v229, v231
    v_cvt_pk_bf16_f32 v215, v6, v7
    s_waitcnt vmcnt(0)
    ds_write_b16 v222, v216
    ds_write_b16 v223, v217
    ds_write_b16 v224, v218
    ds_write_b16 v225, v219
    ds_write_b16 v226, v220
    ds_write_b16 v227, v221
    s_waitcnt lgkmcnt(0)
    s_barrier
    s_add_u32 m0, s57, 36864
    s_nop 0
    buffer_load_dwordx4 v12, s[20:23], s47 offen lds
    s_add_u32 m0, s57, 40960
    s_nop 0
    buffer_load_dwordx4 v13, s[20:23], s47 offen lds
    s_add_u32 m0, s57, 45056
    s_nop 0
    buffer_load_dwordx4 v14, s[20:23], s47 offen lds
    s_add_u32 m0, s57, 49152
    s_nop 0
    buffer_load_dwordx4 v15, s[20:23], s47 offen lds
    s_mul_i32 s53, s50, 2
    s_add_u32 m0, s49, s53
    s_nop 0
    buffer_load_dwordx4 v16, s[40:43], s47 offen lds
    s_add_u32 m0, s58, 20480
    s_nop 0
    buffer_load_dwordx4 v17, s[24:27], s48 offen lds
    s_add_u32 m0, s58, 24576
    s_nop 0
    buffer_load_dwordx4 v18, s[24:27], s48 offen lds
    s_add_u32 s47, s47, 294912
    s_cmp_eq_u32 s47, 5308416
    s_cselect_b32 s47, 0, s47
    s_add_u32 s48, s48, 110592
    s_cmp_eq_u32 s48, 1990656
    s_cselect_b32 s48, 0, s48
    ds_read_b64_tr_b16 v[40:41], v19 offset:0
    ds_read_b64_tr_b16 v[42:43], v19 offset:2304
    ds_read_b64_tr_b16 v[44:45], v20 offset:32
    ds_read_b64_tr_b16 v[46:47], v20 offset:2336
    ds_read_b64_tr_b16 v[48:49], v19 offset:64
    ds_read_b64_tr_b16 v[50:51], v19 offset:2368
    ds_read_b64_tr_b16 v[52:53], v20 offset:96
    ds_read_b64_tr_b16 v[54:55], v20 offset:2400
    ds_read_b64_tr_b16 v[56:57], v19 offset:128
    ds_read_b64_tr_b16 v[58:59], v19 offset:2432
    ds_read_b64_tr_b16 v[60:61], v20 offset:160
    ds_read_b64_tr_b16 v[62:63], v20 offset:2464
    ds_read_b64_tr_b16 v[64:65], v19 offset:192
    ds_read_b64_tr_b16 v[66:67], v19 offset:2496
    s_waitcnt lgkmcnt(12)
    v_mfma_f32_16x16x32_bf16 a[0:3], v[40:43], v[72:75], 0
    v_mfma_f32_16x16x32_bf16 a[4:7], v[40:43], v[144:147], 0
    ds_read_b64_tr_b16 v[68:69], v20 offset:224
    ds_read_b64_tr_b16 v[70:71], v20 offset:2528
    s_waitcnt lgkmcnt(12)
    v_mfma_f32_16x16x32_bf16 a[8:11], v[44:47], v[72:75], 0
    v_mfma_f32_16x16x32_bf16 a[12:15], v[44:47], v[144:147], 0
    ds_read_b64_tr_b16 v[40:41], v19 offset:256
    ds_read_b64_tr_b16 v[42:43], v19 offset:2560
    s_waitcnt lgkmcnt(12)
    v_mfma_f32_16x16x32_bf16 a[16:19], v[48:51], v[72:75], 0
    v_mfma_f32_16x16x32_bf16 a[20:23], v[48:51], v[144:147], 0
    ds_read_b64_tr_b16 v[44:45], v20 offset:288
    ds_read_b64_tr_b16 v[46:47], v20 offset:2592
    s_waitcnt lgkmcnt(12)
    v_mfma_f32_16x16x32_bf16 a[24:27], v[52:55], v[72:75], 0
    v_mfma_f32_16x16x32_bf16 a[28:31], v[52:55], v[144:147], 0
    ds_read_b64_tr_b16 v[48:49], v19 offset:320
    ds_read_b64_tr_b16 v[50:51], v19 offset:2624
    s_waitcnt lgkmcnt(12)
    v_mfma_f32_16x16x32_bf16 a[32:35], v[56:59], v[72:75], 0
    v_mfma_f32_16x16x32_bf16 a[36:39], v[56:59], v[144:147], 0
    ds_read_b64_tr_b16 v[52:53], v20 offset:352
    ds_read_b64_tr_b16 v[54:55], v20 offset:2656
    s_waitcnt lgkmcnt(12)
    v_mfma_f32_16x16x32_bf16 a[40:43], v[60:63], v[72:75], 0
    v_mfma_f32_16x16x32_bf16 a[44:47], v[60:63], v[144:147], 0
    ds_read_b64_tr_b16 v[56:57], v19 offset:384
    ds_read_b64_tr_b16 v[58:59], v19 offset:2688
    s_waitcnt lgkmcnt(12)
    v_mfma_f32_16x16x32_bf16 a[48:51], v[64:67], v[72:75], 0
    v_mfma_f32_16x16x32_bf16 a[52:55], v[64:67], v[144:147], 0
    ds_read_b64_tr_b16 v[60:61], v20 offset:416
    ds_read_b64_tr_b16 v[62:63], v20 offset:2720
    s_waitcnt lgkmcnt(12)
    v_mfma_f32_16x16x32_bf16 a[56:59], v[68:71], v[72:75], 0
    v_mfma_f32_16x16x32_bf16 a[60:63], v[68:71], v[144:147], 0
    ds_read_b64_tr_b16 v[64:65], v19 offset:448
    ds_read_b64_tr_b16 v[66:67], v19 offset:2752
    s_waitcnt lgkmcnt(12)
    v_mfma_f32_16x16x32_bf16 a[64:67], v[40:43], v[72:75], 0
    v_mfma_f32_16x16x32_bf16 a[68:71], v[40:43], v[144:147], 0
    ds_read_b64_tr_b16 v[68:69], v20 offset:480
    ds_read_b64_tr_b16 v[70:71], v20 offset:2784
    s_waitcnt lgkmcnt(12)
    v_mfma_f32_16x16x32_bf16 a[72:75], v[44:47], v[72:75], 0
    v_mfma_f32_16x16x32_bf16 a[76:79], v[44:47], v[144:147], 0
    ds_read_b64_tr_b16 v[40:41], v19 offset:512
    ds_read_b64_tr_b16 v[42:43], v19 offset:2816
    s_waitcnt lgkmcnt(12)
    v_mfma_f32_16x16x32_bf16 a[80:83], v[48:51], v[72:75], 0
    v_mfma_f32_16x16x32_bf16 a[84:87], v[48:51], v[144:147], 0
    ds_read_b64_tr_b16 v[44:45], v20 offset:544
    ds_read_b64_tr_b16 v[46:47], v20 offset:2848
    s_waitcnt lgkmcnt(12)
    v_mfma_f32_16x16x32_bf16 a[88:91], v[52:55], v[72:75], 0
    v_mfma_f32_16x16x32_bf16 a[92:95], v[52:55], v[144:147], 0
    ds_read_b64_tr_b16 v[48:49], v21 offset:0
    ds_read_b64_tr_b16 v[50:51], v21 offset:1024
    s_waitcnt lgkmcnt(12)
    v_mfma_f32_16x16x32_bf16 a[96:99], v[56:59], v[72:75], 0
    v_mfma_f32_16x16x32_bf16 a[100:103], v[56:59], v[144:147], 0
    ds_read_b64_tr_b16 v[52:53], v22 offset:0
    ds_read_b64_tr_b16 v[54:55], v22 offset:1024
    s_waitcnt lgkmcnt(12)
    v_mfma_f32_16x16x32_bf16 a[104:107], v[60:63], v[72:75], 0
    v_mfma_f32_16x16x32_bf16 a[108:111], v[60:63], v[144:147], 0
    ds_read_b64_tr_b16 v[56:57], v23 offset:0
    ds_read_b64_tr_b16 v[58:59], v23 offset:1024
    s_waitcnt lgkmcnt(12)
    v_mfma_f32_16x16x32_bf16 a[112:115], v[64:67], v[72:75], 0
    v_mfma_f32_16x16x32_bf16 a[116:119], v[64:67], v[144:147], 0
    ds_read_b64_tr_b16 v[60:61], v24 offset:0
    ds_read_b64_tr_b16 v[62:63], v24 offset:1024
    s_waitcnt lgkmcnt(12)
    v_mfma_f32_16x16x32_bf16 a[120:123], v[68:71], v[72:75], 0
    v_mfma_f32_16x16x32_bf16 a[124:127], v[68:71], v[144:147], 0
    ds_read_b64_tr_b16 v[64:65], v25 offset:0
    ds_read_b64_tr_b16 v[66:67], v25 offset:1024
    s_waitcnt lgkmcnt(12)
    v_mfma_f32_16x16x32_bf16 a[128:131], v[40:43], v[72:75], 0
    v_mfma_f32_16x16x32_bf16 a[132:135], v[40:43], v[144:147], 0
    ds_read_b64_tr_b16 v[68:69], v26 offset:0
    ds_read_b64_tr_b16 v[70:71], v26 offset:1024
    s_waitcnt lgkmcnt(12)
    v_mfma_f32_16x16x32_bf16 a[136:139], v[44:47], v[72:75], 0
    v_mfma_f32_16x16x32_bf16 a[140:143], v[44:47], v[144:147], 0
    ds_read_b64_tr_b16 v[40:41], v27 offset:0
    ds_read_b64_tr_b16 v[42:43], v27 offset:1024
    s_waitcnt lgkmcnt(12)
    v_mfma_f32_16x16x32_bf16 a[144:147], v[48:51], v[72:75], 0
    v_mfma_f32_16x16x32_bf16 a[148:151], v[48:51], v[144:147], 0
    s_barrier
    s_add_u32 m0, s57, 55296
    s_nop 0
    buffer_load_dwordx4 v12, s[20:23], s47 offen lds
    s_add_u32 m0, s57, 59392
    s_nop 0
    buffer_load_dwordx4 v13, s[20:23], s47 offen lds
    s_add_u32 m0, s57, 63488
    s_nop 0
    buffer_load_dwordx4 v14, s[20:23], s47 offen lds
    s_add_u32 m0, s57, 67584
    s_nop 0
    buffer_load_dwordx4 v15, s[20:23], s47 offen lds
    s_mul_i32 s53, s50, 3
    s_add_u32 m0, s49, s53
    s_nop 0
    buffer_load_dwordx4 v16, s[40:43], s47 offen lds
    s_add_u32 m0, s58, 30720
    s_nop 0
    buffer_load_dwordx4 v17, s[24:27], s48 offen lds
    s_add_u32 m0, s58, 34816
    s_nop 0
    buffer_load_dwordx4 v18, s[24:27], s48 offen lds
    s_add_u32 s47, s47, 294912
    s_cmp_eq_u32 s47, 5308416
    s_cselect_b32 s47, 0, s47
    s_add_u32 s48, s48, 110592
    s_cmp_eq_u32 s48, 1990656
    s_cselect_b32 s48, 0, s48
    ds_read_b64_tr_b16 v[44:45], v19 offset:18432
    ds_read_b64_tr_b16 v[46:47], v19 offset:20736
    s_waitcnt lgkmcnt(12)
    v_mfma_f32_16x16x32_bf16 a[152:155], v[52:55], v[72:75], 0
    v_mfma_f32_16x16x32_bf16 a[156:159], v[52:55], v[144:147], 0
    ds_read_b64_tr_b16 v[48:49], v20 offset:18464
    ds_read_b64_tr_b16 v[50:51], v20 offset:20768
    s_waitcnt lgkmcnt(12)
    v_mfma_f32_16x16x32_bf16 a[160:163], v[56:59], v[72:75], 0
    v_mfma_f32_16x16x32_bf16 a[164:167], v[56:59], v[144:147], 0
    ds_read_b64_tr_b16 v[52:53], v19 offset:18496
    ds_read_b64_tr_b16 v[54:55], v19 offset:20800
    s_waitcnt lgkmcnt(12)
    v_mfma_f32_16x16x32_bf16 a[168:171], v[60:63], v[72:75], 0
    v_mfma_f32_16x16x32_bf16 a[172:175], v[60:63], v[144:147], 0
    ds_read_b64_tr_b16 v[56:57], v20 offset:18528
    ds_read_b64_tr_b16 v[58:59], v20 offset:20832
    s_waitcnt lgkmcnt(12)
    v_mfma_f32_16x16x32_bf16 a[176:179], v[64:67], v[72:75], 0
    v_mfma_f32_16x16x32_bf16 a[180:183], v[64:67], v[144:147], 0
    ds_read_b64_tr_b16 v[60:61], v19 offset:18560
    ds_read_b64_tr_b16 v[62:63], v19 offset:20864
    s_waitcnt lgkmcnt(12)
    v_mfma_f32_16x16x32_bf16 a[184:187], v[68:71], v[72:75], 0
    v_mfma_f32_16x16x32_bf16 a[188:191], v[68:71], v[144:147], 0
    ds_read_b64_tr_b16 v[64:65], v20 offset:18592
    ds_read_b64_tr_b16 v[66:67], v20 offset:20896
    s_waitcnt lgkmcnt(12)
    v_mfma_f32_16x16x32_bf16 a[192:195], v[40:43], v[72:75], 0
    v_mfma_f32_16x16x32_bf16 a[196:199], v[40:43], v[144:147], 0
    ds_read_b64_tr_b16 v[68:69], v19 offset:18624
    ds_read_b64_tr_b16 v[70:71], v19 offset:20928
    s_waitcnt lgkmcnt(12)
    v_mfma_f32_16x16x32_bf16 a[0:3], v[44:47], v[76:79], a[0:3]
    v_mfma_f32_16x16x32_bf16 a[4:7], v[44:47], v[148:151], a[4:7]
    ds_read_b64_tr_b16 v[40:41], v20 offset:18656
    ds_read_b64_tr_b16 v[42:43], v20 offset:20960
    s_waitcnt lgkmcnt(12)
    v_mfma_f32_16x16x32_bf16 a[8:11], v[48:51], v[76:79], a[8:11]
    v_mfma_f32_16x16x32_bf16 a[12:15], v[48:51], v[148:151], a[12:15]
    ds_read_b64_tr_b16 v[44:45], v19 offset:18688
    ds_read_b64_tr_b16 v[46:47], v19 offset:20992
    s_waitcnt lgkmcnt(12)
    v_mfma_f32_16x16x32_bf16 a[16:19], v[52:55], v[76:79], a[16:19]
    v_mfma_f32_16x16x32_bf16 a[20:23], v[52:55], v[148:151], a[20:23]
    ds_read_b64_tr_b16 v[48:49], v20 offset:18720
    ds_read_b64_tr_b16 v[50:51], v20 offset:21024
    s_waitcnt lgkmcnt(12)
    v_mfma_f32_16x16x32_bf16 a[24:27], v[56:59], v[76:79], a[24:27]
    v_mfma_f32_16x16x32_bf16 a[28:31], v[56:59], v[148:151], a[28:31]
    ds_read_b64_tr_b16 v[52:53], v19 offset:18752
    ds_read_b64_tr_b16 v[54:55], v19 offset:21056
    s_waitcnt lgkmcnt(12)
    v_mfma_f32_16x16x32_bf16 a[32:35], v[60:63], v[76:79], a[32:35]
    v_mfma_f32_16x16x32_bf16 a[36:39], v[60:63], v[148:151], a[36:39]
    ds_read_b64_tr_b16 v[56:57], v20 offset:18784
    ds_read_b64_tr_b16 v[58:59], v20 offset:21088
    s_waitcnt lgkmcnt(12)
    v_mfma_f32_16x16x32_bf16 a[40:43], v[64:67], v[76:79], a[40:43]
    v_mfma_f32_16x16x32_bf16 a[44:47], v[64:67], v[148:151], a[44:47]
    ds_read_b64_tr_b16 v[60:61], v19 offset:18816
    ds_read_b64_tr_b16 v[62:63], v19 offset:21120
    s_waitcnt lgkmcnt(12)
    v_mfma_f32_16x16x32_bf16 a[48:51], v[68:71], v[76:79], a[48:51]
    v_mfma_f32_16x16x32_bf16 a[52:55], v[68:71], v[148:151], a[52:55]
    ds_read_b64_tr_b16 v[64:65], v20 offset:18848
    ds_read_b64_tr_b16 v[66:67], v20 offset:21152
    s_waitcnt lgkmcnt(12)
    v_mfma_f32_16x16x32_bf16 a[56:59], v[40:43], v[76:79], a[56:59]
    v_mfma_f32_16x16x32_bf16 a[60:63], v[40:43], v[148:151], a[60:63]
    ds_read_b64_tr_b16 v[68:69], v19 offset:18880
    ds_read_b64_tr_b16 v[70:71], v19 offset:21184
    s_waitcnt lgkmcnt(12)
    v_mfma_f32_16x16x32_bf16 a[64:67], v[44:47], v[76:79], a[64:67]
    v_mfma_f32_16x16x32_bf16 a[68:71], v[44:47], v[148:151], a[68:71]
    ds_read_b64_tr_b16 v[40:41], v20 offset:18912
    ds_read_b64_tr_b16 v[42:43], v20 offset:21216
    s_waitcnt lgkmcnt(12)
    v_mfma_f32_16x16x32_bf16 a[72:75], v[48:51], v[76:79], a[72:75]
    v_mfma_f32_16x16x32_bf16 a[76:79], v[48:51], v[148:151], a[76:79]
    ds_read_b64_tr_b16 v[44:45], v19 offset:18944
    ds_read_b64_tr_b16 v[46:47], v19 offset:21248
    s_waitcnt lgkmcnt(12)
    v_mfma_f32_16x16x32_bf16 a[80:83], v[52:55], v[76:79], a[80:83]
    v_mfma_f32_16x16x32_bf16 a[84:87], v[52:55], v[148:151], a[84:87]
    ds_read_b64_tr_b16 v[48:49], v20 offset:18976
    ds_read_b64_tr_b16 v[50:51], v20 offset:21280
    s_waitcnt lgkmcnt(12)
    v_mfma_f32_16x16x32_bf16 a[88:91], v[56:59], v[76:79], a[88:91]
    v_mfma_f32_16x16x32_bf16 a[92:95], v[56:59], v[148:151], a[92:95]
    ds_read_b64_tr_b16 v[52:53], v21 offset:10240
    ds_read_b64_tr_b16 v[54:55], v21 offset:11264
    s_waitcnt lgkmcnt(12)
    v_mfma_f32_16x16x32_bf16 a[96:99], v[60:63], v[76:79], a[96:99]
    v_mfma_f32_16x16x32_bf16 a[100:103], v[60:63], v[148:151], a[100:103]
    ds_read_b64_tr_b16 v[56:57], v22 offset:10240
    ds_read_b64_tr_b16 v[58:59], v22 offset:11264
    s_waitcnt lgkmcnt(12)
    v_mfma_f32_16x16x32_bf16 a[104:107], v[64:67], v[76:79], a[104:107]
    v_mfma_f32_16x16x32_bf16 a[108:111], v[64:67], v[148:151], a[108:111]
    ds_read_b64_tr_b16 v[60:61], v23 offset:10240
    ds_read_b64_tr_b16 v[62:63], v23 offset:11264
    s_waitcnt lgkmcnt(12)
    v_mfma_f32_16x16x32_bf16 a[112:115], v[68:71], v[76:79], a[112:115]
    v_mfma_f32_16x16x32_bf16 a[116:119], v[68:71], v[148:151], a[116:119]
    ds_read_b64_tr_b16 v[64:65], v24 offset:10240
    ds_read_b64_tr_b16 v[66:67], v24 offset:11264
    s_waitcnt lgkmcnt(12)
    v_mfma_f32_16x16x32_bf16 a[120:123], v[40:43], v[76:79], a[120:123]
    v_mfma_f32_16x16x32_bf16 a[124:127], v[40:43], v[148:151], a[124:127]
    ds_read_b64_tr_b16 v[68:69], v25 offset:10240
    ds_read_b64_tr_b16 v[70:71], v25 offset:11264
    s_waitcnt lgkmcnt(12)
    v_mfma_f32_16x16x32_bf16 a[128:131], v[44:47], v[76:79], a[128:131]
    v_mfma_f32_16x16x32_bf16 a[132:135], v[44:47], v[148:151], a[132:135]
    ds_read_b64_tr_b16 v[40:41], v26 offset:10240
    ds_read_b64_tr_b16 v[42:43], v26 offset:11264
    s_waitcnt lgkmcnt(12)
    v_mfma_f32_16x16x32_bf16 a[136:139], v[48:51], v[76:79], a[136:139]
    v_mfma_f32_16x16x32_bf16 a[140:143], v[48:51], v[148:151], a[140:143]
    ds_read_b64_tr_b16 v[44:45], v27 offset:10240
    ds_read_b64_tr_b16 v[46:47], v27 offset:11264
    s_waitcnt lgkmcnt(12)
    v_mfma_f32_16x16x32_bf16 a[144:147], v[52:55], v[76:79], a[144:147]
    v_mfma_f32_16x16x32_bf16 a[148:151], v[52:55], v[148:151], a[148:151]
    s_waitcnt vmcnt(7)
    s_barrier
    s_add_u32 m0, s57, 0
    s_nop 0
    buffer_load_dwordx4 v12, s[20:23], s47 offen lds
    s_add_u32 m0, s57, 4096
    s_nop 0
    buffer_load_dwordx4 v13, s[20:23], s47 offen lds
    s_add_u32 m0, s57, 8192
    s_nop 0
    buffer_load_dwordx4 v14, s[20:23], s47 offen lds
    s_add_u32 m0, s57, 12288
    s_nop 0
    buffer_load_dwordx4 v15, s[20:23], s47 offen lds
    s_mul_i32 s53, s50, 0
    s_add_u32 m0, s49, s53
    s_nop 0
    buffer_load_dwordx4 v16, s[40:43], s47 offen lds
    s_add_u32 m0, s58, 0
    s_nop 0
    buffer_load_dwordx4 v17, s[24:27], s48 offen lds
    s_add_u32 m0, s58, 4096
    s_nop 0
    buffer_load_dwordx4 v18, s[24:27], s48 offen lds
    s_add_u32 s47, s47, 294912
    s_cmp_eq_u32 s47, 5308416
    s_cselect_b32 s47, 0, s47
    s_add_u32 s48, s48, 110592
    s_cmp_eq_u32 s48, 1990656
    s_cselect_b32 s48, 0, s48
    ds_read_b64_tr_b16 v[48:49], v19 offset:36864
    ds_read_b64_tr_b16 v[50:51], v19 offset:39168
    s_waitcnt lgkmcnt(12)
    v_mfma_f32_16x16x32_bf16 a[152:155], v[56:59], v[76:79], a[152:155]
    v_mfma_f32_16x16x32_bf16 a[156:159], v[56:59], v[148:151], a[156:159]
    ds_read_b64_tr_b16 v[52:53], v20 offset:36896
    ds_read_b64_tr_b16 v[54:55], v20 offset:39200
    s_waitcnt lgkmcnt(12)
    v_mfma_f32_16x16x32_bf16 a[160:163], v[60:63], v[76:79], a[160:163]
    v_mfma_f32_16x16x32_bf16 a[164:167], v[60:63], v[148:151], a[164:167]
    ds_read_b64_tr_b16 v[56:57], v19 offset:36928
    ds_read_b64_tr_b16 v[58:59], v19 offset:39232
    s_waitcnt lgkmcnt(12)
    v_mfma_f32_16x16x32_bf16 a[168:171], v[64:67], v[76:79], a[168:171]
    v_mfma_f32_16x16x32_bf16 a[172:175], v[64:67], v[148:151], a[172:175]
    ds_read_b64_tr_b16 v[60:61], v20 offset:36960
    ds_read_b64_tr_b16 v[62:63], v20 offset:39264
    s_waitcnt lgkmcnt(12)
    v_mfma_f32_16x16x32_bf16 a[176:179], v[68:71], v[76:79], a[176:179]
    v_mfma_f32_16x16x32_bf16 a[180:183], v[68:71], v[148:151], a[180:183]
    ds_read_b64_tr_b16 v[64:65], v19 offset:36992
    ds_read_b64_tr_b16 v[66:67], v19 offset:39296
    s_waitcnt lgkmcnt(12)
    v_mfma_f32_16x16x32_bf16 a[184:187], v[40:43], v[76:79], a[184:187]
    v_mfma_f32_16x16x32_bf16 a[188:191], v[40:43], v[148:151], a[188:191]
    ds_read_b64_tr_b16 v[68:69], v20 offset:37024
    ds_read_b64_tr_b16 v[70:71], v20 offset:39328
    s_waitcnt lgkmcnt(12)
    v_mfma_f32_16x16x32_bf16 a[192:195], v[44:47], v[76:79], a[192:195]
    v_mfma_f32_16x16x32_bf16 a[196:199], v[44:47], v[148:151], a[196:199]
    ds_read_b64_tr_b16 v[40:41], v19 offset:37056
    ds_read_b64_tr_b16 v[42:43], v19 offset:39360
    s_waitcnt lgkmcnt(12)
    v_mfma_f32_16x16x32_bf16 a[0:3], v[48:51], v[80:83], a[0:3]
    v_mfma_f32_16x16x32_bf16 a[4:7], v[48:51], v[152:155], a[4:7]
    ds_read_b64_tr_b16 v[44:45], v20 offset:37088
    ds_read_b64_tr_b16 v[46:47], v20 offset:39392
    s_waitcnt lgkmcnt(12)
    v_mfma_f32_16x16x32_bf16 a[8:11], v[52:55], v[80:83], a[8:11]
    v_mfma_f32_16x16x32_bf16 a[12:15], v[52:55], v[152:155], a[12:15]
    ds_read_b64_tr_b16 v[48:49], v19 offset:37120
    ds_read_b64_tr_b16 v[50:51], v19 offset:39424
    s_waitcnt lgkmcnt(12)
    v_mfma_f32_16x16x32_bf16 a[16:19], v[56:59], v[80:83], a[16:19]
    v_mfma_f32_16x16x32_bf16 a[20:23], v[56:59], v[152:155], a[20:23]
    ds_read_b64_tr_b16 v[52:53], v20 offset:37152
    ds_read_b64_tr_b16 v[54:55], v20 offset:39456
    s_waitcnt lgkmcnt(12)
    v_mfma_f32_16x16x32_bf16 a[24:27], v[60:63], v[80:83], a[24:27]
    v_mfma_f32_16x16x32_bf16 a[28:31], v[60:63], v[152:155], a[28:31]
    ds_read_b64_tr_b16 v[56:57], v19 offset:37184
    ds_read_b64_tr_b16 v[58:59], v19 offset:39488
    s_waitcnt lgkmcnt(12)
    v_mfma_f32_16x16x32_bf16 a[32:35], v[64:67], v[80:83], a[32:35]
    v_mfma_f32_16x16x32_bf16 a[36:39], v[64:67], v[152:155], a[36:39]
    ds_read_b64_tr_b16 v[60:61], v20 offset:37216
    ds_read_b64_tr_b16 v[62:63], v20 offset:39520
    s_waitcnt lgkmcnt(12)
    v_mfma_f32_16x16x32_bf16 a[40:43], v[68:71], v[80:83], a[40:43]
    v_mfma_f32_16x16x32_bf16 a[44:47], v[68:71], v[152:155], a[44:47]
    ds_read_b64_tr_b16 v[64:65], v19 offset:37248
    ds_read_b64_tr_b16 v[66:67], v19 offset:39552
    s_waitcnt lgkmcnt(12)
    v_mfma_f32_16x16x32_bf16 a[48:51], v[40:43], v[80:83], a[48:51]
    v_mfma_f32_16x16x32_bf16 a[52:55], v[40:43], v[152:155], a[52:55]
    ds_read_b64_tr_b16 v[68:69], v20 offset:37280
    ds_read_b64_tr_b16 v[70:71], v20 offset:39584
    s_waitcnt lgkmcnt(12)
    v_mfma_f32_16x16x32_bf16 a[56:59], v[44:47], v[80:83], a[56:59]
    v_mfma_f32_16x16x32_bf16 a[60:63], v[44:47], v[152:155], a[60:63]
    ds_read_b64_tr_b16 v[40:41], v19 offset:37312
    ds_read_b64_tr_b16 v[42:43], v19 offset:39616
    s_waitcnt lgkmcnt(12)
    v_mfma_f32_16x16x32_bf16 a[64:67], v[48:51], v[80:83], a[64:67]
    v_mfma_f32_16x16x32_bf16 a[68:71], v[48:51], v[152:155], a[68:71]
    ds_read_b64_tr_b16 v[44:45], v20 offset:37344
    ds_read_b64_tr_b16 v[46:47], v20 offset:39648
    s_waitcnt lgkmcnt(12)
    v_mfma_f32_16x16x32_bf16 a[72:75], v[52:55], v[80:83], a[72:75]
    v_mfma_f32_16x16x32_bf16 a[76:79], v[52:55], v[152:155], a[76:79]
    ds_read_b64_tr_b16 v[48:49], v19 offset:37376
    ds_read_b64_tr_b16 v[50:51], v19 offset:39680
    s_waitcnt lgkmcnt(12)
    v_mfma_f32_16x16x32_bf16 a[80:83], v[56:59], v[80:83], a[80:83]
    v_mfma_f32_16x16x32_bf16 a[84:87], v[56:59], v[152:155], a[84:87]
    ds_read_b64_tr_b16 v[52:53], v20 offset:37408
    ds_read_b64_tr_b16 v[54:55], v20 offset:39712
    s_waitcnt lgkmcnt(12)
    v_mfma_f32_16x16x32_bf16 a[88:91], v[60:63], v[80:83], a[88:91]
    v_mfma_f32_16x16x32_bf16 a[92:95], v[60:63], v[152:155], a[92:95]
    ds_read_b64_tr_b16 v[56:57], v21 offset:20480
    ds_read_b64_tr_b16 v[58:59], v21 offset:21504
    s_waitcnt lgkmcnt(12)
    v_mfma_f32_16x16x32_bf16 a[96:99], v[64:67], v[80:83], a[96:99]
    v_mfma_f32_16x16x32_bf16 a[100:103], v[64:67], v[152:155], a[100:103]
    ds_read_b64_tr_b16 v[60:61], v22 offset:20480
    ds_read_b64_tr_b16 v[62:63], v22 offset:21504
    s_waitcnt lgkmcnt(12)
    v_mfma_f32_16x16x32_bf16 a[104:107], v[68:71], v[80:83], a[104:107]
    v_mfma_f32_16x16x32_bf16 a[108:111], v[68:71], v[152:155], a[108:111]
    ds_read_b64_tr_b16 v[64:65], v23 offset:20480
    ds_read_b64_tr_b16 v[66:67], v23 offset:21504
    s_waitcnt lgkmcnt(12)
    v_mfma_f32_16x16x32_bf16 a[112:115], v[40:43], v[80:83], a[112:115]
    v_mfma_f32_16x16x32_bf16 a[116:119], v[40:43], v[152:155], a[116:119]
    ds_read_b64_tr_b16 v[68:69], v24 offset:20480
    ds_read_b64_tr_b16 v[70:71], v24 offset:21504
    s_waitcnt lgkmcnt(12)
    v_mfma_f32_16x16x32_bf16 a[120:123], v[44:47], v[80:83], a[120:123]
    v_mfma_f32_16x16x32_bf16 a[124:127], v[44:47], v[152:155], a[124:127]
    ds_read_b64_tr_b16 v[40:41], v25 offset:20480
    ds_read_b64_tr_b16 v[42:43], v25 offset:21504
    s_waitcnt lgkmcnt(12)
    v_mfma_f32_16x16x32_bf16 a[128:131], v[48:51], v[80:83], a[128:131]
    v_mfma_f32_16x16x32_bf16 a[132:135], v[48:51], v[152:155], a[132:135]
    ds_read_b64_tr_b16 v[44:45], v26 offset:20480
    ds_read_b64_tr_b16 v[46:47], v26 offset:21504
    s_waitcnt lgkmcnt(12)
    v_mfma_f32_16x16x32_bf16 a[136:139], v[52:55], v[80:83], a[136:139]
    v_mfma_f32_16x16x32_bf16 a[140:143], v[52:55], v[152:155], a[140:143]
    ds_read_b64_tr_b16 v[48:49], v27 offset:20480
    ds_read_b64_tr_b16 v[50:51], v27 offset:21504
    s_waitcnt lgkmcnt(12)
    v_mfma_f32_16x16x32_bf16 a[144:147], v[56:59], v[80:83], a[144:147]
    v_mfma_f32_16x16x32_bf16 a[148:151], v[56:59], v[152:155], a[148:151]
    s_waitcnt vmcnt(7)
    s_barrier
    s_add_u32 m0, s57, 18432
    s_nop 0
    buffer_load_dwordx4 v12, s[20:23], s47 offen lds
    s_add_u32 m0, s57, 22528
    s_nop 0
    buffer_load_dwordx4 v13, s[20:23], s47 offen lds
    s_add_u32 m0, s57, 26624
    s_nop 0
    buffer_load_dwordx4 v14, s[20:23], s47 offen lds
    s_add_u32 m0, s57, 30720
    s_nop 0
    buffer_load_dwordx4 v15, s[20:23], s47 offen lds
    s_mul_i32 s53, s50, 1
    s_add_u32 m0, s49, s53
    s_nop 0
    buffer_load_dwordx4 v16, s[40:43], s47 offen lds
    s_add_u32 m0, s58, 10240
    s_nop 0
    buffer_load_dwordx4 v17, s[24:27], s48 offen lds
    s_add_u32 m0, s58, 14336
    s_nop 0
    buffer_load_dwordx4 v18, s[24:27], s48 offen lds
    s_add_u32 s47, s47, 294912
    s_cmp_eq_u32 s47, 5308416
    s_cselect_b32 s47, 0, s47
    s_add_u32 s48, s48, 110592
    s_cmp_eq_u32 s48, 1990656
    s_cselect_b32 s48, 0, s48
    ds_read_b64_tr_b16 v[52:53], v19 offset:55296
    ds_read_b64_tr_b16 v[54:55], v19 offset:57600
    s_waitcnt lgkmcnt(12)
    v_mfma_f32_16x16x32_bf16 a[152:155], v[60:63], v[80:83], a[152:155]
    v_mfma_f32_16x16x32_bf16 a[156:159], v[60:63], v[152:155], a[156:159]
    ds_read_b64_tr_b16 v[56:57], v20 offset:55328
    ds_read_b64_tr_b16 v[58:59], v20 offset:57632
    s_waitcnt lgkmcnt(12)
    v_mfma_f32_16x16x32_bf16 a[160:163], v[64:67], v[80:83], a[160:163]
    v_mfma_f32_16x16x32_bf16 a[164:167], v[64:67], v[152:155], a[164:167]
    ds_read_b64_tr_b16 v[60:61], v19 offset:55360
    ds_read_b64_tr_b16 v[62:63], v19 offset:57664
    s_waitcnt lgkmcnt(12)
    v_mfma_f32_16x16x32_bf16 a[168:171], v[68:71], v[80:83], a[168:171]
    v_mfma_f32_16x16x32_bf16 a[172:175], v[68:71], v[152:155], a[172:175]
    ds_read_b64_tr_b16 v[64:65], v20 offset:55392
    ds_read_b64_tr_b16 v[66:67], v20 offset:57696
    s_waitcnt lgkmcnt(12)
    v_mfma_f32_16x16x32_bf16 a[176:179], v[40:43], v[80:83], a[176:179]
    v_mfma_f32_16x16x32_bf16 a[180:183], v[40:43], v[152:155], a[180:183]
    ds_read_b64_tr_b16 v[68:69], v19 offset:55424
    ds_read_b64_tr_b16 v[70:71], v19 offset:57728
    s_waitcnt lgkmcnt(12)
    v_mfma_f32_16x16x32_bf16 a[184:187], v[44:47], v[80:83], a[184:187]
    v_mfma_f32_16x16x32_bf16 a[188:191], v[44:47], v[152:155], a[188:191]
    ds_read_b64_tr_b16 v[40:41], v20 offset:55456
    ds_read_b64_tr_b16 v[42:43], v20 offset:57760
    s_waitcnt lgkmcnt(12)
    v_mfma_f32_16x16x32_bf16 a[192:195], v[48:51], v[80:83], a[192:195]
    v_mfma_f32_16x16x32_bf16 a[196:199], v[48:51], v[152:155], a[196:199]
    ds_read_b64_tr_b16 v[44:45], v19 offset:55488
    ds_read_b64_tr_b16 v[46:47], v19 offset:57792
    s_waitcnt lgkmcnt(12)
    v_mfma_f32_16x16x32_bf16 a[0:3], v[52:55], v[84:87], a[0:3]
    v_mfma_f32_16x16x32_bf16 a[4:7], v[52:55], v[156:159], a[4:7]
    ds_read_b64_tr_b16 v[48:49], v20 offset:55520
    ds_read_b64_tr_b16 v[50:51], v20 offset:57824
    s_waitcnt lgkmcnt(12)
    v_mfma_f32_16x16x32_bf16 a[8:11], v[56:59], v[84:87], a[8:11]
    v_mfma_f32_16x16x32_bf16 a[12:15], v[56:59], v[156:159], a[12:15]
    ds_read_b64_tr_b16 v[52:53], v19 offset:55552
    ds_read_b64_tr_b16 v[54:55], v19 offset:57856
    s_waitcnt lgkmcnt(12)
    v_mfma_f32_16x16x32_bf16 a[16:19], v[60:63], v[84:87], a[16:19]
    v_mfma_f32_16x16x32_bf16 a[20:23], v[60:63], v[156:159], a[20:23]
    ds_read_b64_tr_b16 v[56:57], v20 offset:55584
    ds_read_b64_tr_b16 v[58:59], v20 offset:57888
    s_waitcnt lgkmcnt(12)
    v_mfma_f32_16x16x32_bf16 a[24:27], v[64:67], v[84:87], a[24:27]
    v_mfma_f32_16x16x32_bf16 a[28:31], v[64:67], v[156:159], a[28:31]
    ds_read_b64_tr_b16 v[60:61], v19 offset:55616
    ds_read_b64_tr_b16 v[62:63], v19 offset:57920
    s_waitcnt lgkmcnt(12)
    v_mfma_f32_16x16x32_bf16 a[32:35], v[68:71], v[84:87], a[32:35]
    v_mfma_f32_16x16x32_bf16 a[36:39], v[68:71], v[156:159], a[36:39]
    ds_read_b64_tr_b16 v[64:65], v20 offset:55648
    ds_read_b64_tr_b16 v[66:67], v20 offset:57952
    s_waitcnt lgkmcnt(12)
    v_mfma_f32_16x16x32_bf16 a[40:43], v[40:43], v[84:87], a[40:43]
    v_mfma_f32_16x16x32_bf16 a[44:47], v[40:43], v[156:159], a[44:47]
    ds_read_b64_tr_b16 v[68:69], v19 offset:55680
    ds_read_b64_tr_b16 v[70:71], v19 offset:57984
    s_waitcnt lgkmcnt(12)
    v_mfma_f32_16x16x32_bf16 a[48:51], v[44:47], v[84:87], a[48:51]
    v_mfma_f32_16x16x32_bf16 a[52:55], v[44:47], v[156:159], a[52:55]
    ds_read_b64_tr_b16 v[40:41], v20 offset:55712
    ds_read_b64_tr_b16 v[42:43], v20 offset:58016
    s_waitcnt lgkmcnt(12)
    v_mfma_f32_16x16x32_bf16 a[56:59], v[48:51], v[84:87], a[56:59]
    v_mfma_f32_16x16x32_bf16 a[60:63], v[48:51], v[156:159], a[60:63]
    ds_read_b64_tr_b16 v[44:45], v19 offset:55744
    ds_read_b64_tr_b16 v[46:47], v19 offset:58048
    s_waitcnt lgkmcnt(12)
    v_mfma_f32_16x16x32_bf16 a[64:67], v[52:55], v[84:87], a[64:67]
    v_mfma_f32_16x16x32_bf16 a[68:71], v[52:55], v[156:159], a[68:71]
    ds_read_b64_tr_b16 v[48:49], v20 offset:55776
    ds_read_b64_tr_b16 v[50:51], v20 offset:58080
    s_waitcnt lgkmcnt(12)
    v_mfma_f32_16x16x32_bf16 a[72:75], v[56:59], v[84:87], a[72:75]
    v_mfma_f32_16x16x32_bf16 a[76:79], v[56:59], v[156:159], a[76:79]
    ds_read_b64_tr_b16 v[52:53], v19 offset:55808
    ds_read_b64_tr_b16 v[54:55], v19 offset:58112
    s_waitcnt lgkmcnt(12)
    v_mfma_f32_16x16x32_bf16 a[80:83], v[60:63], v[84:87], a[80:83]
    v_mfma_f32_16x16x32_bf16 a[84:87], v[60:63], v[156:159], a[84:87]
    ds_read_b64_tr_b16 v[56:57], v20 offset:55840
    ds_read_b64_tr_b16 v[58:59], v20 offset:58144
    s_waitcnt lgkmcnt(12)
    v_mfma_f32_16x16x32_bf16 a[88:91], v[64:67], v[84:87], a[88:91]
    v_mfma_f32_16x16x32_bf16 a[92:95], v[64:67], v[156:159], a[92:95]
    ds_read_b64_tr_b16 v[60:61], v21 offset:30720
    ds_read_b64_tr_b16 v[62:63], v21 offset:31744
    s_waitcnt lgkmcnt(12)
    v_mfma_f32_16x16x32_bf16 a[96:99], v[68:71], v[84:87], a[96:99]
    v_mfma_f32_16x16x32_bf16 a[100:103], v[68:71], v[156:159], a[100:103]
    ds_read_b64_tr_b16 v[64:65], v22 offset:30720
    ds_read_b64_tr_b16 v[66:67], v22 offset:31744
    s_waitcnt lgkmcnt(12)
    v_mfma_f32_16x16x32_bf16 a[104:107], v[40:43], v[84:87], a[104:107]
    v_mfma_f32_16x16x32_bf16 a[108:111], v[40:43], v[156:159], a[108:111]
    ds_read_b64_tr_b16 v[68:69], v23 offset:30720
    ds_read_b64_tr_b16 v[70:71], v23 offset:31744
    s_waitcnt lgkmcnt(12)
    v_mfma_f32_16x16x32_bf16 a[112:115], v[44:47], v[84:87], a[112:115]
    v_mfma_f32_16x16x32_bf16 a[116:119], v[44:47], v[156:159], a[116:119]
    ds_read_b64_tr_b16 v[40:41], v24 offset:30720
    ds_read_b64_tr_b16 v[42:43], v24 offset:31744
    s_waitcnt lgkmcnt(12)
    v_mfma_f32_16x16x32_bf16 a[120:123], v[48:51], v[84:87], a[120:123]
    v_mfma_f32_16x16x32_bf16 a[124:127], v[48:51], v[156:159], a[124:127]
    ds_read_b64_tr_b16 v[44:45], v25 offset:30720
    ds_read_b64_tr_b16 v[46:47], v25 offset:31744
    s_waitcnt lgkmcnt(12)
    v_mfma_f32_16x16x32_bf16 a[128:131], v[52:55], v[84:87], a[128:131]
    v_mfma_f32_16x16x32_bf16 a[132:135], v[52:55], v[156:159], a[132:135]
    ds_read_b64_tr_b16 v[48:49], v26 offset:30720
    ds_read_b64_tr_b16 v[50:51], v26 offset:31744
    s_waitcnt lgkmcnt(12)
    v_mfma_f32_16x16x32_bf16 a[136:139], v[56:59], v[84:87], a[136:139]
    v_mfma_f32_16x16x32_bf16 a[140:143], v[56:59], v[156:159], a[140:143]
    ds_read_b64_tr_b16 v[52:53], v27 offset:30720
    ds_read_b64_tr_b16 v[54:55], v27 offset:31744
    s_waitcnt lgkmcnt(12)
    v_mfma_f32_16x16x32_bf16 a[144:147], v[60:63], v[84:87], a[144:147]
    v_mfma_f32_16x16x32_bf16 a[148:151], v[60:63], v[156:159], a[148:151]
    s_waitcnt vmcnt(7)
    s_barrier
    s_add_u32 m0, s57, 36864
    s_nop 0
    buffer_load_dwordx4 v12, s[20:23], s47 offen lds
    s_add_u32 m0, s57, 40960
    s_nop 0
    buffer_load_dwordx4 v13, s[20:23], s47 offen lds
    s_add_u32 m0, s57, 45056
    s_nop 0
    buffer_load_dwordx4 v14, s[20:23], s47 offen lds
    s_add_u32 m0, s57, 49152
    s_nop 0
    buffer_load_dwordx4 v15, s[20:23], s47 offen lds
    s_mul_i32 s53, s50, 2
    s_add_u32 m0, s49, s53
    s_nop 0
    buffer_load_dwordx4 v16, s[40:43], s47 offen lds
    s_add_u32 m0, s58, 20480
    s_nop 0
    buffer_load_dwordx4 v17, s[24:27], s48 offen lds
    s_add_u32 m0, s58, 24576
    s_nop 0
    buffer_load_dwordx4 v18, s[24:27], s48 offen lds
    s_add_u32 s47, s47, 294912
    s_cmp_eq_u32 s47, 5308416
    s_cselect_b32 s47, 0, s47
    s_add_u32 s48, s48, 110592
    s_cmp_eq_u32 s48, 1990656
    s_cselect_b32 s48, 0, s48
    ds_read_b64_tr_b16 v[56:57], v19 offset:0
    ds_read_b64_tr_b16 v[58:59], v19 offset:2304
    s_waitcnt lgkmcnt(12)
    v_mfma_f32_16x16x32_bf16 a[152:155], v[64:67], v[84:87], a[152:155]
    v_mfma_f32_16x16x32_bf16 a[156:159], v[64:67], v[156:159], a[156:159]
    ds_read_b64_tr_b16 v[60:61], v20 offset:32
    ds_read_b64_tr_b16 v[62:63], v20 offset:2336
    s_waitcnt lgkmcnt(12)
    v_mfma_f32_16x16x32_bf16 a[160:163], v[68:71], v[84:87], a[160:163]
    v_mfma_f32_16x16x32_bf16 a[164:167], v[68:71], v[156:159], a[164:167]
    ds_read_b64_tr_b16 v[64:65], v19 offset:64
    ds_read_b64_tr_b16 v[66:67], v19 offset:2368
    s_waitcnt lgkmcnt(12)
    v_mfma_f32_16x16x32_bf16 a[168:171], v[40:43], v[84:87], a[168:171]
    v_mfma_f32_16x16x32_bf16 a[172:175], v[40:43], v[156:159], a[172:175]
    ds_read_b64_tr_b16 v[68:69], v20 offset:96
    ds_read_b64_tr_b16 v[70:71], v20 offset:2400
    s_waitcnt lgkmcnt(12)
    v_mfma_f32_16x16x32_bf16 a[176:179], v[44:47], v[84:87], a[176:179]
    v_mfma_f32_16x16x32_bf16 a[180:183], v[44:47], v[156:159], a[180:183]
    ds_read_b64_tr_b16 v[40:41], v19 offset:128
    ds_read_b64_tr_b16 v[42:43], v19 offset:2432
    s_waitcnt lgkmcnt(12)
    v_mfma_f32_16x16x32_bf16 a[184:187], v[48:51], v[84:87], a[184:187]
    v_mfma_f32_16x16x32_bf16 a[188:191], v[48:51], v[156:159], a[188:191]
    ds_read_b64_tr_b16 v[44:45], v20 offset:160
    ds_read_b64_tr_b16 v[46:47], v20 offset:2464
    s_waitcnt lgkmcnt(12)
    v_mfma_f32_16x16x32_bf16 a[192:195], v[52:55], v[84:87], a[192:195]
    v_mfma_f32_16x16x32_bf16 a[196:199], v[52:55], v[156:159], a[196:199]
    ds_read_b64_tr_b16 v[48:49], v19 offset:192
    ds_read_b64_tr_b16 v[50:51], v19 offset:2496
    s_waitcnt lgkmcnt(12)
    v_mfma_f32_16x16x32_bf16 a[0:3], v[56:59], v[88:91], a[0:3]
    v_mfma_f32_16x16x32_bf16 a[4:7], v[56:59], v[160:163], a[4:7]
    ds_read_b64_tr_b16 v[52:53], v20 offset:224
    ds_read_b64_tr_b16 v[54:55], v20 offset:2528
    s_waitcnt lgkmcnt(12)
    v_mfma_f32_16x16x32_bf16 a[8:11], v[60:63], v[88:91], a[8:11]
    v_mfma_f32_16x16x32_bf16 a[12:15], v[60:63], v[160:163], a[12:15]
    ds_read_b64_tr_b16 v[56:57], v19 offset:256
    ds_read_b64_tr_b16 v[58:59], v19 offset:2560
    s_waitcnt lgkmcnt(12)
    v_mfma_f32_16x16x32_bf16 a[16:19], v[64:67], v[88:91], a[16:19]
    v_mfma_f32_16x16x32_bf16 a[20:23], v[64:67], v[160:163], a[20:23]
    ds_read_b64_tr_b16 v[60:61], v20 offset:288
    ds_read_b64_tr_b16 v[62:63], v20 offset:2592
    s_waitcnt lgkmcnt(12)
    v_mfma_f32_16x16x32_bf16 a[24:27], v[68:71], v[88:91], a[24:27]
    v_mfma_f32_16x16x32_bf16 a[28:31], v[68:71], v[160:163], a[28:31]
    ds_read_b64_tr_b16 v[64:65], v19 offset:320
    ds_read_b64_tr_b16 v[66:67], v19 offset:2624
    s_waitcnt lgkmcnt(12)
    v_mfma_f32_16x16x32_bf16 a[32:35], v[40:43], v[88:91], a[32:35]
    v_mfma_f32_16x16x32_bf16 a[36:39], v[40:43], v[160:163], a[36:39]
    ds_read_b64_tr_b16 v[68:69], v20 offset:352
    ds_read_b64_tr_b16 v[70:71], v20 offset:2656
    s_waitcnt lgkmcnt(12)
    v_mfma_f32_16x16x32_bf16 a[40:43], v[44:47], v[88:91], a[40:43]
    v_mfma_f32_16x16x32_bf16 a[44:47], v[44:47], v[160:163], a[44:47]
    ds_read_b64_tr_b16 v[40:41], v19 offset:384
    ds_read_b64_tr_b16 v[42:43], v19 offset:2688
    s_waitcnt lgkmcnt(12)
    v_mfma_f32_16x16x32_bf16 a[48:51], v[48:51], v[88:91], a[48:51]
    v_mfma_f32_16x16x32_bf16 a[52:55], v[48:51], v[160:163], a[52:55]
    ds_read_b64_tr_b16 v[44:45], v20 offset:416
    ds_read_b64_tr_b16 v[46:47], v20 offset:2720
    s_waitcnt lgkmcnt(12)
    v_mfma_f32_16x16x32_bf16 a[56:59], v[52:55], v[88:91], a[56:59]
    v_mfma_f32_16x16x32_bf16 a[60:63], v[52:55], v[160:163], a[60:63]
    ds_read_b64_tr_b16 v[48:49], v19 offset:448
    ds_read_b64_tr_b16 v[50:51], v19 offset:2752
    s_waitcnt lgkmcnt(12)
    v_mfma_f32_16x16x32_bf16 a[64:67], v[56:59], v[88:91], a[64:67]
    v_mfma_f32_16x16x32_bf16 a[68:71], v[56:59], v[160:163], a[68:71]
    ds_read_b64_tr_b16 v[52:53], v20 offset:480
    ds_read_b64_tr_b16 v[54:55], v20 offset:2784
    s_waitcnt lgkmcnt(12)
    v_mfma_f32_16x16x32_bf16 a[72:75], v[60:63], v[88:91], a[72:75]
    v_mfma_f32_16x16x32_bf16 a[76:79], v[60:63], v[160:163], a[76:79]
    ds_read_b64_tr_b16 v[56:57], v19 offset:512
    ds_read_b64_tr_b16 v[58:59], v19 offset:2816
    s_waitcnt lgkmcnt(12)
    v_mfma_f32_16x16x32_bf16 a[80:83], v[64:67], v[88:91], a[80:83]
    v_mfma_f32_16x16x32_bf16 a[84:87], v[64:67], v[160:163], a[84:87]
    ds_read_b64_tr_b16 v[60:61], v20 offset:544
    ds_read_b64_tr_b16 v[62:63], v20 offset:2848
    s_waitcnt lgkmcnt(12)
    v_mfma_f32_16x16x32_bf16 a[88:91], v[68:71], v[88:91], a[88:91]
    v_mfma_f32_16x16x32_bf16 a[92:95], v[68:71], v[160:163], a[92:95]
    ds_read_b64_tr_b16 v[64:65], v21 offset:0
    ds_read_b64_tr_b16 v[66:67], v21 offset:1024
    s_waitcnt lgkmcnt(12)
    v_mfma_f32_16x16x32_bf16 a[96:99], v[40:43], v[88:91], a[96:99]
    v_mfma_f32_16x16x32_bf16 a[100:103], v[40:43], v[160:163], a[100:103]
    ds_read_b64_tr_b16 v[68:69], v22 offset:0
    ds_read_b64_tr_b16 v[70:71], v22 offset:1024
    s_waitcnt lgkmcnt(12)
    v_mfma_f32_16x16x32_bf16 a[104:107], v[44:47], v[88:91], a[104:107]
    v_mfma_f32_16x16x32_bf16 a[108:111], v[44:47], v[160:163], a[108:111]
    ds_read_b64_tr_b16 v[40:41], v23 offset:0
    ds_read_b64_tr_b16 v[42:43], v23 offset:1024
    s_waitcnt lgkmcnt(12)
    v_mfma_f32_16x16x32_bf16 a[112:115], v[48:51], v[88:91], a[112:115]
    v_mfma_f32_16x16x32_bf16 a[116:119], v[48:51], v[160:163], a[116:119]
    ds_read_b64_tr_b16 v[44:45], v24 offset:0
    ds_read_b64_tr_b16 v[46:47], v24 offset:1024
    s_waitcnt lgkmcnt(12)
    v_mfma_f32_16x16x32_bf16 a[120:123], v[52:55], v[88:91], a[120:123]
    v_mfma_f32_16x16x32_bf16 a[124:127], v[52:55], v[160:163], a[124:127]
    ds_read_b64_tr_b16 v[48:49], v25 offset:0
    ds_read_b64_tr_b16 v[50:51], v25 offset:1024
    s_waitcnt lgkmcnt(12)
    v_mfma_f32_16x16x32_bf16 a[128:131], v[56:59], v[88:91], a[128:131]
    v_mfma_f32_16x16x32_bf16 a[132:135], v[56:59], v[160:163], a[132:135]
    ds_read_b64_tr_b16 v[52:53], v26 offset:0
    ds_read_b64_tr_b16 v[54:55], v26 offset:1024
    s_waitcnt lgkmcnt(12)
    v_mfma_f32_16x16x32_bf16 a[136:139], v[60:63], v[88:91], a[136:139]
    v_mfma_f32_16x16x32_bf16 a[140:143], v[60:63], v[160:163], a[140:143]
    ds_read_b64_tr_b16 v[56:57], v27 offset:0
    ds_read_b64_tr_b16 v[58:59], v27 offset:1024
    s_waitcnt lgkmcnt(12)
    v_mfma_f32_16x16x32_bf16 a[144:147], v[64:67], v[88:91], a[144:147]
    v_mfma_f32_16x16x32_bf16 a[148:151], v[64:67], v[160:163], a[148:151]
    s_waitcnt vmcnt(7)
    s_barrier
    s_add_u32 m0, s57, 55296
    s_nop 0
    buffer_load_dwordx4 v12, s[20:23], s47 offen lds
    s_add_u32 m0, s57, 59392
    s_nop 0
    buffer_load_dwordx4 v13, s[20:23], s47 offen lds
    s_add_u32 m0, s57, 63488
    s_nop 0
    buffer_load_dwordx4 v14, s[20:23], s47 offen lds
    s_add_u32 m0, s57, 67584
    s_nop 0
    buffer_load_dwordx4 v15, s[20:23], s47 offen lds
    s_mul_i32 s53, s50, 3
    s_add_u32 m0, s49, s53
    s_nop 0
    buffer_load_dwordx4 v16, s[40:43], s47 offen lds
    s_add_u32 m0, s58, 30720
    s_nop 0
    buffer_load_dwordx4 v17, s[24:27], s48 offen lds
    s_add_u32 m0, s58, 34816
    s_nop 0
    buffer_load_dwordx4 v18, s[24:27], s48 offen lds
    s_add_u32 s47, s47, 294912
    s_cmp_eq_u32 s47, 5308416
    s_cselect_b32 s47, 0, s47
    s_add_u32 s48, s48, 110592
    s_cmp_eq_u32 s48, 1990656
    s_cselect_b32 s48, 0, s48
    ds_read_b64_tr_b16 v[60:61], v19 offset:18432
    ds_read_b64_tr_b16 v[62:63], v19 offset:20736
    s_waitcnt lgkmcnt(12)
    v_mfma_f32_16x16x32_bf16 a[152:155], v[68:71], v[88:91], a[152:155]
    v_mfma_f32_16x16x32_bf16 a[156:159], v[68:71], v[160:163], a[156:159]
    ds_read_b64_tr_b16 v[64:65], v20 offset:18464
    ds_read_b64_tr_b16 v[66:67], v20 offset:20768
    s_waitcnt lgkmcnt(12)
    v_mfma_f32_16x16x32_bf16 a[160:163], v[40:43], v[88:91], a[160:163]
    v_mfma_f32_16x16x32_bf16 a[164:167], v[40:43], v[160:163], a[164:167]
    ds_read_b64_tr_b16 v[68:69], v19 offset:18496
    ds_read_b64_tr_b16 v[70:71], v19 offset:20800
    s_waitcnt lgkmcnt(12)
    v_mfma_f32_16x16x32_bf16 a[168:171], v[44:47], v[88:91], a[168:171]
    v_mfma_f32_16x16x32_bf16 a[172:175], v[44:47], v[160:163], a[172:175]
    ds_read_b64_tr_b16 v[40:41], v20 offset:18528
    ds_read_b64_tr_b16 v[42:43], v20 offset:20832
    s_waitcnt lgkmcnt(12)
    v_mfma_f32_16x16x32_bf16 a[176:179], v[48:51], v[88:91], a[176:179]
    v_mfma_f32_16x16x32_bf16 a[180:183], v[48:51], v[160:163], a[180:183]
    ds_read_b64_tr_b16 v[44:45], v19 offset:18560
    ds_read_b64_tr_b16 v[46:47], v19 offset:20864
    s_waitcnt lgkmcnt(12)
    v_mfma_f32_16x16x32_bf16 a[184:187], v[52:55], v[88:91], a[184:187]
    v_mfma_f32_16x16x32_bf16 a[188:191], v[52:55], v[160:163], a[188:191]
    ds_read_b64_tr_b16 v[48:49], v20 offset:18592
    ds_read_b64_tr_b16 v[50:51], v20 offset:20896
    s_waitcnt lgkmcnt(12)
    v_mfma_f32_16x16x32_bf16 a[192:195], v[56:59], v[88:91], a[192:195]
    v_mfma_f32_16x16x32_bf16 a[196:199], v[56:59], v[160:163], a[196:199]
    ds_read_b64_tr_b16 v[52:53], v19 offset:18624
    ds_read_b64_tr_b16 v[54:55], v19 offset:20928
    s_waitcnt lgkmcnt(12)
    v_mfma_f32_16x16x32_bf16 a[0:3], v[60:63], v[92:95], a[0:3]
    v_mfma_f32_16x16x32_bf16 a[4:7], v[60:63], v[164:167], a[4:7]
    ds_read_b64_tr_b16 v[56:57], v20 offset:18656
    ds_read_b64_tr_b16 v[58:59], v20 offset:20960
    s_waitcnt lgkmcnt(12)
    v_mfma_f32_16x16x32_bf16 a[8:11], v[64:67], v[92:95], a[8:11]
    v_mfma_f32_16x16x32_bf16 a[12:15], v[64:67], v[164:167], a[12:15]
    ds_read_b64_tr_b16 v[60:61], v19 offset:18688
    ds_read_b64_tr_b16 v[62:63], v19 offset:20992
    s_waitcnt lgkmcnt(12)
    v_mfma_f32_16x16x32_bf16 a[16:19], v[68:71], v[92:95], a[16:19]
    v_mfma_f32_16x16x32_bf16 a[20:23], v[68:71], v[164:167], a[20:23]
    ds_read_b64_tr_b16 v[64:65], v20 offset:18720
    ds_read_b64_tr_b16 v[66:67], v20 offset:21024
    s_waitcnt lgkmcnt(12)
    v_mfma_f32_16x16x32_bf16 a[24:27], v[40:43], v[92:95], a[24:27]
    v_mfma_f32_16x16x32_bf16 a[28:31], v[40:43], v[164:167], a[28:31]
    ds_read_b64_tr_b16 v[68:69], v19 offset:18752
    ds_read_b64_tr_b16 v[70:71], v19 offset:21056
    s_waitcnt lgkmcnt(12)
    v_mfma_f32_16x16x32_bf16 a[32:35], v[44:47], v[92:95], a[32:35]
    v_mfma_f32_16x16x32_bf16 a[36:39], v[44:47], v[164:167], a[36:39]
    ds_read_b64_tr_b16 v[40:41], v20 offset:18784
    ds_read_b64_tr_b16 v[42:43], v20 offset:21088
    s_waitcnt lgkmcnt(12)
    v_mfma_f32_16x16x32_bf16 a[40:43], v[48:51], v[92:95], a[40:43]
    v_mfma_f32_16x16x32_bf16 a[44:47], v[48:51], v[164:167], a[44:47]
    ds_read_b64_tr_b16 v[44:45], v19 offset:18816
    ds_read_b64_tr_b16 v[46:47], v19 offset:21120
    s_waitcnt lgkmcnt(12)
    v_mfma_f32_16x16x32_bf16 a[48:51], v[52:55], v[92:95], a[48:51]
    v_mfma_f32_16x16x32_bf16 a[52:55], v[52:55], v[164:167], a[52:55]
    ds_read_b64_tr_b16 v[48:49], v20 offset:18848
    ds_read_b64_tr_b16 v[50:51], v20 offset:21152
    s_waitcnt lgkmcnt(12)
    v_mfma_f32_16x16x32_bf16 a[56:59], v[56:59], v[92:95], a[56:59]
    v_mfma_f32_16x16x32_bf16 a[60:63], v[56:59], v[164:167], a[60:63]
    ds_read_b64_tr_b16 v[52:53], v19 offset:18880
    ds_read_b64_tr_b16 v[54:55], v19 offset:21184
    s_waitcnt lgkmcnt(12)
    v_mfma_f32_16x16x32_bf16 a[64:67], v[60:63], v[92:95], a[64:67]
    v_mfma_f32_16x16x32_bf16 a[68:71], v[60:63], v[164:167], a[68:71]
    ds_read_b64_tr_b16 v[56:57], v20 offset:18912
    ds_read_b64_tr_b16 v[58:59], v20 offset:21216
    s_waitcnt lgkmcnt(12)
    v_mfma_f32_16x16x32_bf16 a[72:75], v[64:67], v[92:95], a[72:75]
    v_mfma_f32_16x16x32_bf16 a[76:79], v[64:67], v[164:167], a[76:79]
    ds_read_b64_tr_b16 v[60:61], v19 offset:18944
    ds_read_b64_tr_b16 v[62:63], v19 offset:21248
    s_waitcnt lgkmcnt(12)
    v_mfma_f32_16x16x32_bf16 a[80:83], v[68:71], v[92:95], a[80:83]
    v_mfma_f32_16x16x32_bf16 a[84:87], v[68:71], v[164:167], a[84:87]
    ds_read_b64_tr_b16 v[64:65], v20 offset:18976
    ds_read_b64_tr_b16 v[66:67], v20 offset:21280
    s_waitcnt lgkmcnt(12)
    v_mfma_f32_16x16x32_bf16 a[88:91], v[40:43], v[92:95], a[88:91]
    v_mfma_f32_16x16x32_bf16 a[92:95], v[40:43], v[164:167], a[92:95]
    ds_read_b64_tr_b16 v[68:69], v21 offset:10240
    ds_read_b64_tr_b16 v[70:71], v21 offset:11264
    s_waitcnt lgkmcnt(12)
    v_mfma_f32_16x16x32_bf16 a[96:99], v[44:47], v[92:95], a[96:99]
    v_mfma_f32_16x16x32_bf16 a[100:103], v[44:47], v[164:167], a[100:103]
    ds_read_b64_tr_b16 v[40:41], v22 offset:10240
    ds_read_b64_tr_b16 v[42:43], v22 offset:11264
    s_waitcnt lgkmcnt(12)
    v_mfma_f32_16x16x32_bf16 a[104:107], v[48:51], v[92:95], a[104:107]
    v_mfma_f32_16x16x32_bf16 a[108:111], v[48:51], v[164:167], a[108:111]
    ds_read_b64_tr_b16 v[44:45], v23 offset:10240
    ds_read_b64_tr_b16 v[46:47], v23 offset:11264
    s_waitcnt lgkmcnt(12)
    v_mfma_f32_16x16x32_bf16 a[112:115], v[52:55], v[92:95], a[112:115]
    v_mfma_f32_16x16x32_bf16 a[116:119], v[52:55], v[164:167], a[116:119]
    ds_read_b64_tr_b16 v[48:49], v24 offset:10240
    ds_read_b64_tr_b16 v[50:51], v24 offset:11264
    s_waitcnt lgkmcnt(12)
    v_mfma_f32_16x16x32_bf16 a[120:123], v[56:59], v[92:95], a[120:123]
    v_mfma_f32_16x16x32_bf16 a[124:127], v[56:59], v[164:167], a[124:127]
    ds_read_b64_tr_b16 v[52:53], v25 offset:10240
    ds_read_b64_tr_b16 v[54:55], v25 offset:11264
    s_waitcnt lgkmcnt(12)
    v_mfma_f32_16x16x32_bf16 a[128:131], v[60:63], v[92:95], a[128:131]
    v_mfma_f32_16x16x32_bf16 a[132:135], v[60:63], v[164:167], a[132:135]
    ds_read_b64_tr_b16 v[56:57], v26 offset:10240
    ds_read_b64_tr_b16 v[58:59], v26 offset:11264
    s_waitcnt lgkmcnt(12)
    v_mfma_f32_16x16x32_bf16 a[136:139], v[64:67], v[92:95], a[136:139]
    v_mfma_f32_16x16x32_bf16 a[140:143], v[64:67], v[164:167], a[140:143]
    ds_read_b64_tr_b16 v[60:61], v27 offset:10240
    ds_read_b64_tr_b16 v[62:63], v27 offset:11264
    s_waitcnt lgkmcnt(12)
    v_mfma_f32_16x16x32_bf16 a[144:147], v[68:71], v[92:95], a[144:147]
    v_mfma_f32_16x16x32_bf16 a[148:151], v[68:71], v[164:167], a[148:151]
    s_waitcnt vmcnt(7)
    s_barrier
    s_add_u32 m0, s57, 0
    s_nop 0
    buffer_load_dwordx4 v12, s[20:23], s47 offen lds
    s_add_u32 m0, s57, 4096
    s_nop 0
    buffer_load_dwordx4 v13, s[20:23], s47 offen lds
    s_add_u32 m0, s57, 8192
    s_nop 0
    buffer_load_dwordx4 v14, s[20:23], s47 offen lds
    s_add_u32 m0, s57, 12288
    s_nop 0
    buffer_load_dwordx4 v15, s[20:23], s47 offen lds
    s_mul_i32 s53, s50, 0
    s_add_u32 m0, s49, s53
    s_nop 0
    buffer_load_dwordx4 v16, s[40:43], s47 offen lds
    s_add_u32 m0, s58, 0
    s_nop 0
    buffer_load_dwordx4 v17, s[24:27], s48 offen lds
    s_add_u32 m0, s58, 4096
    s_nop 0
    buffer_load_dwordx4 v18, s[24:27], s48 offen lds
    s_add_u32 s47, s47, 294912
    s_cmp_eq_u32 s47, 5308416
    s_cselect_b32 s47, 0, s47
    s_add_u32 s48, s48, 110592
    s_cmp_eq_u32 s48, 1990656
    s_cselect_b32 s48, 0, s48
    ds_read_b64_tr_b16 v[64:65], v19 offset:36864
    ds_read_b64_tr_b16 v[66:67], v19 offset:39168
    s_waitcnt lgkmcnt(12)
    v_mfma_f32_16x16x32_bf16 a[152:155], v[40:43], v[92:95], a[152:155]
    v_mfma_f32_16x16x32_bf16 a[156:159], v[40:43], v[164:167], a[156:159]
    ds_read_b64_tr_b16 v[68:69], v20 offset:36896
    ds_read_b64_tr_b16 v[70:71], v20 offset:39200
    s_waitcnt lgkmcnt(12)
    v_mfma_f32_16x16x32_bf16 a[160:163], v[44:47], v[92:95], a[160:163]
    v_mfma_f32_16x16x32_bf16 a[164:167], v[44:47], v[164:167], a[164:167]
    ds_read_b64_tr_b16 v[40:41], v19 offset:36928
    ds_read_b64_tr_b16 v[42:43], v19 offset:39232
    s_waitcnt lgkmcnt(12)
    v_mfma_f32_16x16x32_bf16 a[168:171], v[48:51], v[92:95], a[168:171]
    v_mfma_f32_16x16x32_bf16 a[172:175], v[48:51], v[164:167], a[172:175]
    ds_read_b64_tr_b16 v[44:45], v20 offset:36960
    ds_read_b64_tr_b16 v[46:47], v20 offset:39264
    s_waitcnt lgkmcnt(12)
    v_mfma_f32_16x16x32_bf16 a[176:179], v[52:55], v[92:95], a[176:179]
    v_mfma_f32_16x16x32_bf16 a[180:183], v[52:55], v[164:167], a[180:183]
    ds_read_b64_tr_b16 v[48:49], v19 offset:36992
    ds_read_b64_tr_b16 v[50:51], v19 offset:39296
    s_waitcnt lgkmcnt(12)
    v_mfma_f32_16x16x32_bf16 a[184:187], v[56:59], v[92:95], a[184:187]
    v_mfma_f32_16x16x32_bf16 a[188:191], v[56:59], v[164:167], a[188:191]
    ds_read_b64_tr_b16 v[52:53], v20 offset:37024
    ds_read_b64_tr_b16 v[54:55], v20 offset:39328
    s_waitcnt lgkmcnt(12)
    v_mfma_f32_16x16x32_bf16 a[192:195], v[60:63], v[92:95], a[192:195]
    v_mfma_f32_16x16x32_bf16 a[196:199], v[60:63], v[164:167], a[196:199]
    ds_read_b64_tr_b16 v[56:57], v19 offset:37056
    ds_read_b64_tr_b16 v[58:59], v19 offset:39360
    s_waitcnt lgkmcnt(12)
    v_mfma_f32_16x16x32_bf16 a[0:3], v[64:67], v[96:99], a[0:3]
    v_mfma_f32_16x16x32_bf16 a[4:7], v[64:67], v[168:171], a[4:7]
    ds_read_b64_tr_b16 v[60:61], v20 offset:37088
    ds_read_b64_tr_b16 v[62:63], v20 offset:39392
    s_waitcnt lgkmcnt(12)
    v_mfma_f32_16x16x32_bf16 a[8:11], v[68:71], v[96:99], a[8:11]
    v_mfma_f32_16x16x32_bf16 a[12:15], v[68:71], v[168:171], a[12:15]
    ds_read_b64_tr_b16 v[64:65], v19 offset:37120
    ds_read_b64_tr_b16 v[66:67], v19 offset:39424
    s_waitcnt lgkmcnt(12)
    v_mfma_f32_16x16x32_bf16 a[16:19], v[40:43], v[96:99], a[16:19]
    v_mfma_f32_16x16x32_bf16 a[20:23], v[40:43], v[168:171], a[20:23]
    ds_read_b64_tr_b16 v[68:69], v20 offset:37152
    ds_read_b64_tr_b16 v[70:71], v20 offset:39456
    s_waitcnt lgkmcnt(12)
    v_mfma_f32_16x16x32_bf16 a[24:27], v[44:47], v[96:99], a[24:27]
    v_mfma_f32_16x16x32_bf16 a[28:31], v[44:47], v[168:171], a[28:31]
    ds_read_b64_tr_b16 v[40:41], v19 offset:37184
    ds_read_b64_tr_b16 v[42:43], v19 offset:39488
    s_waitcnt lgkmcnt(12)
    v_mfma_f32_16x16x32_bf16 a[32:35], v[48:51], v[96:99], a[32:35]
    v_mfma_f32_16x16x32_bf16 a[36:39], v[48:51], v[168:171], a[36:39]
    ds_read_b64_tr_b16 v[44:45], v20 offset:37216
    ds_read_b64_tr_b16 v[46:47], v20 offset:39520
    s_waitcnt lgkmcnt(12)
    v_mfma_f32_16x16x32_bf16 a[40:43], v[52:55], v[96:99], a[40:43]
    v_mfma_f32_16x16x32_bf16 a[44:47], v[52:55], v[168:171], a[44:47]
    ds_read_b64_tr_b16 v[48:49], v19 offset:37248
    ds_read_b64_tr_b16 v[50:51], v19 offset:39552
    s_waitcnt lgkmcnt(12)
    v_mfma_f32_16x16x32_bf16 a[48:51], v[56:59], v[96:99], a[48:51]
    v_mfma_f32_16x16x32_bf16 a[52:55], v[56:59], v[168:171], a[52:55]
    ds_read_b64_tr_b16 v[52:53], v20 offset:37280
    ds_read_b64_tr_b16 v[54:55], v20 offset:39584
    s_waitcnt lgkmcnt(12)
    v_mfma_f32_16x16x32_bf16 a[56:59], v[60:63], v[96:99], a[56:59]
    v_mfma_f32_16x16x32_bf16 a[60:63], v[60:63], v[168:171], a[60:63]
    ds_read_b64_tr_b16 v[56:57], v19 offset:37312
    ds_read_b64_tr_b16 v[58:59], v19 offset:39616
    s_waitcnt lgkmcnt(12)
    v_mfma_f32_16x16x32_bf16 a[64:67], v[64:67], v[96:99], a[64:67]
    v_mfma_f32_16x16x32_bf16 a[68:71], v[64:67], v[168:171], a[68:71]
    ds_read_b64_tr_b16 v[60:61], v20 offset:37344
    ds_read_b64_tr_b16 v[62:63], v20 offset:39648
    s_waitcnt lgkmcnt(12)
    v_mfma_f32_16x16x32_bf16 a[72:75], v[68:71], v[96:99], a[72:75]
    v_mfma_f32_16x16x32_bf16 a[76:79], v[68:71], v[168:171], a[76:79]
    ds_read_b64_tr_b16 v[64:65], v19 offset:37376
    ds_read_b64_tr_b16 v[66:67], v19 offset:39680
    s_waitcnt lgkmcnt(12)
    v_mfma_f32_16x16x32_bf16 a[80:83], v[40:43], v[96:99], a[80:83]
    v_mfma_f32_16x16x32_bf16 a[84:87], v[40:43], v[168:171], a[84:87]
    ds_read_b64_tr_b16 v[68:69], v20 offset:37408
    ds_read_b64_tr_b16 v[70:71], v20 offset:39712
    s_waitcnt lgkmcnt(12)
    v_mfma_f32_16x16x32_bf16 a[88:91], v[44:47], v[96:99], a[88:91]
    v_mfma_f32_16x16x32_bf16 a[92:95], v[44:47], v[168:171], a[92:95]
    ds_read_b64_tr_b16 v[40:41], v21 offset:20480
    ds_read_b64_tr_b16 v[42:43], v21 offset:21504
    s_waitcnt lgkmcnt(12)
    v_mfma_f32_16x16x32_bf16 a[96:99], v[48:51], v[96:99], a[96:99]
    v_mfma_f32_16x16x32_bf16 a[100:103], v[48:51], v[168:171], a[100:103]
    ds_read_b64_tr_b16 v[44:45], v22 offset:20480
    ds_read_b64_tr_b16 v[46:47], v22 offset:21504
    s_waitcnt lgkmcnt(12)
    v_mfma_f32_16x16x32_bf16 a[104:107], v[52:55], v[96:99], a[104:107]
    v_mfma_f32_16x16x32_bf16 a[108:111], v[52:55], v[168:171], a[108:111]
    ds_read_b64_tr_b16 v[48:49], v23 offset:20480
    ds_read_b64_tr_b16 v[50:51], v23 offset:21504
    s_waitcnt lgkmcnt(12)
    v_mfma_f32_16x16x32_bf16 a[112:115], v[56:59], v[96:99], a[112:115]
    v_mfma_f32_16x16x32_bf16 a[116:119], v[56:59], v[168:171], a[116:119]
    ds_read_b64_tr_b16 v[52:53], v24 offset:20480
    ds_read_b64_tr_b16 v[54:55], v24 offset:21504
    s_waitcnt lgkmcnt(12)
    v_mfma_f32_16x16x32_bf16 a[120:123], v[60:63], v[96:99], a[120:123]
    v_mfma_f32_16x16x32_bf16 a[124:127], v[60:63], v[168:171], a[124:127]
    ds_read_b64_tr_b16 v[56:57], v25 offset:20480
    ds_read_b64_tr_b16 v[58:59], v25 offset:21504
    s_waitcnt lgkmcnt(12)
    v_mfma_f32_16x16x32_bf16 a[128:131], v[64:67], v[96:99], a[128:131]
    v_mfma_f32_16x16x32_bf16 a[132:135], v[64:67], v[168:171], a[132:135]
    ds_read_b64_tr_b16 v[60:61], v26 offset:20480
    ds_read_b64_tr_b16 v[62:63], v26 offset:21504
    s_waitcnt lgkmcnt(12)
    v_mfma_f32_16x16x32_bf16 a[136:139], v[68:71], v[96:99], a[136:139]
    v_mfma_f32_16x16x32_bf16 a[140:143], v[68:71], v[168:171], a[140:143]
    ds_read_b64_tr_b16 v[64:65], v27 offset:20480
    ds_read_b64_tr_b16 v[66:67], v27 offset:21504
    s_waitcnt lgkmcnt(12)
    v_mfma_f32_16x16x32_bf16 a[144:147], v[40:43], v[96:99], a[144:147]
    v_mfma_f32_16x16x32_bf16 a[148:151], v[40:43], v[168:171], a[148:151]
    s_waitcnt vmcnt(7)
    s_barrier
    s_add_u32 m0, s57, 18432
    s_nop 0
    buffer_load_dwordx4 v12, s[20:23], s47 offen lds
    s_add_u32 m0, s57, 22528
    s_nop 0
    buffer_load_dwordx4 v13, s[20:23], s47 offen lds
    s_add_u32 m0, s57, 26624
    s_nop 0
    buffer_load_dwordx4 v14, s[20:23], s47 offen lds
    s_add_u32 m0, s57, 30720
    s_nop 0
    buffer_load_dwordx4 v15, s[20:23], s47 offen lds
    s_mul_i32 s53, s50, 1
    s_add_u32 m0, s49, s53
    s_nop 0
    buffer_load_dwordx4 v16, s[40:43], s47 offen lds
    s_add_u32 m0, s58, 10240
    s_nop 0
    buffer_load_dwordx4 v17, s[24:27], s48 offen lds
    s_add_u32 m0, s58, 14336
    s_nop 0
    buffer_load_dwordx4 v18, s[24:27], s48 offen lds
    s_add_u32 s47, s47, 294912
    s_cmp_eq_u32 s47, 5308416
    s_cselect_b32 s47, 0, s47
    s_add_u32 s48, s48, 110592
    s_cmp_eq_u32 s48, 1990656
    s_cselect_b32 s48, 0, s48
    ds_read_b64_tr_b16 v[68:69], v19 offset:55296
    ds_read_b64_tr_b16 v[70:71], v19 offset:57600
    s_waitcnt lgkmcnt(12)
    v_mfma_f32_16x16x32_bf16 a[152:155], v[44:47], v[96:99], a[152:155]
    v_mfma_f32_16x16x32_bf16 a[156:159], v[44:47], v[168:171], a[156:159]
    ds_read_b64_tr_b16 v[40:41], v20 offset:55328
    ds_read_b64_tr_b16 v[42:43], v20 offset:57632
    s_waitcnt lgkmcnt(12)
    v_mfma_f32_16x16x32_bf16 a[160:163], v[48:51], v[96:99], a[160:163]
    v_mfma_f32_16x16x32_bf16 a[164:167], v[48:51], v[168:171], a[164:167]
    ds_read_b64_tr_b16 v[44:45], v19 offset:55360
    ds_read_b64_tr_b16 v[46:47], v19 offset:57664
    s_waitcnt lgkmcnt(12)
    v_mfma_f32_16x16x32_bf16 a[168:171], v[52:55], v[96:99], a[168:171]
    v_mfma_f32_16x16x32_bf16 a[172:175], v[52:55], v[168:171], a[172:175]
    ds_read_b64_tr_b16 v[48:49], v20 offset:55392
    ds_read_b64_tr_b16 v[50:51], v20 offset:57696
    s_waitcnt lgkmcnt(12)
    v_mfma_f32_16x16x32_bf16 a[176:179], v[56:59], v[96:99], a[176:179]
    v_mfma_f32_16x16x32_bf16 a[180:183], v[56:59], v[168:171], a[180:183]
    ds_read_b64_tr_b16 v[52:53], v19 offset:55424
    ds_read_b64_tr_b16 v[54:55], v19 offset:57728
    s_waitcnt lgkmcnt(12)
    v_mfma_f32_16x16x32_bf16 a[184:187], v[60:63], v[96:99], a[184:187]
    v_mfma_f32_16x16x32_bf16 a[188:191], v[60:63], v[168:171], a[188:191]
    ds_read_b64_tr_b16 v[56:57], v20 offset:55456
    ds_read_b64_tr_b16 v[58:59], v20 offset:57760
    s_waitcnt lgkmcnt(12)
    v_mfma_f32_16x16x32_bf16 a[192:195], v[64:67], v[96:99], a[192:195]
    v_mfma_f32_16x16x32_bf16 a[196:199], v[64:67], v[168:171], a[196:199]
    ds_read_b64_tr_b16 v[60:61], v19 offset:55488
    ds_read_b64_tr_b16 v[62:63], v19 offset:57792
    s_waitcnt lgkmcnt(12)
    v_mfma_f32_16x16x32_bf16 a[0:3], v[68:71], v[100:103], a[0:3]
    v_mfma_f32_16x16x32_bf16 a[4:7], v[68:71], v[172:175], a[4:7]
    ds_read_b64_tr_b16 v[64:65], v20 offset:55520
    ds_read_b64_tr_b16 v[66:67], v20 offset:57824
    s_waitcnt lgkmcnt(12)
    v_mfma_f32_16x16x32_bf16 a[8:11], v[40:43], v[100:103], a[8:11]
    v_mfma_f32_16x16x32_bf16 a[12:15], v[40:43], v[172:175], a[12:15]
    ds_read_b64_tr_b16 v[68:69], v19 offset:55552
    ds_read_b64_tr_b16 v[70:71], v19 offset:57856
    s_waitcnt lgkmcnt(12)
    v_mfma_f32_16x16x32_bf16 a[16:19], v[44:47], v[100:103], a[16:19]
    v_mfma_f32_16x16x32_bf16 a[20:23], v[44:47], v[172:175], a[20:23]
    ds_read_b64_tr_b16 v[40:41], v20 offset:55584
    ds_read_b64_tr_b16 v[42:43], v20 offset:57888
    s_waitcnt lgkmcnt(12)
    v_mfma_f32_16x16x32_bf16 a[24:27], v[48:51], v[100:103], a[24:27]
    v_mfma_f32_16x16x32_bf16 a[28:31], v[48:51], v[172:175], a[28:31]
    ds_read_b64_tr_b16 v[44:45], v19 offset:55616
    ds_read_b64_tr_b16 v[46:47], v19 offset:57920
    s_waitcnt lgkmcnt(12)
    v_mfma_f32_16x16x32_bf16 a[32:35], v[52:55], v[100:103], a[32:35]
    v_mfma_f32_16x16x32_bf16 a[36:39], v[52:55], v[172:175], a[36:39]
    ds_read_b64_tr_b16 v[48:49], v20 offset:55648
    ds_read_b64_tr_b16 v[50:51], v20 offset:57952
    s_waitcnt lgkmcnt(12)
    v_mfma_f32_16x16x32_bf16 a[40:43], v[56:59], v[100:103], a[40:43]
    v_mfma_f32_16x16x32_bf16 a[44:47], v[56:59], v[172:175], a[44:47]
    ds_read_b64_tr_b16 v[52:53], v19 offset:55680
    ds_read_b64_tr_b16 v[54:55], v19 offset:57984
    s_waitcnt lgkmcnt(12)
    v_mfma_f32_16x16x32_bf16 a[48:51], v[60:63], v[100:103], a[48:51]
    v_mfma_f32_16x16x32_bf16 a[52:55], v[60:63], v[172:175], a[52:55]
    ds_read_b64_tr_b16 v[56:57], v20 offset:55712
    ds_read_b64_tr_b16 v[58:59], v20 offset:58016
    s_waitcnt lgkmcnt(12)
    v_mfma_f32_16x16x32_bf16 a[56:59], v[64:67], v[100:103], a[56:59]
    v_mfma_f32_16x16x32_bf16 a[60:63], v[64:67], v[172:175], a[60:63]
    ds_read_b64_tr_b16 v[60:61], v19 offset:55744
    ds_read_b64_tr_b16 v[62:63], v19 offset:58048
    s_waitcnt lgkmcnt(12)
    v_mfma_f32_16x16x32_bf16 a[64:67], v[68:71], v[100:103], a[64:67]
    v_mfma_f32_16x16x32_bf16 a[68:71], v[68:71], v[172:175], a[68:71]
    ds_read_b64_tr_b16 v[64:65], v20 offset:55776
    ds_read_b64_tr_b16 v[66:67], v20 offset:58080
    s_waitcnt lgkmcnt(12)
    v_mfma_f32_16x16x32_bf16 a[72:75], v[40:43], v[100:103], a[72:75]
    v_mfma_f32_16x16x32_bf16 a[76:79], v[40:43], v[172:175], a[76:79]
    ds_read_b64_tr_b16 v[68:69], v19 offset:55808
    ds_read_b64_tr_b16 v[70:71], v19 offset:58112
    s_waitcnt lgkmcnt(12)
    v_mfma_f32_16x16x32_bf16 a[80:83], v[44:47], v[100:103], a[80:83]
    v_mfma_f32_16x16x32_bf16 a[84:87], v[44:47], v[172:175], a[84:87]
    ds_read_b64_tr_b16 v[40:41], v20 offset:55840
    ds_read_b64_tr_b16 v[42:43], v20 offset:58144
    s_waitcnt lgkmcnt(12)
    v_mfma_f32_16x16x32_bf16 a[88:91], v[48:51], v[100:103], a[88:91]
    v_mfma_f32_16x16x32_bf16 a[92:95], v[48:51], v[172:175], a[92:95]
    ds_read_b64_tr_b16 v[44:45], v21 offset:30720
    ds_read_b64_tr_b16 v[46:47], v21 offset:31744
    s_waitcnt lgkmcnt(12)
    v_mfma_f32_16x16x32_bf16 a[96:99], v[52:55], v[100:103], a[96:99]
    v_mfma_f32_16x16x32_bf16 a[100:103], v[52:55], v[172:175], a[100:103]
    ds_read_b64_tr_b16 v[48:49], v22 offset:30720
    ds_read_b64_tr_b16 v[50:51], v22 offset:31744
    s_waitcnt lgkmcnt(12)
    v_mfma_f32_16x16x32_bf16 a[104:107], v[56:59], v[100:103], a[104:107]
    v_mfma_f32_16x16x32_bf16 a[108:111], v[56:59], v[172:175], a[108:111]
    ds_read_b64_tr_b16 v[52:53], v23 offset:30720
    ds_read_b64_tr_b16 v[54:55], v23 offset:31744
    s_waitcnt lgkmcnt(12)
    v_mfma_f32_16x16x32_bf16 a[112:115], v[60:63], v[100:103], a[112:115]
    v_mfma_f32_16x16x32_bf16 a[116:119], v[60:63], v[172:175], a[116:119]
    ds_read_b64_tr_b16 v[56:57], v24 offset:30720
    ds_read_b64_tr_b16 v[58:59], v24 offset:31744
    s_waitcnt lgkmcnt(12)
    v_mfma_f32_16x16x32_bf16 a[120:123], v[64:67], v[100:103], a[120:123]
    v_mfma_f32_16x16x32_bf16 a[124:127], v[64:67], v[172:175], a[124:127]
    ds_read_b64_tr_b16 v[60:61], v25 offset:30720
    ds_read_b64_tr_b16 v[62:63], v25 offset:31744
    s_waitcnt lgkmcnt(12)
    v_mfma_f32_16x16x32_bf16 a[128:131], v[68:71], v[100:103], a[128:131]
    v_mfma_f32_16x16x32_bf16 a[132:135], v[68:71], v[172:175], a[132:135]
    ds_read_b64_tr_b16 v[64:65], v26 offset:30720
    ds_read_b64_tr_b16 v[66:67], v26 offset:31744
    s_waitcnt lgkmcnt(12)
    v_mfma_f32_16x16x32_bf16 a[136:139], v[40:43], v[100:103], a[136:139]
    v_mfma_f32_16x16x32_bf16 a[140:143], v[40:43], v[172:175], a[140:143]
    ds_read_b64_tr_b16 v[68:69], v27 offset:30720
    ds_read_b64_tr_b16 v[70:71], v27 offset:31744
    s_waitcnt lgkmcnt(12)
    v_mfma_f32_16x16x32_bf16 a[144:147], v[44:47], v[100:103], a[144:147]
    v_mfma_f32_16x16x32_bf16 a[148:151], v[44:47], v[172:175], a[148:151]
    s_waitcnt vmcnt(7)
    s_barrier
    s_add_u32 m0, s57, 36864
    s_nop 0
    buffer_load_dwordx4 v12, s[20:23], s47 offen lds
    s_add_u32 m0, s57, 40960
    s_nop 0
    buffer_load_dwordx4 v13, s[20:23], s47 offen lds
    s_add_u32 m0, s57, 45056
    s_nop 0
    buffer_load_dwordx4 v14, s[20:23], s47 offen lds
    s_add_u32 m0, s57, 49152
    s_nop 0
    buffer_load_dwordx4 v15, s[20:23], s47 offen lds
    s_mul_i32 s53, s50, 2
    s_add_u32 m0, s49, s53
    s_nop 0
    buffer_load_dwordx4 v16, s[40:43], s47 offen lds
    s_add_u32 m0, s58, 20480
    s_nop 0
    buffer_load_dwordx4 v17, s[24:27], s48 offen lds
    s_add_u32 m0, s58, 24576
    s_nop 0
    buffer_load_dwordx4 v18, s[24:27], s48 offen lds
    s_add_u32 s47, s47, 294912
    s_cmp_eq_u32 s47, 5308416
    s_cselect_b32 s47, 0, s47
    s_add_u32 s48, s48, 110592
    s_cmp_eq_u32 s48, 1990656
    s_cselect_b32 s48, 0, s48
    ds_read_b64_tr_b16 v[40:41], v19 offset:0
    ds_read_b64_tr_b16 v[42:43], v19 offset:2304
    s_waitcnt lgkmcnt(12)
    v_mfma_f32_16x16x32_bf16 a[152:155], v[48:51], v[100:103], a[152:155]
    v_mfma_f32_16x16x32_bf16 a[156:159], v[48:51], v[172:175], a[156:159]
    ds_read_b64_tr_b16 v[44:45], v20 offset:32
    ds_read_b64_tr_b16 v[46:47], v20 offset:2336
    s_waitcnt lgkmcnt(12)
    v_mfma_f32_16x16x32_bf16 a[160:163], v[52:55], v[100:103], a[160:163]
    v_mfma_f32_16x16x32_bf16 a[164:167], v[52:55], v[172:175], a[164:167]
    ds_read_b64_tr_b16 v[48:49], v19 offset:64
    ds_read_b64_tr_b16 v[50:51], v19 offset:2368
    s_waitcnt lgkmcnt(12)
    v_mfma_f32_16x16x32_bf16 a[168:171], v[56:59], v[100:103], a[168:171]
    v_mfma_f32_16x16x32_bf16 a[172:175], v[56:59], v[172:175], a[172:175]
    ds_read_b64_tr_b16 v[52:53], v20 offset:96
    ds_read_b64_tr_b16 v[54:55], v20 offset:2400
    s_waitcnt lgkmcnt(12)
    v_mfma_f32_16x16x32_bf16 a[176:179], v[60:63], v[100:103], a[176:179]
    v_mfma_f32_16x16x32_bf16 a[180:183], v[60:63], v[172:175], a[180:183]
    ds_read_b64_tr_b16 v[56:57], v19 offset:128
    ds_read_b64_tr_b16 v[58:59], v19 offset:2432
    s_waitcnt lgkmcnt(12)
    v_mfma_f32_16x16x32_bf16 a[184:187], v[64:67], v[100:103], a[184:187]
    v_mfma_f32_16x16x32_bf16 a[188:191], v[64:67], v[172:175], a[188:191]
    ds_read_b64_tr_b16 v[60:61], v20 offset:160
    ds_read_b64_tr_b16 v[62:63], v20 offset:2464
    s_waitcnt lgkmcnt(12)
    v_mfma_f32_16x16x32_bf16 a[192:195], v[68:71], v[100:103], a[192:195]
    v_mfma_f32_16x16x32_bf16 a[196:199], v[68:71], v[172:175], a[196:199]
    ds_read_b64_tr_b16 v[64:65], v19 offset:192
    ds_read_b64_tr_b16 v[66:67], v19 offset:2496
    s_waitcnt lgkmcnt(12)
    v_mfma_f32_16x16x32_bf16 a[0:3], v[40:43], v[104:107], a[0:3]
    v_mfma_f32_16x16x32_bf16 a[4:7], v[40:43], v[176:179], a[4:7]
    ds_read_b64_tr_b16 v[68:69], v20 offset:224
    ds_read_b64_tr_b16 v[70:71], v20 offset:2528
    s_waitcnt lgkmcnt(12)
    v_mfma_f32_16x16x32_bf16 a[8:11], v[44:47], v[104:107], a[8:11]
    v_mfma_f32_16x16x32_bf16 a[12:15], v[44:47], v[176:179], a[12:15]
    ds_read_b64_tr_b16 v[40:41], v19 offset:256
    ds_read_b64_tr_b16 v[42:43], v19 offset:2560
    s_waitcnt lgkmcnt(12)
    v_mfma_f32_16x16x32_bf16 a[16:19], v[48:51], v[104:107], a[16:19]
    v_mfma_f32_16x16x32_bf16 a[20:23], v[48:51], v[176:179], a[20:23]
    ds_read_b64_tr_b16 v[44:45], v20 offset:288
    ds_read_b64_tr_b16 v[46:47], v20 offset:2592
    s_waitcnt lgkmcnt(12)
    v_mfma_f32_16x16x32_bf16 a[24:27], v[52:55], v[104:107], a[24:27]
    v_mfma_f32_16x16x32_bf16 a[28:31], v[52:55], v[176:179], a[28:31]
    ds_read_b64_tr_b16 v[48:49], v19 offset:320
    ds_read_b64_tr_b16 v[50:51], v19 offset:2624
    s_waitcnt lgkmcnt(12)
    v_mfma_f32_16x16x32_bf16 a[32:35], v[56:59], v[104:107], a[32:35]
    v_mfma_f32_16x16x32_bf16 a[36:39], v[56:59], v[176:179], a[36:39]
    ds_read_b64_tr_b16 v[52:53], v20 offset:352
    ds_read_b64_tr_b16 v[54:55], v20 offset:2656
    s_waitcnt lgkmcnt(12)
    v_mfma_f32_16x16x32_bf16 a[40:43], v[60:63], v[104:107], a[40:43]
    v_mfma_f32_16x16x32_bf16 a[44:47], v[60:63], v[176:179], a[44:47]
    ds_read_b64_tr_b16 v[56:57], v19 offset:384
    ds_read_b64_tr_b16 v[58:59], v19 offset:2688
    s_waitcnt lgkmcnt(12)
    v_mfma_f32_16x16x32_bf16 a[48:51], v[64:67], v[104:107], a[48:51]
    v_mfma_f32_16x16x32_bf16 a[52:55], v[64:67], v[176:179], a[52:55]
    ds_read_b64_tr_b16 v[60:61], v20 offset:416
    ds_read_b64_tr_b16 v[62:63], v20 offset:2720
    s_waitcnt lgkmcnt(12)
    v_mfma_f32_16x16x32_bf16 a[56:59], v[68:71], v[104:107], a[56:59]
    v_mfma_f32_16x16x32_bf16 a[60:63], v[68:71], v[176:179], a[60:63]
    ds_read_b64_tr_b16 v[64:65], v19 offset:448
    ds_read_b64_tr_b16 v[66:67], v19 offset:2752
    s_waitcnt lgkmcnt(12)
    v_mfma_f32_16x16x32_bf16 a[64:67], v[40:43], v[104:107], a[64:67]
    v_mfma_f32_16x16x32_bf16 a[68:71], v[40:43], v[176:179], a[68:71]
    ds_read_b64_tr_b16 v[68:69], v20 offset:480
    ds_read_b64_tr_b16 v[70:71], v20 offset:2784
    s_waitcnt lgkmcnt(12)
    v_mfma_f32_16x16x32_bf16 a[72:75], v[44:47], v[104:107], a[72:75]
    v_mfma_f32_16x16x32_bf16 a[76:79], v[44:47], v[176:179], a[76:79]
    ds_read_b64_tr_b16 v[40:41], v19 offset:512
    ds_read_b64_tr_b16 v[42:43], v19 offset:2816
    s_waitcnt lgkmcnt(12)
    v_mfma_f32_16x16x32_bf16 a[80:83], v[48:51], v[104:107], a[80:83]
    v_mfma_f32_16x16x32_bf16 a[84:87], v[48:51], v[176:179], a[84:87]
    ds_read_b64_tr_b16 v[44:45], v20 offset:544
    ds_read_b64_tr_b16 v[46:47], v20 offset:2848
    s_waitcnt lgkmcnt(12)
    v_mfma_f32_16x16x32_bf16 a[88:91], v[52:55], v[104:107], a[88:91]
    v_mfma_f32_16x16x32_bf16 a[92:95], v[52:55], v[176:179], a[92:95]
    ds_read_b64_tr_b16 v[48:49], v21 offset:0
    ds_read_b64_tr_b16 v[50:51], v21 offset:1024
    s_waitcnt lgkmcnt(12)
    v_mfma_f32_16x16x32_bf16 a[96:99], v[56:59], v[104:107], a[96:99]
    v_mfma_f32_16x16x32_bf16 a[100:103], v[56:59], v[176:179], a[100:103]
    ds_read_b64_tr_b16 v[52:53], v22 offset:0
    ds_read_b64_tr_b16 v[54:55], v22 offset:1024
    s_waitcnt lgkmcnt(12)
    v_mfma_f32_16x16x32_bf16 a[104:107], v[60:63], v[104:107], a[104:107]
    v_mfma_f32_16x16x32_bf16 a[108:111], v[60:63], v[176:179], a[108:111]
    ds_read_b64_tr_b16 v[56:57], v23 offset:0
    ds_read_b64_tr_b16 v[58:59], v23 offset:1024
    s_waitcnt lgkmcnt(12)
    v_mfma_f32_16x16x32_bf16 a[112:115], v[64:67], v[104:107], a[112:115]
    v_mfma_f32_16x16x32_bf16 a[116:119], v[64:67], v[176:179], a[116:119]
    ds_read_b64_tr_b16 v[60:61], v24 offset:0
    ds_read_b64_tr_b16 v[62:63], v24 offset:1024
    s_waitcnt lgkmcnt(12)
    v_mfma_f32_16x16x32_bf16 a[120:123], v[68:71], v[104:107], a[120:123]
    v_mfma_f32_16x16x32_bf16 a[124:127], v[68:71], v[176:179], a[124:127]
    ds_read_b64_tr_b16 v[64:65], v25 offset:0
    ds_read_b64_tr_b16 v[66:67], v25 offset:1024
    s_waitcnt lgkmcnt(12)
    v_mfma_f32_16x16x32_bf16 a[128:131], v[40:43], v[104:107], a[128:131]
    v_mfma_f32_16x16x32_bf16 a[132:135], v[40:43], v[176:179], a[132:135]
    ds_read_b64_tr_b16 v[68:69], v26 offset:0
    ds_read_b64_tr_b16 v[70:71], v26 offset:1024
    s_waitcnt lgkmcnt(12)
    v_mfma_f32_16x16x32_bf16 a[136:139], v[44:47], v[104:107], a[136:139]
    v_mfma_f32_16x16x32_bf16 a[140:143], v[44:47], v[176:179], a[140:143]
    ds_read_b64_tr_b16 v[40:41], v27 offset:0
    ds_read_b64_tr_b16 v[42:43], v27 offset:1024
    s_waitcnt lgkmcnt(12)
    v_mfma_f32_16x16x32_bf16 a[144:147], v[48:51], v[104:107], a[144:147]
    v_mfma_f32_16x16x32_bf16 a[148:151], v[48:51], v[176:179], a[148:151]
    s_waitcnt vmcnt(7)
    s_barrier
    s_add_u32 m0, s57, 55296
    s_nop 0
    buffer_load_dwordx4 v12, s[20:23], s47 offen lds
    s_add_u32 m0, s57, 59392
    s_nop 0
    buffer_load_dwordx4 v13, s[20:23], s47 offen lds
    s_add_u32 m0, s57, 63488
    s_nop 0
    buffer_load_dwordx4 v14, s[20:23], s47 offen lds
    s_add_u32 m0, s57, 67584
    s_nop 0
    buffer_load_dwordx4 v15, s[20:23], s47 offen lds
    s_mul_i32 s53, s50, 3
    s_add_u32 m0, s49, s53
    s_nop 0
    buffer_load_dwordx4 v16, s[40:43], s47 offen lds
    s_add_u32 m0, s58, 30720
    s_nop 0
    buffer_load_dwordx4 v17, s[24:27], s48 offen lds
    s_add_u32 m0, s58, 34816
    s_nop 0
    buffer_load_dwordx4 v18, s[24:27], s48 offen lds
    s_add_u32 s47, s47, 294912
    s_cmp_eq_u32 s47, 5308416
    s_cselect_b32 s47, 0, s47
    s_add_u32 s48, s48, 110592
    s_cmp_eq_u32 s48, 1990656
    s_cselect_b32 s48, 0, s48
    ds_read_b64_tr_b16 v[44:45], v19 offset:18432
    ds_read_b64_tr_b16 v[46:47], v19 offset:20736
    s_waitcnt lgkmcnt(12)
    v_mfma_f32_16x16x32_bf16 a[152:155], v[52:55], v[104:107], a[152:155]
    v_mfma_f32_16x16x32_bf16 a[156:159], v[52:55], v[176:179], a[156:159]
    ds_read_b64_tr_b16 v[48:49], v20 offset:18464
    ds_read_b64_tr_b16 v[50:51], v20 offset:20768
    s_waitcnt lgkmcnt(12)
    v_mfma_f32_16x16x32_bf16 a[160:163], v[56:59], v[104:107], a[160:163]
    v_mfma_f32_16x16x32_bf16 a[164:167], v[56:59], v[176:179], a[164:167]
    ds_read_b64_tr_b16 v[52:53], v19 offset:18496
    ds_read_b64_tr_b16 v[54:55], v19 offset:20800
    s_waitcnt lgkmcnt(12)
    v_mfma_f32_16x16x32_bf16 a[168:171], v[60:63], v[104:107], a[168:171]
    v_mfma_f32_16x16x32_bf16 a[172:175], v[60:63], v[176:179], a[172:175]
    ds_read_b64_tr_b16 v[56:57], v20 offset:18528
    ds_read_b64_tr_b16 v[58:59], v20 offset:20832
    s_waitcnt lgkmcnt(12)
    v_mfma_f32_16x16x32_bf16 a[176:179], v[64:67], v[104:107], a[176:179]
    v_mfma_f32_16x16x32_bf16 a[180:183], v[64:67], v[176:179], a[180:183]
    ds_read_b64_tr_b16 v[60:61], v19 offset:18560
    ds_read_b64_tr_b16 v[62:63], v19 offset:20864
    s_waitcnt lgkmcnt(12)
    v_mfma_f32_16x16x32_bf16 a[184:187], v[68:71], v[104:107], a[184:187]
    v_mfma_f32_16x16x32_bf16 a[188:191], v[68:71], v[176:179], a[188:191]
    ds_read_b64_tr_b16 v[64:65], v20 offset:18592
    ds_read_b64_tr_b16 v[66:67], v20 offset:20896
    s_waitcnt lgkmcnt(12)
    v_mfma_f32_16x16x32_bf16 a[192:195], v[40:43], v[104:107], a[192:195]
    v_mfma_f32_16x16x32_bf16 a[196:199], v[40:43], v[176:179], a[196:199]
    ds_read_b64_tr_b16 v[68:69], v19 offset:18624
    ds_read_b64_tr_b16 v[70:71], v19 offset:20928
    s_waitcnt lgkmcnt(12)
    v_mfma_f32_16x16x32_bf16 a[0:3], v[44:47], v[108:111], a[0:3]
    v_mfma_f32_16x16x32_bf16 a[4:7], v[44:47], v[180:183], a[4:7]
    ds_read_b64_tr_b16 v[40:41], v20 offset:18656
    ds_read_b64_tr_b16 v[42:43], v20 offset:20960
    s_waitcnt lgkmcnt(12)
    v_mfma_f32_16x16x32_bf16 a[8:11], v[48:51], v[108:111], a[8:11]
    v_mfma_f32_16x16x32_bf16 a[12:15], v[48:51], v[180:183], a[12:15]
    ds_read_b64_tr_b16 v[44:45], v19 offset:18688
    ds_read_b64_tr_b16 v[46:47], v19 offset:20992
    s_waitcnt lgkmcnt(12)
    v_mfma_f32_16x16x32_bf16 a[16:19], v[52:55], v[108:111], a[16:19]
    v_mfma_f32_16x16x32_bf16 a[20:23], v[52:55], v[180:183], a[20:23]
    ds_read_b64_tr_b16 v[48:49], v20 offset:18720
    ds_read_b64_tr_b16 v[50:51], v20 offset:21024
    s_waitcnt lgkmcnt(12)
    v_mfma_f32_16x16x32_bf16 a[24:27], v[56:59], v[108:111], a[24:27]
    v_mfma_f32_16x16x32_bf16 a[28:31], v[56:59], v[180:183], a[28:31]
    ds_read_b64_tr_b16 v[52:53], v19 offset:18752
    ds_read_b64_tr_b16 v[54:55], v19 offset:21056
    s_waitcnt lgkmcnt(12)
    v_mfma_f32_16x16x32_bf16 a[32:35], v[60:63], v[108:111], a[32:35]
    v_mfma_f32_16x16x32_bf16 a[36:39], v[60:63], v[180:183], a[36:39]
    ds_read_b64_tr_b16 v[56:57], v20 offset:18784
    ds_read_b64_tr_b16 v[58:59], v20 offset:21088
    s_waitcnt lgkmcnt(12)
    v_mfma_f32_16x16x32_bf16 a[40:43], v[64:67], v[108:111], a[40:43]
    v_mfma_f32_16x16x32_bf16 a[44:47], v[64:67], v[180:183], a[44:47]
    ds_read_b64_tr_b16 v[60:61], v19 offset:18816
    ds_read_b64_tr_b16 v[62:63], v19 offset:21120
    s_waitcnt lgkmcnt(12)
    v_mfma_f32_16x16x32_bf16 a[48:51], v[68:71], v[108:111], a[48:51]
    v_mfma_f32_16x16x32_bf16 a[52:55], v[68:71], v[180:183], a[52:55]
    ds_read_b64_tr_b16 v[64:65], v20 offset:18848
    ds_read_b64_tr_b16 v[66:67], v20 offset:21152
    s_waitcnt lgkmcnt(12)
    v_mfma_f32_16x16x32_bf16 a[56:59], v[40:43], v[108:111], a[56:59]
    v_mfma_f32_16x16x32_bf16 a[60:63], v[40:43], v[180:183], a[60:63]
    ds_read_b64_tr_b16 v[68:69], v19 offset:18880
    ds_read_b64_tr_b16 v[70:71], v19 offset:21184
    s_waitcnt lgkmcnt(12)
    v_mfma_f32_16x16x32_bf16 a[64:67], v[44:47], v[108:111], a[64:67]
    v_mfma_f32_16x16x32_bf16 a[68:71], v[44:47], v[180:183], a[68:71]
    ds_read_b64_tr_b16 v[40:41], v20 offset:18912
    ds_read_b64_tr_b16 v[42:43], v20 offset:21216
    s_waitcnt lgkmcnt(12)
    v_mfma_f32_16x16x32_bf16 a[72:75], v[48:51], v[108:111], a[72:75]
    v_mfma_f32_16x16x32_bf16 a[76:79], v[48:51], v[180:183], a[76:79]
    ds_read_b64_tr_b16 v[44:45], v19 offset:18944
    ds_read_b64_tr_b16 v[46:47], v19 offset:21248
    s_waitcnt lgkmcnt(12)
    v_mfma_f32_16x16x32_bf16 a[80:83], v[52:55], v[108:111], a[80:83]
    v_mfma_f32_16x16x32_bf16 a[84:87], v[52:55], v[180:183], a[84:87]
    ds_read_b64_tr_b16 v[48:49], v20 offset:18976
    ds_read_b64_tr_b16 v[50:51], v20 offset:21280
    s_waitcnt lgkmcnt(12)
    v_mfma_f32_16x16x32_bf16 a[88:91], v[56:59], v[108:111], a[88:91]
    v_mfma_f32_16x16x32_bf16 a[92:95], v[56:59], v[180:183], a[92:95]
    ds_read_b64_tr_b16 v[52:53], v21 offset:10240
    ds_read_b64_tr_b16 v[54:55], v21 offset:11264
    s_waitcnt lgkmcnt(12)
    v_mfma_f32_16x16x32_bf16 a[96:99], v[60:63], v[108:111], a[96:99]
    v_mfma_f32_16x16x32_bf16 a[100:103], v[60:63], v[180:183], a[100:103]
    ds_read_b64_tr_b16 v[56:57], v22 offset:10240
    ds_read_b64_tr_b16 v[58:59], v22 offset:11264
    s_waitcnt lgkmcnt(12)
    v_mfma_f32_16x16x32_bf16 a[104:107], v[64:67], v[108:111], a[104:107]
    v_mfma_f32_16x16x32_bf16 a[108:111], v[64:67], v[180:183], a[108:111]
    ds_read_b64_tr_b16 v[60:61], v23 offset:10240
    ds_read_b64_tr_b16 v[62:63], v23 offset:11264
    s_waitcnt lgkmcnt(12)
    v_mfma_f32_16x16x32_bf16 a[112:115], v[68:71], v[108:111], a[112:115]
    v_mfma_f32_16x16x32_bf16 a[116:119], v[68:71], v[180:183], a[116:119]
    ds_read_b64_tr_b16 v[64:65], v24 offset:10240
    ds_read_b64_tr_b16 v[66:67], v24 offset:11264
    s_waitcnt lgkmcnt(12)
    v_mfma_f32_16x16x32_bf16 a[120:123], v[40:43], v[108:111], a[120:123]
    v_mfma_f32_16x16x32_bf16 a[124:127], v[40:43], v[180:183], a[124:127]
    ds_read_b64_tr_b16 v[68:69], v25 offset:10240
    ds_read_b64_tr_b16 v[70:71], v25 offset:11264
    s_waitcnt lgkmcnt(12)
    v_mfma_f32_16x16x32_bf16 a[128:131], v[44:47], v[108:111], a[128:131]
    v_mfma_f32_16x16x32_bf16 a[132:135], v[44:47], v[180:183], a[132:135]
    ds_read_b64_tr_b16 v[40:41], v26 offset:10240
    ds_read_b64_tr_b16 v[42:43], v26 offset:11264
    s_waitcnt lgkmcnt(12)
    v_mfma_f32_16x16x32_bf16 a[136:139], v[48:51], v[108:111], a[136:139]
    v_mfma_f32_16x16x32_bf16 a[140:143], v[48:51], v[180:183], a[140:143]
    ds_read_b64_tr_b16 v[44:45], v27 offset:10240
    ds_read_b64_tr_b16 v[46:47], v27 offset:11264
    s_waitcnt lgkmcnt(12)
    v_mfma_f32_16x16x32_bf16 a[144:147], v[52:55], v[108:111], a[144:147]
    v_mfma_f32_16x16x32_bf16 a[148:151], v[52:55], v[180:183], a[148:151]
    s_waitcnt vmcnt(7)
    s_barrier
    s_add_u32 m0, s57, 0
    s_nop 0
    buffer_load_dwordx4 v12, s[20:23], s47 offen lds
    s_add_u32 m0, s57, 4096
    s_nop 0
    buffer_load_dwordx4 v13, s[20:23], s47 offen lds
    s_add_u32 m0, s57, 8192
    s_nop 0
    buffer_load_dwordx4 v14, s[20:23], s47 offen lds
    s_add_u32 m0, s57, 12288
    s_nop 0
    buffer_load_dwordx4 v15, s[20:23], s47 offen lds
    s_mul_i32 s53, s50, 0
    s_add_u32 m0, s49, s53
    s_nop 0
    buffer_load_dwordx4 v16, s[40:43], s47 offen lds
    s_add_u32 m0, s58, 0
    s_nop 0
    buffer_load_dwordx4 v17, s[24:27], s48 offen lds
    s_add_u32 m0, s58, 4096
    s_nop 0
    buffer_load_dwordx4 v18, s[24:27], s48 offen lds
    s_add_u32 s47, s47, 294912
    s_cmp_eq_u32 s47, 5308416
    s_cselect_b32 s47, 0, s47
    s_add_u32 s48, s48, 110592
    s_cmp_eq_u32 s48, 1990656
    s_cselect_b32 s48, 0, s48
    ds_read_b64_tr_b16 v[48:49], v19 offset:36864
    ds_read_b64_tr_b16 v[50:51], v19 offset:39168
    s_waitcnt lgkmcnt(12)
    v_mfma_f32_16x16x32_bf16 a[152:155], v[56:59], v[108:111], a[152:155]
    v_mfma_f32_16x16x32_bf16 a[156:159], v[56:59], v[180:183], a[156:159]
    ds_read_b64_tr_b16 v[52:53], v20 offset:36896
    ds_read_b64_tr_b16 v[54:55], v20 offset:39200
    s_waitcnt lgkmcnt(12)
    v_mfma_f32_16x16x32_bf16 a[160:163], v[60:63], v[108:111], a[160:163]
    v_mfma_f32_16x16x32_bf16 a[164:167], v[60:63], v[180:183], a[164:167]
    ds_read_b64_tr_b16 v[56:57], v19 offset:36928
    ds_read_b64_tr_b16 v[58:59], v19 offset:39232
    s_waitcnt lgkmcnt(12)
    v_mfma_f32_16x16x32_bf16 a[168:171], v[64:67], v[108:111], a[168:171]
    v_mfma_f32_16x16x32_bf16 a[172:175], v[64:67], v[180:183], a[172:175]
    ds_read_b64_tr_b16 v[60:61], v20 offset:36960
    ds_read_b64_tr_b16 v[62:63], v20 offset:39264
    s_waitcnt lgkmcnt(12)
    v_mfma_f32_16x16x32_bf16 a[176:179], v[68:71], v[108:111], a[176:179]
    v_mfma_f32_16x16x32_bf16 a[180:183], v[68:71], v[180:183], a[180:183]
    ds_read_b64_tr_b16 v[64:65], v19 offset:36992
    ds_read_b64_tr_b16 v[66:67], v19 offset:39296
    s_waitcnt lgkmcnt(12)
    v_mfma_f32_16x16x32_bf16 a[184:187], v[40:43], v[108:111], a[184:187]
    v_mfma_f32_16x16x32_bf16 a[188:191], v[40:43], v[180:183], a[188:191]
    ds_read_b64_tr_b16 v[68:69], v20 offset:37024
    ds_read_b64_tr_b16 v[70:71], v20 offset:39328
    s_waitcnt lgkmcnt(12)
    v_mfma_f32_16x16x32_bf16 a[192:195], v[44:47], v[108:111], a[192:195]
    v_mfma_f32_16x16x32_bf16 a[196:199], v[44:47], v[180:183], a[196:199]
    ds_read_b64_tr_b16 v[40:41], v19 offset:37056
    ds_read_b64_tr_b16 v[42:43], v19 offset:39360
    s_waitcnt lgkmcnt(12)
    v_mfma_f32_16x16x32_bf16 a[0:3], v[48:51], v[112:115], a[0:3]
    v_mfma_f32_16x16x32_bf16 a[4:7], v[48:51], v[184:187], a[4:7]
    ds_read_b64_tr_b16 v[44:45], v20 offset:37088
    ds_read_b64_tr_b16 v[46:47], v20 offset:39392
    s_waitcnt lgkmcnt(12)
    v_mfma_f32_16x16x32_bf16 a[8:11], v[52:55], v[112:115], a[8:11]
    v_mfma_f32_16x16x32_bf16 a[12:15], v[52:55], v[184:187], a[12:15]
    ds_read_b64_tr_b16 v[48:49], v19 offset:37120
    ds_read_b64_tr_b16 v[50:51], v19 offset:39424
    s_waitcnt lgkmcnt(12)
    v_mfma_f32_16x16x32_bf16 a[16:19], v[56:59], v[112:115], a[16:19]
    v_mfma_f32_16x16x32_bf16 a[20:23], v[56:59], v[184:187], a[20:23]
    ds_read_b64_tr_b16 v[52:53], v20 offset:37152
    ds_read_b64_tr_b16 v[54:55], v20 offset:39456
    s_waitcnt lgkmcnt(12)
    v_mfma_f32_16x16x32_bf16 a[24:27], v[60:63], v[112:115], a[24:27]
    v_mfma_f32_16x16x32_bf16 a[28:31], v[60:63], v[184:187], a[28:31]
    ds_read_b64_tr_b16 v[56:57], v19 offset:37184
    ds_read_b64_tr_b16 v[58:59], v19 offset:39488
    s_waitcnt lgkmcnt(12)
    v_mfma_f32_16x16x32_bf16 a[32:35], v[64:67], v[112:115], a[32:35]
    v_mfma_f32_16x16x32_bf16 a[36:39], v[64:67], v[184:187], a[36:39]
    ds_read_b64_tr_b16 v[60:61], v20 offset:37216
    ds_read_b64_tr_b16 v[62:63], v20 offset:39520
    s_waitcnt lgkmcnt(12)
    v_mfma_f32_16x16x32_bf16 a[40:43], v[68:71], v[112:115], a[40:43]
    v_mfma_f32_16x16x32_bf16 a[44:47], v[68:71], v[184:187], a[44:47]
    ds_read_b64_tr_b16 v[64:65], v19 offset:37248
    ds_read_b64_tr_b16 v[66:67], v19 offset:39552
    s_waitcnt lgkmcnt(12)
    v_mfma_f32_16x16x32_bf16 a[48:51], v[40:43], v[112:115], a[48:51]
    v_mfma_f32_16x16x32_bf16 a[52:55], v[40:43], v[184:187], a[52:55]
    ds_read_b64_tr_b16 v[68:69], v20 offset:37280
    ds_read_b64_tr_b16 v[70:71], v20 offset:39584
    s_waitcnt lgkmcnt(12)
    v_mfma_f32_16x16x32_bf16 a[56:59], v[44:47], v[112:115], a[56:59]
    v_mfma_f32_16x16x32_bf16 a[60:63], v[44:47], v[184:187], a[60:63]
    ds_read_b64_tr_b16 v[40:41], v19 offset:37312
    ds_read_b64_tr_b16 v[42:43], v19 offset:39616
    s_waitcnt lgkmcnt(12)
    v_mfma_f32_16x16x32_bf16 a[64:67], v[48:51], v[112:115], a[64:67]
    v_mfma_f32_16x16x32_bf16 a[68:71], v[48:51], v[184:187], a[68:71]
    ds_read_b64_tr_b16 v[44:45], v20 offset:37344
    ds_read_b64_tr_b16 v[46:47], v20 offset:39648
    s_waitcnt lgkmcnt(12)
    v_mfma_f32_16x16x32_bf16 a[72:75], v[52:55], v[112:115], a[72:75]
    v_mfma_f32_16x16x32_bf16 a[76:79], v[52:55], v[184:187], a[76:79]
    ds_read_b64_tr_b16 v[48:49], v19 offset:37376
    ds_read_b64_tr_b16 v[50:51], v19 offset:39680
    s_waitcnt lgkmcnt(12)
    v_mfma_f32_16x16x32_bf16 a[80:83], v[56:59], v[112:115], a[80:83]
    v_mfma_f32_16x16x32_bf16 a[84:87], v[56:59], v[184:187], a[84:87]
    ds_read_b64_tr_b16 v[52:53], v20 offset:37408
    ds_read_b64_tr_b16 v[54:55], v20 offset:39712
    s_waitcnt lgkmcnt(12)
    v_mfma_f32_16x16x32_bf16 a[88:91], v[60:63], v[112:115], a[88:91]
    v_mfma_f32_16x16x32_bf16 a[92:95], v[60:63], v[184:187], a[92:95]
    ds_read_b64_tr_b16 v[56:57], v21 offset:20480
    ds_read_b64_tr_b16 v[58:59], v21 offset:21504
    s_waitcnt lgkmcnt(12)
    v_mfma_f32_16x16x32_bf16 a[96:99], v[64:67], v[112:115], a[96:99]
    v_mfma_f32_16x16x32_bf16 a[100:103], v[64:67], v[184:187], a[100:103]
    ds_read_b64_tr_b16 v[60:61], v22 offset:20480
    ds_read_b64_tr_b16 v[62:63], v22 offset:21504
    s_waitcnt lgkmcnt(12)
    v_mfma_f32_16x16x32_bf16 a[104:107], v[68:71], v[112:115], a[104:107]
    v_mfma_f32_16x16x32_bf16 a[108:111], v[68:71], v[184:187], a[108:111]
    ds_read_b64_tr_b16 v[64:65], v23 offset:20480
    ds_read_b64_tr_b16 v[66:67], v23 offset:21504
    s_waitcnt lgkmcnt(12)
    v_mfma_f32_16x16x32_bf16 a[112:115], v[40:43], v[112:115], a[112:115]
    v_mfma_f32_16x16x32_bf16 a[116:119], v[40:43], v[184:187], a[116:119]
    ds_read_b64_tr_b16 v[68:69], v24 offset:20480
    ds_read_b64_tr_b16 v[70:71], v24 offset:21504
    s_waitcnt lgkmcnt(12)
    v_mfma_f32_16x16x32_bf16 a[120:123], v[44:47], v[112:115], a[120:123]
    v_mfma_f32_16x16x32_bf16 a[124:127], v[44:47], v[184:187], a[124:127]
    ds_read_b64_tr_b16 v[40:41], v25 offset:20480
    ds_read_b64_tr_b16 v[42:43], v25 offset:21504
    s_waitcnt lgkmcnt(12)
    v_mfma_f32_16x16x32_bf16 a[128:131], v[48:51], v[112:115], a[128:131]
    v_mfma_f32_16x16x32_bf16 a[132:135], v[48:51], v[184:187], a[132:135]
    ds_read_b64_tr_b16 v[44:45], v26 offset:20480
    ds_read_b64_tr_b16 v[46:47], v26 offset:21504
    s_waitcnt lgkmcnt(12)
    v_mfma_f32_16x16x32_bf16 a[136:139], v[52:55], v[112:115], a[136:139]
    v_mfma_f32_16x16x32_bf16 a[140:143], v[52:55], v[184:187], a[140:143]
    ds_read_b64_tr_b16 v[48:49], v27 offset:20480
    ds_read_b64_tr_b16 v[50:51], v27 offset:21504
    s_waitcnt lgkmcnt(12)
    v_mfma_f32_16x16x32_bf16 a[144:147], v[56:59], v[112:115], a[144:147]
    v_mfma_f32_16x16x32_bf16 a[148:151], v[56:59], v[184:187], a[148:151]
    s_waitcnt vmcnt(7)
    s_barrier
    s_add_u32 m0, s57, 18432
    s_nop 0
    buffer_load_dwordx4 v12, s[20:23], s47 offen lds
    s_add_u32 m0, s57, 22528
    s_nop 0
    buffer_load_dwordx4 v13, s[20:23], s47 offen lds
    s_add_u32 m0, s57, 26624
    s_nop 0
    buffer_load_dwordx4 v14, s[20:23], s47 offen lds
    s_add_u32 m0, s57, 30720
    s_nop 0
    buffer_load_dwordx4 v15, s[20:23], s47 offen lds
    s_mul_i32 s53, s50, 1
    s_add_u32 m0, s49, s53
    s_nop 0
    buffer_load_dwordx4 v16, s[40:43], s47 offen lds
    s_add_u32 m0, s58, 10240
    s_nop 0
    buffer_load_dwordx4 v17, s[24:27], s48 offen lds
    s_add_u32 m0, s58, 14336
    s_nop 0
    buffer_load_dwordx4 v18, s[24:27], s48 offen lds
    s_add_u32 s47, s47, 294912
    s_cmp_eq_u32 s47, 5308416
    s_cselect_b32 s47, 0, s47
    s_add_u32 s48, s48, 110592
    s_cmp_eq_u32 s48, 1990656
    s_cselect_b32 s48, 0, s48
    ds_read_b64_tr_b16 v[52:53], v19 offset:55296
    ds_read_b64_tr_b16 v[54:55], v19 offset:57600
    s_waitcnt lgkmcnt(12)
    v_mfma_f32_16x16x32_bf16 a[152:155], v[60:63], v[112:115], a[152:155]
    v_mfma_f32_16x16x32_bf16 a[156:159], v[60:63], v[184:187], a[156:159]
    ds_read_b64_tr_b16 v[56:57], v20 offset:55328
    ds_read_b64_tr_b16 v[58:59], v20 offset:57632
    s_waitcnt lgkmcnt(12)
    v_mfma_f32_16x16x32_bf16 a[160:163], v[64:67], v[112:115], a[160:163]
    v_mfma_f32_16x16x32_bf16 a[164:167], v[64:67], v[184:187], a[164:167]
    ds_read_b64_tr_b16 v[60:61], v19 offset:55360
    ds_read_b64_tr_b16 v[62:63], v19 offset:57664
    s_waitcnt lgkmcnt(12)
    v_mfma_f32_16x16x32_bf16 a[168:171], v[68:71], v[112:115], a[168:171]
    v_mfma_f32_16x16x32_bf16 a[172:175], v[68:71], v[184:187], a[172:175]
    ds_read_b64_tr_b16 v[64:65], v20 offset:55392
    ds_read_b64_tr_b16 v[66:67], v20 offset:57696
    s_waitcnt lgkmcnt(12)
    v_mfma_f32_16x16x32_bf16 a[176:179], v[40:43], v[112:115], a[176:179]
    v_mfma_f32_16x16x32_bf16 a[180:183], v[40:43], v[184:187], a[180:183]
    ds_read_b64_tr_b16 v[68:69], v19 offset:55424
    ds_read_b64_tr_b16 v[70:71], v19 offset:57728
    s_waitcnt lgkmcnt(12)
    v_mfma_f32_16x16x32_bf16 a[184:187], v[44:47], v[112:115], a[184:187]
    v_mfma_f32_16x16x32_bf16 a[188:191], v[44:47], v[184:187], a[188:191]
    ds_read_b64_tr_b16 v[40:41], v20 offset:55456
    ds_read_b64_tr_b16 v[42:43], v20 offset:57760
    s_waitcnt lgkmcnt(12)
    v_mfma_f32_16x16x32_bf16 a[192:195], v[48:51], v[112:115], a[192:195]
    v_mfma_f32_16x16x32_bf16 a[196:199], v[48:51], v[184:187], a[196:199]
    ds_read_b64_tr_b16 v[44:45], v19 offset:55488
    ds_read_b64_tr_b16 v[46:47], v19 offset:57792
    s_waitcnt lgkmcnt(12)
    v_mfma_f32_16x16x32_bf16 a[0:3], v[52:55], v[116:119], a[0:3]
    v_mfma_f32_16x16x32_bf16 a[4:7], v[52:55], v[188:191], a[4:7]
    ds_read_b64_tr_b16 v[48:49], v20 offset:55520
    ds_read_b64_tr_b16 v[50:51], v20 offset:57824
    s_waitcnt lgkmcnt(12)
    v_mfma_f32_16x16x32_bf16 a[8:11], v[56:59], v[116:119], a[8:11]
    v_mfma_f32_16x16x32_bf16 a[12:15], v[56:59], v[188:191], a[12:15]
    ds_read_b64_tr_b16 v[52:53], v19 offset:55552
    ds_read_b64_tr_b16 v[54:55], v19 offset:57856
    s_waitcnt lgkmcnt(12)
    v_mfma_f32_16x16x32_bf16 a[16:19], v[60:63], v[116:119], a[16:19]
    v_mfma_f32_16x16x32_bf16 a[20:23], v[60:63], v[188:191], a[20:23]
    ds_read_b64_tr_b16 v[56:57], v20 offset:55584
    ds_read_b64_tr_b16 v[58:59], v20 offset:57888
    s_waitcnt lgkmcnt(12)
    v_mfma_f32_16x16x32_bf16 a[24:27], v[64:67], v[116:119], a[24:27]
    v_mfma_f32_16x16x32_bf16 a[28:31], v[64:67], v[188:191], a[28:31]
    ds_read_b64_tr_b16 v[60:61], v19 offset:55616
    ds_read_b64_tr_b16 v[62:63], v19 offset:57920
    s_waitcnt lgkmcnt(12)
    v_mfma_f32_16x16x32_bf16 a[32:35], v[68:71], v[116:119], a[32:35]
    v_mfma_f32_16x16x32_bf16 a[36:39], v[68:71], v[188:191], a[36:39]
    ds_read_b64_tr_b16 v[64:65], v20 offset:55648
    ds_read_b64_tr_b16 v[66:67], v20 offset:57952
    s_waitcnt lgkmcnt(12)
    v_mfma_f32_16x16x32_bf16 a[40:43], v[40:43], v[116:119], a[40:43]
    v_mfma_f32_16x16x32_bf16 a[44:47], v[40:43], v[188:191], a[44:47]
    ds_read_b64_tr_b16 v[68:69], v19 offset:55680
    ds_read_b64_tr_b16 v[70:71], v19 offset:57984
    s_waitcnt lgkmcnt(12)
    v_mfma_f32_16x16x32_bf16 a[48:51], v[44:47], v[116:119], a[48:51]
    v_mfma_f32_16x16x32_bf16 a[52:55], v[44:47], v[188:191], a[52:55]
    ds_read_b64_tr_b16 v[40:41], v20 offset:55712
    ds_read_b64_tr_b16 v[42:43], v20 offset:58016
    s_waitcnt lgkmcnt(12)
    v_mfma_f32_16x16x32_bf16 a[56:59], v[48:51], v[116:119], a[56:59]
    v_mfma_f32_16x16x32_bf16 a[60:63], v[48:51], v[188:191], a[60:63]
    ds_read_b64_tr_b16 v[44:45], v19 offset:55744
    ds_read_b64_tr_b16 v[46:47], v19 offset:58048
    s_waitcnt lgkmcnt(12)
    v_mfma_f32_16x16x32_bf16 a[64:67], v[52:55], v[116:119], a[64:67]
    v_mfma_f32_16x16x32_bf16 a[68:71], v[52:55], v[188:191], a[68:71]
    ds_read_b64_tr_b16 v[48:49], v20 offset:55776
    ds_read_b64_tr_b16 v[50:51], v20 offset:58080
    s_waitcnt lgkmcnt(12)
    v_mfma_f32_16x16x32_bf16 a[72:75], v[56:59], v[116:119], a[72:75]
    v_mfma_f32_16x16x32_bf16 a[76:79], v[56:59], v[188:191], a[76:79]
    ds_read_b64_tr_b16 v[52:53], v19 offset:55808
    ds_read_b64_tr_b16 v[54:55], v19 offset:58112
    s_waitcnt lgkmcnt(12)
    v_mfma_f32_16x16x32_bf16 a[80:83], v[60:63], v[116:119], a[80:83]
    v_mfma_f32_16x16x32_bf16 a[84:87], v[60:63], v[188:191], a[84:87]
    ds_read_b64_tr_b16 v[56:57], v20 offset:55840
    ds_read_b64_tr_b16 v[58:59], v20 offset:58144
    s_waitcnt lgkmcnt(12)
    v_mfma_f32_16x16x32_bf16 a[88:91], v[64:67], v[116:119], a[88:91]
    v_mfma_f32_16x16x32_bf16 a[92:95], v[64:67], v[188:191], a[92:95]
    ds_read_b64_tr_b16 v[60:61], v21 offset:30720
    ds_read_b64_tr_b16 v[62:63], v21 offset:31744
    s_waitcnt lgkmcnt(12)
    v_mfma_f32_16x16x32_bf16 a[96:99], v[68:71], v[116:119], a[96:99]
    v_mfma_f32_16x16x32_bf16 a[100:103], v[68:71], v[188:191], a[100:103]
    ds_read_b64_tr_b16 v[64:65], v22 offset:30720
    ds_read_b64_tr_b16 v[66:67], v22 offset:31744
    s_waitcnt lgkmcnt(12)
    v_mfma_f32_16x16x32_bf16 a[104:107], v[40:43], v[116:119], a[104:107]
    v_mfma_f32_16x16x32_bf16 a[108:111], v[40:43], v[188:191], a[108:111]
    ds_read_b64_tr_b16 v[68:69], v23 offset:30720
    ds_read_b64_tr_b16 v[70:71], v23 offset:31744
    s_waitcnt lgkmcnt(12)
    v_mfma_f32_16x16x32_bf16 a[112:115], v[44:47], v[116:119], a[112:115]
    v_mfma_f32_16x16x32_bf16 a[116:119], v[44:47], v[188:191], a[116:119]
    ds_read_b64_tr_b16 v[40:41], v24 offset:30720
    ds_read_b64_tr_b16 v[42:43], v24 offset:31744
    s_waitcnt lgkmcnt(12)
    v_mfma_f32_16x16x32_bf16 a[120:123], v[48:51], v[116:119], a[120:123]
    v_mfma_f32_16x16x32_bf16 a[124:127], v[48:51], v[188:191], a[124:127]
    ds_read_b64_tr_b16 v[44:45], v25 offset:30720
    ds_read_b64_tr_b16 v[46:47], v25 offset:31744
    s_waitcnt lgkmcnt(12)
    v_mfma_f32_16x16x32_bf16 a[128:131], v[52:55], v[116:119], a[128:131]
    v_mfma_f32_16x16x32_bf16 a[132:135], v[52:55], v[188:191], a[132:135]
    ds_read_b64_tr_b16 v[48:49], v26 offset:30720
    ds_read_b64_tr_b16 v[50:51], v26 offset:31744
    s_waitcnt lgkmcnt(12)
    v_mfma_f32_16x16x32_bf16 a[136:139], v[56:59], v[116:119], a[136:139]
    v_mfma_f32_16x16x32_bf16 a[140:143], v[56:59], v[188:191], a[140:143]
    ds_read_b64_tr_b16 v[52:53], v27 offset:30720
    ds_read_b64_tr_b16 v[54:55], v27 offset:31744
    s_waitcnt lgkmcnt(12)
    v_mfma_f32_16x16x32_bf16 a[144:147], v[60:63], v[116:119], a[144:147]
    v_mfma_f32_16x16x32_bf16 a[148:151], v[60:63], v[188:191], a[148:151]
    s_waitcnt vmcnt(7)
    s_barrier
    s_add_u32 m0, s57, 36864
    s_nop 0
    buffer_load_dwordx4 v12, s[20:23], s47 offen lds
    s_add_u32 m0, s57, 40960
    s_nop 0
    buffer_load_dwordx4 v13, s[20:23], s47 offen lds
    s_add_u32 m0, s57, 45056
    s_nop 0
    buffer_load_dwordx4 v14, s[20:23], s47 offen lds
    s_add_u32 m0, s57, 49152
    s_nop 0
    buffer_load_dwordx4 v15, s[20:23], s47 offen lds
    s_mul_i32 s53, s50, 2
    s_add_u32 m0, s49, s53
    s_nop 0
    buffer_load_dwordx4 v16, s[40:43], s47 offen lds
    s_add_u32 m0, s58, 20480
    s_nop 0
    buffer_load_dwordx4 v17, s[24:27], s48 offen lds
    s_add_u32 m0, s58, 24576
    s_nop 0
    buffer_load_dwordx4 v18, s[24:27], s48 offen lds
    s_add_u32 s47, s47, 294912
    s_cmp_eq_u32 s47, 5308416
    s_cselect_b32 s47, 0, s47
    s_add_u32 s48, s48, 110592
    s_cmp_eq_u32 s48, 1990656
    s_cselect_b32 s48, 0, s48
    ds_read_b64_tr_b16 v[56:57], v19 offset:0
    ds_read_b64_tr_b16 v[58:59], v19 offset:2304
    s_waitcnt lgkmcnt(12)
    v_mfma_f32_16x16x32_bf16 a[152:155], v[64:67], v[116:119], a[152:155]
    v_mfma_f32_16x16x32_bf16 a[156:159], v[64:67], v[188:191], a[156:159]
    ds_read_b64_tr_b16 v[60:61], v20 offset:32
    ds_read_b64_tr_b16 v[62:63], v20 offset:2336
    s_waitcnt lgkmcnt(12)
    v_mfma_f32_16x16x32_bf16 a[160:163], v[68:71], v[116:119], a[160:163]
    v_mfma_f32_16x16x32_bf16 a[164:167], v[68:71], v[188:191], a[164:167]
    ds_read_b64_tr_b16 v[64:65], v19 offset:64
    ds_read_b64_tr_b16 v[66:67], v19 offset:2368
    s_waitcnt lgkmcnt(12)
    v_mfma_f32_16x16x32_bf16 a[168:171], v[40:43], v[116:119], a[168:171]
    v_mfma_f32_16x16x32_bf16 a[172:175], v[40:43], v[188:191], a[172:175]
    ds_read_b64_tr_b16 v[68:69], v20 offset:96
    ds_read_b64_tr_b16 v[70:71], v20 offset:2400
    s_waitcnt lgkmcnt(12)
    v_mfma_f32_16x16x32_bf16 a[176:179], v[44:47], v[116:119], a[176:179]
    v_mfma_f32_16x16x32_bf16 a[180:183], v[44:47], v[188:191], a[180:183]
    ds_read_b64_tr_b16 v[40:41], v19 offset:128
    ds_read_b64_tr_b16 v[42:43], v19 offset:2432
    s_waitcnt lgkmcnt(12)
    v_mfma_f32_16x16x32_bf16 a[184:187], v[48:51], v[116:119], a[184:187]
    v_mfma_f32_16x16x32_bf16 a[188:191], v[48:51], v[188:191], a[188:191]
    ds_read_b64_tr_b16 v[44:45], v20 offset:160
    ds_read_b64_tr_b16 v[46:47], v20 offset:2464
    s_waitcnt lgkmcnt(12)
    v_mfma_f32_16x16x32_bf16 a[192:195], v[52:55], v[116:119], a[192:195]
    v_mfma_f32_16x16x32_bf16 a[196:199], v[52:55], v[188:191], a[196:199]
    ds_read_b64_tr_b16 v[48:49], v19 offset:192
    ds_read_b64_tr_b16 v[50:51], v19 offset:2496
    s_waitcnt lgkmcnt(12)
    v_mfma_f32_16x16x32_bf16 a[0:3], v[56:59], v[120:123], a[0:3]
    v_mfma_f32_16x16x32_bf16 a[4:7], v[56:59], v[192:195], a[4:7]
    ds_read_b64_tr_b16 v[52:53], v20 offset:224
    ds_read_b64_tr_b16 v[54:55], v20 offset:2528
    s_waitcnt lgkmcnt(12)
    v_mfma_f32_16x16x32_bf16 a[8:11], v[60:63], v[120:123], a[8:11]
    v_mfma_f32_16x16x32_bf16 a[12:15], v[60:63], v[192:195], a[12:15]
    ds_read_b64_tr_b16 v[56:57], v19 offset:256
    ds_read_b64_tr_b16 v[58:59], v19 offset:2560
    s_waitcnt lgkmcnt(12)
    v_mfma_f32_16x16x32_bf16 a[16:19], v[64:67], v[120:123], a[16:19]
    v_mfma_f32_16x16x32_bf16 a[20:23], v[64:67], v[192:195], a[20:23]
    ds_read_b64_tr_b16 v[60:61], v20 offset:288
    ds_read_b64_tr_b16 v[62:63], v20 offset:2592
    s_waitcnt lgkmcnt(12)
    v_mfma_f32_16x16x32_bf16 a[24:27], v[68:71], v[120:123], a[24:27]
    v_mfma_f32_16x16x32_bf16 a[28:31], v[68:71], v[192:195], a[28:31]
    ds_read_b64_tr_b16 v[64:65], v19 offset:320
    ds_read_b64_tr_b16 v[66:67], v19 offset:2624
    s_waitcnt lgkmcnt(12)
    v_mfma_f32_16x16x32_bf16 a[32:35], v[40:43], v[120:123], a[32:35]
    v_mfma_f32_16x16x32_bf16 a[36:39], v[40:43], v[192:195], a[36:39]
    ds_read_b64_tr_b16 v[68:69], v20 offset:352
    ds_read_b64_tr_b16 v[70:71], v20 offset:2656
    s_waitcnt lgkmcnt(12)
    v_mfma_f32_16x16x32_bf16 a[40:43], v[44:47], v[120:123], a[40:43]
    v_mfma_f32_16x16x32_bf16 a[44:47], v[44:47], v[192:195], a[44:47]
    ds_read_b64_tr_b16 v[40:41], v19 offset:384
    ds_read_b64_tr_b16 v[42:43], v19 offset:2688
    s_waitcnt lgkmcnt(12)
    v_mfma_f32_16x16x32_bf16 a[48:51], v[48:51], v[120:123], a[48:51]
    v_mfma_f32_16x16x32_bf16 a[52:55], v[48:51], v[192:195], a[52:55]
    ds_read_b64_tr_b16 v[44:45], v20 offset:416
    ds_read_b64_tr_b16 v[46:47], v20 offset:2720
    s_waitcnt lgkmcnt(12)
    v_mfma_f32_16x16x32_bf16 a[56:59], v[52:55], v[120:123], a[56:59]
    v_mfma_f32_16x16x32_bf16 a[60:63], v[52:55], v[192:195], a[60:63]
    ds_read_b64_tr_b16 v[48:49], v19 offset:448
    ds_read_b64_tr_b16 v[50:51], v19 offset:2752
    s_waitcnt lgkmcnt(12)
    v_mfma_f32_16x16x32_bf16 a[64:67], v[56:59], v[120:123], a[64:67]
    v_mfma_f32_16x16x32_bf16 a[68:71], v[56:59], v[192:195], a[68:71]
    ds_read_b64_tr_b16 v[52:53], v20 offset:480
    ds_read_b64_tr_b16 v[54:55], v20 offset:2784
    s_waitcnt lgkmcnt(12)
    v_mfma_f32_16x16x32_bf16 a[72:75], v[60:63], v[120:123], a[72:75]
    v_mfma_f32_16x16x32_bf16 a[76:79], v[60:63], v[192:195], a[76:79]
    ds_read_b64_tr_b16 v[56:57], v19 offset:512
    ds_read_b64_tr_b16 v[58:59], v19 offset:2816
    s_waitcnt lgkmcnt(12)
    v_mfma_f32_16x16x32_bf16 a[80:83], v[64:67], v[120:123], a[80:83]
    v_mfma_f32_16x16x32_bf16 a[84:87], v[64:67], v[192:195], a[84:87]
    ds_read_b64_tr_b16 v[60:61], v20 offset:544
    ds_read_b64_tr_b16 v[62:63], v20 offset:2848
    s_waitcnt lgkmcnt(12)
    v_mfma_f32_16x16x32_bf16 a[88:91], v[68:71], v[120:123], a[88:91]
    v_mfma_f32_16x16x32_bf16 a[92:95], v[68:71], v[192:195], a[92:95]
    ds_read_b64_tr_b16 v[64:65], v21 offset:0
    ds_read_b64_tr_b16 v[66:67], v21 offset:1024
    s_waitcnt lgkmcnt(12)
    v_mfma_f32_16x16x32_bf16 a[96:99], v[40:43], v[120:123], a[96:99]
    v_mfma_f32_16x16x32_bf16 a[100:103], v[40:43], v[192:195], a[100:103]
    ds_read_b64_tr_b16 v[68:69], v22 offset:0
    ds_read_b64_tr_b16 v[70:71], v22 offset:1024
    s_waitcnt lgkmcnt(12)
    v_mfma_f32_16x16x32_bf16 a[104:107], v[44:47], v[120:123], a[104:107]
    v_mfma_f32_16x16x32_bf16 a[108:111], v[44:47], v[192:195], a[108:111]
    ds_read_b64_tr_b16 v[40:41], v23 offset:0
    ds_read_b64_tr_b16 v[42:43], v23 offset:1024
    s_waitcnt lgkmcnt(12)
    v_mfma_f32_16x16x32_bf16 a[112:115], v[48:51], v[120:123], a[112:115]
    v_mfma_f32_16x16x32_bf16 a[116:119], v[48:51], v[192:195], a[116:119]
    ds_read_b64_tr_b16 v[44:45], v24 offset:0
    ds_read_b64_tr_b16 v[46:47], v24 offset:1024
    s_waitcnt lgkmcnt(12)
    v_mfma_f32_16x16x32_bf16 a[120:123], v[52:55], v[120:123], a[120:123]
    v_mfma_f32_16x16x32_bf16 a[124:127], v[52:55], v[192:195], a[124:127]
    ds_read_b64_tr_b16 v[48:49], v25 offset:0
    ds_read_b64_tr_b16 v[50:51], v25 offset:1024
    s_waitcnt lgkmcnt(12)
    v_mfma_f32_16x16x32_bf16 a[128:131], v[56:59], v[120:123], a[128:131]
    v_mfma_f32_16x16x32_bf16 a[132:135], v[56:59], v[192:195], a[132:135]
    ds_read_b64_tr_b16 v[52:53], v26 offset:0
    ds_read_b64_tr_b16 v[54:55], v26 offset:1024
    s_waitcnt lgkmcnt(12)
    v_mfma_f32_16x16x32_bf16 a[136:139], v[60:63], v[120:123], a[136:139]
    v_mfma_f32_16x16x32_bf16 a[140:143], v[60:63], v[192:195], a[140:143]
    ds_read_b64_tr_b16 v[56:57], v27 offset:0
    ds_read_b64_tr_b16 v[58:59], v27 offset:1024
    s_waitcnt lgkmcnt(12)
    v_mfma_f32_16x16x32_bf16 a[144:147], v[64:67], v[120:123], a[144:147]
    v_mfma_f32_16x16x32_bf16 a[148:151], v[64:67], v[192:195], a[148:151]
    s_waitcnt vmcnt(7)
    s_barrier
    s_add_u32 m0, s57, 55296
    s_nop 0
    buffer_load_dwordx4 v12, s[20:23], s47 offen lds
    s_add_u32 m0, s57, 59392
    s_nop 0
    buffer_load_dwordx4 v13, s[20:23], s47 offen lds
    s_add_u32 m0, s57, 63488
    s_nop 0
    buffer_load_dwordx4 v14, s[20:23], s47 offen lds
    s_add_u32 m0, s57, 67584
    s_nop 0
    buffer_load_dwordx4 v15, s[20:23], s47 offen lds
    s_mul_i32 s53, s50, 3
    s_add_u32 m0, s49, s53
    s_nop 0
    buffer_load_dwordx4 v16, s[40:43], s47 offen lds
    s_add_u32 m0, s58, 30720
    s_nop 0
    buffer_load_dwordx4 v17, s[24:27], s48 offen lds
    s_add_u32 m0, s58, 34816
    s_nop 0
    buffer_load_dwordx4 v18, s[24:27], s48 offen lds
    s_add_u32 s47, s47, 294912
    s_cmp_eq_u32 s47, 5308416
    s_cselect_b32 s47, 0, s47
    s_add_u32 s48, s48, 110592
    s_cmp_eq_u32 s48, 1990656
    s_cselect_b32 s48, 0, s48
    ds_read_b64_tr_b16 v[60:61], v19 offset:18432
    ds_read_b64_tr_b16 v[62:63], v19 offset:20736
    s_waitcnt lgkmcnt(12)
    v_mfma_f32_16x16x32_bf16 a[152:155], v[68:71], v[120:123], a[152:155]
    v_mfma_f32_16x16x32_bf16 a[156:159], v[68:71], v[192:195], a[156:159]
    ds_read_b64_tr_b16 v[64:65], v20 offset:18464
    ds_read_b64_tr_b16 v[66:67], v20 offset:20768
    s_waitcnt lgkmcnt(12)
    v_mfma_f32_16x16x32_bf16 a[160:163], v[40:43], v[120:123], a[160:163]
    v_mfma_f32_16x16x32_bf16 a[164:167], v[40:43], v[192:195], a[164:167]
    ds_read_b64_tr_b16 v[68:69], v19 offset:18496
    ds_read_b64_tr_b16 v[70:71], v19 offset:20800
    s_waitcnt lgkmcnt(12)
    v_mfma_f32_16x16x32_bf16 a[168:171], v[44:47], v[120:123], a[168:171]
    v_mfma_f32_16x16x32_bf16 a[172:175], v[44:47], v[192:195], a[172:175]
    ds_read_b64_tr_b16 v[40:41], v20 offset:18528
    ds_read_b64_tr_b16 v[42:43], v20 offset:20832
    s_waitcnt lgkmcnt(12)
    v_mfma_f32_16x16x32_bf16 a[176:179], v[48:51], v[120:123], a[176:179]
    v_mfma_f32_16x16x32_bf16 a[180:183], v[48:51], v[192:195], a[180:183]
    ds_read_b64_tr_b16 v[44:45], v19 offset:18560
    ds_read_b64_tr_b16 v[46:47], v19 offset:20864
    s_waitcnt lgkmcnt(12)
    v_mfma_f32_16x16x32_bf16 a[184:187], v[52:55], v[120:123], a[184:187]
    v_mfma_f32_16x16x32_bf16 a[188:191], v[52:55], v[192:195], a[188:191]
    ds_read_b64_tr_b16 v[48:49], v20 offset:18592
    ds_read_b64_tr_b16 v[50:51], v20 offset:20896
    s_waitcnt lgkmcnt(12)
    v_mfma_f32_16x16x32_bf16 a[192:195], v[56:59], v[120:123], a[192:195]
    v_mfma_f32_16x16x32_bf16 a[196:199], v[56:59], v[192:195], a[196:199]
    ds_read_b64_tr_b16 v[52:53], v19 offset:18624
    ds_read_b64_tr_b16 v[54:55], v19 offset:20928
    s_waitcnt lgkmcnt(12)
    v_mfma_f32_16x16x32_bf16 a[0:3], v[60:63], v[124:127], a[0:3]
    v_mfma_f32_16x16x32_bf16 a[4:7], v[60:63], v[196:199], a[4:7]
    ds_read_b64_tr_b16 v[56:57], v20 offset:18656
    ds_read_b64_tr_b16 v[58:59], v20 offset:20960
    s_waitcnt lgkmcnt(12)
    v_mfma_f32_16x16x32_bf16 a[8:11], v[64:67], v[124:127], a[8:11]
    v_mfma_f32_16x16x32_bf16 a[12:15], v[64:67], v[196:199], a[12:15]
    ds_read_b64_tr_b16 v[60:61], v19 offset:18688
    ds_read_b64_tr_b16 v[62:63], v19 offset:20992
    s_waitcnt lgkmcnt(12)
    v_mfma_f32_16x16x32_bf16 a[16:19], v[68:71], v[124:127], a[16:19]
    v_mfma_f32_16x16x32_bf16 a[20:23], v[68:71], v[196:199], a[20:23]
    ds_read_b64_tr_b16 v[64:65], v20 offset:18720
    ds_read_b64_tr_b16 v[66:67], v20 offset:21024
    s_waitcnt lgkmcnt(12)
    v_mfma_f32_16x16x32_bf16 a[24:27], v[40:43], v[124:127], a[24:27]
    v_mfma_f32_16x16x32_bf16 a[28:31], v[40:43], v[196:199], a[28:31]
    ds_read_b64_tr_b16 v[68:69], v19 offset:18752
    ds_read_b64_tr_b16 v[70:71], v19 offset:21056
    s_waitcnt lgkmcnt(12)
    v_mfma_f32_16x16x32_bf16 a[32:35], v[44:47], v[124:127], a[32:35]
    v_mfma_f32_16x16x32_bf16 a[36:39], v[44:47], v[196:199], a[36:39]
    ds_read_b64_tr_b16 v[40:41], v20 offset:18784
    ds_read_b64_tr_b16 v[42:43], v20 offset:21088
    s_waitcnt lgkmcnt(12)
    v_mfma_f32_16x16x32_bf16 a[40:43], v[48:51], v[124:127], a[40:43]
    v_mfma_f32_16x16x32_bf16 a[44:47], v[48:51], v[196:199], a[44:47]
    ds_read_b64_tr_b16 v[44:45], v19 offset:18816
    ds_read_b64_tr_b16 v[46:47], v19 offset:21120
    s_waitcnt lgkmcnt(12)
    v_mfma_f32_16x16x32_bf16 a[48:51], v[52:55], v[124:127], a[48:51]
    v_mfma_f32_16x16x32_bf16 a[52:55], v[52:55], v[196:199], a[52:55]
    ds_read_b64_tr_b16 v[48:49], v20 offset:18848
    ds_read_b64_tr_b16 v[50:51], v20 offset:21152
    s_waitcnt lgkmcnt(12)
    v_mfma_f32_16x16x32_bf16 a[56:59], v[56:59], v[124:127], a[56:59]
    v_mfma_f32_16x16x32_bf16 a[60:63], v[56:59], v[196:199], a[60:63]
    ds_read_b64_tr_b16 v[52:53], v19 offset:18880
    ds_read_b64_tr_b16 v[54:55], v19 offset:21184
    s_waitcnt lgkmcnt(12)
    v_mfma_f32_16x16x32_bf16 a[64:67], v[60:63], v[124:127], a[64:67]
    v_mfma_f32_16x16x32_bf16 a[68:71], v[60:63], v[196:199], a[68:71]
    ds_read_b64_tr_b16 v[56:57], v20 offset:18912
    ds_read_b64_tr_b16 v[58:59], v20 offset:21216
    s_waitcnt lgkmcnt(12)
    v_mfma_f32_16x16x32_bf16 a[72:75], v[64:67], v[124:127], a[72:75]
    v_mfma_f32_16x16x32_bf16 a[76:79], v[64:67], v[196:199], a[76:79]
    ds_read_b64_tr_b16 v[60:61], v19 offset:18944
    ds_read_b64_tr_b16 v[62:63], v19 offset:21248
    s_waitcnt lgkmcnt(12)
    v_mfma_f32_16x16x32_bf16 a[80:83], v[68:71], v[124:127], a[80:83]
    v_mfma_f32_16x16x32_bf16 a[84:87], v[68:71], v[196:199], a[84:87]
    ds_read_b64_tr_b16 v[64:65], v20 offset:18976
    ds_read_b64_tr_b16 v[66:67], v20 offset:21280
    s_waitcnt lgkmcnt(12)
    v_mfma_f32_16x16x32_bf16 a[88:91], v[40:43], v[124:127], a[88:91]
    v_mfma_f32_16x16x32_bf16 a[92:95], v[40:43], v[196:199], a[92:95]
    ds_read_b64_tr_b16 v[68:69], v21 offset:10240
    ds_read_b64_tr_b16 v[70:71], v21 offset:11264
    s_waitcnt lgkmcnt(12)
    v_mfma_f32_16x16x32_bf16 a[96:99], v[44:47], v[124:127], a[96:99]
    v_mfma_f32_16x16x32_bf16 a[100:103], v[44:47], v[196:199], a[100:103]
    ds_read_b64_tr_b16 v[40:41], v22 offset:10240
    ds_read_b64_tr_b16 v[42:43], v22 offset:11264
    s_waitcnt lgkmcnt(12)
    v_mfma_f32_16x16x32_bf16 a[104:107], v[48:51], v[124:127], a[104:107]
    v_mfma_f32_16x16x32_bf16 a[108:111], v[48:51], v[196:199], a[108:111]
    ds_read_b64_tr_b16 v[44:45], v23 offset:10240
    ds_read_b64_tr_b16 v[46:47], v23 offset:11264
    s_waitcnt lgkmcnt(12)
    v_mfma_f32_16x16x32_bf16 a[112:115], v[52:55], v[124:127], a[112:115]
    v_mfma_f32_16x16x32_bf16 a[116:119], v[52:55], v[196:199], a[116:119]
    ds_read_b64_tr_b16 v[48:49], v24 offset:10240
    ds_read_b64_tr_b16 v[50:51], v24 offset:11264
    s_waitcnt lgkmcnt(12)
    v_mfma_f32_16x16x32_bf16 a[120:123], v[56:59], v[124:127], a[120:123]
    v_mfma_f32_16x16x32_bf16 a[124:127], v[56:59], v[196:199], a[124:127]
    ds_read_b64_tr_b16 v[52:53], v25 offset:10240
    ds_read_b64_tr_b16 v[54:55], v25 offset:11264
    s_waitcnt lgkmcnt(12)
    v_mfma_f32_16x16x32_bf16 a[128:131], v[60:63], v[124:127], a[128:131]
    v_mfma_f32_16x16x32_bf16 a[132:135], v[60:63], v[196:199], a[132:135]
    ds_read_b64_tr_b16 v[56:57], v26 offset:10240
    ds_read_b64_tr_b16 v[58:59], v26 offset:11264
    s_waitcnt lgkmcnt(12)
    v_mfma_f32_16x16x32_bf16 a[136:139], v[64:67], v[124:127], a[136:139]
    v_mfma_f32_16x16x32_bf16 a[140:143], v[64:67], v[196:199], a[140:143]
    ds_read_b64_tr_b16 v[60:61], v27 offset:10240
    ds_read_b64_tr_b16 v[62:63], v27 offset:11264
    s_waitcnt lgkmcnt(12)
    v_mfma_f32_16x16x32_bf16 a[144:147], v[68:71], v[124:127], a[144:147]
    v_mfma_f32_16x16x32_bf16 a[148:151], v[68:71], v[196:199], a[148:151]
    s_waitcnt vmcnt(7)
    s_barrier
    s_add_u32 m0, s57, 0
    s_nop 0
    buffer_load_dwordx4 v12, s[20:23], s47 offen lds
    s_add_u32 m0, s57, 4096
    s_nop 0
    buffer_load_dwordx4 v13, s[20:23], s47 offen lds
    s_add_u32 m0, s57, 8192
    s_nop 0
    buffer_load_dwordx4 v14, s[20:23], s47 offen lds
    s_add_u32 m0, s57, 12288
    s_nop 0
    buffer_load_dwordx4 v15, s[20:23], s47 offen lds
    s_mul_i32 s53, s50, 0
    s_add_u32 m0, s49, s53
    s_nop 0
    buffer_load_dwordx4 v16, s[40:43], s47 offen lds
    s_add_u32 m0, s58, 0
    s_nop 0
    buffer_load_dwordx4 v17, s[24:27], s48 offen lds
    s_add_u32 m0, s58, 4096
    s_nop 0
    buffer_load_dwordx4 v18, s[24:27], s48 offen lds
    s_add_u32 s47, s47, 294912
    s_cmp_eq_u32 s47, 5308416
    s_cselect_b32 s47, 0, s47
    s_add_u32 s48, s48, 110592
    s_cmp_eq_u32 s48, 1990656
    s_cselect_b32 s48, 0, s48
    ds_read_b64_tr_b16 v[64:65], v19 offset:36864
    ds_read_b64_tr_b16 v[66:67], v19 offset:39168
    s_waitcnt lgkmcnt(12)
    v_mfma_f32_16x16x32_bf16 a[152:155], v[40:43], v[124:127], a[152:155]
    v_mfma_f32_16x16x32_bf16 a[156:159], v[40:43], v[196:199], a[156:159]
    ds_read_b64_tr_b16 v[68:69], v20 offset:36896
    ds_read_b64_tr_b16 v[70:71], v20 offset:39200
    s_waitcnt lgkmcnt(12)
    v_mfma_f32_16x16x32_bf16 a[160:163], v[44:47], v[124:127], a[160:163]
    v_mfma_f32_16x16x32_bf16 a[164:167], v[44:47], v[196:199], a[164:167]
    ds_read_b64_tr_b16 v[40:41], v19 offset:36928
    ds_read_b64_tr_b16 v[42:43], v19 offset:39232
    s_waitcnt lgkmcnt(12)
    v_mfma_f32_16x16x32_bf16 a[168:171], v[48:51], v[124:127], a[168:171]
    v_mfma_f32_16x16x32_bf16 a[172:175], v[48:51], v[196:199], a[172:175]
    ds_read_b64_tr_b16 v[44:45], v20 offset:36960
    ds_read_b64_tr_b16 v[46:47], v20 offset:39264
    s_waitcnt lgkmcnt(12)
    v_mfma_f32_16x16x32_bf16 a[176:179], v[52:55], v[124:127], a[176:179]
    v_mfma_f32_16x16x32_bf16 a[180:183], v[52:55], v[196:199], a[180:183]
    ds_read_b64_tr_b16 v[48:49], v19 offset:36992
    ds_read_b64_tr_b16 v[50:51], v19 offset:39296
    s_waitcnt lgkmcnt(12)
    v_mfma_f32_16x16x32_bf16 a[184:187], v[56:59], v[124:127], a[184:187]
    v_mfma_f32_16x16x32_bf16 a[188:191], v[56:59], v[196:199], a[188:191]
    ds_read_b64_tr_b16 v[52:53], v20 offset:37024
    ds_read_b64_tr_b16 v[54:55], v20 offset:39328
    s_waitcnt lgkmcnt(12)
    v_mfma_f32_16x16x32_bf16 a[192:195], v[60:63], v[124:127], a[192:195]
    v_mfma_f32_16x16x32_bf16 a[196:199], v[60:63], v[196:199], a[196:199]
    ds_read_b64_tr_b16 v[56:57], v19 offset:37056
    ds_read_b64_tr_b16 v[58:59], v19 offset:39360
    s_waitcnt lgkmcnt(12)
    v_mfma_f32_16x16x32_bf16 a[0:3], v[64:67], v[128:131], a[0:3]
    v_mfma_f32_16x16x32_bf16 a[4:7], v[64:67], v[200:203], a[4:7]
    ds_read_b64_tr_b16 v[60:61], v20 offset:37088
    ds_read_b64_tr_b16 v[62:63], v20 offset:39392
    s_waitcnt lgkmcnt(12)
    v_mfma_f32_16x16x32_bf16 a[8:11], v[68:71], v[128:131], a[8:11]
    v_mfma_f32_16x16x32_bf16 a[12:15], v[68:71], v[200:203], a[12:15]
    ds_read_b64_tr_b16 v[64:65], v19 offset:37120
    ds_read_b64_tr_b16 v[66:67], v19 offset:39424
    s_waitcnt lgkmcnt(12)
    v_mfma_f32_16x16x32_bf16 a[16:19], v[40:43], v[128:131], a[16:19]
    v_mfma_f32_16x16x32_bf16 a[20:23], v[40:43], v[200:203], a[20:23]
    ds_read_b64_tr_b16 v[68:69], v20 offset:37152
    ds_read_b64_tr_b16 v[70:71], v20 offset:39456
    s_waitcnt lgkmcnt(12)
    v_mfma_f32_16x16x32_bf16 a[24:27], v[44:47], v[128:131], a[24:27]
    v_mfma_f32_16x16x32_bf16 a[28:31], v[44:47], v[200:203], a[28:31]
    ds_read_b64_tr_b16 v[40:41], v19 offset:37184
    ds_read_b64_tr_b16 v[42:43], v19 offset:39488
    s_waitcnt lgkmcnt(12)
    v_mfma_f32_16x16x32_bf16 a[32:35], v[48:51], v[128:131], a[32:35]
    v_mfma_f32_16x16x32_bf16 a[36:39], v[48:51], v[200:203], a[36:39]
    ds_read_b64_tr_b16 v[44:45], v20 offset:37216
    ds_read_b64_tr_b16 v[46:47], v20 offset:39520
    s_waitcnt lgkmcnt(12)
    v_mfma_f32_16x16x32_bf16 a[40:43], v[52:55], v[128:131], a[40:43]
    v_mfma_f32_16x16x32_bf16 a[44:47], v[52:55], v[200:203], a[44:47]
    ds_read_b64_tr_b16 v[48:49], v19 offset:37248
    ds_read_b64_tr_b16 v[50:51], v19 offset:39552
    s_waitcnt lgkmcnt(12)
    v_mfma_f32_16x16x32_bf16 a[48:51], v[56:59], v[128:131], a[48:51]
    v_mfma_f32_16x16x32_bf16 a[52:55], v[56:59], v[200:203], a[52:55]
    ds_read_b64_tr_b16 v[52:53], v20 offset:37280
    ds_read_b64_tr_b16 v[54:55], v20 offset:39584
    s_waitcnt lgkmcnt(12)
    v_mfma_f32_16x16x32_bf16 a[56:59], v[60:63], v[128:131], a[56:59]
    v_mfma_f32_16x16x32_bf16 a[60:63], v[60:63], v[200:203], a[60:63]
    ds_read_b64_tr_b16 v[56:57], v19 offset:37312
    ds_read_b64_tr_b16 v[58:59], v19 offset:39616
    s_waitcnt lgkmcnt(12)
    v_mfma_f32_16x16x32_bf16 a[64:67], v[64:67], v[128:131], a[64:67]
    v_mfma_f32_16x16x32_bf16 a[68:71], v[64:67], v[200:203], a[68:71]
    ds_read_b64_tr_b16 v[60:61], v20 offset:37344
    ds_read_b64_tr_b16 v[62:63], v20 offset:39648
    s_waitcnt lgkmcnt(12)
    v_mfma_f32_16x16x32_bf16 a[72:75], v[68:71], v[128:131], a[72:75]
    v_mfma_f32_16x16x32_bf16 a[76:79], v[68:71], v[200:203], a[76:79]
    ds_read_b64_tr_b16 v[64:65], v19 offset:37376
    ds_read_b64_tr_b16 v[66:67], v19 offset:39680
    s_waitcnt lgkmcnt(12)
    v_mfma_f32_16x16x32_bf16 a[80:83], v[40:43], v[128:131], a[80:83]
    v_mfma_f32_16x16x32_bf16 a[84:87], v[40:43], v[200:203], a[84:87]
    ds_read_b64_tr_b16 v[68:69], v20 offset:37408
    ds_read_b64_tr_b16 v[70:71], v20 offset:39712
    s_waitcnt lgkmcnt(12)
    v_mfma_f32_16x16x32_bf16 a[88:91], v[44:47], v[128:131], a[88:91]
    v_mfma_f32_16x16x32_bf16 a[92:95], v[44:47], v[200:203], a[92:95]
    ds_read_b64_tr_b16 v[40:41], v21 offset:20480
    ds_read_b64_tr_b16 v[42:43], v21 offset:21504
    s_waitcnt lgkmcnt(12)
    v_mfma_f32_16x16x32_bf16 a[96:99], v[48:51], v[128:131], a[96:99]
    v_mfma_f32_16x16x32_bf16 a[100:103], v[48:51], v[200:203], a[100:103]
    ds_read_b64_tr_b16 v[44:45], v22 offset:20480
    ds_read_b64_tr_b16 v[46:47], v22 offset:21504
    s_waitcnt lgkmcnt(12)
    v_mfma_f32_16x16x32_bf16 a[104:107], v[52:55], v[128:131], a[104:107]
    v_mfma_f32_16x16x32_bf16 a[108:111], v[52:55], v[200:203], a[108:111]
    ds_read_b64_tr_b16 v[48:49], v23 offset:20480
    ds_read_b64_tr_b16 v[50:51], v23 offset:21504
    s_waitcnt lgkmcnt(12)
    v_mfma_f32_16x16x32_bf16 a[112:115], v[56:59], v[128:131], a[112:115]
    v_mfma_f32_16x16x32_bf16 a[116:119], v[56:59], v[200:203], a[116:119]
    ds_read_b64_tr_b16 v[52:53], v24 offset:20480
    ds_read_b64_tr_b16 v[54:55], v24 offset:21504
    s_waitcnt lgkmcnt(12)
    v_mfma_f32_16x16x32_bf16 a[120:123], v[60:63], v[128:131], a[120:123]
    v_mfma_f32_16x16x32_bf16 a[124:127], v[60:63], v[200:203], a[124:127]
    ds_read_b64_tr_b16 v[56:57], v25 offset:20480
    ds_read_b64_tr_b16 v[58:59], v25 offset:21504
    s_waitcnt lgkmcnt(12)
    v_mfma_f32_16x16x32_bf16 a[128:131], v[64:67], v[128:131], a[128:131]
    v_mfma_f32_16x16x32_bf16 a[132:135], v[64:67], v[200:203], a[132:135]
    ds_read_b64_tr_b16 v[60:61], v26 offset:20480
    ds_read_b64_tr_b16 v[62:63], v26 offset:21504
    s_waitcnt lgkmcnt(12)
    v_mfma_f32_16x16x32_bf16 a[136:139], v[68:71], v[128:131], a[136:139]
    v_mfma_f32_16x16x32_bf16 a[140:143], v[68:71], v[200:203], a[140:143]
    ds_read_b64_tr_b16 v[64:65], v27 offset:20480
    ds_read_b64_tr_b16 v[66:67], v27 offset:21504
    s_waitcnt lgkmcnt(12)
    v_mfma_f32_16x16x32_bf16 a[144:147], v[40:43], v[128:131], a[144:147]
    v_mfma_f32_16x16x32_bf16 a[148:151], v[40:43], v[200:203], a[148:151]
    s_waitcnt vmcnt(7)
    s_barrier
    s_add_u32 m0, s57, 18432
    s_nop 0
    buffer_load_dwordx4 v12, s[20:23], s47 offen lds
    s_add_u32 m0, s57, 22528
    s_nop 0
    buffer_load_dwordx4 v13, s[20:23], s47 offen lds
    s_add_u32 m0, s57, 26624
    s_nop 0
    buffer_load_dwordx4 v14, s[20:23], s47 offen lds
    s_add_u32 m0, s57, 30720
    s_nop 0
    buffer_load_dwordx4 v15, s[20:23], s47 offen lds
    s_mul_i32 s53, s50, 1
    s_add_u32 m0, s49, s53
    s_nop 0
    buffer_load_dwordx4 v16, s[40:43], s47 offen lds
    s_add_u32 m0, s58, 10240
    s_nop 0
    buffer_load_dwordx4 v17, s[24:27], s48 offen lds
    s_add_u32 m0, s58, 14336
    s_nop 0
    buffer_load_dwordx4 v18, s[24:27], s48 offen lds
    s_add_u32 s47, s47, 294912
    s_cmp_eq_u32 s47, 5308416
    s_cselect_b32 s47, 0, s47
    s_add_u32 s48, s48, 110592
    s_cmp_eq_u32 s48, 1990656
    s_cselect_b32 s48, 0, s48
    ds_read_b64_tr_b16 v[68:69], v19 offset:55296
    ds_read_b64_tr_b16 v[70:71], v19 offset:57600
    s_waitcnt lgkmcnt(12)
    v_mfma_f32_16x16x32_bf16 a[152:155], v[44:47], v[128:131], a[152:155]
    v_mfma_f32_16x16x32_bf16 a[156:159], v[44:47], v[200:203], a[156:159]
    ds_read_b64_tr_b16 v[40:41], v20 offset:55328
    ds_read_b64_tr_b16 v[42:43], v20 offset:57632
    s_waitcnt lgkmcnt(12)
    v_mfma_f32_16x16x32_bf16 a[160:163], v[48:51], v[128:131], a[160:163]
    v_mfma_f32_16x16x32_bf16 a[164:167], v[48:51], v[200:203], a[164:167]
    ds_read_b64_tr_b16 v[44:45], v19 offset:55360
    ds_read_b64_tr_b16 v[46:47], v19 offset:57664
    s_waitcnt lgkmcnt(12)
    v_mfma_f32_16x16x32_bf16 a[168:171], v[52:55], v[128:131], a[168:171]
    v_mfma_f32_16x16x32_bf16 a[172:175], v[52:55], v[200:203], a[172:175]
    ds_read_b64_tr_b16 v[48:49], v20 offset:55392
    ds_read_b64_tr_b16 v[50:51], v20 offset:57696
    s_waitcnt lgkmcnt(12)
    v_mfma_f32_16x16x32_bf16 a[176:179], v[56:59], v[128:131], a[176:179]
    v_mfma_f32_16x16x32_bf16 a[180:183], v[56:59], v[200:203], a[180:183]
    ds_read_b64_tr_b16 v[52:53], v19 offset:55424
    ds_read_b64_tr_b16 v[54:55], v19 offset:57728
    s_waitcnt lgkmcnt(12)
    v_mfma_f32_16x16x32_bf16 a[184:187], v[60:63], v[128:131], a[184:187]
    v_mfma_f32_16x16x32_bf16 a[188:191], v[60:63], v[200:203], a[188:191]
    ds_read_b64_tr_b16 v[56:57], v20 offset:55456
    ds_read_b64_tr_b16 v[58:59], v20 offset:57760
    s_waitcnt lgkmcnt(12)
    v_mfma_f32_16x16x32_bf16 a[192:195], v[64:67], v[128:131], a[192:195]
    v_mfma_f32_16x16x32_bf16 a[196:199], v[64:67], v[200:203], a[196:199]
    ds_read_b64_tr_b16 v[60:61], v19 offset:55488
    ds_read_b64_tr_b16 v[62:63], v19 offset:57792
    s_waitcnt lgkmcnt(12)
    v_mfma_f32_16x16x32_bf16 a[0:3], v[68:71], v[132:135], a[0:3]
    v_mfma_f32_16x16x32_bf16 a[4:7], v[68:71], v[204:207], a[4:7]
    ds_read_b64_tr_b16 v[64:65], v20 offset:55520
    ds_read_b64_tr_b16 v[66:67], v20 offset:57824
    s_waitcnt lgkmcnt(12)
    v_mfma_f32_16x16x32_bf16 a[8:11], v[40:43], v[132:135], a[8:11]
    v_mfma_f32_16x16x32_bf16 a[12:15], v[40:43], v[204:207], a[12:15]
    ds_read_b64_tr_b16 v[68:69], v19 offset:55552
    ds_read_b64_tr_b16 v[70:71], v19 offset:57856
    s_waitcnt lgkmcnt(12)
    v_mfma_f32_16x16x32_bf16 a[16:19], v[44:47], v[132:135], a[16:19]
    v_mfma_f32_16x16x32_bf16 a[20:23], v[44:47], v[204:207], a[20:23]
    ds_read_b64_tr_b16 v[40:41], v20 offset:55584
    ds_read_b64_tr_b16 v[42:43], v20 offset:57888
    s_waitcnt lgkmcnt(12)
    v_mfma_f32_16x16x32_bf16 a[24:27], v[48:51], v[132:135], a[24:27]
    v_mfma_f32_16x16x32_bf16 a[28:31], v[48:51], v[204:207], a[28:31]
    ds_read_b64_tr_b16 v[44:45], v19 offset:55616
    ds_read_b64_tr_b16 v[46:47], v19 offset:57920
    s_waitcnt lgkmcnt(12)
    v_mfma_f32_16x16x32_bf16 a[32:35], v[52:55], v[132:135], a[32:35]
    v_mfma_f32_16x16x32_bf16 a[36:39], v[52:55], v[204:207], a[36:39]
    ds_read_b64_tr_b16 v[48:49], v20 offset:55648
    ds_read_b64_tr_b16 v[50:51], v20 offset:57952
    s_waitcnt lgkmcnt(12)
    v_mfma_f32_16x16x32_bf16 a[40:43], v[56:59], v[132:135], a[40:43]
    v_mfma_f32_16x16x32_bf16 a[44:47], v[56:59], v[204:207], a[44:47]
    ds_read_b64_tr_b16 v[52:53], v19 offset:55680
    ds_read_b64_tr_b16 v[54:55], v19 offset:57984
    s_waitcnt lgkmcnt(12)
    v_mfma_f32_16x16x32_bf16 a[48:51], v[60:63], v[132:135], a[48:51]
    v_mfma_f32_16x16x32_bf16 a[52:55], v[60:63], v[204:207], a[52:55]
    ds_read_b64_tr_b16 v[56:57], v20 offset:55712
    ds_read_b64_tr_b16 v[58:59], v20 offset:58016
    s_waitcnt lgkmcnt(12)
    v_mfma_f32_16x16x32_bf16 a[56:59], v[64:67], v[132:135], a[56:59]
    v_mfma_f32_16x16x32_bf16 a[60:63], v[64:67], v[204:207], a[60:63]
    ds_read_b64_tr_b16 v[60:61], v19 offset:55744
    ds_read_b64_tr_b16 v[62:63], v19 offset:58048
    s_waitcnt lgkmcnt(12)
    v_mfma_f32_16x16x32_bf16 a[64:67], v[68:71], v[132:135], a[64:67]
    v_mfma_f32_16x16x32_bf16 a[68:71], v[68:71], v[204:207], a[68:71]
    ds_read_b64_tr_b16 v[64:65], v20 offset:55776
    ds_read_b64_tr_b16 v[66:67], v20 offset:58080
    s_waitcnt lgkmcnt(12)
    v_mfma_f32_16x16x32_bf16 a[72:75], v[40:43], v[132:135], a[72:75]
    v_mfma_f32_16x16x32_bf16 a[76:79], v[40:43], v[204:207], a[76:79]
    ds_read_b64_tr_b16 v[68:69], v19 offset:55808
    ds_read_b64_tr_b16 v[70:71], v19 offset:58112
    s_waitcnt lgkmcnt(12)
    v_mfma_f32_16x16x32_bf16 a[80:83], v[44:47], v[132:135], a[80:83]
    v_mfma_f32_16x16x32_bf16 a[84:87], v[44:47], v[204:207], a[84:87]
    ds_read_b64_tr_b16 v[40:41], v20 offset:55840
    ds_read_b64_tr_b16 v[42:43], v20 offset:58144
    s_waitcnt lgkmcnt(12)
    v_mfma_f32_16x16x32_bf16 a[88:91], v[48:51], v[132:135], a[88:91]
    v_mfma_f32_16x16x32_bf16 a[92:95], v[48:51], v[204:207], a[92:95]
    ds_read_b64_tr_b16 v[44:45], v21 offset:30720
    ds_read_b64_tr_b16 v[46:47], v21 offset:31744
    s_waitcnt lgkmcnt(12)
    v_mfma_f32_16x16x32_bf16 a[96:99], v[52:55], v[132:135], a[96:99]
    v_mfma_f32_16x16x32_bf16 a[100:103], v[52:55], v[204:207], a[100:103]
    ds_read_b64_tr_b16 v[48:49], v22 offset:30720
    ds_read_b64_tr_b16 v[50:51], v22 offset:31744
    s_waitcnt lgkmcnt(12)
    v_mfma_f32_16x16x32_bf16 a[104:107], v[56:59], v[132:135], a[104:107]
    v_mfma_f32_16x16x32_bf16 a[108:111], v[56:59], v[204:207], a[108:111]
    ds_read_b64_tr_b16 v[52:53], v23 offset:30720
    ds_read_b64_tr_b16 v[54:55], v23 offset:31744
    s_waitcnt lgkmcnt(12)
    v_mfma_f32_16x16x32_bf16 a[112:115], v[60:63], v[132:135], a[112:115]
    v_mfma_f32_16x16x32_bf16 a[116:119], v[60:63], v[204:207], a[116:119]
    ds_read_b64_tr_b16 v[56:57], v24 offset:30720
    ds_read_b64_tr_b16 v[58:59], v24 offset:31744
    s_waitcnt lgkmcnt(12)
    v_mfma_f32_16x16x32_bf16 a[120:123], v[64:67], v[132:135], a[120:123]
    v_mfma_f32_16x16x32_bf16 a[124:127], v[64:67], v[204:207], a[124:127]
    ds_read_b64_tr_b16 v[60:61], v25 offset:30720
    ds_read_b64_tr_b16 v[62:63], v25 offset:31744
    s_waitcnt lgkmcnt(12)
    v_mfma_f32_16x16x32_bf16 a[128:131], v[68:71], v[132:135], a[128:131]
    v_mfma_f32_16x16x32_bf16 a[132:135], v[68:71], v[204:207], a[132:135]
    ds_read_b64_tr_b16 v[64:65], v26 offset:30720
    ds_read_b64_tr_b16 v[66:67], v26 offset:31744
    s_waitcnt lgkmcnt(12)
    v_mfma_f32_16x16x32_bf16 a[136:139], v[40:43], v[132:135], a[136:139]
    v_mfma_f32_16x16x32_bf16 a[140:143], v[40:43], v[204:207], a[140:143]
    ds_read_b64_tr_b16 v[68:69], v27 offset:30720
    ds_read_b64_tr_b16 v[70:71], v27 offset:31744
    s_waitcnt lgkmcnt(12)
    v_mfma_f32_16x16x32_bf16 a[144:147], v[44:47], v[132:135], a[144:147]
    v_mfma_f32_16x16x32_bf16 a[148:151], v[44:47], v[204:207], a[148:151]
    s_waitcnt vmcnt(7)
    s_barrier
    ds_read_b64_tr_b16 v[40:41], v19 offset:0
    ds_read_b64_tr_b16 v[42:43], v19 offset:2304
    s_waitcnt lgkmcnt(12)
    v_mfma_f32_16x16x32_bf16 a[152:155], v[48:51], v[132:135], a[152:155]
    v_mfma_f32_16x16x32_bf16 a[156:159], v[48:51], v[204:207], a[156:159]
    ds_read_b64_tr_b16 v[44:45], v20 offset:32
    ds_read_b64_tr_b16 v[46:47], v20 offset:2336
    s_waitcnt lgkmcnt(12)
    v_mfma_f32_16x16x32_bf16 a[160:163], v[52:55], v[132:135], a[160:163]
    v_mfma_f32_16x16x32_bf16 a[164:167], v[52:55], v[204:207], a[164:167]
    ds_read_b64_tr_b16 v[48:49], v19 offset:64
    ds_read_b64_tr_b16 v[50:51], v19 offset:2368
    s_waitcnt lgkmcnt(12)
    v_mfma_f32_16x16x32_bf16 a[168:171], v[56:59], v[132:135], a[168:171]
    v_mfma_f32_16x16x32_bf16 a[172:175], v[56:59], v[204:207], a[172:175]
    ds_read_b64_tr_b16 v[52:53], v20 offset:96
    ds_read_b64_tr_b16 v[54:55], v20 offset:2400
    s_waitcnt lgkmcnt(12)
    v_mfma_f32_16x16x32_bf16 a[176:179], v[60:63], v[132:135], a[176:179]
    v_mfma_f32_16x16x32_bf16 a[180:183], v[60:63], v[204:207], a[180:183]
    ds_read_b64_tr_b16 v[56:57], v19 offset:128
    ds_read_b64_tr_b16 v[58:59], v19 offset:2432
    s_waitcnt lgkmcnt(12)
    v_mfma_f32_16x16x32_bf16 a[184:187], v[64:67], v[132:135], a[184:187]
    v_mfma_f32_16x16x32_bf16 a[188:191], v[64:67], v[204:207], a[188:191]
    ds_read_b64_tr_b16 v[60:61], v20 offset:160
    ds_read_b64_tr_b16 v[62:63], v20 offset:2464
    s_waitcnt lgkmcnt(12)
    v_mfma_f32_16x16x32_bf16 a[192:195], v[68:71], v[132:135], a[192:195]
    v_mfma_f32_16x16x32_bf16 a[196:199], v[68:71], v[204:207], a[196:199]
    ds_read_b64_tr_b16 v[64:65], v19 offset:192
    ds_read_b64_tr_b16 v[66:67], v19 offset:2496
    s_waitcnt lgkmcnt(12)
    v_mfma_f32_16x16x32_bf16 a[0:3], v[40:43], v[136:139], a[0:3]
    v_mfma_f32_16x16x32_bf16 a[4:7], v[40:43], v[208:211], a[4:7]
    ds_read_b64_tr_b16 v[68:69], v20 offset:224
    ds_read_b64_tr_b16 v[70:71], v20 offset:2528
    s_waitcnt lgkmcnt(12)
    v_mfma_f32_16x16x32_bf16 a[8:11], v[44:47], v[136:139], a[8:11]
    v_mfma_f32_16x16x32_bf16 a[12:15], v[44:47], v[208:211], a[12:15]
    ds_read_b64_tr_b16 v[40:41], v19 offset:256
    ds_read_b64_tr_b16 v[42:43], v19 offset:2560
    s_waitcnt lgkmcnt(12)
    v_mfma_f32_16x16x32_bf16 a[16:19], v[48:51], v[136:139], a[16:19]
    v_mfma_f32_16x16x32_bf16 a[20:23], v[48:51], v[208:211], a[20:23]
    ds_read_b64_tr_b16 v[44:45], v20 offset:288
    ds_read_b64_tr_b16 v[46:47], v20 offset:2592
    s_waitcnt lgkmcnt(12)
    v_mfma_f32_16x16x32_bf16 a[24:27], v[52:55], v[136:139], a[24:27]
    v_mfma_f32_16x16x32_bf16 a[28:31], v[52:55], v[208:211], a[28:31]
    ds_read_b64_tr_b16 v[48:49], v19 offset:320
    ds_read_b64_tr_b16 v[50:51], v19 offset:2624
    s_waitcnt lgkmcnt(12)
    v_mfma_f32_16x16x32_bf16 a[32:35], v[56:59], v[136:139], a[32:35]
    v_mfma_f32_16x16x32_bf16 a[36:39], v[56:59], v[208:211], a[36:39]
    ds_read_b64_tr_b16 v[52:53], v20 offset:352
    ds_read_b64_tr_b16 v[54:55], v20 offset:2656
    s_waitcnt lgkmcnt(12)
    v_mfma_f32_16x16x32_bf16 a[40:43], v[60:63], v[136:139], a[40:43]
    v_mfma_f32_16x16x32_bf16 a[44:47], v[60:63], v[208:211], a[44:47]
    ds_read_b64_tr_b16 v[56:57], v19 offset:384
    ds_read_b64_tr_b16 v[58:59], v19 offset:2688
    s_waitcnt lgkmcnt(12)
    v_mfma_f32_16x16x32_bf16 a[48:51], v[64:67], v[136:139], a[48:51]
    v_mfma_f32_16x16x32_bf16 a[52:55], v[64:67], v[208:211], a[52:55]
    ds_read_b64_tr_b16 v[60:61], v20 offset:416
    ds_read_b64_tr_b16 v[62:63], v20 offset:2720
    s_waitcnt lgkmcnt(12)
    v_mfma_f32_16x16x32_bf16 a[56:59], v[68:71], v[136:139], a[56:59]
    v_mfma_f32_16x16x32_bf16 a[60:63], v[68:71], v[208:211], a[60:63]
    ds_read_b64_tr_b16 v[64:65], v19 offset:448
    ds_read_b64_tr_b16 v[66:67], v19 offset:2752
    s_waitcnt lgkmcnt(12)
    v_mfma_f32_16x16x32_bf16 a[64:67], v[40:43], v[136:139], a[64:67]
    v_mfma_f32_16x16x32_bf16 a[68:71], v[40:43], v[208:211], a[68:71]
    ds_read_b64_tr_b16 v[68:69], v20 offset:480
    ds_read_b64_tr_b16 v[70:71], v20 offset:2784
    s_waitcnt lgkmcnt(12)
    v_mfma_f32_16x16x32_bf16 a[72:75], v[44:47], v[136:139], a[72:75]
    v_mfma_f32_16x16x32_bf16 a[76:79], v[44:47], v[208:211], a[76:79]
    ds_read_b64_tr_b16 v[40:41], v19 offset:512
    ds_read_b64_tr_b16 v[42:43], v19 offset:2816
    s_waitcnt lgkmcnt(12)
    v_mfma_f32_16x16x32_bf16 a[80:83], v[48:51], v[136:139], a[80:83]
    v_mfma_f32_16x16x32_bf16 a[84:87], v[48:51], v[208:211], a[84:87]
    ds_read_b64_tr_b16 v[44:45], v20 offset:544
    ds_read_b64_tr_b16 v[46:47], v20 offset:2848
    s_waitcnt lgkmcnt(12)
    v_mfma_f32_16x16x32_bf16 a[88:91], v[52:55], v[136:139], a[88:91]
    v_mfma_f32_16x16x32_bf16 a[92:95], v[52:55], v[208:211], a[92:95]
    ds_read_b64_tr_b16 v[48:49], v21 offset:0
    ds_read_b64_tr_b16 v[50:51], v21 offset:1024
    s_waitcnt lgkmcnt(12)
    v_mfma_f32_16x16x32_bf16 a[96:99], v[56:59], v[136:139], a[96:99]
    v_mfma_f32_16x16x32_bf16 a[100:103], v[56:59], v[208:211], a[100:103]
    ds_read_b64_tr_b16 v[52:53], v22 offset:0
    ds_read_b64_tr_b16 v[54:55], v22 offset:1024
    s_waitcnt lgkmcnt(12)
    v_mfma_f32_16x16x32_bf16 a[104:107], v[60:63], v[136:139], a[104:107]
    v_mfma_f32_16x16x32_bf16 a[108:111], v[60:63], v[208:211], a[108:111]
    ds_read_b64_tr_b16 v[56:57], v23 offset:0
    ds_read_b64_tr_b16 v[58:59], v23 offset:1024
    s_waitcnt lgkmcnt(12)
    v_mfma_f32_16x16x32_bf16 a[112:115], v[64:67], v[136:139], a[112:115]
    v_mfma_f32_16x16x32_bf16 a[116:119], v[64:67], v[208:211], a[116:119]
    ds_read_b64_tr_b16 v[60:61], v24 offset:0
    ds_read_b64_tr_b16 v[62:63], v24 offset:1024
    s_waitcnt lgkmcnt(12)
    v_mfma_f32_16x16x32_bf16 a[120:123], v[68:71], v[136:139], a[120:123]
    v_mfma_f32_16x16x32_bf16 a[124:127], v[68:71], v[208:211], a[124:127]
    ds_read_b64_tr_b16 v[64:65], v25 offset:0
    ds_read_b64_tr_b16 v[66:67], v25 offset:1024
    s_waitcnt lgkmcnt(12)
    v_mfma_f32_16x16x32_bf16 a[128:131], v[40:43], v[136:139], a[128:131]
    v_mfma_f32_16x16x32_bf16 a[132:135], v[40:43], v[208:211], a[132:135]
    ds_read_b64_tr_b16 v[68:69], v26 offset:0
    ds_read_b64_tr_b16 v[70:71], v26 offset:1024
    s_waitcnt lgkmcnt(12)
    v_mfma_f32_16x16x32_bf16 a[136:139], v[44:47], v[136:139], a[136:139]
    v_mfma_f32_16x16x32_bf16 a[140:143], v[44:47], v[208:211], a[140:143]
    ds_read_b64_tr_b16 v[40:41], v27 offset:0
    ds_read_b64_tr_b16 v[42:43], v27 offset:1024
    s_waitcnt lgkmcnt(12)
    v_mfma_f32_16x16x32_bf16 a[144:147], v[48:51], v[136:139], a[144:147]
    v_mfma_f32_16x16x32_bf16 a[148:151], v[48:51], v[208:211], a[148:151]
    s_waitcnt vmcnt(0)
    s_barrier
    ds_read_b64_tr_b16 v[44:45], v19 offset:18432
    ds_read_b64_tr_b16 v[46:47], v19 offset:20736
    s_waitcnt lgkmcnt(12)
    v_mfma_f32_16x16x32_bf16 a[152:155], v[52:55], v[136:139], a[152:155]
    v_mfma_f32_16x16x32_bf16 a[156:159], v[52:55], v[208:211], a[156:159]
    ds_read_b64_tr_b16 v[48:49], v20 offset:18464
    ds_read_b64_tr_b16 v[50:51], v20 offset:20768
    s_waitcnt lgkmcnt(12)
    v_mfma_f32_16x16x32_bf16 a[160:163], v[56:59], v[136:139], a[160:163]
    v_mfma_f32_16x16x32_bf16 a[164:167], v[56:59], v[208:211], a[164:167]
    ds_read_b64_tr_b16 v[52:53], v19 offset:18496
    ds_read_b64_tr_b16 v[54:55], v19 offset:20800
    s_waitcnt lgkmcnt(12)
    v_mfma_f32_16x16x32_bf16 a[168:171], v[60:63], v[136:139], a[168:171]
    v_mfma_f32_16x16x32_bf16 a[172:175], v[60:63], v[208:211], a[172:175]
    ds_read_b64_tr_b16 v[56:57], v20 offset:18528
    ds_read_b64_tr_b16 v[58:59], v20 offset:20832
    s_waitcnt lgkmcnt(12)
    v_mfma_f32_16x16x32_bf16 a[176:179], v[64:67], v[136:139], a[176:179]
    v_mfma_f32_16x16x32_bf16 a[180:183], v[64:67], v[208:211], a[180:183]
    ds_read_b64_tr_b16 v[60:61], v19 offset:18560
    ds_read_b64_tr_b16 v[62:63], v19 offset:20864
    s_waitcnt lgkmcnt(12)
    v_mfma_f32_16x16x32_bf16 a[184:187], v[68:71], v[136:139], a[184:187]
    v_mfma_f32_16x16x32_bf16 a[188:191], v[68:71], v[208:211], a[188:191]
    ds_read_b64_tr_b16 v[64:65], v20 offset:18592
    ds_read_b64_tr_b16 v[66:67], v20 offset:20896
    s_waitcnt lgkmcnt(12)
    v_mfma_f32_16x16x32_bf16 a[192:195], v[40:43], v[136:139], a[192:195]
    v_mfma_f32_16x16x32_bf16 a[196:199], v[40:43], v[208:211], a[196:199]
    ds_read_b64_tr_b16 v[68:69], v19 offset:18624
    ds_read_b64_tr_b16 v[70:71], v19 offset:20928
    s_waitcnt lgkmcnt(12)
    v_mfma_f32_16x16x32_bf16 a[0:3], v[44:47], v[140:143], a[0:3]
    v_mfma_f32_16x16x32_bf16 a[4:7], v[44:47], v[212:215], a[4:7]
    ds_read_b64_tr_b16 v[40:41], v20 offset:18656
    ds_read_b64_tr_b16 v[42:43], v20 offset:20960
    s_waitcnt lgkmcnt(12)
    v_mfma_f32_16x16x32_bf16 a[8:11], v[48:51], v[140:143], a[8:11]
    v_mfma_f32_16x16x32_bf16 a[12:15], v[48:51], v[212:215], a[12:15]
    ds_read_b64_tr_b16 v[44:45], v19 offset:18688
    ds_read_b64_tr_b16 v[46:47], v19 offset:20992
    s_waitcnt lgkmcnt(12)
    v_mfma_f32_16x16x32_bf16 a[16:19], v[52:55], v[140:143], a[16:19]
    v_mfma_f32_16x16x32_bf16 a[20:23], v[52:55], v[212:215], a[20:23]
    ds_read_b64_tr_b16 v[48:49], v20 offset:18720
    ds_read_b64_tr_b16 v[50:51], v20 offset:21024
    s_waitcnt lgkmcnt(12)
    v_mfma_f32_16x16x32_bf16 a[24:27], v[56:59], v[140:143], a[24:27]
    v_mfma_f32_16x16x32_bf16 a[28:31], v[56:59], v[212:215], a[28:31]
    ds_read_b64_tr_b16 v[52:53], v19 offset:18752
    ds_read_b64_tr_b16 v[54:55], v19 offset:21056
    s_waitcnt lgkmcnt(12)
    v_mfma_f32_16x16x32_bf16 a[32:35], v[60:63], v[140:143], a[32:35]
    v_mfma_f32_16x16x32_bf16 a[36:39], v[60:63], v[212:215], a[36:39]
    ds_read_b64_tr_b16 v[56:57], v20 offset:18784
    ds_read_b64_tr_b16 v[58:59], v20 offset:21088
    s_waitcnt lgkmcnt(12)
    v_mfma_f32_16x16x32_bf16 a[40:43], v[64:67], v[140:143], a[40:43]
    v_mfma_f32_16x16x32_bf16 a[44:47], v[64:67], v[212:215], a[44:47]
    ds_read_b64_tr_b16 v[60:61], v19 offset:18816
    ds_read_b64_tr_b16 v[62:63], v19 offset:21120
    s_waitcnt lgkmcnt(12)
    v_mfma_f32_16x16x32_bf16 a[48:51], v[68:71], v[140:143], a[48:51]
    v_mfma_f32_16x16x32_bf16 a[52:55], v[68:71], v[212:215], a[52:55]
    ds_read_b64_tr_b16 v[64:65], v20 offset:18848
    ds_read_b64_tr_b16 v[66:67], v20 offset:21152
    s_waitcnt lgkmcnt(12)
    v_mfma_f32_16x16x32_bf16 a[56:59], v[40:43], v[140:143], a[56:59]
    v_mfma_f32_16x16x32_bf16 a[60:63], v[40:43], v[212:215], a[60:63]
    ds_read_b64_tr_b16 v[68:69], v19 offset:18880
    ds_read_b64_tr_b16 v[70:71], v19 offset:21184
    s_waitcnt lgkmcnt(12)
    v_mfma_f32_16x16x32_bf16 a[64:67], v[44:47], v[140:143], a[64:67]
    v_mfma_f32_16x16x32_bf16 a[68:71], v[44:47], v[212:215], a[68:71]
    ds_read_b64_tr_b16 v[40:41], v20 offset:18912
    ds_read_b64_tr_b16 v[42:43], v20 offset:21216
    s_waitcnt lgkmcnt(12)
    v_mfma_f32_16x16x32_bf16 a[72:75], v[48:51], v[140:143], a[72:75]
    v_mfma_f32_16x16x32_bf16 a[76:79], v[48:51], v[212:215], a[76:79]
    ds_read_b64_tr_b16 v[44:45], v19 offset:18944
    ds_read_b64_tr_b16 v[46:47], v19 offset:21248
    s_waitcnt lgkmcnt(12)
    v_mfma_f32_16x16x32_bf16 a[80:83], v[52:55], v[140:143], a[80:83]
    v_mfma_f32_16x16x32_bf16 a[84:87], v[52:55], v[212:215], a[84:87]
    ds_read_b64_tr_b16 v[48:49], v20 offset:18976
    ds_read_b64_tr_b16 v[50:51], v20 offset:21280
    s_waitcnt lgkmcnt(12)
    v_mfma_f32_16x16x32_bf16 a[88:91], v[56:59], v[140:143], a[88:91]
    v_mfma_f32_16x16x32_bf16 a[92:95], v[56:59], v[212:215], a[92:95]
    ds_read_b64_tr_b16 v[52:53], v21 offset:10240
    ds_read_b64_tr_b16 v[54:55], v21 offset:11264
    s_waitcnt lgkmcnt(12)
    v_mfma_f32_16x16x32_bf16 a[96:99], v[60:63], v[140:143], a[96:99]
    v_mfma_f32_16x16x32_bf16 a[100:103], v[60:63], v[212:215], a[100:103]
    ds_read_b64_tr_b16 v[56:57], v22 offset:10240
    ds_read_b64_tr_b16 v[58:59], v22 offset:11264
    s_waitcnt lgkmcnt(12)
    v_mfma_f32_16x16x32_bf16 a[104:107], v[64:67], v[140:143], a[104:107]
    v_mfma_f32_16x16x32_bf16 a[108:111], v[64:67], v[212:215], a[108:111]
    ds_read_b64_tr_b16 v[60:61], v23 offset:10240
    ds_read_b64_tr_b16 v[62:63], v23 offset:11264
    s_waitcnt lgkmcnt(12)
    v_mfma_f32_16x16x32_bf16 a[112:115], v[68:71], v[140:143], a[112:115]
    v_mfma_f32_16x16x32_bf16 a[116:119], v[68:71], v[212:215], a[116:119]
    ds_read_b64_tr_b16 v[64:65], v24 offset:10240
    ds_read_b64_tr_b16 v[66:67], v24 offset:11264
    s_waitcnt lgkmcnt(12)
    v_mfma_f32_16x16x32_bf16 a[120:123], v[40:43], v[140:143], a[120:123]
    v_mfma_f32_16x16x32_bf16 a[124:127], v[40:43], v[212:215], a[124:127]
    ds_read_b64_tr_b16 v[68:69], v25 offset:10240
    ds_read_b64_tr_b16 v[70:71], v25 offset:11264
    s_waitcnt lgkmcnt(12)
    v_mfma_f32_16x16x32_bf16 a[128:131], v[44:47], v[140:143], a[128:131]
    v_mfma_f32_16x16x32_bf16 a[132:135], v[44:47], v[212:215], a[132:135]
    ds_read_b64_tr_b16 v[40:41], v26 offset:10240
    ds_read_b64_tr_b16 v[42:43], v26 offset:11264
    s_waitcnt lgkmcnt(12)
    v_mfma_f32_16x16x32_bf16 a[136:139], v[48:51], v[140:143], a[136:139]
    v_mfma_f32_16x16x32_bf16 a[140:143], v[48:51], v[212:215], a[140:143]
    ds_read_b64_tr_b16 v[44:45], v27 offset:10240
    ds_read_b64_tr_b16 v[46:47], v27 offset:11264
    s_waitcnt lgkmcnt(12)
    v_mfma_f32_16x16x32_bf16 a[144:147], v[52:55], v[140:143], a[144:147]
    v_mfma_f32_16x16x32_bf16 a[148:151], v[52:55], v[212:215], a[148:151]
    s_waitcnt lgkmcnt(10)
    v_mfma_f32_16x16x32_bf16 a[152:155], v[56:59], v[140:143], a[152:155]
    v_mfma_f32_16x16x32_bf16 a[156:159], v[56:59], v[212:215], a[156:159]
    s_waitcnt lgkmcnt(8)
    v_mfma_f32_16x16x32_bf16 a[160:163], v[60:63], v[140:143], a[160:163]
    v_mfma_f32_16x16x32_bf16 a[164:167], v[60:63], v[212:215], a[164:167]
    s_waitcnt lgkmcnt(6)
    v_mfma_f32_16x16x32_bf16 a[168:171], v[64:67], v[140:143], a[168:171]
    v_mfma_f32_16x16x32_bf16 a[172:175], v[64:67], v[212:215], a[172:175]
    s_waitcnt lgkmcnt(4)
    v_mfma_f32_16x16x32_bf16 a[176:179], v[68:71], v[140:143], a[176:179]
    v_mfma_f32_16x16x32_bf16 a[180:183], v[68:71], v[212:215], a[180:183]
    s_waitcnt lgkmcnt(2)
    v_mfma_f32_16x16x32_bf16 a[184:187], v[40:43], v[140:143], a[184:187]
    v_mfma_f32_16x16x32_bf16 a[188:191], v[40:43], v[212:215], a[188:191]
    s_waitcnt lgkmcnt(0)
    v_mfma_f32_16x16x32_bf16 a[192:195], v[44:47], v[140:143], a[192:195]
    v_mfma_f32_16x16x32_bf16 a[196:199], v[44:47], v[212:215], a[196:199]
    s_nop 9
    v_accvgpr_read_b32 v72, a0
    v_accvgpr_read_b32 v73, a1
    v_accvgpr_read_b32 v74, a2
    v_accvgpr_read_b32 v75, a3
    v_accvgpr_read_b32 v76, a8
    v_accvgpr_read_b32 v77, a9
    v_accvgpr_read_b32 v78, a10
    v_accvgpr_read_b32 v79, a11
    v_mul_f32 v80, 0xbfb8aa3b, v72
    v_mul_f32 v81, 0xbfb8aa3b, v73
    v_mul_f32 v82, 0xbfb8aa3b, v74
    v_mul_f32 v83, 0xbfb8aa3b, v75
    v_mul_f32 v84, 0xbfb8aa3b, v76
    v_mul_f32 v85, 0xbfb8aa3b, v77
    v_mul_f32 v86, 0xbfb8aa3b, v78
    v_mul_f32 v87, 0xbfb8aa3b, v79
    v_exp_f32 v80, v80
    v_exp_f32 v81, v81
    v_exp_f32 v82, v82
    v_exp_f32 v83, v83
    v_exp_f32 v84, v84
    v_exp_f32 v85, v85
    v_exp_f32 v86, v86
    v_exp_f32 v87, v87
    v_add_f32 v80, 1.0, v80
    v_add_f32 v81, 1.0, v81
    v_add_f32 v82, 1.0, v82
    v_add_f32 v83, 1.0, v83
    v_add_f32 v84, 1.0, v84
    v_add_f32 v85, 1.0, v85
    v_add_f32 v86, 1.0, v86
    v_add_f32 v87, 1.0, v87
    v_rcp_f32 v80, v80
    v_rcp_f32 v81, v81
    v_rcp_f32 v82, v82
    v_rcp_f32 v83, v83
    v_rcp_f32 v84, v84
    v_rcp_f32 v85, v85
    v_rcp_f32 v86, v86
    v_rcp_f32 v87, v87
    v_mul_f32 v72, v72, v80
    v_mul_f32 v73, v73, v81
    v_mul_f32 v74, v74, v82
    v_mul_f32 v75, v75, v83
    v_mul_f32 v76, v76, v84
    v_mul_f32 v77, v77, v85
    v_mul_f32 v78, v78, v86
    v_mul_f32 v79, v79, v87
    v_cvt_pk_bf16_f32 v88, v72, v73
    v_cvt_pk_bf16_f32 v89, v74, v75
    v_cvt_pk_bf16_f32 v90, v76, v77
    v_cvt_pk_bf16_f32 v91, v78, v79
    s_nop 1
    v_permlane16_swap_b32 v88, v90
    v_permlane16_swap_b32 v89, v91
    s_mov_b32 s53, 0
    s_nop 0
    buffer_store_dwordx4 v[88:91], v39, s[28:31], s53 offen
    v_accvgpr_read_b32 v92, a16
    v_accvgpr_read_b32 v93, a17
    v_accvgpr_read_b32 v94, a18
    v_accvgpr_read_b32 v95, a19
    v_accvgpr_read_b32 v96, a24
    v_accvgpr_read_b32 v97, a25
    v_accvgpr_read_b32 v98, a26
    v_accvgpr_read_b32 v99, a27
    v_mul_f32 v100, 0xbfb8aa3b, v92
    v_mul_f32 v101, 0xbfb8aa3b, v93
    v_mul_f32 v102, 0xbfb8aa3b, v94
    v_mul_f32 v103, 0xbfb8aa3b, v95
    v_mul_f32 v104, 0xbfb8aa3b, v96
    v_mul_f32 v105, 0xbfb8aa3b, v97
    v_mul_f32 v106, 0xbfb8aa3b, v98
    v_mul_f32 v107, 0xbfb8aa3b, v99
    v_exp_f32 v100, v100
    v_exp_f32 v101, v101
    v_exp_f32 v102, v102
    v_exp_f32 v103, v103
    v_exp_f32 v104, v104
    v_exp_f32 v105, v105
    v_exp_f32 v106, v106
    v_exp_f32 v107, v107
    v_add_f32 v100, 1.0, v100
    v_add_f32 v101, 1.0, v101
    v_add_f32 v102, 1.0, v102
    v_add_f32 v103, 1.0, v103
    v_add_f32 v104, 1.0, v104
    v_add_f32 v105, 1.0, v105
    v_add_f32 v106, 1.0, v106
    v_add_f32 v107, 1.0, v107
    v_rcp_f32 v100, v100
    v_rcp_f32 v101, v101
    v_rcp_f32 v102, v102
    v_rcp_f32 v103, v103
    v_rcp_f32 v104, v104
    v_rcp_f32 v105, v105
    v_rcp_f32 v106, v106
    v_rcp_f32 v107, v107
    v_mul_f32 v92, v92, v100
    v_mul_f32 v93, v93, v101
    v_mul_f32 v94, v94, v102
    v_mul_f32 v95, v95, v103
    v_mul_f32 v96, v96, v104
    v_mul_f32 v97, v97, v105
    v_mul_f32 v98, v98, v106
    v_mul_f32 v99, v99, v107
    v_cvt_pk_bf16_f32 v108, v92, v93
    v_cvt_pk_bf16_f32 v109, v94, v95
    v_cvt_pk_bf16_f32 v110, v96, v97
    v_cvt_pk_bf16_f32 v111, v98, v99
    s_nop 1
    v_permlane16_swap_b32 v108, v110
    v_permlane16_swap_b32 v109, v111
    s_mov_b32 s53, 1024
    s_nop 0
    buffer_store_dwordx4 v[108:111], v39, s[28:31], s53 offen
    v_accvgpr_read_b32 v112, a32
    v_accvgpr_read_b32 v113, a33
    v_accvgpr_read_b32 v114, a34
    v_accvgpr_read_b32 v115, a35
    v_accvgpr_read_b32 v116, a40
    v_accvgpr_read_b32 v117, a41
    v_accvgpr_read_b32 v118, a42
    v_accvgpr_read_b32 v119, a43
    v_mul_f32 v120, 0xbfb8aa3b, v112
    v_mul_f32 v121, 0xbfb8aa3b, v113
    v_mul_f32 v122, 0xbfb8aa3b, v114
    v_mul_f32 v123, 0xbfb8aa3b, v115
    v_mul_f32 v124, 0xbfb8aa3b, v116
    v_mul_f32 v125, 0xbfb8aa3b, v117
    v_mul_f32 v126, 0xbfb8aa3b, v118
    v_mul_f32 v127, 0xbfb8aa3b, v119
    v_exp_f32 v120, v120
    v_exp_f32 v121, v121
    v_exp_f32 v122, v122
    v_exp_f32 v123, v123
    v_exp_f32 v124, v124
    v_exp_f32 v125, v125
    v_exp_f32 v126, v126
    v_exp_f32 v127, v127
    v_add_f32 v120, 1.0, v120
    v_add_f32 v121, 1.0, v121
    v_add_f32 v122, 1.0, v122
    v_add_f32 v123, 1.0, v123
    v_add_f32 v124, 1.0, v124
    v_add_f32 v125, 1.0, v125
    v_add_f32 v126, 1.0, v126
    v_add_f32 v127, 1.0, v127
    v_rcp_f32 v120, v120
    v_rcp_f32 v121, v121
    v_rcp_f32 v122, v122
    v_rcp_f32 v123, v123
    v_rcp_f32 v124, v124
    v_rcp_f32 v125, v125
    v_rcp_f32 v126, v126
    v_rcp_f32 v127, v127
    v_mul_f32 v112, v112, v120
    v_mul_f32 v113, v113, v121
    v_mul_f32 v114, v114, v122
    v_mul_f32 v115, v115, v123
    v_mul_f32 v116, v116, v124
    v_mul_f32 v117, v117, v125
    v_mul_f32 v118, v118, v126
    v_mul_f32 v119, v119, v127
    v_cvt_pk_bf16_f32 v128, v112, v113
    v_cvt_pk_bf16_f32 v129, v114, v115
    v_cvt_pk_bf16_f32 v130, v116, v117
    v_cvt_pk_bf16_f32 v131, v118, v119
    s_nop 1
    v_permlane16_swap_b32 v128, v130
    v_permlane16_swap_b32 v129, v131
    s_mov_b32 s53, 2048
    s_nop 0
    buffer_store_dwordx4 v[128:131], v39, s[28:31], s53 offen
    v_accvgpr_read_b32 v132, a48
    v_accvgpr_read_b32 v133, a49
    v_accvgpr_read_b32 v134, a50
    v_accvgpr_read_b32 v135, a51
    v_accvgpr_read_b32 v136, a56
    v_accvgpr_read_b32 v137, a57
    v_accvgpr_read_b32 v138, a58
    v_accvgpr_read_b32 v139, a59
    v_mul_f32 v140, 0xbfb8aa3b, v132
    v_mul_f32 v141, 0xbfb8aa3b, v133
    v_mul_f32 v142, 0xbfb8aa3b, v134
    v_mul_f32 v143, 0xbfb8aa3b, v135
    v_mul_f32 v144, 0xbfb8aa3b, v136
    v_mul_f32 v145, 0xbfb8aa3b, v137
    v_mul_f32 v146, 0xbfb8aa3b, v138
    v_mul_f32 v147, 0xbfb8aa3b, v139
    v_exp_f32 v140, v140
    v_exp_f32 v141, v141
    v_exp_f32 v142, v142
    v_exp_f32 v143, v143
    v_exp_f32 v144, v144
    v_exp_f32 v145, v145
    v_exp_f32 v146, v146
    v_exp_f32 v147, v147
    v_add_f32 v140, 1.0, v140
    v_add_f32 v141, 1.0, v141
    v_add_f32 v142, 1.0, v142
    v_add_f32 v143, 1.0, v143
    v_add_f32 v144, 1.0, v144
    v_add_f32 v145, 1.0, v145
    v_add_f32 v146, 1.0, v146
    v_add_f32 v147, 1.0, v147
    v_rcp_f32 v140, v140
    v_rcp_f32 v141, v141
    v_rcp_f32 v142, v142
    v_rcp_f32 v143, v143
    v_rcp_f32 v144, v144
    v_rcp_f32 v145, v145
    v_rcp_f32 v146, v146
    v_rcp_f32 v147, v147
    v_mul_f32 v132, v132, v140
    v_mul_f32 v133, v133, v141
    v_mul_f32 v134, v134, v142
    v_mul_f32 v135, v135, v143
    v_mul_f32 v136, v136, v144
    v_mul_f32 v137, v137, v145
    v_mul_f32 v138, v138, v146
    v_mul_f32 v139, v139, v147
    v_cvt_pk_bf16_f32 v148, v132, v133
    v_cvt_pk_bf16_f32 v149, v134, v135
    v_cvt_pk_bf16_f32 v150, v136, v137
    v_cvt_pk_bf16_f32 v151, v138, v139
    s_nop 1
    v_permlane16_swap_b32 v148, v150
    v_permlane16_swap_b32 v149, v151
    s_mov_b32 s53, 3072
    s_nop 0
    buffer_store_dwordx4 v[148:151], v39, s[28:31], s53 offen
    v_accvgpr_read_b32 v152, a64
    v_accvgpr_read_b32 v153, a65
    v_accvgpr_read_b32 v154, a66
    v_accvgpr_read_b32 v155, a67
    v_accvgpr_read_b32 v156, a72
    v_accvgpr_read_b32 v157, a73
    v_accvgpr_read_b32 v158, a74
    v_accvgpr_read_b32 v159, a75
    v_mul_f32 v160, 0xbfb8aa3b, v152
    v_mul_f32 v161, 0xbfb8aa3b, v153
    v_mul_f32 v162, 0xbfb8aa3b, v154
    v_mul_f32 v163, 0xbfb8aa3b, v155
    v_mul_f32 v164, 0xbfb8aa3b, v156
    v_mul_f32 v165, 0xbfb8aa3b, v157
    v_mul_f32 v166, 0xbfb8aa3b, v158
    v_mul_f32 v167, 0xbfb8aa3b, v159
    v_exp_f32 v160, v160
    v_exp_f32 v161, v161
    v_exp_f32 v162, v162
    v_exp_f32 v163, v163
    v_exp_f32 v164, v164
    v_exp_f32 v165, v165
    v_exp_f32 v166, v166
    v_exp_f32 v167, v167
    v_add_f32 v160, 1.0, v160
    v_add_f32 v161, 1.0, v161
    v_add_f32 v162, 1.0, v162
    v_add_f32 v163, 1.0, v163
    v_add_f32 v164, 1.0, v164
    v_add_f32 v165, 1.0, v165
    v_add_f32 v166, 1.0, v166
    v_add_f32 v167, 1.0, v167
    v_rcp_f32 v160, v160
    v_rcp_f32 v161, v161
    v_rcp_f32 v162, v162
    v_rcp_f32 v163, v163
    v_rcp_f32 v164, v164
    v_rcp_f32 v165, v165
    v_rcp_f32 v166, v166
    v_rcp_f32 v167, v167
    v_mul_f32 v152, v152, v160
    v_mul_f32 v153, v153, v161
    v_mul_f32 v154, v154, v162
    v_mul_f32 v155, v155, v163
    v_mul_f32 v156, v156, v164
    v_mul_f32 v157, v157, v165
    v_mul_f32 v158, v158, v166
    v_mul_f32 v159, v159, v167
    v_cvt_pk_bf16_f32 v168, v152, v153
    v_cvt_pk_bf16_f32 v169, v154, v155
    v_cvt_pk_bf16_f32 v170, v156, v157
    v_cvt_pk_bf16_f32 v171, v158, v159
    s_nop 1
    v_permlane16_swap_b32 v168, v170
    v_permlane16_swap_b32 v169, v171
    s_mov_b32 s53, 4096
    s_nop 0
    buffer_store_dwordx4 v[168:171], v39, s[28:31], s53 offen
    v_accvgpr_read_b32 v172, a80
    v_accvgpr_read_b32 v173, a81
    v_accvgpr_read_b32 v174, a82
    v_accvgpr_read_b32 v175, a83
    v_accvgpr_read_b32 v176, a88
    v_accvgpr_read_b32 v177, a89
    v_accvgpr_read_b32 v178, a90
    v_accvgpr_read_b32 v179, a91
    v_mul_f32 v180, 0xbfb8aa3b, v172
    v_mul_f32 v181, 0xbfb8aa3b, v173
    v_mul_f32 v182, 0xbfb8aa3b, v174
    v_mul_f32 v183, 0xbfb8aa3b, v175
    v_mul_f32 v184, 0xbfb8aa3b, v176
    v_mul_f32 v185, 0xbfb8aa3b, v177
    v_mul_f32 v186, 0xbfb8aa3b, v178
    v_mul_f32 v187, 0xbfb8aa3b, v179
    v_exp_f32 v180, v180
    v_exp_f32 v181, v181
    v_exp_f32 v182, v182
    v_exp_f32 v183, v183
    v_exp_f32 v184, v184
    v_exp_f32 v185, v185
    v_exp_f32 v186, v186
    v_exp_f32 v187, v187
    v_add_f32 v180, 1.0, v180
    v_add_f32 v181, 1.0, v181
    v_add_f32 v182, 1.0, v182
    v_add_f32 v183, 1.0, v183
    v_add_f32 v184, 1.0, v184
    v_add_f32 v185, 1.0, v185
    v_add_f32 v186, 1.0, v186
    v_add_f32 v187, 1.0, v187
    v_rcp_f32 v180, v180
    v_rcp_f32 v181, v181
    v_rcp_f32 v182, v182
    v_rcp_f32 v183, v183
    v_rcp_f32 v184, v184
    v_rcp_f32 v185, v185
    v_rcp_f32 v186, v186
    v_rcp_f32 v187, v187
    v_mul_f32 v172, v172, v180
    v_mul_f32 v173, v173, v181
    v_mul_f32 v174, v174, v182
    v_mul_f32 v175, v175, v183
    v_mul_f32 v176, v176, v184
    v_mul_f32 v177, v177, v185
    v_mul_f32 v178, v178, v186
    v_mul_f32 v179, v179, v187
    v_cvt_pk_bf16_f32 v188, v172, v173
    v_cvt_pk_bf16_f32 v189, v174, v175
    v_cvt_pk_bf16_f32 v190, v176, v177
    v_cvt_pk_bf16_f32 v191, v178, v179
    s_nop 1
    v_permlane16_swap_b32 v188, v190
    v_permlane16_swap_b32 v189, v191
    s_mov_b32 s53, 5120
    s_nop 0
    buffer_store_dwordx4 v[188:191], v39, s[28:31], s53 offen
    v_accvgpr_read_b32 v72, a96
    v_accvgpr_read_b32 v73, a97
    v_accvgpr_read_b32 v74, a98
    v_accvgpr_read_b32 v75, a99
    v_accvgpr_read_b32 v76, a104
    v_accvgpr_read_b32 v77, a105
    v_accvgpr_read_b32 v78, a106
    v_accvgpr_read_b32 v79, a107
    v_mul_f32 v80, 0xbfb8aa3b, v72
    v_mul_f32 v81, 0xbfb8aa3b, v73
    v_mul_f32 v82, 0xbfb8aa3b, v74
    v_mul_f32 v83, 0xbfb8aa3b, v75
    v_mul_f32 v84, 0xbfb8aa3b, v76
    v_mul_f32 v85, 0xbfb8aa3b, v77
    v_mul_f32 v86, 0xbfb8aa3b, v78
    v_mul_f32 v87, 0xbfb8aa3b, v79
    v_exp_f32 v80, v80
    v_exp_f32 v81, v81
    v_exp_f32 v82, v82
    v_exp_f32 v83, v83
    v_exp_f32 v84, v84
    v_exp_f32 v85, v85
    v_exp_f32 v86, v86
    v_exp_f32 v87, v87
    v_add_f32 v80, 1.0, v80
    v_add_f32 v81, 1.0, v81
    v_add_f32 v82, 1.0, v82
    v_add_f32 v83, 1.0, v83
    v_add_f32 v84, 1.0, v84
    v_add_f32 v85, 1.0, v85
    v_add_f32 v86, 1.0, v86
    v_add_f32 v87, 1.0, v87
    v_rcp_f32 v80, v80
    v_rcp_f32 v81, v81
    v_rcp_f32 v82, v82
    v_rcp_f32 v83, v83
    v_rcp_f32 v84, v84
    v_rcp_f32 v85, v85
    v_rcp_f32 v86, v86
    v_rcp_f32 v87, v87
    v_mul_f32 v72, v72, v80
    v_mul_f32 v73, v73, v81
    v_mul_f32 v74, v74, v82
    v_mul_f32 v75, v75, v83
    v_mul_f32 v76, v76, v84
    v_mul_f32 v77, v77, v85
    v_mul_f32 v78, v78, v86
    v_mul_f32 v79, v79, v87
    v_cvt_pk_bf16_f32 v88, v72, v73
    v_cvt_pk_bf16_f32 v89, v74, v75
    v_cvt_pk_bf16_f32 v90, v76, v77
    v_cvt_pk_bf16_f32 v91, v78, v79
    s_nop 1
    v_permlane16_swap_b32 v88, v90
    v_permlane16_swap_b32 v89, v91
    s_mov_b32 s53, 6144
    s_nop 0
    buffer_store_dwordx4 v[88:91], v39, s[28:31], s53 offen
    v_accvgpr_read_b32 v92, a112
    v_accvgpr_read_b32 v93, a113
    v_accvgpr_read_b32 v94, a114
    v_accvgpr_read_b32 v95, a115
    v_accvgpr_read_b32 v96, a120
    v_accvgpr_read_b32 v97, a121
    v_accvgpr_read_b32 v98, a122
    v_accvgpr_read_b32 v99, a123
    v_mul_f32 v100, 0xbfb8aa3b, v92
    v_mul_f32 v101, 0xbfb8aa3b, v93
    v_mul_f32 v102, 0xbfb8aa3b, v94
    v_mul_f32 v103, 0xbfb8aa3b, v95
    v_mul_f32 v104, 0xbfb8aa3b, v96
    v_mul_f32 v105, 0xbfb8aa3b, v97
    v_mul_f32 v106, 0xbfb8aa3b, v98
    v_mul_f32 v107, 0xbfb8aa3b, v99
    v_exp_f32 v100, v100
    v_exp_f32 v101, v101
    v_exp_f32 v102, v102
    v_exp_f32 v103, v103
    v_exp_f32 v104, v104
    v_exp_f32 v105, v105
    v_exp_f32 v106, v106
    v_exp_f32 v107, v107
    v_add_f32 v100, 1.0, v100
    v_add_f32 v101, 1.0, v101
    v_add_f32 v102, 1.0, v102
    v_add_f32 v103, 1.0, v103
    v_add_f32 v104, 1.0, v104
    v_add_f32 v105, 1.0, v105
    v_add_f32 v106, 1.0, v106
    v_add_f32 v107, 1.0, v107
    v_rcp_f32 v100, v100
    v_rcp_f32 v101, v101
    v_rcp_f32 v102, v102
    v_rcp_f32 v103, v103
    v_rcp_f32 v104, v104
    v_rcp_f32 v105, v105
    v_rcp_f32 v106, v106
    v_rcp_f32 v107, v107
    v_mul_f32 v92, v92, v100
    v_mul_f32 v93, v93, v101
    v_mul_f32 v94, v94, v102
    v_mul_f32 v95, v95, v103
    v_mul_f32 v96, v96, v104
    v_mul_f32 v97, v97, v105
    v_mul_f32 v98, v98, v106
    v_mul_f32 v99, v99, v107
    v_cvt_pk_bf16_f32 v108, v92, v93
    v_cvt_pk_bf16_f32 v109, v94, v95
    v_cvt_pk_bf16_f32 v110, v96, v97
    v_cvt_pk_bf16_f32 v111, v98, v99
    s_nop 1
    v_permlane16_swap_b32 v108, v110
    v_permlane16_swap_b32 v109, v111
    s_mov_b32 s53, 7168
    s_nop 0
    buffer_store_dwordx4 v[108:111], v39, s[28:31], s53 offen
    v_accvgpr_read_b32 v112, a128
    v_accvgpr_read_b32 v113, a129
    v_accvgpr_read_b32 v114, a130
    v_accvgpr_read_b32 v115, a131
    v_accvgpr_read_b32 v116, a136
    v_accvgpr_read_b32 v117, a137
    v_accvgpr_read_b32 v118, a138
    v_accvgpr_read_b32 v119, a139
    v_mul_f32 v120, 0xbfb8aa3b, v112
    v_mul_f32 v121, 0xbfb8aa3b, v113
    v_mul_f32 v122, 0xbfb8aa3b, v114
    v_mul_f32 v123, 0xbfb8aa3b, v115
    v_mul_f32 v124, 0xbfb8aa3b, v116
    v_mul_f32 v125, 0xbfb8aa3b, v117
    v_mul_f32 v126, 0xbfb8aa3b, v118
    v_mul_f32 v127, 0xbfb8aa3b, v119
    v_exp_f32 v120, v120
    v_exp_f32 v121, v121
    v_exp_f32 v122, v122
    v_exp_f32 v123, v123
    v_exp_f32 v124, v124
    v_exp_f32 v125, v125
    v_exp_f32 v126, v126
    v_exp_f32 v127, v127
    v_add_f32 v120, 1.0, v120
    v_add_f32 v121, 1.0, v121
    v_add_f32 v122, 1.0, v122
    v_add_f32 v123, 1.0, v123
    v_add_f32 v124, 1.0, v124
    v_add_f32 v125, 1.0, v125
    v_add_f32 v126, 1.0, v126
    v_add_f32 v127, 1.0, v127
    v_rcp_f32 v120, v120
    v_rcp_f32 v121, v121
    v_rcp_f32 v122, v122
    v_rcp_f32 v123, v123
    v_rcp_f32 v124, v124
    v_rcp_f32 v125, v125
    v_rcp_f32 v126, v126
    v_rcp_f32 v127, v127
    v_mul_f32 v112, v112, v120
    v_mul_f32 v113, v113, v121
    v_mul_f32 v114, v114, v122
    v_mul_f32 v115, v115, v123
    v_mul_f32 v116, v116, v124
    v_mul_f32 v117, v117, v125
    v_mul_f32 v118, v118, v126
    v_mul_f32 v119, v119, v127
    v_cvt_pk_bf16_f32 v128, v112, v113
    v_cvt_pk_bf16_f32 v129, v114, v115
    v_cvt_pk_bf16_f32 v130, v116, v117
    v_cvt_pk_bf16_f32 v131, v118, v119
    s_nop 1
    v_permlane16_swap_b32 v128, v130
    v_permlane16_swap_b32 v129, v131
    s_mov_b32 s53, 8192
    s_nop 0
    buffer_store_dwordx4 v[128:131], v39, s[28:31], s53 offen
    v_accvgpr_read_b32 v132, a4
    v_accvgpr_read_b32 v133, a5
    v_accvgpr_read_b32 v134, a6
    v_accvgpr_read_b32 v135, a7
    v_accvgpr_read_b32 v136, a12
    v_accvgpr_read_b32 v137, a13
    v_accvgpr_read_b32 v138, a14
    v_accvgpr_read_b32 v139, a15
    v_mul_f32 v140, 0xbfb8aa3b, v132
    v_mul_f32 v141, 0xbfb8aa3b, v133
    v_mul_f32 v142, 0xbfb8aa3b, v134
    v_mul_f32 v143, 0xbfb8aa3b, v135
    v_mul_f32 v144, 0xbfb8aa3b, v136
    v_mul_f32 v145, 0xbfb8aa3b, v137
    v_mul_f32 v146, 0xbfb8aa3b, v138
    v_mul_f32 v147, 0xbfb8aa3b, v139
    v_exp_f32 v140, v140
    v_exp_f32 v141, v141
    v_exp_f32 v142, v142
    v_exp_f32 v143, v143
    v_exp_f32 v144, v144
    v_exp_f32 v145, v145
    v_exp_f32 v146, v146
    v_exp_f32 v147, v147
    v_add_f32 v140, 1.0, v140
    v_add_f32 v141, 1.0, v141
    v_add_f32 v142, 1.0, v142
    v_add_f32 v143, 1.0, v143
    v_add_f32 v144, 1.0, v144
    v_add_f32 v145, 1.0, v145
    v_add_f32 v146, 1.0, v146
    v_add_f32 v147, 1.0, v147
    v_rcp_f32 v140, v140
    v_rcp_f32 v141, v141
    v_rcp_f32 v142, v142
    v_rcp_f32 v143, v143
    v_rcp_f32 v144, v144
    v_rcp_f32 v145, v145
    v_rcp_f32 v146, v146
    v_rcp_f32 v147, v147
    v_mul_f32 v132, v132, v140
    v_mul_f32 v133, v133, v141
    v_mul_f32 v134, v134, v142
    v_mul_f32 v135, v135, v143
    v_mul_f32 v136, v136, v144
    v_mul_f32 v137, v137, v145
    v_mul_f32 v138, v138, v146
    v_mul_f32 v139, v139, v147
    v_cvt_pk_bf16_f32 v148, v132, v133
    v_cvt_pk_bf16_f32 v149, v134, v135
    v_cvt_pk_bf16_f32 v150, v136, v137
    v_cvt_pk_bf16_f32 v151, v138, v139
    s_nop 1
    v_permlane16_swap_b32 v148, v150
    v_permlane16_swap_b32 v149, v151
    s_mov_b32 s53, 165888
    s_nop 0
    buffer_store_dwordx4 v[148:151], v39, s[28:31], s53 offen
    v_accvgpr_read_b32 v152, a20
    v_accvgpr_read_b32 v153, a21
    v_accvgpr_read_b32 v154, a22
    v_accvgpr_read_b32 v155, a23
    v_accvgpr_read_b32 v156, a28
    v_accvgpr_read_b32 v157, a29
    v_accvgpr_read_b32 v158, a30
    v_accvgpr_read_b32 v159, a31
    v_mul_f32 v160, 0xbfb8aa3b, v152
    v_mul_f32 v161, 0xbfb8aa3b, v153
    v_mul_f32 v162, 0xbfb8aa3b, v154
    v_mul_f32 v163, 0xbfb8aa3b, v155
    v_mul_f32 v164, 0xbfb8aa3b, v156
    v_mul_f32 v165, 0xbfb8aa3b, v157
    v_mul_f32 v166, 0xbfb8aa3b, v158
    v_mul_f32 v167, 0xbfb8aa3b, v159
    v_exp_f32 v160, v160
    v_exp_f32 v161, v161
    v_exp_f32 v162, v162
    v_exp_f32 v163, v163
    v_exp_f32 v164, v164
    v_exp_f32 v165, v165
    v_exp_f32 v166, v166
    v_exp_f32 v167, v167
    v_add_f32 v160, 1.0, v160
    v_add_f32 v161, 1.0, v161
    v_add_f32 v162, 1.0, v162
    v_add_f32 v163, 1.0, v163
    v_add_f32 v164, 1.0, v164
    v_add_f32 v165, 1.0, v165
    v_add_f32 v166, 1.0, v166
    v_add_f32 v167, 1.0, v167
    v_rcp_f32 v160, v160
    v_rcp_f32 v161, v161
    v_rcp_f32 v162, v162
    v_rcp_f32 v163, v163
    v_rcp_f32 v164, v164
    v_rcp_f32 v165, v165
    v_rcp_f32 v166, v166
    v_rcp_f32 v167, v167
    v_mul_f32 v152, v152, v160
    v_mul_f32 v153, v153, v161
    v_mul_f32 v154, v154, v162
    v_mul_f32 v155, v155, v163
    v_mul_f32 v156, v156, v164
    v_mul_f32 v157, v157, v165
    v_mul_f32 v158, v158, v166
    v_mul_f32 v159, v159, v167
    v_cvt_pk_bf16_f32 v168, v152, v153
    v_cvt_pk_bf16_f32 v169, v154, v155
    v_cvt_pk_bf16_f32 v170, v156, v157
    v_cvt_pk_bf16_f32 v171, v158, v159
    s_nop 1
    v_permlane16_swap_b32 v168, v170
    v_permlane16_swap_b32 v169, v171
    s_mov_b32 s53, 166912
    s_nop 0
    buffer_store_dwordx4 v[168:171], v39, s[28:31], s53 offen
    v_accvgpr_read_b32 v172, a36
    v_accvgpr_read_b32 v173, a37
    v_accvgpr_read_b32 v174, a38
    v_accvgpr_read_b32 v175, a39
    v_accvgpr_read_b32 v176, a44
    v_accvgpr_read_b32 v177, a45
    v_accvgpr_read_b32 v178, a46
    v_accvgpr_read_b32 v179, a47
    v_mul_f32 v180, 0xbfb8aa3b, v172
    v_mul_f32 v181, 0xbfb8aa3b, v173
    v_mul_f32 v182, 0xbfb8aa3b, v174
    v_mul_f32 v183, 0xbfb8aa3b, v175
    v_mul_f32 v184, 0xbfb8aa3b, v176
    v_mul_f32 v185, 0xbfb8aa3b, v177
    v_mul_f32 v186, 0xbfb8aa3b, v178
    v_mul_f32 v187, 0xbfb8aa3b, v179
    v_exp_f32 v180, v180
    v_exp_f32 v181, v181
    v_exp_f32 v182, v182
    v_exp_f32 v183, v183
    v_exp_f32 v184, v184
    v_exp_f32 v185, v185
    v_exp_f32 v186, v186
    v_exp_f32 v187, v187
    v_add_f32 v180, 1.0, v180
    v_add_f32 v181, 1.0, v181
    v_add_f32 v182, 1.0, v182
    v_add_f32 v183, 1.0, v183
    v_add_f32 v184, 1.0, v184
    v_add_f32 v185, 1.0, v185
    v_add_f32 v186, 1.0, v186
    v_add_f32 v187, 1.0, v187
    v_rcp_f32 v180, v180
    v_rcp_f32 v181, v181
    v_rcp_f32 v182, v182
    v_rcp_f32 v183, v183
    v_rcp_f32 v184, v184
    v_rcp_f32 v185, v185
    v_rcp_f32 v186, v186
    v_rcp_f32 v187, v187
    v_mul_f32 v172, v172, v180
    v_mul_f32 v173, v173, v181
    v_mul_f32 v174, v174, v182
    v_mul_f32 v175, v175, v183
    v_mul_f32 v176, v176, v184
    v_mul_f32 v177, v177, v185
    v_mul_f32 v178, v178, v186
    v_mul_f32 v179, v179, v187
    v_cvt_pk_bf16_f32 v188, v172, v173
    v_cvt_pk_bf16_f32 v189, v174, v175
    v_cvt_pk_bf16_f32 v190, v176, v177
    v_cvt_pk_bf16_f32 v191, v178, v179
    s_nop 1
    v_permlane16_swap_b32 v188, v190
    v_permlane16_swap_b32 v189, v191
    s_mov_b32 s53, 167936
    s_nop 0
    buffer_store_dwordx4 v[188:191], v39, s[28:31], s53 offen
    v_accvgpr_read_b32 v72, a52
    v_accvgpr_read_b32 v73, a53
    v_accvgpr_read_b32 v74, a54
    v_accvgpr_read_b32 v75, a55
    v_accvgpr_read_b32 v76, a60
    v_accvgpr_read_b32 v77, a61
    v_accvgpr_read_b32 v78, a62
    v_accvgpr_read_b32 v79, a63
    v_mul_f32 v80, 0xbfb8aa3b, v72
    v_mul_f32 v81, 0xbfb8aa3b, v73
    v_mul_f32 v82, 0xbfb8aa3b, v74
    v_mul_f32 v83, 0xbfb8aa3b, v75
    v_mul_f32 v84, 0xbfb8aa3b, v76
    v_mul_f32 v85, 0xbfb8aa3b, v77
    v_mul_f32 v86, 0xbfb8aa3b, v78
    v_mul_f32 v87, 0xbfb8aa3b, v79
    v_exp_f32 v80, v80
    v_exp_f32 v81, v81
    v_exp_f32 v82, v82
    v_exp_f32 v83, v83
    v_exp_f32 v84, v84
    v_exp_f32 v85, v85
    v_exp_f32 v86, v86
    v_exp_f32 v87, v87
    v_add_f32 v80, 1.0, v80
    v_add_f32 v81, 1.0, v81
    v_add_f32 v82, 1.0, v82
    v_add_f32 v83, 1.0, v83
    v_add_f32 v84, 1.0, v84
    v_add_f32 v85, 1.0, v85
    v_add_f32 v86, 1.0, v86
    v_add_f32 v87, 1.0, v87
    v_rcp_f32 v80, v80
    v_rcp_f32 v81, v81
    v_rcp_f32 v82, v82
    v_rcp_f32 v83, v83
    v_rcp_f32 v84, v84
    v_rcp_f32 v85, v85
    v_rcp_f32 v86, v86
    v_rcp_f32 v87, v87
    v_mul_f32 v72, v72, v80
    v_mul_f32 v73, v73, v81
    v_mul_f32 v74, v74, v82
    v_mul_f32 v75, v75, v83
    v_mul_f32 v76, v76, v84
    v_mul_f32 v77, v77, v85
    v_mul_f32 v78, v78, v86
    v_mul_f32 v79, v79, v87
    v_cvt_pk_bf16_f32 v88, v72, v73
    v_cvt_pk_bf16_f32 v89, v74, v75
    v_cvt_pk_bf16_f32 v90, v76, v77
    v_cvt_pk_bf16_f32 v91, v78, v79
    s_nop 1
    v_permlane16_swap_b32 v88, v90
    v_permlane16_swap_b32 v89, v91
    s_mov_b32 s53, 168960
    s_nop 0
    buffer_store_dwordx4 v[88:91], v39, s[28:31], s53 offen
    v_accvgpr_read_b32 v92, a68
    v_accvgpr_read_b32 v93, a69
    v_accvgpr_read_b32 v94, a70
    v_accvgpr_read_b32 v95, a71
    v_accvgpr_read_b32 v96, a76
    v_accvgpr_read_b32 v97, a77
    v_accvgpr_read_b32 v98, a78
    v_accvgpr_read_b32 v99, a79
    v_mul_f32 v100, 0xbfb8aa3b, v92
    v_mul_f32 v101, 0xbfb8aa3b, v93
    v_mul_f32 v102, 0xbfb8aa3b, v94
    v_mul_f32 v103, 0xbfb8aa3b, v95
    v_mul_f32 v104, 0xbfb8aa3b, v96
    v_mul_f32 v105, 0xbfb8aa3b, v97
    v_mul_f32 v106, 0xbfb8aa3b, v98
    v_mul_f32 v107, 0xbfb8aa3b, v99
    v_exp_f32 v100, v100
    v_exp_f32 v101, v101
    v_exp_f32 v102, v102
    v_exp_f32 v103, v103
    v_exp_f32 v104, v104
    v_exp_f32 v105, v105
    v_exp_f32 v106, v106
    v_exp_f32 v107, v107
    v_add_f32 v100, 1.0, v100
    v_add_f32 v101, 1.0, v101
    v_add_f32 v102, 1.0, v102
    v_add_f32 v103, 1.0, v103
    v_add_f32 v104, 1.0, v104
    v_add_f32 v105, 1.0, v105
    v_add_f32 v106, 1.0, v106
    v_add_f32 v107, 1.0, v107
    v_rcp_f32 v100, v100
    v_rcp_f32 v101, v101
    v_rcp_f32 v102, v102
    v_rcp_f32 v103, v103
    v_rcp_f32 v104, v104
    v_rcp_f32 v105, v105
    v_rcp_f32 v106, v106
    v_rcp_f32 v107, v107
    v_mul_f32 v92, v92, v100
    v_mul_f32 v93, v93, v101
    v_mul_f32 v94, v94, v102
    v_mul_f32 v95, v95, v103
    v_mul_f32 v96, v96, v104
    v_mul_f32 v97, v97, v105
    v_mul_f32 v98, v98, v106
    v_mul_f32 v99, v99, v107
    v_cvt_pk_bf16_f32 v108, v92, v93
    v_cvt_pk_bf16_f32 v109, v94, v95
    v_cvt_pk_bf16_f32 v110, v96, v97
    v_cvt_pk_bf16_f32 v111, v98, v99
    s_nop 1
    v_permlane16_swap_b32 v108, v110
    v_permlane16_swap_b32 v109, v111
    s_mov_b32 s53, 169984
    s_nop 0
    buffer_store_dwordx4 v[108:111], v39, s[28:31], s53 offen
    v_accvgpr_read_b32 v112, a84
    v_accvgpr_read_b32 v113, a85
    v_accvgpr_read_b32 v114, a86
    v_accvgpr_read_b32 v115, a87
    v_accvgpr_read_b32 v116, a92
    v_accvgpr_read_b32 v117, a93
    v_accvgpr_read_b32 v118, a94
    v_accvgpr_read_b32 v119, a95
    v_mul_f32 v120, 0xbfb8aa3b, v112
    v_mul_f32 v121, 0xbfb8aa3b, v113
    v_mul_f32 v122, 0xbfb8aa3b, v114
    v_mul_f32 v123, 0xbfb8aa3b, v115
    v_mul_f32 v124, 0xbfb8aa3b, v116
    v_mul_f32 v125, 0xbfb8aa3b, v117
    v_mul_f32 v126, 0xbfb8aa3b, v118
    v_mul_f32 v127, 0xbfb8aa3b, v119
    v_exp_f32 v120, v120
    v_exp_f32 v121, v121
    v_exp_f32 v122, v122
    v_exp_f32 v123, v123
    v_exp_f32 v124, v124
    v_exp_f32 v125, v125
    v_exp_f32 v126, v126
    v_exp_f32 v127, v127
    v_add_f32 v120, 1.0, v120
    v_add_f32 v121, 1.0, v121
    v_add_f32 v122, 1.0, v122
    v_add_f32 v123, 1.0, v123
    v_add_f32 v124, 1.0, v124
    v_add_f32 v125, 1.0, v125
    v_add_f32 v126, 1.0, v126
    v_add_f32 v127, 1.0, v127
    v_rcp_f32 v120, v120
    v_rcp_f32 v121, v121
    v_rcp_f32 v122, v122
    v_rcp_f32 v123, v123
    v_rcp_f32 v124, v124
    v_rcp_f32 v125, v125
    v_rcp_f32 v126, v126
    v_rcp_f32 v127, v127
    v_mul_f32 v112, v112, v120
    v_mul_f32 v113, v113, v121
    v_mul_f32 v114, v114, v122
    v_mul_f32 v115, v115, v123
    v_mul_f32 v116, v116, v124
    v_mul_f32 v117, v117, v125
    v_mul_f32 v118, v118, v126
    v_mul_f32 v119, v119, v127
    v_cvt_pk_bf16_f32 v128, v112, v113
    v_cvt_pk_bf16_f32 v129, v114, v115
    v_cvt_pk_bf16_f32 v130, v116, v117
    v_cvt_pk_bf16_f32 v131, v118, v119
    s_nop 1
    v_permlane16_swap_b32 v128, v130
    v_permlane16_swap_b32 v129, v131
    s_mov_b32 s53, 171008
    s_nop 0
    buffer_store_dwordx4 v[128:131], v39, s[28:31], s53 offen
    v_accvgpr_read_b32 v132, a100
    v_accvgpr_read_b32 v133, a101
    v_accvgpr_read_b32 v134, a102
    v_accvgpr_read_b32 v135, a103
    v_accvgpr_read_b32 v136, a108
    v_accvgpr_read_b32 v137, a109
    v_accvgpr_read_b32 v138, a110
    v_accvgpr_read_b32 v139, a111
    v_mul_f32 v140, 0xbfb8aa3b, v132
    v_mul_f32 v141, 0xbfb8aa3b, v133
    v_mul_f32 v142, 0xbfb8aa3b, v134
    v_mul_f32 v143, 0xbfb8aa3b, v135
    v_mul_f32 v144, 0xbfb8aa3b, v136
    v_mul_f32 v145, 0xbfb8aa3b, v137
    v_mul_f32 v146, 0xbfb8aa3b, v138
    v_mul_f32 v147, 0xbfb8aa3b, v139
    v_exp_f32 v140, v140
    v_exp_f32 v141, v141
    v_exp_f32 v142, v142
    v_exp_f32 v143, v143
    v_exp_f32 v144, v144
    v_exp_f32 v145, v145
    v_exp_f32 v146, v146
    v_exp_f32 v147, v147
    v_add_f32 v140, 1.0, v140
    v_add_f32 v141, 1.0, v141
    v_add_f32 v142, 1.0, v142
    v_add_f32 v143, 1.0, v143
    v_add_f32 v144, 1.0, v144
    v_add_f32 v145, 1.0, v145
    v_add_f32 v146, 1.0, v146
    v_add_f32 v147, 1.0, v147
    v_rcp_f32 v140, v140
    v_rcp_f32 v141, v141
    v_rcp_f32 v142, v142
    v_rcp_f32 v143, v143
    v_rcp_f32 v144, v144
    v_rcp_f32 v145, v145
    v_rcp_f32 v146, v146
    v_rcp_f32 v147, v147
    v_mul_f32 v132, v132, v140
    v_mul_f32 v133, v133, v141
    v_mul_f32 v134, v134, v142
    v_mul_f32 v135, v135, v143
    v_mul_f32 v136, v136, v144
    v_mul_f32 v137, v137, v145
    v_mul_f32 v138, v138, v146
    v_mul_f32 v139, v139, v147
    v_cvt_pk_bf16_f32 v148, v132, v133
    v_cvt_pk_bf16_f32 v149, v134, v135
    v_cvt_pk_bf16_f32 v150, v136, v137
    v_cvt_pk_bf16_f32 v151, v138, v139
    s_nop 1
    v_permlane16_swap_b32 v148, v150
    v_permlane16_swap_b32 v149, v151
    s_mov_b32 s53, 172032
    s_nop 0
    buffer_store_dwordx4 v[148:151], v39, s[28:31], s53 offen
    v_accvgpr_read_b32 v152, a116
    v_accvgpr_read_b32 v153, a117
    v_accvgpr_read_b32 v154, a118
    v_accvgpr_read_b32 v155, a119
    v_accvgpr_read_b32 v156, a124
    v_accvgpr_read_b32 v157, a125
    v_accvgpr_read_b32 v158, a126
    v_accvgpr_read_b32 v159, a127
    v_mul_f32 v160, 0xbfb8aa3b, v152
    v_mul_f32 v161, 0xbfb8aa3b, v153
    v_mul_f32 v162, 0xbfb8aa3b, v154
    v_mul_f32 v163, 0xbfb8aa3b, v155
    v_mul_f32 v164, 0xbfb8aa3b, v156
    v_mul_f32 v165, 0xbfb8aa3b, v157
    v_mul_f32 v166, 0xbfb8aa3b, v158
    v_mul_f32 v167, 0xbfb8aa3b, v159
    v_exp_f32 v160, v160
    v_exp_f32 v161, v161
    v_exp_f32 v162, v162
    v_exp_f32 v163, v163
    v_exp_f32 v164, v164
    v_exp_f32 v165, v165
    v_exp_f32 v166, v166
    v_exp_f32 v167, v167
    v_add_f32 v160, 1.0, v160
    v_add_f32 v161, 1.0, v161
    v_add_f32 v162, 1.0, v162
    v_add_f32 v163, 1.0, v163
    v_add_f32 v164, 1.0, v164
    v_add_f32 v165, 1.0, v165
    v_add_f32 v166, 1.0, v166
    v_add_f32 v167, 1.0, v167
    v_rcp_f32 v160, v160
    v_rcp_f32 v161, v161
    v_rcp_f32 v162, v162
    v_rcp_f32 v163, v163
    v_rcp_f32 v164, v164
    v_rcp_f32 v165, v165
    v_rcp_f32 v166, v166
    v_rcp_f32 v167, v167
    v_mul_f32 v152, v152, v160
    v_mul_f32 v153, v153, v161
    v_mul_f32 v154, v154, v162
    v_mul_f32 v155, v155, v163
    v_mul_f32 v156, v156, v164
    v_mul_f32 v157, v157, v165
    v_mul_f32 v158, v158, v166
    v_mul_f32 v159, v159, v167
    v_cvt_pk_bf16_f32 v168, v152, v153
    v_cvt_pk_bf16_f32 v169, v154, v155
    v_cvt_pk_bf16_f32 v170, v156, v157
    v_cvt_pk_bf16_f32 v171, v158, v159
    s_nop 1
    v_permlane16_swap_b32 v168, v170
    v_permlane16_swap_b32 v169, v171
    s_mov_b32 s53, 173056
    s_nop 0
    buffer_store_dwordx4 v[168:171], v39, s[28:31], s53 offen
    v_accvgpr_read_b32 v172, a132
    v_accvgpr_read_b32 v173, a133
    v_accvgpr_read_b32 v174, a134
    v_accvgpr_read_b32 v175, a135
    v_accvgpr_read_b32 v176, a140
    v_accvgpr_read_b32 v177, a141
    v_accvgpr_read_b32 v178, a142
    v_accvgpr_read_b32 v179, a143
    v_mul_f32 v180, 0xbfb8aa3b, v172
    v_mul_f32 v181, 0xbfb8aa3b, v173
    v_mul_f32 v182, 0xbfb8aa3b, v174
    v_mul_f32 v183, 0xbfb8aa3b, v175
    v_mul_f32 v184, 0xbfb8aa3b, v176
    v_mul_f32 v185, 0xbfb8aa3b, v177
    v_mul_f32 v186, 0xbfb8aa3b, v178
    v_mul_f32 v187, 0xbfb8aa3b, v179
    v_exp_f32 v180, v180
    v_exp_f32 v181, v181
    v_exp_f32 v182, v182
    v_exp_f32 v183, v183
    v_exp_f32 v184, v184
    v_exp_f32 v185, v185
    v_exp_f32 v186, v186
    v_exp_f32 v187, v187
    v_add_f32 v180, 1.0, v180
    v_add_f32 v181, 1.0, v181
    v_add_f32 v182, 1.0, v182
    v_add_f32 v183, 1.0, v183
    v_add_f32 v184, 1.0, v184
    v_add_f32 v185, 1.0, v185
    v_add_f32 v186, 1.0, v186
    v_add_f32 v187, 1.0, v187
    v_rcp_f32 v180, v180
    v_rcp_f32 v181, v181
    v_rcp_f32 v182, v182
    v_rcp_f32 v183, v183
    v_rcp_f32 v184, v184
    v_rcp_f32 v185, v185
    v_rcp_f32 v186, v186
    v_rcp_f32 v187, v187
    v_mul_f32 v172, v172, v180
    v_mul_f32 v173, v173, v181
    v_mul_f32 v174, v174, v182
    v_mul_f32 v175, v175, v183
    v_mul_f32 v176, v176, v184
    v_mul_f32 v177, v177, v185
    v_mul_f32 v178, v178, v186
    v_mul_f32 v179, v179, v187
    v_cvt_pk_bf16_f32 v188, v172, v173
    v_cvt_pk_bf16_f32 v189, v174, v175
    v_cvt_pk_bf16_f32 v190, v176, v177
    v_cvt_pk_bf16_f32 v191, v178, v179
    s_nop 1
    v_permlane16_swap_b32 v188, v190
    v_permlane16_swap_b32 v189, v191
    s_mov_b32 s53, 174080
    s_nop 0
    buffer_store_dwordx4 v[188:191], v39, s[28:31], s53 offen
    v_accvgpr_read_b32 v72, a144
    v_accvgpr_read_b32 v73, a145
    v_accvgpr_read_b32 v74, a146
    v_accvgpr_read_b32 v75, a147
    v_accvgpr_read_b32 v76, a152
    v_accvgpr_read_b32 v77, a153
    v_accvgpr_read_b32 v78, a154
    v_accvgpr_read_b32 v79, a155
    v_cvt_pk_bf16_f32 v216, v72, v73
    v_cvt_pk_bf16_f32 v217, v74, v75
    v_cvt_pk_bf16_f32 v218, v76, v77
    v_cvt_pk_bf16_f32 v219, v78, v79
    s_nop 1
    v_permlane16_swap_b32 v216, v218
    v_permlane16_swap_b32 v217, v219
    v_accvgpr_read_b32 v72, a160
    v_accvgpr_read_b32 v73, a161
    v_accvgpr_read_b32 v74, a162
    v_accvgpr_read_b32 v75, a163
    v_accvgpr_read_b32 v76, a168
    v_accvgpr_read_b32 v77, a169
    v_accvgpr_read_b32 v78, a170
    v_accvgpr_read_b32 v79, a171
    v_cvt_pk_bf16_f32 v220, v72, v73
    v_cvt_pk_bf16_f32 v221, v74, v75
    v_cvt_pk_bf16_f32 v222, v76, v77
    v_cvt_pk_bf16_f32 v223, v78, v79
    s_nop 1
    v_permlane16_swap_b32 v220, v222
    v_permlane16_swap_b32 v221, v223
    v_accvgpr_read_b32 v72, a176
    v_accvgpr_read_b32 v73, a177
    v_accvgpr_read_b32 v74, a178
    v_accvgpr_read_b32 v75, a179
    v_accvgpr_read_b32 v76, a184
    v_accvgpr_read_b32 v77, a185
    v_accvgpr_read_b32 v78, a186
    v_accvgpr_read_b32 v79, a187
    v_cvt_pk_bf16_f32 v224, v72, v73
    v_cvt_pk_bf16_f32 v225, v74, v75
    v_cvt_pk_bf16_f32 v226, v76, v77
    v_cvt_pk_bf16_f32 v227, v78, v79
    v_mov_b32 v240, v224
    v_mov_b32 v241, v225
    v_mov_b32 v242, v226
    v_mov_b32 v243, v227
    s_nop 1
    v_permlane16_swap_b32 v224, v226
    v_permlane16_swap_b32 v225, v227
    v_accvgpr_read_b32 v72, a192
    v_accvgpr_read_b32 v73, a193
    v_accvgpr_read_b32 v74, a194
    v_accvgpr_read_b32 v75, a195
    v_cvt_pk_bf16_f32 v244, v72, v73
    v_cvt_pk_bf16_f32 v245, v74, v75
    v_accvgpr_read_b32 v72, a148
    v_accvgpr_read_b32 v73, a149
    v_accvgpr_read_b32 v74, a150
    v_accvgpr_read_b32 v75, a151
    v_accvgpr_read_b32 v76, a156
    v_accvgpr_read_b32 v77, a157
    v_accvgpr_read_b32 v78, a158
    v_accvgpr_read_b32 v79, a159
    v_cvt_pk_bf16_f32 v228, v72, v73
    v_cvt_pk_bf16_f32 v229, v74, v75
    v_cvt_pk_bf16_f32 v230, v76, v77
    v_cvt_pk_bf16_f32 v231, v78, v79
    s_nop 1
    v_permlane16_swap_b32 v228, v230
    v_permlane16_swap_b32 v229, v231
    v_accvgpr_read_b32 v72, a164
    v_accvgpr_read_b32 v73, a165
    v_accvgpr_read_b32 v74, a166
    v_accvgpr_read_b32 v75, a167
    v_accvgpr_read_b32 v76, a172
    v_accvgpr_read_b32 v77, a173
    v_accvgpr_read_b32 v78, a174
    v_accvgpr_read_b32 v79, a175
    v_cvt_pk_bf16_f32 v232, v72, v73
    v_cvt_pk_bf16_f32 v233, v74, v75
    v_cvt_pk_bf16_f32 v234, v76, v77
    v_cvt_pk_bf16_f32 v235, v78, v79
    s_nop 1
    v_permlane16_swap_b32 v232, v234
    v_permlane16_swap_b32 v233, v235
    v_accvgpr_read_b32 v72, a180
    v_accvgpr_read_b32 v73, a181
    v_accvgpr_read_b32 v74, a182
    v_accvgpr_read_b32 v75, a183
    v_accvgpr_read_b32 v76, a188
    v_accvgpr_read_b32 v77, a189
    v_accvgpr_read_b32 v78, a190
    v_accvgpr_read_b32 v79, a191
    v_cvt_pk_bf16_f32 v236, v72, v73
    v_cvt_pk_bf16_f32 v237, v74, v75
    v_cvt_pk_bf16_f32 v238, v76, v77
    v_cvt_pk_bf16_f32 v239, v78, v79
    v_mov_b32 v246, v236
    v_mov_b32 v247, v237
    v_mov_b32 v248, v238
    v_mov_b32 v249, v239
    s_nop 1
    v_permlane16_swap_b32 v236, v238
    v_permlane16_swap_b32 v237, v239
    v_accvgpr_read_b32 v72, a196
    v_accvgpr_read_b32 v73, a197
    v_accvgpr_read_b32 v74, a198
    v_accvgpr_read_b32 v75, a199
    v_cvt_pk_bf16_f32 v250, v72, v73
    v_cvt_pk_bf16_f32 v251, v74, v75
    v_and_b32 v4, 1, v2
    v_lshrrev_b32 v5, 1, v2
    v_lshl_or_b32 v4, v4, 1, v5
    v_lshlrev_b32 v4, 4, v4
    v_mul_u32_u24 v5, 192, v3
    v_add_u32 v4, v4, v5
    v_add_u32 v4, 114688, v4
    ds_read_b128 v[168:171], v4 offset:0
    ds_read_b128 v[172:175], v4 offset:3072
    ds_read_b128 v[176:179], v4 offset:3136
    ds_read_b128 v[180:183], v4 offset:6144
    ds_read_b128 v[184:187], v4 offset:6208
    ds_read_b128 v[188:191], v4 offset:9280
    ds_read_b128 v[192:195], v4 offset:9344
    ds_read_b128 v[196:199], v4 offset:12352
    ds_read_b128 v[200:203], v4 offset:12416
    s_waitcnt lgkmcnt(8)
    v_mfma_f32_16x16x32_bf16 a[200:203], v[168:171], v[216:219], 0
    v_mfma_f32_16x16x32_bf16 a[204:207], v[168:171], v[228:231], 0
    s_waitcnt lgkmcnt(7)
    v_mfma_f32_16x16x32_bf16 a[208:211], v[172:175], v[216:219], 0
    v_mfma_f32_16x16x32_bf16 a[212:215], v[172:175], v[228:231], 0
    s_waitcnt lgkmcnt(6)
    v_mfma_f32_16x16x32_bf16 a[208:211], v[176:179], v[220:223], a[208:211]
    v_mfma_f32_16x16x32_bf16 a[212:215], v[176:179], v[232:235], a[212:215]
    s_waitcnt lgkmcnt(5)
    v_mfma_f32_16x16x32_bf16 a[216:219], v[180:183], v[216:219], 0
    v_mfma_f32_16x16x32_bf16 a[220:223], v[180:183], v[228:231], 0
    s_waitcnt lgkmcnt(4)
    v_mfma_f32_16x16x32_bf16 a[216:219], v[184:187], v[220:223], a[216:219]
    v_mfma_f32_16x16x32_bf16 a[220:223], v[184:187], v[232:235], a[220:223]
    s_waitcnt lgkmcnt(3)
    v_mfma_f32_16x16x32_bf16 a[224:227], v[188:191], v[220:223], 0
    v_mfma_f32_16x16x32_bf16 a[228:231], v[188:191], v[232:235], 0
    s_waitcnt lgkmcnt(2)
    v_mfma_f32_16x16x32_bf16 a[224:227], v[192:195], v[224:227], a[224:227]
    v_mfma_f32_16x16x32_bf16 a[228:231], v[192:195], v[236:239], a[228:231]
    s_waitcnt lgkmcnt(1)
    v_mfma_f32_16x16x32_bf16 a[232:235], v[196:199], v[220:223], 0
    v_mfma_f32_16x16x32_bf16 a[236:239], v[196:199], v[232:235], 0
    s_waitcnt lgkmcnt(0)
    v_mfma_f32_16x16x32_bf16 a[232:235], v[200:203], v[224:227], a[232:235]
    v_mfma_f32_16x16x32_bf16 a[236:239], v[200:203], v[236:239], a[236:239]
    s_nop 9
    s_barrier
    s_lshl_b32 s53, s46, 5
    v_add_u32 v4, s53, v3
    v_mul_u32_u24 v4, 264, v4
    v_lshl_add_u32 v4, v2, 3, v4
    v_add_u32 v4, 0, v4
    v_accvgpr_read_b32 v72, a200
    v_accvgpr_read_b32 v73, a201
    v_accvgpr_read_b32 v74, a202
    v_accvgpr_read_b32 v75, a203
    v_cvt_pk_bf16_f32 v76, v72, v73
    v_cvt_pk_bf16_f32 v77, v74, v75
    ds_write_b64 v4, v[76:77] offset:0
    v_accvgpr_read_b32 v72, a208
    v_accvgpr_read_b32 v73, a209
    v_accvgpr_read_b32 v74, a210
    v_accvgpr_read_b32 v75, a211
    v_cvt_pk_bf16_f32 v76, v72, v73
    v_cvt_pk_bf16_f32 v77, v74, v75
    ds_write_b64 v4, v[76:77] offset:32
    v_accvgpr_read_b32 v72, a216
    v_accvgpr_read_b32 v73, a217
    v_accvgpr_read_b32 v74, a218
    v_accvgpr_read_b32 v75, a219
    v_cvt_pk_bf16_f32 v76, v72, v73
    v_cvt_pk_bf16_f32 v77, v74, v75
    ds_write_b64 v4, v[76:77] offset:64
    v_accvgpr_read_b32 v72, a224
    v_accvgpr_read_b32 v73, a225
    v_accvgpr_read_b32 v74, a226
    v_accvgpr_read_b32 v75, a227
    v_cvt_pk_bf16_f32 v76, v72, v73
    v_cvt_pk_bf16_f32 v77, v74, v75
    ds_write_b64 v4, v[76:77] offset:96
    v_accvgpr_read_b32 v72, a232
    v_accvgpr_read_b32 v73, a233
    v_accvgpr_read_b32 v74, a234
    v_accvgpr_read_b32 v75, a235
    v_cvt_pk_bf16_f32 v76, v72, v73
    v_cvt_pk_bf16_f32 v77, v74, v75
    ds_write_b64 v4, v[76:77] offset:128
    ds_write_b64 v4, v[240:241] offset:160
    ds_write_b64 v4, v[242:243] offset:192
    ds_write_b64 v4, v[244:245] offset:224
    v_accvgpr_read_b32 v72, a204
    v_accvgpr_read_b32 v73, a205
    v_accvgpr_read_b32 v74, a206
    v_accvgpr_read_b32 v75, a207
    v_cvt_pk_bf16_f32 v76, v72, v73
    v_cvt_pk_bf16_f32 v77, v74, v75
    ds_write_b64 v4, v[76:77] offset:4224
    v_accvgpr_read_b32 v72, a212
    v_accvgpr_read_b32 v73, a213
    v_accvgpr_read_b32 v74, a214
    v_accvgpr_read_b32 v75, a215
    v_cvt_pk_bf16_f32 v76, v72, v73
    v_cvt_pk_bf16_f32 v77, v74, v75
    ds_write_b64 v4, v[76:77] offset:4256
    v_accvgpr_read_b32 v72, a220
    v_accvgpr_read_b32 v73, a221
    v_accvgpr_read_b32 v74, a222
    v_accvgpr_read_b32 v75, a223
    v_cvt_pk_bf16_f32 v76, v72, v73
    v_cvt_pk_bf16_f32 v77, v74, v75
    ds_write_b64 v4, v[76:77] offset:4288
    v_accvgpr_read_b32 v72, a228
    v_accvgpr_read_b32 v73, a229
    v_accvgpr_read_b32 v74, a230
    v_accvgpr_read_b32 v75, a231
    v_cvt_pk_bf16_f32 v76, v72, v73
    v_cvt_pk_bf16_f32 v77, v74, v75
    ds_write_b64 v4, v[76:77] offset:4320
    v_accvgpr_read_b32 v72, a236
    v_accvgpr_read_b32 v73, a237
    v_accvgpr_read_b32 v74, a238
    v_accvgpr_read_b32 v75, a239
    v_cvt_pk_bf16_f32 v76, v72, v73
    v_cvt_pk_bf16_f32 v77, v74, v75
    ds_write_b64 v4, v[76:77] offset:4352
    ds_write_b64 v4, v[246:247] offset:4384
    ds_write_b64 v4, v[248:249] offset:4416
    ds_write_b64 v4, v[250:251] offset:4448
    s_waitcnt lgkmcnt(0)
    s_barrier
    v_and_b32 v4, 127, v0
    v_lshrrev_b32 v5, 7, v0
    v_mul_u32_u24 v6, 264, v4
    v_mul_u32_u24 v7, 36, v5
    v_add_u32 v6, v6, v7
    v_add_u32 v6, 0, v6
    ds_read_b32 v72, v6 offset:0
    ds_read_b32 v81, v6 offset:72
    ds_read_b32 v90, v6 offset:176
    ds_read_b32 v73, v6 offset:4
    ds_read_b32 v82, v6 offset:76
    ds_read_b32 v91, v6 offset:180
    ds_read_b32 v74, v6 offset:8
    ds_read_b32 v83, v6 offset:80
    ds_read_b32 v92, v6 offset:184
    ds_read_b32 v75, v6 offset:12
    ds_read_b32 v84, v6 offset:84
    ds_read_b32 v93, v6 offset:188
    ds_read_b32 v76, v6 offset:16
    ds_read_b32 v85, v6 offset:88
    ds_read_b32 v94, v6 offset:192
    ds_read_b32 v77, v6 offset:20
    ds_read_b32 v86, v6 offset:92
    ds_read_b32 v95, v6 offset:196
    ds_read_b32 v78, v6 offset:24
    ds_read_b32 v87, v6 offset:96
    ds_read_b32 v96, v6 offset:200
    ds_read_b32 v79, v6 offset:28
    ds_read_b32 v88, v6 offset:100
    ds_read_b32 v97, v6 offset:204
    ds_read_b32 v80, v6 offset:32
    ds_read_b32 v89, v6 offset:104
    ds_read_b32 v98, v6 offset:208
    v_lshlrev_b32 v7, 1, v4
    v_mul_u32_u24 v8, 8704, v5
    v_add_u32 v8, v8, v7
    v_add_u32 v8, 33792, v8
    v_mul_u32_u24 v9, 13056, v5
    v_add_u32 v9, v9, v7
    v_add_u32 v9, 51200, v9
    s_lshl_b32 s53, s45, 1
    v_add_u32 v28, s53, v5
    v_lshlrev_b32 v28, 11, v28
    s_lshl_b32 s53, s44, 7
    v_add3_u32 v28, v28, v4, s53
    v_mul_u32_u24 v28, 72, v28
    s_waitcnt lgkmcnt(0)
    ds_write_b16 v8, v90 offset:0
    ds_write_b16_d16_hi v8, v90 offset:272
    ds_write_b16 v8, v91 offset:544
    ds_write_b16_d16_hi v8, v91 offset:816
    ds_write_b16 v8, v92 offset:1088
    ds_write_b16_d16_hi v8, v92 offset:1360
    ds_write_b16 v8, v93 offset:1632
    ds_write_b16_d16_hi v8, v93 offset:1904
    ds_write_b16 v8, v94 offset:2176
    ds_write_b16_d16_hi v8, v94 offset:2448
    ds_write_b16 v8, v95 offset:2720
    ds_write_b16_d16_hi v8, v95 offset:2992
    ds_write_b16 v8, v96 offset:3264
    ds_write_b16_d16_hi v8, v96 offset:3536
    ds_write_b16 v8, v97 offset:3808
    ds_write_b16_d16_hi v8, v97 offset:4080
    ds_write_b16 v8, v98 offset:4352
    ds_write_b16_d16_hi v8, v98 offset:4624
    v_mov_b32 v29, 0x3f80
    ds_write_b16 v8, v29 offset:4896
    v_lshlrev_b32 v136, 16, v72
    v_and_b32 v137, 0xffff0000, v72
    v_lshlrev_b32 v138, 16, v73
    v_and_b32 v139, 0xffff0000, v73
    v_lshlrev_b32 v140, 16, v74
    v_and_b32 v141, 0xffff0000, v74
    v_lshlrev_b32 v142, 16, v75
    v_and_b32 v143, 0xffff0000, v75
    v_lshlrev_b32 v144, 16, v76
    v_and_b32 v145, 0xffff0000, v76
    v_lshlrev_b32 v146, 16, v77
    v_and_b32 v147, 0xffff0000, v77
    v_lshlrev_b32 v148, 16, v78
    v_and_b32 v149, 0xffff0000, v78
    v_lshlrev_b32 v150, 16, v79
    v_and_b32 v151, 0xffff0000, v79
    v_lshlrev_b32 v152, 16, v80
    v_and_b32 v153, 0xffff0000, v80
    v_max3_f32 v196, v136, v137, v138
    v_min3_f32 v197, v136, v137, v138
    v_max3_f32 v196, v196, v139, v140
    v_min3_f32 v197, v197, v139, v140
    v_max3_f32 v196, v196, v141, v142
    v_min3_f32 v197, v197, v141, v142
    v_max3_f32 v196, v196, v143, v144
    v_min3_f32 v197, v197, v143, v144
    v_max3_f32 v196, v196, v145, v146
    v_min3_f32 v197, v197, v145, v146
    v_max3_f32 v196, v196, v147, v148
    v_min3_f32 v197, v197, v147, v148
    v_max3_f32 v196, v196, v149, v150
    v_min3_f32 v197, v197, v149, v150
    v_max3_f32 v196, v196, v151, v152
    v_min3_f32 v197, v197, v151, v152
    v_max_f32 v196, v196, v153
    v_min_f32 v197, v197, v153
    v_mul_f32 v196, 0xbfb8aa3b, v196
    v_mul_f32 v197, 0x3fb8aa3b, v197
    v_mov_b32 v199, 0x3fb8aa3b
    v_fma_f32 v156, v136, v199, v196
    v_fma_f32 v174, -v136, v199, v197
    v_fma_f32 v157, v137, v199, v196
    v_fma_f32 v175, -v137, v199, v197
    v_fma_f32 v158, v138, v199, v196
    v_fma_f32 v176, -v138, v199, v197
    v_fma_f32 v159, v139, v199, v196
    v_fma_f32 v177, -v139, v199, v197
    v_fma_f32 v160, v140, v199, v196
    v_fma_f32 v178, -v140, v199, v197
    v_fma_f32 v161, v141, v199, v196
    v_fma_f32 v179, -v141, v199, v197
    v_fma_f32 v162, v142, v199, v196
    v_fma_f32 v180, -v142, v199, v197
    v_fma_f32 v163, v143, v199, v196
    v_fma_f32 v181, -v143, v199, v197
    v_fma_f32 v164, v144, v199, v196
    v_fma_f32 v182, -v144, v199, v197
    v_fma_f32 v165, v145, v199, v196
    v_fma_f32 v183, -v145, v199, v197
    v_fma_f32 v166, v146, v199, v196
    v_fma_f32 v184, -v146, v199, v197
    v_fma_f32 v167, v147, v199, v196
    v_fma_f32 v185, -v147, v199, v197
    v_fma_f32 v168, v148, v199, v196
    v_fma_f32 v186, -v148, v199, v197
    v_fma_f32 v169, v149, v199, v196
    v_fma_f32 v187, -v149, v199, v197
    v_fma_f32 v170, v150, v199, v196
    v_fma_f32 v188, -v150, v199, v197
    v_fma_f32 v171, v151, v199, v196
    v_fma_f32 v189, -v151, v199, v197
    v_fma_f32 v172, v152, v199, v196
    v_fma_f32 v190, -v152, v199, v197
    v_fma_f32 v173, v153, v199, v196
    v_fma_f32 v191, -v153, v199, v197
    v_exp_f32 v156, v156
    v_exp_f32 v157, v157
    v_exp_f32 v158, v158
    v_exp_f32 v159, v159
    v_exp_f32 v160, v160
    v_exp_f32 v161, v161
    v_exp_f32 v162, v162
    v_exp_f32 v163, v163
    v_exp_f32 v164, v164
    v_exp_f32 v165, v165
    v_exp_f32 v166, v166
    v_exp_f32 v167, v167
    v_exp_f32 v168, v168
    v_exp_f32 v169, v169
    v_exp_f32 v170, v170
    v_exp_f32 v171, v171
    v_exp_f32 v172, v172
    v_exp_f32 v173, v173
    v_exp_f32 v174, v174
    v_exp_f32 v175, v175
    v_exp_f32 v176, v176
    v_exp_f32 v177, v177
    v_exp_f32 v178, v178
    v_exp_f32 v179, v179
    v_exp_f32 v180, v180
    v_exp_f32 v181, v181
    v_exp_f32 v182, v182
    v_exp_f32 v183, v183
    v_exp_f32 v184, v184
    v_exp_f32 v185, v185
    v_exp_f32 v186, v186
    v_exp_f32 v187, v187
    v_exp_f32 v188, v188
    v_exp_f32 v189, v189
    v_exp_f32 v190, v190
    v_exp_f32 v191, v191
    s_nop 0
    v_add_f32 v198, v156, v157
    v_add_f32 v199, v174, v175
    v_add_f32 v198, v198, v158
    v_add_f32 v199, v199, v176
    v_add_f32 v198, v198, v159
    v_add_f32 v199, v199, v177
    v_add_f32 v198, v198, v160
    v_add_f32 v199, v199, v178
    v_add_f32 v198, v198, v161
    v_add_f32 v199, v199, v179
    v_add_f32 v198, v198, v162
    v_add_f32 v199, v199, v180
    v_add_f32 v198, v198, v163
    v_add_f32 v199, v199, v181
    v_add_f32 v198, v198, v164
    v_add_f32 v199, v199, v182
    v_add_f32 v198, v198, v165
    v_add_f32 v199, v199, v183
    v_add_f32 v198, v198, v166
    v_add_f32 v199, v199, v184
    v_add_f32 v198, v198, v167
    v_add_f32 v199, v199, v185
    v_add_f32 v198, v198, v168
    v_add_f32 v199, v199, v186
    v_add_f32 v198, v198, v169
    v_add_f32 v199, v199, v187
    v_add_f32 v198, v198, v170
    v_add_f32 v199, v199, v188
    v_add_f32 v198, v198, v171
    v_add_f32 v199, v199, v189
    v_add_f32 v198, v198, v172
    v_add_f32 v199, v199, v190
    v_add_f32 v198, v198, v173
    v_add_f32 v199, v199, v191
    v_rcp_f32 v198, v198
    v_rcp_f32 v199, v199
    s_nop 0
    v_mul_f32 v156, v156, v198
    v_mul_f32 v174, v174, v199
    v_mul_f32 v157, v157, v198
    v_mul_f32 v175, v175, v199
    v_mul_f32 v158, v158, v198
    v_mul_f32 v176, v176, v199
    v_mul_f32 v159, v159, v198
    v_mul_f32 v177, v177, v199
    v_mul_f32 v160, v160, v198
    v_mul_f32 v178, v178, v199
    v_mul_f32 v161, v161, v198
    v_mul_f32 v179, v179, v199
    v_mul_f32 v162, v162, v198
    v_mul_f32 v180, v180, v199
    v_mul_f32 v163, v163, v198
    v_mul_f32 v181, v181, v199
    v_mul_f32 v164, v164, v198
    v_mul_f32 v182, v182, v199
    v_mul_f32 v165, v165, v198
    v_mul_f32 v183, v183, v199
    v_mul_f32 v166, v166, v198
    v_mul_f32 v184, v184, v199
    v_mul_f32 v167, v167, v198
    v_mul_f32 v185, v185, v199
    v_mul_f32 v168, v168, v198
    v_mul_f32 v186, v186, v199
    v_mul_f32 v169, v169, v198
    v_mul_f32 v187, v187, v199
    v_mul_f32 v170, v170, v198
    v_mul_f32 v188, v188, v199
    v_mul_f32 v171, v171, v198
    v_mul_f32 v189, v189, v199
    v_mul_f32 v172, v172, v198
    v_mul_f32 v190, v190, v199
    v_mul_f32 v173, v173, v198
    v_mul_f32 v191, v191, v199
    v_cvt_pk_bf16_f32 v104, v156, v157
    v_cvt_pk_bf16_f32 v105, v158, v159
    v_cvt_pk_bf16_f32 v106, v160, v161
    v_cvt_pk_bf16_f32 v107, v162, v163
    v_cvt_pk_bf16_f32 v108, v164, v165
    v_cvt_pk_bf16_f32 v109, v166, v167
    v_cvt_pk_bf16_f32 v110, v168, v169
    v_cvt_pk_bf16_f32 v111, v170, v171
    v_cvt_pk_bf16_f32 v112, v172, v173
    v_cvt_pk_bf16_f32 v113, v174, v175
    v_cvt_pk_bf16_f32 v114, v176, v177
    v_cvt_pk_bf16_f32 v115, v178, v179
    v_cvt_pk_bf16_f32 v116, v180, v181
    v_cvt_pk_bf16_f32 v117, v182, v183
    v_cvt_pk_bf16_f32 v118, v184, v185
    v_cvt_pk_bf16_f32 v119, v186, v187
    v_cvt_pk_bf16_f32 v120, v188, v189
    v_cvt_pk_bf16_f32 v121, v190, v191
    buffer_store_dwordx2 v[104:105], v28, s[32:35], 0 offen offset:0
    buffer_store_dwordx2 v[106:107], v28, s[32:35], 0 offen offset:8
    buffer_store_dwordx2 v[108:109], v28, s[32:35], 0 offen offset:16
    buffer_store_dwordx2 v[110:111], v28, s[32:35], 0 offen offset:24
    buffer_store_dwordx2 v[112:113], v28, s[32:35], 0 offen offset:32
    buffer_store_dwordx2 v[114:115], v28, s[32:35], 0 offen offset:40
    buffer_store_dwordx2 v[116:117], v28, s[32:35], 0 offen offset:48
    buffer_store_dwordx2 v[118:119], v28, s[32:35], 0 offen offset:56
    buffer_store_dwordx2 v[120:121], v28, s[32:35], 0 offen offset:64
    s_nop 1
    v_lshlrev_b32 v136, 16, v81
    v_and_b32 v137, 0xffff0000, v81
    v_lshlrev_b32 v138, 16, v82
    v_and_b32 v139, 0xffff0000, v82
    v_lshlrev_b32 v140, 16, v83
    v_and_b32 v141, 0xffff0000, v83
    v_lshlrev_b32 v142, 16, v84
    v_and_b32 v143, 0xffff0000, v84
    v_lshlrev_b32 v144, 16, v85
    v_and_b32 v145, 0xffff0000, v85
    v_lshlrev_b32 v146, 16, v86
    v_and_b32 v147, 0xffff0000, v86
    v_lshlrev_b32 v148, 16, v87
    v_and_b32 v149, 0xffff0000, v87
    v_lshlrev_b32 v150, 16, v88
    v_and_b32 v151, 0xffff0000, v88
    v_lshlrev_b32 v152, 16, v89
    v_and_b32 v153, 0xffff0000, v89
    v_max3_f32 v196, v136, v137, v138
    v_min3_f32 v197, v136, v137, v138
    v_max3_f32 v196, v196, v139, v140
    v_min3_f32 v197, v197, v139, v140
    v_max3_f32 v196, v196, v141, v142
    v_min3_f32 v197, v197, v141, v142
    v_max3_f32 v196, v196, v143, v144
    v_min3_f32 v197, v197, v143, v144
    v_max3_f32 v196, v196, v145, v146
    v_min3_f32 v197, v197, v145, v146
    v_max3_f32 v196, v196, v147, v148
    v_min3_f32 v197, v197, v147, v148
    v_max3_f32 v196, v196, v149, v150
    v_min3_f32 v197, v197, v149, v150
    v_max3_f32 v196, v196, v151, v152
    v_min3_f32 v197, v197, v151, v152
    v_max_f32 v196, v196, v153
    v_min_f32 v197, v197, v153
    v_mul_f32 v196, 0xbfb8aa3b, v196
    v_mul_f32 v197, 0x3fb8aa3b, v197
    v_mov_b32 v199, 0x3fb8aa3b
    v_fma_f32 v156, v136, v199, v196
    v_fma_f32 v174, -v136, v199, v197
    v_fma_f32 v157, v137, v199, v196
    v_fma_f32 v175, -v137, v199, v197
    v_fma_f32 v158, v138, v199, v196
    v_fma_f32 v176, -v138, v199, v197
    v_fma_f32 v159, v139, v199, v196
    v_fma_f32 v177, -v139, v199, v197
    v_fma_f32 v160, v140, v199, v196
    v_fma_f32 v178, -v140, v199, v197
    v_fma_f32 v161, v141, v199, v196
    v_fma_f32 v179, -v141, v199, v197
    v_fma_f32 v162, v142, v199, v196
    v_fma_f32 v180, -v142, v199, v197
    v_fma_f32 v163, v143, v199, v196
    v_fma_f32 v181, -v143, v199, v197
    v_fma_f32 v164, v144, v199, v196
    v_fma_f32 v182, -v144, v199, v197
    v_fma_f32 v165, v145, v199, v196
    v_fma_f32 v183, -v145, v199, v197
    v_fma_f32 v166, v146, v199, v196
    v_fma_f32 v184, -v146, v199, v197
    v_fma_f32 v167, v147, v199, v196
    v_fma_f32 v185, -v147, v199, v197
    v_fma_f32 v168, v148, v199, v196
    v_fma_f32 v186, -v148, v199, v197
    v_fma_f32 v169, v149, v199, v196
    v_fma_f32 v187, -v149, v199, v197
    v_fma_f32 v170, v150, v199, v196
    v_fma_f32 v188, -v150, v199, v197
    v_fma_f32 v171, v151, v199, v196
    v_fma_f32 v189, -v151, v199, v197
    v_fma_f32 v172, v152, v199, v196
    v_fma_f32 v190, -v152, v199, v197
    v_fma_f32 v173, v153, v199, v196
    v_fma_f32 v191, -v153, v199, v197
    v_exp_f32 v156, v156
    v_exp_f32 v157, v157
    v_exp_f32 v158, v158
    v_exp_f32 v159, v159
    v_exp_f32 v160, v160
    v_exp_f32 v161, v161
    v_exp_f32 v162, v162
    v_exp_f32 v163, v163
    v_exp_f32 v164, v164
    v_exp_f32 v165, v165
    v_exp_f32 v166, v166
    v_exp_f32 v167, v167
    v_exp_f32 v168, v168
    v_exp_f32 v169, v169
    v_exp_f32 v170, v170
    v_exp_f32 v171, v171
    v_exp_f32 v172, v172
    v_exp_f32 v173, v173
    v_exp_f32 v174, v174
    v_exp_f32 v175, v175
    v_exp_f32 v176, v176
    v_exp_f32 v177, v177
    v_exp_f32 v178, v178
    v_exp_f32 v179, v179
    v_exp_f32 v180, v180
    v_exp_f32 v181, v181
    v_exp_f32 v182, v182
    v_exp_f32 v183, v183
    v_exp_f32 v184, v184
    v_exp_f32 v185, v185
    v_exp_f32 v186, v186
    v_exp_f32 v187, v187
    v_exp_f32 v188, v188
    v_exp_f32 v189, v189
    v_exp_f32 v190, v190
    v_exp_f32 v191, v191
    s_nop 0
    v_add_f32 v198, v156, v157
    v_add_f32 v199, v174, v175
    v_add_f32 v198, v198, v158
    v_add_f32 v199, v199, v176
    v_add_f32 v198, v198, v159
    v_add_f32 v199, v199, v177
    v_add_f32 v198, v198, v160
    v_add_f32 v199, v199, v178
    v_add_f32 v198, v198, v161
    v_add_f32 v199, v199, v179
    v_add_f32 v198, v198, v162
    v_add_f32 v199, v199, v180
    v_add_f32 v198, v198, v163
    v_add_f32 v199, v199, v181
    v_add_f32 v198, v198, v164
    v_add_f32 v199, v199, v182
    v_add_f32 v198, v198, v165
    v_add_f32 v199, v199, v183
    v_add_f32 v198, v198, v166
    v_add_f32 v199, v199, v184
    v_add_f32 v198, v198, v167
    v_add_f32 v199, v199, v185
    v_add_f32 v198, v198, v168
    v_add_f32 v199, v199, v186
    v_add_f32 v198, v198, v169
    v_add_f32 v199, v199, v187
    v_add_f32 v198, v198, v170
    v_add_f32 v199, v199, v188
    v_add_f32 v198, v198, v171
    v_add_f32 v199, v199, v189
    v_add_f32 v198, v198, v172
    v_add_f32 v199, v199, v190
    v_add_f32 v198, v198, v173
    v_add_f32 v199, v199, v191
    v_rcp_f32 v198, v198
    v_rcp_f32 v199, v199
    s_nop 0
    v_mul_f32 v156, v156, v198
    v_mul_f32 v174, v174, v199
    v_mul_f32 v157, v157, v198
    v_mul_f32 v175, v175, v199
    v_mul_f32 v158, v158, v198
    v_mul_f32 v176, v176, v199
    v_mul_f32 v159, v159, v198
    v_mul_f32 v177, v177, v199
    v_mul_f32 v160, v160, v198
    v_mul_f32 v178, v178, v199
    v_mul_f32 v161, v161, v198
    v_mul_f32 v179, v179, v199
    v_mul_f32 v162, v162, v198
    v_mul_f32 v180, v180, v199
    v_mul_f32 v163, v163, v198
    v_mul_f32 v181, v181, v199
    v_mul_f32 v164, v164, v198
    v_mul_f32 v182, v182, v199
    v_mul_f32 v165, v165, v198
    v_mul_f32 v183, v183, v199
    v_mul_f32 v166, v166, v198
    v_mul_f32 v184, v184, v199
    v_mul_f32 v167, v167, v198
    v_mul_f32 v185, v185, v199
    v_mul_f32 v168, v168, v198
    v_mul_f32 v186, v186, v199
    v_mul_f32 v169, v169, v198
    v_mul_f32 v187, v187, v199
    v_mul_f32 v170, v170, v198
    v_mul_f32 v188, v188, v199
    v_mul_f32 v171, v171, v198
    v_mul_f32 v189, v189, v199
    v_mul_f32 v172, v172, v198
    v_mul_f32 v190, v190, v199
    v_mul_f32 v173, v173, v198
    v_mul_f32 v191, v191, v199
    v_cvt_pk_bf16_f32 v104, v156, v157
    v_cvt_pk_bf16_f32 v105, v158, v159
    v_cvt_pk_bf16_f32 v106, v160, v161
    v_cvt_pk_bf16_f32 v107, v162, v163
    v_cvt_pk_bf16_f32 v108, v164, v165
    v_cvt_pk_bf16_f32 v109, v166, v167
    v_cvt_pk_bf16_f32 v110, v168, v169
    v_cvt_pk_bf16_f32 v111, v170, v171
    v_cvt_pk_bf16_f32 v112, v172, v173
    v_cvt_pk_bf16_f32 v113, v174, v175
    v_cvt_pk_bf16_f32 v114, v176, v177
    v_cvt_pk_bf16_f32 v115, v178, v179
    v_cvt_pk_bf16_f32 v116, v180, v181
    v_cvt_pk_bf16_f32 v117, v182, v183
    v_cvt_pk_bf16_f32 v118, v184, v185
    v_cvt_pk_bf16_f32 v119, v186, v187
    v_cvt_pk_bf16_f32 v120, v188, v189
    v_cvt_pk_bf16_f32 v121, v190, v191
    ds_write_b16 v9, v104 offset:0
    ds_write_b16_d16_hi v9, v104 offset:272
    ds_write_b16 v9, v105 offset:544
    ds_write_b16_d16_hi v9, v105 offset:816
    ds_write_b16 v9, v106 offset:1088
    ds_write_b16_d16_hi v9, v106 offset:1360
    ds_write_b16 v9, v107 offset:1632
    ds_write_b16_d16_hi v9, v107 offset:1904
    ds_write_b16 v9, v108 offset:2176
    ds_write_b16_d16_hi v9, v108 offset:2448
    ds_write_b16 v9, v109 offset:2720
    ds_write_b16_d16_hi v9, v109 offset:2992
    ds_write_b16 v9, v110 offset:3264
    ds_write_b16_d16_hi v9, v110 offset:3536
    ds_write_b16 v9, v111 offset:3808
    ds_write_b16_d16_hi v9, v111 offset:4080
    ds_write_b16 v9, v112 offset:4352
    ds_write_b16_d16_hi v9, v112 offset:4624
    ds_write_b16 v9, v113 offset:4896
    ds_write_b16_d16_hi v9, v113 offset:5168
    ds_write_b16 v9, v114 offset:5440
    ds_write_b16_d16_hi v9, v114 offset:5712
    ds_write_b16 v9, v115 offset:5984
    ds_write_b16_d16_hi v9, v115 offset:6256
    ds_write_b16 v9, v116 offset:6528
    ds_write_b16_d16_hi v9, v116 offset:6800
    ds_write_b16 v9, v117 offset:7072
    ds_write_b16_d16_hi v9, v117 offset:7344
    ds_write_b16 v9, v118 offset:7616
    ds_write_b16_d16_hi v9, v118 offset:7888
    ds_write_b16 v9, v119 offset:8160
    ds_write_b16_d16_hi v9, v119 offset:8432
    ds_write_b16 v9, v120 offset:8704
    ds_write_b16_d16_hi v9, v120 offset:8976
    ds_write_b16 v9, v121 offset:9248
    ds_write_b16_d16_hi v9, v121 offset:9520
    s_waitcnt lgkmcnt(0)
    s_barrier
    s_lshr_b32 s53, s46, 1
    s_and_b32 s54, s46, 1
    v_mul_u32_u24 v4, 272, v3
    v_lshl_add_u32 v4, v2, 4, v4
    s_mul_i32 s55, s53, 13056
    s_add_u32 s55, s55, 51200
    v_add_u32 v5, s55, v4
    s_mul_i32 s55, s53, 8704
    s_mul_i32 s56, s54, 4352
    s_add_u32 s55, s55, s56
    s_add_u32 s55, s55, 33792
    v_add_u32 v6, s55, v4
    ds_read_b128 v[120:123], v6 offset:0
    ds_read_b128 v[72:75], v5 offset:0
    ds_read_b128 v[76:79], v5 offset:4352
    ds_read_b128 v[80:83], v5 offset:8704
    ds_read_b128 v[124:127], v6 offset:64
    ds_read_b128 v[84:87], v5 offset:64
    ds_read_b128 v[88:91], v5 offset:4416
    ds_read_b128 v[92:95], v5 offset:8768
    ds_read_b128 v[128:131], v6 offset:128
    ds_read_b128 v[96:99], v5 offset:128
    ds_read_b128 v[100:103], v5 offset:4480
    ds_read_b128 v[104:107], v5 offset:8832
    ds_read_b128 v[132:135], v6 offset:192
    ds_read_b128 v[108:111], v5 offset:192
    ds_read_b128 v[112:115], v5 offset:4544
    ds_read_b128 v[116:119], v5 offset:8896
    s_waitcnt lgkmcnt(12)
    v_mfma_f32_16x16x32_bf16 a[200:203], v[72:75], v[120:123], 0
    v_mfma_f32_16x16x32_bf16 a[204:207], v[76:79], v[120:123], 0
    v_mfma_f32_16x16x32_bf16 a[208:211], v[80:83], v[120:123], 0
    s_waitcnt lgkmcnt(8)
    v_mfma_f32_16x16x32_bf16 a[200:203], v[84:87], v[124:127], a[200:203]
    v_mfma_f32_16x16x32_bf16 a[204:207], v[88:91], v[124:127], a[204:207]
    v_mfma_f32_16x16x32_bf16 a[208:211], v[92:95], v[124:127], a[208:211]
    s_waitcnt lgkmcnt(4)
    v_mfma_f32_16x16x32_bf16 a[200:203], v[96:99], v[128:131], a[200:203]
    v_mfma_f32_16x16x32_bf16 a[204:207], v[100:103], v[128:131], a[204:207]
    v_mfma_f32_16x16x32_bf16 a[208:211], v[104:107], v[128:131], a[208:211]
    s_waitcnt lgkmcnt(0)
    v_mfma_f32_16x16x32_bf16 a[200:203], v[108:111], v[132:135], a[200:203]
    v_mfma_f32_16x16x32_bf16 a[204:207], v[112:115], v[132:135], a[204:207]
    v_mfma_f32_16x16x32_bf16 a[208:211], v[116:119], v[132:135], a[208:211]
    s_nop 9
    s_lshl_b32 s55, s45, 1
    s_add_u32 s55, s55, s53
    s_lshl_b32 s56, s44, 5
    s_add_u32 s55, s55, s56
    s_mul_i32 s55, s55, 6144
    s_lshl_b32 s56, s54, 6
    s_add_u32 s55, s55, s56
    v_lshlrev_b32 v4, 2, v3
    v_lshl_add_u32 v4, v2, 9, v4
    v_add_u32 v4, s55, v4
    s_mov_b32 s56, 0
    buffer_store_dword a200, v4, s[36:39], s56 offen offset:0
    buffer_store_dword a201, v4, s[36:39], s56 offen offset:128
    buffer_store_dword a202, v4, s[36:39], s56 offen offset:256
    buffer_store_dword a203, v4, s[36:39], s56 offen offset:384
    s_mov_b32 s56, 2048
    buffer_store_dword a204, v4, s[36:39], s56 offen offset:0
    buffer_store_dword a205, v4, s[36:39], s56 offen offset:128
    buffer_store_dword a206, v4, s[36:39], s56 offen offset:256
    buffer_store_dword a207, v4, s[36:39], s56 offen offset:384
    s_mov_b32 s56, 4096
    buffer_store_dword a208, v4, s[36:39], s56 offen offset:0
    buffer_store_dword a209, v4, s[36:39], s56 offen offset:128
    buffer_store_dword a210, v4, s[36:39], s56 offen offset:256
    buffer_store_dword a211, v4, s[36:39], s56 offen offset:384
L_k1_ln_gemm1_kernel_end:
    s_endpgm
.text
.globl k2_attn_out_kernel
.p2align 8
.type k2_attn_out_kernel,@function
k2_attn_out_kernel:
    s_load_dwordx2 s[4:5], s[0:1], 72
    s_cmp_ge_u32 s2, 256
    s_cbranch_scc1 L_k2_attn_out_kernel_end
    s_and_b32 s20, s2, 31
    s_lshr_b32 s21, s2, 5
    s_waitcnt lgkmcnt(0)
    s_mov_b32 s8, s4
    s_mov_b32 s9, s5
    s_mov_b32 s10, 21233664
    s_mov_b32 s11, 0x00020000
    s_add_u32 s12, s4, 25165824
    s_addc_u32 s13, s5, 0
    s_mov_b32 s14, 4718592
    s_mov_b32 s15, 0x00020000
    s_add_u32 s16, s4, 33554432
    s_addc_u32 s17, s5, 0
    s_mov_b32 s18, 3145728
    s_mov_b32 s19, 0x00020000
    s_lshl_b32 s22, s21, 8
    v_add_u32 v1, s22, v0
    s_lshl_b32 s23, s20, 11
    v_add_u32 v3, s23, v1
    v_mul_u32_u24 v3, 72, v3
    buffer_load_dwordx2 v[4:5], v3, s[12:15], 0 offen offset:0
    buffer_load_dwordx2 v[6:7], v3, s[12:15], 0 offen offset:8
    buffer_load_dwordx2 v[8:9], v3, s[12:15], 0 offen offset:16
    buffer_load_dwordx2 v[10:11], v3, s[12:15], 0 offen offset:24
    buffer_load_dwordx2 v[12:13], v3, s[12:15], 0 offen offset:32
    buffer_load_dwordx2 v[14:15], v3, s[12:15], 0 offen offset:40
    buffer_load_dwordx2 v[16:17], v3, s[12:15], 0 offen offset:48
    buffer_load_dwordx2 v[18:19], v3, s[12:15], 0 offen offset:56
    buffer_load_dwordx2 v[20:21], v3, s[12:15], 0 offen offset:64
    v_lshlrev_b32 v2, 2, v0
    v_add_u32 v22, 4096, v2
    s_mul_i32 s22, s20, 6144
    buffer_load_dword v24, v2, s[16:19], s22 offen offset:0
    buffer_load_dword v25, v2, s[16:19], s22 offen offset:1024
    buffer_load_dword v26, v2, s[16:19], s22 offen offset:2048
    buffer_load_dword v27, v2, s[16:19], s22 offen offset:3072
    buffer_load_dword v28, v22, s[16:19], s22 offen offset:0
    buffer_load_dword v29, v22, s[16:19], s22 offen offset:1024
    s_add_u32 s22, s22, 196608
    buffer_load_dword v30, v2, s[16:19], s22 offen offset:0
    buffer_load_dword v31, v2, s[16:19], s22 offen offset:1024
    buffer_load_dword v32, v2, s[16:19], s22 offen offset:2048
    buffer_load_dword v33, v2, s[16:19], s22 offen offset:3072
    buffer_load_dword v34, v22, s[16:19], s22 offen offset:0
    buffer_load_dword v35, v22, s[16:19], s22 offen offset:1024
    s_add_u32 s22, s22, 196608
    buffer_load_dword v36, v2, s[16:19], s22 offen offset:0
    buffer_load_dword v37, v2, s[16:19], s22 offen offset:1024
    buffer_load_dword v38, v2, s[16:19], s22 offen offset:2048
    buffer_load_dword v39, v2, s[16:19], s22 offen offset:3072
    buffer_load_dword v40, v22, s[16:19], s22 offen offset:0
    buffer_load_dword v41, v22, s[16:19], s22 offen offset:1024
    s_add_u32 s22, s22, 196608
    buffer_load_dword v42, v2, s[16:19], s22 offen offset:0
    buffer_load_dword v43, v2, s[16:19], s22 offen offset:1024
    buffer_load_dword v44, v2, s[16:19], s22 offen offset:2048
    buffer_load_dword v45, v2, s[16:19], s22 offen offset:3072
    buffer_load_dword v46, v22, s[16:19], s22 offen offset:0
    buffer_load_dword v47, v22, s[16:19], s22 offen offset:1024
    s_add_u32 s22, s22, 196608
    buffer_load_dword v48, v2, s[16:19], s22 offen offset:0
    buffer_load_dword v49, v2, s[16:19], s22 offen offset:1024
    buffer_load_dword v50, v2, s[16:19], s22 offen offset:2048
    buffer_load_dword v51, v2, s[16:19], s22 offen offset:3072
    buffer_load_dword v52, v22, s[16:19], s22 offen offset:0
    buffer_load_dword v53, v22, s[16:19], s22 offen offset:1024
    s_add_u32 s22, s22, 196608
    buffer_load_dword v54, v2, s[16:19], s22 offen offset:0
    buffer_load_dword v55, v2, s[16:19], s22 offen offset:1024
    buffer_load_dword v56, v2, s[16:19], s22 offen offset:2048
    buffer_load_dword v57, v2, s[16:19], s22 offen offset:3072
    buffer_load_dword v58, v22, s[16:19], s22 offen offset:0
    buffer_load_dword v59, v22, s[16:19], s22 offen offset:1024
    s_add_u32 s22, s22, 196608
    buffer_load_dword v60, v2, s[16:19], s22 offen offset:0
    buffer_load_dword v61, v2, s[16:19], s22 offen offset:1024
    buffer_load_dword v62, v2, s[16:19], s22 offen offset:2048
    buffer_load_dword v63, v2, s[16:19], s22 offen offset:3072
    buffer_load_dword v64, v22, s[16:19], s22 offen offset:0
    buffer_load_dword v65, v22, s[16:19], s22 offen offset:1024
    s_add_u32 s22, s22, 196608
    buffer_load_dword v66, v2, s[16:19], s22 offen offset:0
    buffer_load_dword v67, v2, s[16:19], s22 offen offset:1024
    buffer_load_dword v68, v2, s[16:19], s22 offen offset:2048
    buffer_load_dword v69, v2, s[16:19], s22 offen offset:3072
    buffer_load_dword v70, v22, s[16:19], s22 offen offset:0
    buffer_load_dword v71, v22, s[16:19], s22 offen offset:1024
    s_add_u32 s22, s22, 196608
    buffer_load_dword v72, v2, s[16:19], s22 offen offset:0
    buffer_load_dword v73, v2, s[16:19], s22 offen offset:1024
    buffer_load_dword v74, v2, s[16:19], s22 offen offset:2048
    buffer_load_dword v75, v2, s[16:19], s22 offen offset:3072
    buffer_load_dword v76, v22, s[16:19], s22 offen offset:0
    buffer_load_dword v77, v22, s[16:19], s22 offen offset:1024
    s_add_u32 s22, s22, 196608
    s_waitcnt vmcnt(48)
    v_mov_b32 v120, v24
    v_mov_b32 v121, v25
    v_mov_b32 v122, v26
    v_mov_b32 v123, v27
    v_mov_b32 v124, v28
    v_mov_b32 v125, v29
    buffer_load_dword v78, v2, s[16:19], s22 offen offset:0
    buffer_load_dword v79, v2, s[16:19], s22 offen offset:1024
    buffer_load_dword v80, v2, s[16:19], s22 offen offset:2048
    buffer_load_dword v81, v2, s[16:19], s22 offen offset:3072
    buffer_load_dword v82, v22, s[16:19], s22 offen offset:0
    buffer_load_dword v83, v22, s[16:19], s22 offen offset:1024
    s_add_u32 s22, s22, 196608
    s_waitcnt vmcnt(48)
    v_add_f32 v120, v120, v30
    v_add_f32 v121, v121, v31
    v_add_f32 v122, v122, v32
    v_add_f32 v123, v123, v33
    v_add_f32 v124, v124, v34
    v_add_f32 v125, v125, v35
    buffer_load_dword v84, v2, s[16:19], s22 offen offset:0
    buffer_load_dword v85, v2, s[16:19], s22 offen offset:1024
    buffer_load_dword v86, v2, s[16:19], s22 offen offset:2048
    buffer_load_dword v87, v2, s[16:19], s22 offen offset:3072
    buffer_load_dword v88, v22, s[16:19], s22 offen offset:0
    buffer_load_dword v89, v22, s[16:19], s22 offen offset:1024
    s_add_u32 s22, s22, 196608
    s_waitcnt vmcnt(48)
    v_add_f32 v120, v120, v36
    v_add_f32 v121, v121, v37
    v_add_f32 v122, v122, v38
    v_add_f32 v123, v123, v39
    v_add_f32 v124, v124, v40
    v_add_f32 v125, v125, v41
    buffer_load_dword v90, v2, s[16:19], s22 offen offset:0
    buffer_load_dword v91, v2, s[16:19], s22 offen offset:1024
    buffer_load_dword v92, v2, s[16:19], s22 offen offset:2048
    buffer_load_dword v93, v2, s[16:19], s22 offen offset:3072
    buffer_load_dword v94, v22, s[16:19], s22 offen offset:0
    buffer_load_dword v95, v22, s[16:19], s22 offen offset:1024
    s_add_u32 s22, s22, 196608
    s_waitcnt vmcnt(48)
    v_add_f32 v120, v120, v42
    v_add_f32 v121, v121, v43
    v_add_f32 v122, v122, v44
    v_add_f32 v123, v123, v45
    v_add_f32 v124, v124, v46
    v_add_f32 v125, v125, v47
    buffer_load_dword v96, v2, s[16:19], s22 offen offset:0
    buffer_load_dword v97, v2, s[16:19], s22 offen offset:1024
    buffer_load_dword v98, v2, s[16:19], s22 offen offset:2048
    buffer_load_dword v99, v2, s[16:19], s22 offen offset:3072
    buffer_load_dword v100, v22, s[16:19], s22 offen offset:0
    buffer_load_dword v101, v22, s[16:19], s22 offen offset:1024
    s_add_u32 s22, s22, 196608
    s_waitcnt vmcnt(48)
    v_add_f32 v120, v120, v48
    v_add_f32 v121, v121, v49
    v_add_f32 v122, v122, v50
    v_add_f32 v123, v123, v51
    v_add_f32 v124, v124, v52
    v_add_f32 v125, v125, v53
    buffer_load_dword v102, v2, s[16:19], s22 offen offset:0
    buffer_load_dword v103, v2, s[16:19], s22 offen offset:1024
    buffer_load_dword v104, v2, s[16:19], s22 offen offset:2048
    buffer_load_dword v105, v2, s[16:19], s22 offen offset:3072
    buffer_load_dword v106, v22, s[16:19], s22 offen offset:0
    buffer_load_dword v107, v22, s[16:19], s22 offen offset:1024
    s_add_u32 s22, s22, 196608
    s_waitcnt vmcnt(48)
    v_add_f32 v120, v120, v54
    v_add_f32 v121, v121, v55
    v_add_f32 v122, v122, v56
    v_add_f32 v123, v123, v57
    v_add_f32 v124, v124, v58
    v_add_f32 v125, v125, v59
    buffer_load_dword v108, v2, s[16:19], s22 offen offset:0
    buffer_load_dword v109, v2, s[16:19], s22 offen offset:1024
    buffer_load_dword v110, v2, s[16:19], s22 offen offset:2048
    buffer_load_dword v111, v2, s[16:19], s22 offen offset:3072
    buffer_load_dword v112, v22, s[16:19], s22 offen offset:0
    buffer_load_dword v113, v22, s[16:19], s22 offen offset:1024
    s_add_u32 s22, s22, 196608
    s_waitcnt vmcnt(48)
    v_add_f32 v120, v120, v60
    v_add_f32 v121, v121, v61
    v_add_f32 v122, v122, v62
    v_add_f32 v123, v123, v63
    v_add_f32 v124, v124, v64
    v_add_f32 v125, v125, v65
    buffer_load_dword v114, v2, s[16:19], s22 offen offset:0
    buffer_load_dword v115, v2, s[16:19], s22 offen offset:1024
    buffer_load_dword v116, v2, s[16:19], s22 offen offset:2048
    buffer_load_dword v117, v2, s[16:19], s22 offen offset:3072
    buffer_load_dword v118, v22, s[16:19], s22 offen offset:0
    buffer_load_dword v119, v22, s[16:19], s22 offen offset:1024
    s_add_u32 s22, s22, 196608
    s_waitcnt vmcnt(48)
    v_add_f32 v120, v120, v66
    v_add_f32 v121, v121, v67
    v_add_f32 v122, v122, v68
    v_add_f32 v123, v123, v69
    v_add_f32 v124, v124, v70
    v_add_f32 v125, v125, v71
    s_waitcnt vmcnt(42)
    v_add_f32 v120, v120, v72
    v_add_f32 v121, v121, v73
    v_add_f32 v122, v122, v74
    v_add_f32 v123, v123, v75
    v_add_f32 v124, v124, v76
    v_add_f32 v125, v125, v77
    s_waitcnt vmcnt(36)
    v_add_f32 v120, v120, v78
    v_add_f32 v121, v121, v79
    v_add_f32 v122, v122, v80
    v_add_f32 v123, v123, v81
    v_add_f32 v124, v124, v82
    v_add_f32 v125, v125, v83
    s_waitcnt vmcnt(30)
    v_add_f32 v120, v120, v84
    v_add_f32 v121, v121, v85
    v_add_f32 v122, v122, v86
    v_add_f32 v123, v123, v87
    v_add_f32 v124, v124, v88
    v_add_f32 v125, v125, v89
    s_waitcnt vmcnt(24)
    v_add_f32 v120, v120, v90
    v_add_f32 v121, v121, v91
    v_add_f32 v122, v122, v92
    v_add_f32 v123, v123, v93
    v_add_f32 v124, v124, v94
    v_add_f32 v125, v125, v95
    s_waitcnt vmcnt(18)
    v_add_f32 v120, v120, v96
    v_add_f32 v121, v121, v97
    v_add_f32 v122, v122, v98
    v_add_f32 v123, v123, v99
    v_add_f32 v124, v124, v100
    v_add_f32 v125, v125, v101
    s_waitcnt vmcnt(12)
    v_add_f32 v120, v120, v102
    v_add_f32 v121, v121, v103
    v_add_f32 v122, v122, v104
    v_add_f32 v123, v123, v105
    v_add_f32 v124, v124, v106
    v_add_f32 v125, v125, v107
    s_waitcnt vmcnt(6)
    v_add_f32 v120, v120, v108
    v_add_f32 v121, v121, v109
    v_add_f32 v122, v122, v110
    v_add_f32 v123, v123, v111
    v_add_f32 v124, v124, v112
    v_add_f32 v125, v125, v113
    s_waitcnt vmcnt(0)
    v_add_f32 v120, v120, v114
    v_add_f32 v121, v121, v115
    v_add_f32 v122, v122, v116
    v_add_f32 v123, v123, v117
    v_add_f32 v124, v124, v118
    v_add_f32 v125, v125, v119
    ds_write_b32 v2, v120 offset:0
    ds_write_b32 v2, v121 offset:1024
    ds_write_b32 v2, v122 offset:2048
    ds_write_b32 v2, v123 offset:3072
    ds_write_b32 v2, v124 offset:4096
    ds_write_b32 v2, v125 offset:5120
    v_lshlrev_b32 v24, 16, v4
    v_and_b32 v25, 0xffff0000, v4
    v_lshlrev_b32 v26, 16, v5
    v_and_b32 v27, 0xffff0000, v5
    v_lshlrev_b32 v28, 16, v6
    v_and_b32 v29, 0xffff0000, v6
    v_lshlrev_b32 v30, 16, v7
    v_and_b32 v31, 0xffff0000, v7
    v_lshlrev_b32 v32, 16, v8
    v_and_b32 v33, 0xffff0000, v8
    v_lshlrev_b32 v34, 16, v9
    v_and_b32 v35, 0xffff0000, v9
    v_lshlrev_b32 v36, 16, v10
    v_and_b32 v37, 0xffff0000, v10
    v_lshlrev_b32 v38, 16, v11
    v_and_b32 v39, 0xffff0000, v11
    v_lshlrev_b32 v40, 16, v12
    v_and_b32 v41, 0xffff0000, v12
    v_lshlrev_b32 v42, 16, v13
    v_and_b32 v43, 0xffff0000, v13
    v_lshlrev_b32 v44, 16, v14
    v_and_b32 v45, 0xffff0000, v14
    v_lshlrev_b32 v46, 16, v15
    v_and_b32 v47, 0xffff0000, v15
    v_lshlrev_b32 v48, 16, v16
    v_and_b32 v49, 0xffff0000, v16
    v_lshlrev_b32 v50, 16, v17
    v_and_b32 v51, 0xffff0000, v17
    v_lshlrev_b32 v52, 16, v18
    v_and_b32 v53, 0xffff0000, v18
    v_lshlrev_b32 v54, 16, v19
    v_and_b32 v55, 0xffff0000, v19
    v_lshlrev_b32 v56, 16, v20
    v_and_b32 v57, 0xffff0000, v20
    v_lshlrev_b32 v58, 16, v21
    v_and_b32 v59, 0xffff0000, v21
    v_mov_b32 v64, 0
    v_mov_b32 v65, 0
    v_mov_b32 v66, 0
    v_mov_b32 v67, 0
    v_mov_b32 v68, 0
    v_mov_b32 v69, 0
    v_mov_b32 v70, 0
    v_mov_b32 v71, 0
    v_mov_b32 v72, 0
    v_mov_b32 v73, 0
    v_mov_b32 v74, 0
    v_mov_b32 v75, 0
    v_mov_b32 v76, 0
    v_mov_b32 v77, 0
    v_mov_b32 v78, 0
    v_mov_b32 v79, 0
    v_mov_b32 v80, 0
    v_mov_b32 v81, 0
    v_mov_b32 v82, 0
    v_mov_b32 v3, 0
    s_waitcnt lgkmcnt(0)
    s_barrier
    ds_read_b128 v[88:91], v3 offset:0
    ds_read_b128 v[92:95], v3 offset:16
    ds_read_b128 v[96:99], v3 offset:32
    ds_read_b128 v[100:103], v3 offset:48
    ds_read_b128 v[104:107], v3 offset:64
    ds_read_b128 v[108:111], v3 offset:128
    ds_read_b128 v[112:115], v3 offset:144
    ds_read_b128 v[116:119], v3 offset:160
    ds_read_b128 v[120:123], v3 offset:176
    ds_read_b128 v[124:127], v3 offset:192
    s_waitcnt lgkmcnt(5)
    v_fmac_f32 v64, v24, v88
    v_fmac_f32 v65, v24, v89
    v_fmac_f32 v66, v24, v90
    v_fmac_f32 v67, v24, v91
    v_fmac_f32 v68, v24, v92
    v_fmac_f32 v69, v24, v93
    v_fmac_f32 v70, v24, v94
    v_fmac_f32 v71, v24, v95
    v_fmac_f32 v72, v24, v96
    v_fmac_f32 v73, v24, v97
    v_fmac_f32 v74, v24, v98
    v_fmac_f32 v75, v24, v99
    v_fmac_f32 v76, v24, v100
    v_fmac_f32 v77, v24, v101
    v_fmac_f32 v78, v24, v102
    v_fmac_f32 v79, v24, v103
    v_fmac_f32 v80, v24, v104
    v_fmac_f32 v81, v24, v105
    v_fmac_f32 v82, v24, v106
    ds_read_b128 v[88:91], v3 offset:256
    ds_read_b128 v[92:95], v3 offset:272
    ds_read_b128 v[96:99], v3 offset:288
    ds_read_b128 v[100:103], v3 offset:304
    ds_read_b128 v[104:107], v3 offset:320
    s_waitcnt lgkmcnt(5)
    v_fmac_f32 v64, v25, v108
    v_fmac_f32 v65, v25, v109
    v_fmac_f32 v66, v25, v110
    v_fmac_f32 v67, v25, v111
    v_fmac_f32 v68, v25, v112
    v_fmac_f32 v69, v25, v113
    v_fmac_f32 v70, v25, v114
    v_fmac_f32 v71, v25, v115
    v_fmac_f32 v72, v25, v116
    v_fmac_f32 v73, v25, v117
    v_fmac_f32 v74, v25, v118
    v_fmac_f32 v75, v25, v119
    v_fmac_f32 v76, v25, v120
    v_fmac_f32 v77, v25, v121
    v_fmac_f32 v78, v25, v122
    v_fmac_f32 v79, v25, v123
    v_fmac_f32 v80, v25, v124
    v_fmac_f32 v81, v25, v125
    v_fmac_f32 v82, v25, v126
    ds_read_b128 v[108:111], v3 offset:384
    ds_read_b128 v[112:115], v3 offset:400
    ds_read_b128 v[116:119], v3 offset:416
    ds_read_b128 v[120:123], v3 offset:432
    ds_read_b128 v[124:127], v3 offset:448
    s_waitcnt lgkmcnt(5)
    v_fmac_f32 v64, v26, v88
    v_fmac_f32 v65, v26, v89
    v_fmac_f32 v66, v26, v90
    v_fmac_f32 v67, v26, v91
    v_fmac_f32 v68, v26, v92
    v_fmac_f32 v69, v26, v93
    v_fmac_f32 v70, v26, v94
    v_fmac_f32 v71, v26, v95
    v_fmac_f32 v72, v26, v96
    v_fmac_f32 v73, v26, v97
    v_fmac_f32 v74, v26, v98
    v_fmac_f32 v75, v26, v99
    v_fmac_f32 v76, v26, v100
    v_fmac_f32 v77, v26, v101
    v_fmac_f32 v78, v26, v102
    v_fmac_f32 v79, v26, v103
    v_fmac_f32 v80, v26, v104
    v_fmac_f32 v81, v26, v105
    v_fmac_f32 v82, v26, v106
    ds_read_b128 v[88:91], v3 offset:512
    ds_read_b128 v[92:95], v3 offset:528
    ds_read_b128 v[96:99], v3 offset:544
    ds_read_b128 v[100:103], v3 offset:560
    ds_read_b128 v[104:107], v3 offset:576
    s_waitcnt lgkmcnt(5)
    v_fmac_f32 v64, v27, v108
    v_fmac_f32 v65, v27, v109
    v_fmac_f32 v66, v27, v110
    v_fmac_f32 v67, v27, v111
    v_fmac_f32 v68, v27, v112
    v_fmac_f32 v69, v27, v113
    v_fmac_f32 v70, v27, v114
    v_fmac_f32 v71, v27, v115
    v_fmac_f32 v72, v27, v116
    v_fmac_f32 v73, v27, v117
    v_fmac_f32 v74, v27, v118
    v_fmac_f32 v75, v27, v119
    v_fmac_f32 v76, v27, v120
    v_fmac_f32 v77, v27, v121
    v_fmac_f32 v78, v27, v122
    v_fmac_f32 v79, v27, v123
    v_fmac_f32 v80, v27, v124
    v_fmac_f32 v81, v27, v125
    v_fmac_f32 v82, v27, v126
    ds_read_b128 v[108:111], v3 offset:640
    ds_read_b128 v[112:115], v3 offset:656
    ds_read_b128 v[116:119], v3 offset:672
    ds_read_b128 v[120:123], v3 offset:688
    ds_read_b128 v[124:127], v3 offset:704
    s_waitcnt lgkmcnt(5)
    v_fmac_f32 v64, v28, v88
    v_fmac_f32 v65, v28, v89
    v_fmac_f32 v66, v28, v90
    v_fmac_f32 v67, v28, v91
    v_fmac_f32 v68, v28, v92
    v_fmac_f32 v69, v28, v93
    v_fmac_f32 v70, v28, v94
    v_fmac_f32 v71, v28, v95
    v_fmac_f32 v72, v28, v96
    v_fmac_f32 v73, v28, v97
    v_fmac_f32 v74, v28, v98
    v_fmac_f32 v75, v28, v99
    v_fmac_f32 v76, v28, v100
    v_fmac_f32 v77, v28, v101
    v_fmac_f32 v78, v28, v102
    v_fmac_f32 v79, v28, v103
    v_fmac_f32 v80, v28, v104
    v_fmac_f32 v81, v28, v105
    v_fmac_f32 v82, v28, v106
    ds_read_b128 v[88:91], v3 offset:768
    ds_read_b128 v[92:95], v3 offset:784
    ds_read_b128 v[96:99], v3 offset:800
    ds_read_b128 v[100:103], v3 offset:816
    ds_read_b128 v[104:107], v3 offset:832
    s_waitcnt lgkmcnt(5)
    v_fmac_f32 v64, v29, v108
    v_fmac_f32 v65, v29, v109
    v_fmac_f32 v66, v29, v110
    v_fmac_f32 v67, v29, v111
    v_fmac_f32 v68, v29, v112
    v_fmac_f32 v69, v29, v113
    v_fmac_f32 v70, v29, v114
    v_fmac_f32 v71, v29, v115
    v_fmac_f32 v72, v29, v116
    v_fmac_f32 v73, v29, v117
    v_fmac_f32 v74, v29, v118
    v_fmac_f32 v75, v29, v119
    v_fmac_f32 v76, v29, v120
    v_fmac_f32 v77, v29, v121
    v_fmac_f32 v78, v29, v122
    v_fmac_f32 v79, v29, v123
    v_fmac_f32 v80, v29, v124
    v_fmac_f32 v81, v29, v125
    v_fmac_f32 v82, v29, v126
    ds_read_b128 v[108:111], v3 offset:896
    ds_read_b128 v[112:115], v3 offset:912
    ds_read_b128 v[116:119], v3 offset:928
    ds_read_b128 v[120:123], v3 offset:944
    ds_read_b128 v[124:127], v3 offset:960
    s_waitcnt lgkmcnt(5)
    v_fmac_f32 v64, v30, v88
    v_fmac_f32 v65, v30, v89
    v_fmac_f32 v66, v30, v90
    v_fmac_f32 v67, v30, v91
    v_fmac_f32 v68, v30, v92
    v_fmac_f32 v69, v30, v93
    v_fmac_f32 v70, v30, v94
    v_fmac_f32 v71, v30, v95
    v_fmac_f32 v72, v30, v96
    v_fmac_f32 v73, v30, v97
    v_fmac_f32 v74, v30, v98
    v_fmac_f32 v75, v30, v99
    v_fmac_f32 v76, v30, v100
    v_fmac_f32 v77, v30, v101
    v_fmac_f32 v78, v30, v102
    v_fmac_f32 v79, v30, v103
    v_fmac_f32 v80, v30, v104
    v_fmac_f32 v81, v30, v105
    v_fmac_f32 v82, v30, v106
    ds_read_b128 v[88:91], v3 offset:1024
    ds_read_b128 v[92:95], v3 offset:1040
    ds_read_b128 v[96:99], v3 offset:1056
    ds_read_b128 v[100:103], v3 offset:1072
    ds_read_b128 v[104:107], v3 offset:1088
    s_waitcnt lgkmcnt(5)
    v_fmac_f32 v64, v31, v108
    v_fmac_f32 v65, v31, v109
    v_fmac_f32 v66, v31, v110
    v_fmac_f32 v67, v31, v111
    v_fmac_f32 v68, v31, v112
    v_fmac_f32 v69, v31, v113
    v_fmac_f32 v70, v31, v114
    v_fmac_f32 v71, v31, v115
    v_fmac_f32 v72, v31, v116
    v_fmac_f32 v73, v31, v117
    v_fmac_f32 v74, v31, v118
    v_fmac_f32 v75, v31, v119
    v_fmac_f32 v76, v31, v120
    v_fmac_f32 v77, v31, v121
    v_fmac_f32 v78, v31, v122
    v_fmac_f32 v79, v31, v123
    v_fmac_f32 v80, v31, v124
    v_fmac_f32 v81, v31, v125
    v_fmac_f32 v82, v31, v126
    ds_read_b128 v[108:111], v3 offset:1152
    ds_read_b128 v[112:115], v3 offset:1168
    ds_read_b128 v[116:119], v3 offset:1184
    ds_read_b128 v[120:123], v3 offset:1200
    ds_read_b128 v[124:127], v3 offset:1216
    s_waitcnt lgkmcnt(5)
    v_fmac_f32 v64, v32, v88
    v_fmac_f32 v65, v32, v89
    v_fmac_f32 v66, v32, v90
    v_fmac_f32 v67, v32, v91
    v_fmac_f32 v68, v32, v92
    v_fmac_f32 v69, v32, v93
    v_fmac_f32 v70, v32, v94
    v_fmac_f32 v71, v32, v95
    v_fmac_f32 v72, v32, v96
    v_fmac_f32 v73, v32, v97
    v_fmac_f32 v74, v32, v98
    v_fmac_f32 v75, v32, v99
    v_fmac_f32 v76, v32, v100
    v_fmac_f32 v77, v32, v101
    v_fmac_f32 v78, v32, v102
    v_fmac_f32 v79, v32, v103
    v_fmac_f32 v80, v32, v104
    v_fmac_f32 v81, v32, v105
    v_fmac_f32 v82, v32, v106
    ds_read_b128 v[88:91], v3 offset:1280
    ds_read_b128 v[92:95], v3 offset:1296
    ds_read_b128 v[96:99], v3 offset:1312
    ds_read_b128 v[100:103], v3 offset:1328
    ds_read_b128 v[104:107], v3 offset:1344
    s_waitcnt lgkmcnt(5)
    v_fmac_f32 v64, v33, v108
    v_fmac_f32 v65, v33, v109
    v_fmac_f32 v66, v33, v110
    v_fmac_f32 v67, v33, v111
    v_fmac_f32 v68, v33, v112
    v_fmac_f32 v69, v33, v113
    v_fmac_f32 v70, v33, v114
    v_fmac_f32 v71, v33, v115
    v_fmac_f32 v72, v33, v116
    v_fmac_f32 v73, v33, v117
    v_fmac_f32 v74, v33, v118
    v_fmac_f32 v75, v33, v119
    v_fmac_f32 v76, v33, v120
    v_fmac_f32 v77, v33, v121
    v_fmac_f32 v78, v33, v122
    v_fmac_f32 v79, v33, v123
    v_fmac_f32 v80, v33, v124
    v_fmac_f32 v81, v33, v125
    v_fmac_f32 v82, v33, v126
    ds_read_b128 v[108:111], v3 offset:1408
    ds_read_b128 v[112:115], v3 offset:1424
    ds_read_b128 v[116:119], v3 offset:1440
    ds_read_b128 v[120:123], v3 offset:1456
    ds_read_b128 v[124:127], v3 offset:1472
    s_waitcnt lgkmcnt(5)
    v_fmac_f32 v64, v34, v88
    v_fmac_f32 v65, v34, v89
    v_fmac_f32 v66, v34, v90
    v_fmac_f32 v67, v34, v91
    v_fmac_f32 v68, v34, v92
    v_fmac_f32 v69, v34, v93
    v_fmac_f32 v70, v34, v94
    v_fmac_f32 v71, v34, v95
    v_fmac_f32 v72, v34, v96
    v_fmac_f32 v73, v34, v97
    v_fmac_f32 v74, v34, v98
    v_fmac_f32 v75, v34, v99
    v_fmac_f32 v76, v34, v100
    v_fmac_f32 v77, v34, v101
    v_fmac_f32 v78, v34, v102
    v_fmac_f32 v79, v34, v103
    v_fmac_f32 v80, v34, v104
    v_fmac_f32 v81, v34, v105
    v_fmac_f32 v82, v34, v106
    ds_read_b128 v[88:91], v3 offset:1536
    ds_read_b128 v[92:95], v3 offset:1552
    ds_read_b128 v[96:99], v3 offset:1568
    ds_read_b128 v[100:103], v3 offset:1584
    ds_read_b128 v[104:107], v3 offset:1600
    s_waitcnt lgkmcnt(5)
    v_fmac_f32 v64, v35, v108
    v_fmac_f32 v65, v35, v109
    v_fmac_f32 v66, v35, v110
    v_fmac_f32 v67, v35, v111
    v_fmac_f32 v68, v35, v112
    v_fmac_f32 v69, v35, v113
    v_fmac_f32 v70, v35, v114
    v_fmac_f32 v71, v35, v115
    v_fmac_f32 v72, v35, v116
    v_fmac_f32 v73, v35, v117
    v_fmac_f32 v74, v35, v118
    v_fmac_f32 v75, v35, v119
    v_fmac_f32 v76, v35, v120
    v_fmac_f32 v77, v35, v121
    v_fmac_f32 v78, v35, v122
    v_fmac_f32 v79, v35, v123
    v_fmac_f32 v80, v35, v124
    v_fmac_f32 v81, v35, v125
    v_fmac_f32 v82, v35, v126
    ds_read_b128 v[108:111], v3 offset:1664
    ds_read_b128 v[112:115], v3 offset:1680
    ds_read_b128 v[116:119], v3 offset:1696
    ds_read_b128 v[120:123], v3 offset:1712
    ds_read_b128 v[124:127], v3 offset:1728
    s_waitcnt lgkmcnt(5)
    v_fmac_f32 v64, v36, v88
    v_fmac_f32 v65, v36, v89
    v_fmac_f32 v66, v36, v90
    v_fmac_f32 v67, v36, v91
    v_fmac_f32 v68, v36, v92
    v_fmac_f32 v69, v36, v93
    v_fmac_f32 v70, v36, v94
    v_fmac_f32 v71, v36, v95
    v_fmac_f32 v72, v36, v96
    v_fmac_f32 v73, v36, v97
    v_fmac_f32 v74, v36, v98
    v_fmac_f32 v75, v36, v99
    v_fmac_f32 v76, v36, v100
    v_fmac_f32 v77, v36, v101
    v_fmac_f32 v78, v36, v102
    v_fmac_f32 v79, v36, v103
    v_fmac_f32 v80, v36, v104
    v_fmac_f32 v81, v36, v105
    v_fmac_f32 v82, v36, v106
    ds_read_b128 v[88:91], v3 offset:1792
    ds_read_b128 v[92:95], v3 offset:1808
    ds_read_b128 v[96:99], v3 offset:1824
    ds_read_b128 v[100:103], v3 offset:1840
    ds_read_b128 v[104:107], v3 offset:1856
    s_waitcnt lgkmcnt(5)
    v_fmac_f32 v64, v37, v108
    v_fmac_f32 v65, v37, v109
    v_fmac_f32 v66, v37, v110
    v_fmac_f32 v67, v37, v111
    v_fmac_f32 v68, v37, v112
    v_fmac_f32 v69, v37, v113
    v_fmac_f32 v70, v37, v114
    v_fmac_f32 v71, v37, v115
    v_fmac_f32 v72, v37, v116
    v_fmac_f32 v73, v37, v117
    v_fmac_f32 v74, v37, v118
    v_fmac_f32 v75, v37, v119
    v_fmac_f32 v76, v37, v120
    v_fmac_f32 v77, v37, v121
    v_fmac_f32 v78, v37, v122
    v_fmac_f32 v79, v37, v123
    v_fmac_f32 v80, v37, v124
    v_fmac_f32 v81, v37, v125
    v_fmac_f32 v82, v37, v126
    ds_read_b128 v[108:111], v3 offset:1920
    ds_read_b128 v[112:115], v3 offset:1936
    ds_read_b128 v[116:119], v3 offset:1952
    ds_read_b128 v[120:123], v3 offset:1968
    ds_read_b128 v[124:127], v3 offset:1984
    s_waitcnt lgkmcnt(5)
    v_fmac_f32 v64, v38, v88
    v_fmac_f32 v65, v38, v89
    v_fmac_f32 v66, v38, v90
    v_fmac_f32 v67, v38, v91
    v_fmac_f32 v68, v38, v92
    v_fmac_f32 v69, v38, v93
    v_fmac_f32 v70, v38, v94
    v_fmac_f32 v71, v38, v95
    v_fmac_f32 v72, v38, v96
    v_fmac_f32 v73, v38, v97
    v_fmac_f32 v74, v38, v98
    v_fmac_f32 v75, v38, v99
    v_fmac_f32 v76, v38, v100
    v_fmac_f32 v77, v38, v101
    v_fmac_f32 v78, v38, v102
    v_fmac_f32 v79, v38, v103
    v_fmac_f32 v80, v38, v104
    v_fmac_f32 v81, v38, v105
    v_fmac_f32 v82, v38, v106
    ds_read_b128 v[88:91], v3 offset:2048
    ds_read_b128 v[92:95], v3 offset:2064
    ds_read_b128 v[96:99], v3 offset:2080
    ds_read_b128 v[100:103], v3 offset:2096
    ds_read_b128 v[104:107], v3 offset:2112
    s_waitcnt lgkmcnt(5)
    v_fmac_f32 v64, v39, v108
    v_fmac_f32 v65, v39, v109
    v_fmac_f32 v66, v39, v110
    v_fmac_f32 v67, v39, v111
    v_fmac_f32 v68, v39, v112
    v_fmac_f32 v69, v39, v113
    v_fmac_f32 v70, v39, v114
    v_fmac_f32 v71, v39, v115
    v_fmac_f32 v72, v39, v116
    v_fmac_f32 v73, v39, v117
    v_fmac_f32 v74, v39, v118
    v_fmac_f32 v75, v39, v119
    v_fmac_f32 v76, v39, v120
    v_fmac_f32 v77, v39, v121
    v_fmac_f32 v78, v39, v122
    v_fmac_f32 v79, v39, v123
    v_fmac_f32 v80, v39, v124
    v_fmac_f32 v81, v39, v125
    v_fmac_f32 v82, v39, v126
    ds_read_b128 v[108:111], v3 offset:2176
    ds_read_b128 v[112:115], v3 offset:2192
    ds_read_b128 v[116:119], v3 offset:2208
    ds_read_b128 v[120:123], v3 offset:2224
    ds_read_b128 v[124:127], v3 offset:2240
    s_waitcnt lgkmcnt(5)
    v_fmac_f32 v64, v40, v88
    v_fmac_f32 v65, v40, v89
    v_fmac_f32 v66, v40, v90
    v_fmac_f32 v67, v40, v91
    v_fmac_f32 v68, v40, v92
    v_fmac_f32 v69, v40, v93
    v_fmac_f32 v70, v40, v94
    v_fmac_f32 v71, v40, v95
    v_fmac_f32 v72, v40, v96
    v_fmac_f32 v73, v40, v97
    v_fmac_f32 v74, v40, v98
    v_fmac_f32 v75, v40, v99
    v_fmac_f32 v76, v40, v100
    v_fmac_f32 v77, v40, v101
    v_fmac_f32 v78, v40, v102
    v_fmac_f32 v79, v40, v103
    v_fmac_f32 v80, v40, v104
    v_fmac_f32 v81, v40, v105
    v_fmac_f32 v82, v40, v106
    ds_read_b128 v[88:91], v3 offset:2304
    ds_read_b128 v[92:95], v3 offset:2320
    ds_read_b128 v[96:99], v3 offset:2336
    ds_read_b128 v[100:103], v3 offset:2352
    ds_read_b128 v[104:107], v3 offset:2368
    s_waitcnt lgkmcnt(5)
    v_fmac_f32 v64, v41, v108
    v_fmac_f32 v65, v41, v109
    v_fmac_f32 v66, v41, v110
    v_fmac_f32 v67, v41, v111
    v_fmac_f32 v68, v41, v112
    v_fmac_f32 v69, v41, v113
    v_fmac_f32 v70, v41, v114
    v_fmac_f32 v71, v41, v115
    v_fmac_f32 v72, v41, v116
    v_fmac_f32 v73, v41, v117
    v_fmac_f32 v74, v41, v118
    v_fmac_f32 v75, v41, v119
    v_fmac_f32 v76, v41, v120
    v_fmac_f32 v77, v41, v121
    v_fmac_f32 v78, v41, v122
    v_fmac_f32 v79, v41, v123
    v_fmac_f32 v80, v41, v124
    v_fmac_f32 v81, v41, v125
    v_fmac_f32 v82, v41, v126
    ds_read_b128 v[108:111], v3 offset:2432
    ds_read_b128 v[112:115], v3 offset:2448
    ds_read_b128 v[116:119], v3 offset:2464
    ds_read_b128 v[120:123], v3 offset:2480
    ds_read_b128 v[124:127], v3 offset:2496
    s_waitcnt lgkmcnt(5)
    v_fmac_f32 v64, v42, v88
    v_fmac_f32 v65, v42, v89
    v_fmac_f32 v66, v42, v90
    v_fmac_f32 v67, v42, v91
    v_fmac_f32 v68, v42, v92
    v_fmac_f32 v69, v42, v93
    v_fmac_f32 v70, v42, v94
    v_fmac_f32 v71, v42, v95
    v_fmac_f32 v72, v42, v96
    v_fmac_f32 v73, v42, v97
    v_fmac_f32 v74, v42, v98
    v_fmac_f32 v75, v42, v99
    v_fmac_f32 v76, v42, v100
    v_fmac_f32 v77, v42, v101
    v_fmac_f32 v78, v42, v102
    v_fmac_f32 v79, v42, v103
    v_fmac_f32 v80, v42, v104
    v_fmac_f32 v81, v42, v105
    v_fmac_f32 v82, v42, v106
    ds_read_b128 v[88:91], v3 offset:2560
    ds_read_b128 v[92:95], v3 offset:2576
    ds_read_b128 v[96:99], v3 offset:2592
    ds_read_b128 v[100:103], v3 offset:2608
    ds_read_b128 v[104:107], v3 offset:2624
    s_waitcnt lgkmcnt(5)
    v_fmac_f32 v64, v43, v108
    v_fmac_f32 v65, v43, v109
    v_fmac_f32 v66, v43, v110
    v_fmac_f32 v67, v43, v111
    v_fmac_f32 v68, v43, v112
    v_fmac_f32 v69, v43, v113
    v_fmac_f32 v70, v43, v114
    v_fmac_f32 v71, v43, v115
    v_fmac_f32 v72, v43, v116
    v_fmac_f32 v73, v43, v117
    v_fmac_f32 v74, v43, v118
    v_fmac_f32 v75, v43, v119
    v_fmac_f32 v76, v43, v120
    v_fmac_f32 v77, v43, v121
    v_fmac_f32 v78, v43, v122
    v_fmac_f32 v79, v43, v123
    v_fmac_f32 v80, v43, v124
    v_fmac_f32 v81, v43, v125
    v_fmac_f32 v82, v43, v126
    ds_read_b128 v[108:111], v3 offset:2688
    ds_read_b128 v[112:115], v3 offset:2704
    ds_read_b128 v[116:119], v3 offset:2720
    ds_read_b128 v[120:123], v3 offset:2736
    ds_read_b128 v[124:127], v3 offset:2752
    s_waitcnt lgkmcnt(5)
    v_fmac_f32 v64, v44, v88
    v_fmac_f32 v65, v44, v89
    v_fmac_f32 v66, v44, v90
    v_fmac_f32 v67, v44, v91
    v_fmac_f32 v68, v44, v92
    v_fmac_f32 v69, v44, v93
    v_fmac_f32 v70, v44, v94
    v_fmac_f32 v71, v44, v95
    v_fmac_f32 v72, v44, v96
    v_fmac_f32 v73, v44, v97
    v_fmac_f32 v74, v44, v98
    v_fmac_f32 v75, v44, v99
    v_fmac_f32 v76, v44, v100
    v_fmac_f32 v77, v44, v101
    v_fmac_f32 v78, v44, v102
    v_fmac_f32 v79, v44, v103
    v_fmac_f32 v80, v44, v104
    v_fmac_f32 v81, v44, v105
    v_fmac_f32 v82, v44, v106
    ds_read_b128 v[88:91], v3 offset:2816
    ds_read_b128 v[92:95], v3 offset:2832
    ds_read_b128 v[96:99], v3 offset:2848
    ds_read_b128 v[100:103], v3 offset:2864
    ds_read_b128 v[104:107], v3 offset:2880
    s_waitcnt lgkmcnt(5)
    v_fmac_f32 v64, v45, v108
    v_fmac_f32 v65, v45, v109
    v_fmac_f32 v66, v45, v110
    v_fmac_f32 v67, v45, v111
    v_fmac_f32 v68, v45, v112
    v_fmac_f32 v69, v45, v113
    v_fmac_f32 v70, v45, v114
    v_fmac_f32 v71, v45, v115
    v_fmac_f32 v72, v45, v116
    v_fmac_f32 v73, v45, v117
    v_fmac_f32 v74, v45, v118
    v_fmac_f32 v75, v45, v119
    v_fmac_f32 v76, v45, v120
    v_fmac_f32 v77, v45, v121
    v_fmac_f32 v78, v45, v122
    v_fmac_f32 v79, v45, v123
    v_fmac_f32 v80, v45, v124
    v_fmac_f32 v81, v45, v125
    v_fmac_f32 v82, v45, v126
    ds_read_b128 v[108:111], v3 offset:2944
    ds_read_b128 v[112:115], v3 offset:2960
    ds_read_b128 v[116:119], v3 offset:2976
    ds_read_b128 v[120:123], v3 offset:2992
    ds_read_b128 v[124:127], v3 offset:3008
    s_waitcnt lgkmcnt(5)
    v_fmac_f32 v64, v46, v88
    v_fmac_f32 v65, v46, v89
    v_fmac_f32 v66, v46, v90
    v_fmac_f32 v67, v46, v91
    v_fmac_f32 v68, v46, v92
    v_fmac_f32 v69, v46, v93
    v_fmac_f32 v70, v46, v94
    v_fmac_f32 v71, v46, v95
    v_fmac_f32 v72, v46, v96
    v_fmac_f32 v73, v46, v97
    v_fmac_f32 v74, v46, v98
    v_fmac_f32 v75, v46, v99
    v_fmac_f32 v76, v46, v100
    v_fmac_f32 v77, v46, v101
    v_fmac_f32 v78, v46, v102
    v_fmac_f32 v79, v46, v103
    v_fmac_f32 v80, v46, v104
    v_fmac_f32 v81, v46, v105
    v_fmac_f32 v82, v46, v106
    ds_read_b128 v[88:91], v3 offset:3072
    ds_read_b128 v[92:95], v3 offset:3088
    ds_read_b128 v[96:99], v3 offset:3104
    ds_read_b128 v[100:103], v3 offset:3120
    ds_read_b128 v[104:107], v3 offset:3136
    s_waitcnt lgkmcnt(5)
    v_fmac_f32 v64, v47, v108
    v_fmac_f32 v65, v47, v109
    v_fmac_f32 v66, v47, v110
    v_fmac_f32 v67, v47, v111
    v_fmac_f32 v68, v47, v112
    v_fmac_f32 v69, v47, v113
    v_fmac_f32 v70, v47, v114
    v_fmac_f32 v71, v47, v115
    v_fmac_f32 v72, v47, v116
    v_fmac_f32 v73, v47, v117
    v_fmac_f32 v74, v47, v118
    v_fmac_f32 v75, v47, v119
    v_fmac_f32 v76, v47, v120
    v_fmac_f32 v77, v47, v121
    v_fmac_f32 v78, v47, v122
    v_fmac_f32 v79, v47, v123
    v_fmac_f32 v80, v47, v124
    v_fmac_f32 v81, v47, v125
    v_fmac_f32 v82, v47, v126
    ds_read_b128 v[108:111], v3 offset:3200
    ds_read_b128 v[112:115], v3 offset:3216
    ds_read_b128 v[116:119], v3 offset:3232
    ds_read_b128 v[120:123], v3 offset:3248
    ds_read_b128 v[124:127], v3 offset:3264
    s_waitcnt lgkmcnt(5)
    v_fmac_f32 v64, v48, v88
    v_fmac_f32 v65, v48, v89
    v_fmac_f32 v66, v48, v90
    v_fmac_f32 v67, v48, v91
    v_fmac_f32 v68, v48, v92
    v_fmac_f32 v69, v48, v93
    v_fmac_f32 v70, v48, v94
    v_fmac_f32 v71, v48, v95
    v_fmac_f32 v72, v48, v96
    v_fmac_f32 v73, v48, v97
    v_fmac_f32 v74, v48, v98
    v_fmac_f32 v75, v48, v99
    v_fmac_f32 v76, v48, v100
    v_fmac_f32 v77, v48, v101
    v_fmac_f32 v78, v48, v102
    v_fmac_f32 v79, v48, v103
    v_fmac_f32 v80, v48, v104
    v_fmac_f32 v81, v48, v105
    v_fmac_f32 v82, v48, v106
    ds_read_b128 v[88:91], v3 offset:3328
    ds_read_b128 v[92:95], v3 offset:3344
    ds_read_b128 v[96:99], v3 offset:3360
    ds_read_b128 v[100:103], v3 offset:3376
    ds_read_b128 v[104:107], v3 offset:3392
    s_waitcnt lgkmcnt(5)
    v_fmac_f32 v64, v49, v108
    v_fmac_f32 v65, v49, v109
    v_fmac_f32 v66, v49, v110
    v_fmac_f32 v67, v49, v111
    v_fmac_f32 v68, v49, v112
    v_fmac_f32 v69, v49, v113
    v_fmac_f32 v70, v49, v114
    v_fmac_f32 v71, v49, v115
    v_fmac_f32 v72, v49, v116
    v_fmac_f32 v73, v49, v117
    v_fmac_f32 v74, v49, v118
    v_fmac_f32 v75, v49, v119
    v_fmac_f32 v76, v49, v120
    v_fmac_f32 v77, v49, v121
    v_fmac_f32 v78, v49, v122
    v_fmac_f32 v79, v49, v123
    v_fmac_f32 v80, v49, v124
    v_fmac_f32 v81, v49, v125
    v_fmac_f32 v82, v49, v126
    ds_read_b128 v[108:111], v3 offset:3456
    ds_read_b128 v[112:115], v3 offset:3472
    ds_read_b128 v[116:119], v3 offset:3488
    ds_read_b128 v[120:123], v3 offset:3504
    ds_read_b128 v[124:127], v3 offset:3520
    s_waitcnt lgkmcnt(5)
    v_fmac_f32 v64, v50, v88
    v_fmac_f32 v65, v50, v89
    v_fmac_f32 v66, v50, v90
    v_fmac_f32 v67, v50, v91
    v_fmac_f32 v68, v50, v92
    v_fmac_f32 v69, v50, v93
    v_fmac_f32 v70, v50, v94
    v_fmac_f32 v71, v50, v95
    v_fmac_f32 v72, v50, v96
    v_fmac_f32 v73, v50, v97
    v_fmac_f32 v74, v50, v98
    v_fmac_f32 v75, v50, v99
    v_fmac_f32 v76, v50, v100
    v_fmac_f32 v77, v50, v101
    v_fmac_f32 v78, v50, v102
    v_fmac_f32 v79, v50, v103
    v_fmac_f32 v80, v50, v104
    v_fmac_f32 v81, v50, v105
    v_fmac_f32 v82, v50, v106
    ds_read_b128 v[88:91], v3 offset:3584
    ds_read_b128 v[92:95], v3 offset:3600
    ds_read_b128 v[96:99], v3 offset:3616
    ds_read_b128 v[100:103], v3 offset:3632
    ds_read_b128 v[104:107], v3 offset:3648
    s_waitcnt lgkmcnt(5)
    v_fmac_f32 v64, v51, v108
    v_fmac_f32 v65, v51, v109
    v_fmac_f32 v66, v51, v110
    v_fmac_f32 v67, v51, v111
    v_fmac_f32 v68, v51, v112
    v_fmac_f32 v69, v51, v113
    v_fmac_f32 v70, v51, v114
    v_fmac_f32 v71, v51, v115
    v_fmac_f32 v72, v51, v116
    v_fmac_f32 v73, v51, v117
    v_fmac_f32 v74, v51, v118
    v_fmac_f32 v75, v51, v119
    v_fmac_f32 v76, v51, v120
    v_fmac_f32 v77, v51, v121
    v_fmac_f32 v78, v51, v122
    v_fmac_f32 v79, v51, v123
    v_fmac_f32 v80, v51, v124
    v_fmac_f32 v81, v51, v125
    v_fmac_f32 v82, v51, v126
    ds_read_b128 v[108:111], v3 offset:3712
    ds_read_b128 v[112:115], v3 offset:3728
    ds_read_b128 v[116:119], v3 offset:3744
    ds_read_b128 v[120:123], v3 offset:3760
    ds_read_b128 v[124:127], v3 offset:3776
    s_waitcnt lgkmcnt(5)
    v_fmac_f32 v64, v52, v88
    v_fmac_f32 v65, v52, v89
    v_fmac_f32 v66, v52, v90
    v_fmac_f32 v67, v52, v91
    v_fmac_f32 v68, v52, v92
    v_fmac_f32 v69, v52, v93
    v_fmac_f32 v70, v52, v94
    v_fmac_f32 v71, v52, v95
    v_fmac_f32 v72, v52, v96
    v_fmac_f32 v73, v52, v97
    v_fmac_f32 v74, v52, v98
    v_fmac_f32 v75, v52, v99
    v_fmac_f32 v76, v52, v100
    v_fmac_f32 v77, v52, v101
    v_fmac_f32 v78, v52, v102
    v_fmac_f32 v79, v52, v103
    v_fmac_f32 v80, v52, v104
    v_fmac_f32 v81, v52, v105
    v_fmac_f32 v82, v52, v106
    ds_read_b128 v[88:91], v3 offset:3840
    ds_read_b128 v[92:95], v3 offset:3856
    ds_read_b128 v[96:99], v3 offset:3872
    ds_read_b128 v[100:103], v3 offset:3888
    ds_read_b128 v[104:107], v3 offset:3904
    s_waitcnt lgkmcnt(5)
    v_fmac_f32 v64, v53, v108
    v_fmac_f32 v65, v53, v109
    v_fmac_f32 v66, v53, v110
    v_fmac_f32 v67, v53, v111
    v_fmac_f32 v68, v53, v112
    v_fmac_f32 v69, v53, v113
    v_fmac_f32 v70, v53, v114
    v_fmac_f32 v71, v53, v115
    v_fmac_f32 v72, v53, v116
    v_fmac_f32 v73, v53, v117
    v_fmac_f32 v74, v53, v118
    v_fmac_f32 v75, v53, v119
    v_fmac_f32 v76, v53, v120
    v_fmac_f32 v77, v53, v121
    v_fmac_f32 v78, v53, v122
    v_fmac_f32 v79, v53, v123
    v_fmac_f32 v80, v53, v124
    v_fmac_f32 v81, v53, v125
    v_fmac_f32 v82, v53, v126
    ds_read_b128 v[108:111], v3 offset:3968
    ds_read_b128 v[112:115], v3 offset:3984
    ds_read_b128 v[116:119], v3 offset:4000
    ds_read_b128 v[120:123], v3 offset:4016
    ds_read_b128 v[124:127], v3 offset:4032
    s_waitcnt lgkmcnt(5)
    v_fmac_f32 v64, v54, v88
    v_fmac_f32 v65, v54, v89
    v_fmac_f32 v66, v54, v90
    v_fmac_f32 v67, v54, v91
    v_fmac_f32 v68, v54, v92
    v_fmac_f32 v69, v54, v93
    v_fmac_f32 v70, v54, v94
    v_fmac_f32 v71, v54, v95
    v_fmac_f32 v72, v54, v96
    v_fmac_f32 v73, v54, v97
    v_fmac_f32 v74, v54, v98
    v_fmac_f32 v75, v54, v99
    v_fmac_f32 v76, v54, v100
    v_fmac_f32 v77, v54, v101
    v_fmac_f32 v78, v54, v102
    v_fmac_f32 v79, v54, v103
    v_fmac_f32 v80, v54, v104
    v_fmac_f32 v81, v54, v105
    v_fmac_f32 v82, v54, v106
    ds_read_b128 v[88:91], v3 offset:4096
    ds_read_b128 v[92:95], v3 offset:4112
    ds_read_b128 v[96:99], v3 offset:4128
    ds_read_b128 v[100:103], v3 offset:4144
    ds_read_b128 v[104:107], v3 offset:4160
    s_waitcnt lgkmcnt(5)
    v_fmac_f32 v64, v55, v108
    v_fmac_f32 v65, v55, v109
    v_fmac_f32 v66, v55, v110
    v_fmac_f32 v67, v55, v111
    v_fmac_f32 v68, v55, v112
    v_fmac_f32 v69, v55, v113
    v_fmac_f32 v70, v55, v114
    v_fmac_f32 v71, v55, v115
    v_fmac_f32 v72, v55, v116
    v_fmac_f32 v73, v55, v117
    v_fmac_f32 v74, v55, v118
    v_fmac_f32 v75, v55, v119
    v_fmac_f32 v76, v55, v120
    v_fmac_f32 v77, v55, v121
    v_fmac_f32 v78, v55, v122
    v_fmac_f32 v79, v55, v123
    v_fmac_f32 v80, v55, v124
    v_fmac_f32 v81, v55, v125
    v_fmac_f32 v82, v55, v126
    ds_read_b128 v[108:111], v3 offset:4224
    ds_read_b128 v[112:115], v3 offset:4240
    ds_read_b128 v[116:119], v3 offset:4256
    ds_read_b128 v[120:123], v3 offset:4272
    ds_read_b128 v[124:127], v3 offset:4288
    s_waitcnt lgkmcnt(5)
    v_fmac_f32 v64, v56, v88
    v_fmac_f32 v65, v56, v89
    v_fmac_f32 v66, v56, v90
    v_fmac_f32 v67, v56, v91
    v_fmac_f32 v68, v56, v92
    v_fmac_f32 v69, v56, v93
    v_fmac_f32 v70, v56, v94
    v_fmac_f32 v71, v56, v95
    v_fmac_f32 v72, v56, v96
    v_fmac_f32 v73, v56, v97
    v_fmac_f32 v74, v56, v98
    v_fmac_f32 v75, v56, v99
    v_fmac_f32 v76, v56, v100
    v_fmac_f32 v77, v56, v101
    v_fmac_f32 v78, v56, v102
    v_fmac_f32 v79, v56, v103
    v_fmac_f32 v80, v56, v104
    v_fmac_f32 v81, v56, v105
    v_fmac_f32 v82, v56, v106
    ds_read_b128 v[88:91], v3 offset:4352
    ds_read_b128 v[92:95], v3 offset:4368
    ds_read_b128 v[96:99], v3 offset:4384
    ds_read_b128 v[100:103], v3 offset:4400
    ds_read_b128 v[104:107], v3 offset:4416
    s_waitcnt lgkmcnt(5)
    v_fmac_f32 v64, v57, v108
    v_fmac_f32 v65, v57, v109
    v_fmac_f32 v66, v57, v110
    v_fmac_f32 v67, v57, v111
    v_fmac_f32 v68, v57, v112
    v_fmac_f32 v69, v57, v113
    v_fmac_f32 v70, v57, v114
    v_fmac_f32 v71, v57, v115
    v_fmac_f32 v72, v57, v116
    v_fmac_f32 v73, v57, v117
    v_fmac_f32 v74, v57, v118
    v_fmac_f32 v75, v57, v119
    v_fmac_f32 v76, v57, v120
    v_fmac_f32 v77, v57, v121
    v_fmac_f32 v78, v57, v122
    v_fmac_f32 v79, v57, v123
    v_fmac_f32 v80, v57, v124
    v_fmac_f32 v81, v57, v125
    v_fmac_f32 v82, v57, v126
    ds_read_b128 v[108:111], v3 offset:4480
    ds_read_b128 v[112:115], v3 offset:4496
    ds_read_b128 v[116:119], v3 offset:4512
    ds_read_b128 v[120:123], v3 offset:4528
    ds_read_b128 v[124:127], v3 offset:4544
    s_waitcnt lgkmcnt(5)
    v_fmac_f32 v64, v58, v88
    v_fmac_f32 v65, v58, v89
    v_fmac_f32 v66, v58, v90
    v_fmac_f32 v67, v58, v91
    v_fmac_f32 v68, v58, v92
    v_fmac_f32 v69, v58, v93
    v_fmac_f32 v70, v58, v94
    v_fmac_f32 v71, v58, v95
    v_fmac_f32 v72, v58, v96
    v_fmac_f32 v73, v58, v97
    v_fmac_f32 v74, v58, v98
    v_fmac_f32 v75, v58, v99
    v_fmac_f32 v76, v58, v100
    v_fmac_f32 v77, v58, v101
    v_fmac_f32 v78, v58, v102
    v_fmac_f32 v79, v58, v103
    v_fmac_f32 v80, v58, v104
    v_fmac_f32 v81, v58, v105
    v_fmac_f32 v82, v58, v106
    s_waitcnt lgkmcnt(0)
    v_fmac_f32 v64, v59, v108
    v_fmac_f32 v65, v59, v109
    v_fmac_f32 v66, v59, v110
    v_fmac_f32 v67, v59, v111
    v_fmac_f32 v68, v59, v112
    v_fmac_f32 v69, v59, v113
    v_fmac_f32 v70, v59, v114
    v_fmac_f32 v71, v59, v115
    v_fmac_f32 v72, v59, v116
    v_fmac_f32 v73, v59, v117
    v_fmac_f32 v74, v59, v118
    v_fmac_f32 v75, v59, v119
    v_fmac_f32 v76, v59, v120
    v_fmac_f32 v77, v59, v121
    v_fmac_f32 v78, v59, v122
    v_fmac_f32 v79, v59, v123
    v_fmac_f32 v80, v59, v124
    v_fmac_f32 v81, v59, v125
    v_fmac_f32 v82, v59, v126
    v_add_f32 v82, 0x358637bd, v82
    v_rcp_f32 v82, v82
    s_nop 0
    v_mul_f32 v64, v64, v82
    v_mul_f32 v65, v65, v82
    v_mul_f32 v66, v66, v82
    v_mul_f32 v67, v67, v82
    v_mul_f32 v68, v68, v82
    v_mul_f32 v69, v69, v82
    v_mul_f32 v70, v70, v82
    v_mul_f32 v71, v71, v82
    v_mul_f32 v72, v72, v82
    v_mul_f32 v73, v73, v82
    v_mul_f32 v74, v74, v82
    v_mul_f32 v75, v75, v82
    v_mul_f32 v76, v76, v82
    v_mul_f32 v77, v77, v82
    v_mul_f32 v78, v78, v82
    v_mul_f32 v79, v79, v82
    v_mul_f32 v80, v80, v82
    v_mul_f32 v81, v81, v82
    v_cvt_pk_bf16_f32 v4, v64, v65
    v_cvt_pk_bf16_f32 v5, v66, v67
    v_cvt_pk_bf16_f32 v6, v68, v69
    v_cvt_pk_bf16_f32 v7, v70, v71
    v_cvt_pk_bf16_f32 v8, v72, v73
    v_cvt_pk_bf16_f32 v9, v74, v75
    v_cvt_pk_bf16_f32 v10, v76, v77
    v_cvt_pk_bf16_f32 v11, v78, v79
    v_cvt_pk_bf16_f32 v12, v80, v81
    v_lshrrev_b32 v2, 4, v1
    s_mov_b32 s22, 165888
    v_mul_lo_u32 v2, v2, s22
    v_and_b32 v3, 15, v1
    v_lshl_add_u32 v2, v3, 4, v2
    s_mul_i32 s23, s20, 18
    s_add_u32 s22, s23, 0
    s_lshr_b32 s24, s22, 5
    s_lshl_b32 s24, s24, 10
    s_bfe_u32 s25, s22, 0x20003
    s_lshl_b32 s25, s25, 8
    s_add_u32 s24, s24, s25
    s_and_b32 s25, s22, 7
    s_lshl_b32 s25, s25, 1
    s_add_u32 s24, s24, s25
    buffer_store_dword v4, v2, s[8:11], s24 offen
    s_add_u32 s22, s23, 2
    s_lshr_b32 s24, s22, 5
    s_lshl_b32 s24, s24, 10
    s_bfe_u32 s25, s22, 0x20003
    s_lshl_b32 s25, s25, 8
    s_add_u32 s24, s24, s25
    s_and_b32 s25, s22, 7
    s_lshl_b32 s25, s25, 1
    s_add_u32 s24, s24, s25
    buffer_store_dword v5, v2, s[8:11], s24 offen
    s_add_u32 s22, s23, 4
    s_lshr_b32 s24, s22, 5
    s_lshl_b32 s24, s24, 10
    s_bfe_u32 s25, s22, 0x20003
    s_lshl_b32 s25, s25, 8
    s_add_u32 s24, s24, s25
    s_and_b32 s25, s22, 7
    s_lshl_b32 s25, s25, 1
    s_add_u32 s24, s24, s25
    buffer_store_dword v6, v2, s[8:11], s24 offen
    s_add_u32 s22, s23, 6
    s_lshr_b32 s24, s22, 5
    s_lshl_b32 s24, s24, 10
    s_bfe_u32 s25, s22, 0x20003
    s_lshl_b32 s25, s25, 8
    s_add_u32 s24, s24, s25
    s_and_b32 s25, s22, 7
    s_lshl_b32 s25, s25, 1
    s_add_u32 s24, s24, s25
    buffer_store_dword v7, v2, s[8:11], s24 offen
    s_add_u32 s22, s23, 8
    s_lshr_b32 s24, s22, 5
    s_lshl_b32 s24, s24, 10
    s_bfe_u32 s25, s22, 0x20003
    s_lshl_b32 s25, s25, 8
    s_add_u32 s24, s24, s25
    s_and_b32 s25, s22, 7
    s_lshl_b32 s25, s25, 1
    s_add_u32 s24, s24, s25
    buffer_store_dword v8, v2, s[8:11], s24 offen
    s_add_u32 s22, s23, 10
    s_lshr_b32 s24, s22, 5
    s_lshl_b32 s24, s24, 10
    s_bfe_u32 s25, s22, 0x20003
    s_lshl_b32 s25, s25, 8
    s_add_u32 s24, s24, s25
    s_and_b32 s25, s22, 7
    s_lshl_b32 s25, s25, 1
    s_add_u32 s24, s24, s25
    buffer_store_dword v9, v2, s[8:11], s24 offen
    s_add_u32 s22, s23, 12
    s_lshr_b32 s24, s22, 5
    s_lshl_b32 s24, s24, 10
    s_bfe_u32 s25, s22, 0x20003
    s_lshl_b32 s25, s25, 8
    s_add_u32 s24, s24, s25
    s_and_b32 s25, s22, 7
    s_lshl_b32 s25, s25, 1
    s_add_u32 s24, s24, s25
    buffer_store_dword v10, v2, s[8:11], s24 offen
    s_add_u32 s22, s23, 14
    s_lshr_b32 s24, s22, 5
    s_lshl_b32 s24, s24, 10
    s_bfe_u32 s25, s22, 0x20003
    s_lshl_b32 s25, s25, 8
    s_add_u32 s24, s24, s25
    s_and_b32 s25, s22, 7
    s_lshl_b32 s25, s25, 1
    s_add_u32 s24, s24, s25
    buffer_store_dword v11, v2, s[8:11], s24 offen
    s_add_u32 s22, s23, 16
    s_lshr_b32 s24, s22, 5
    s_lshl_b32 s24, s24, 10
    s_bfe_u32 s25, s22, 0x20003
    s_lshl_b32 s25, s25, 8
    s_add_u32 s24, s24, s25
    s_and_b32 s25, s22, 7
    s_lshl_b32 s25, s25, 1
    s_add_u32 s24, s24, s25
    buffer_store_dword v12, v2, s[8:11], s24 offen
L_k2_attn_out_kernel_end:
    s_endpgm
.text
.globl k3_gemm2_kernel
.p2align 8
.type k3_gemm2_kernel,@function
k3_gemm2_kernel:
    s_load_dwordx2 s[4:5], s[0:1], 24
    s_load_dwordx2 s[6:7], s[0:1], 48
    s_load_dwordx2 s[8:9], s[0:1], 72
    s_cmp_ge_u32 s2, 256
    s_cbranch_scc1 L_k3_gemm2_kernel_end
    s_and_b32 s28, s2, 3
    s_bfe_u32 s29, s2, 0x40002
    s_lshr_b32 s30, s2, 6
    v_and_b32 v1, 63, v0
    v_lshrrev_b32 v4, 6, v0
    v_lshrrev_b32 v2, 4, v1
    v_and_b32 v3, 15, v1
    v_readfirstlane_b32 s31, v4
    s_waitcnt lgkmcnt(0)
    s_mov_b32 s12, s4
    s_mov_b32 s13, s5
    s_mov_b32 s14, 663552
    s_mov_b32 s15, 0x00020000
    s_mov_b32 s16, s6
    s_mov_b32 s17, s7
    s_mov_b32 s18, 5308416
    s_mov_b32 s19, 0x00020000
    s_mov_b32 s20, s8
    s_mov_b32 s21, s9
    s_mov_b32 s22, 21233664
    s_mov_b32 s23, 0x00020000
    s_add_u32 s24, s8, 50331648
    s_addc_u32 s25, s9, 0
    s_mov_b32 s26, 18874368
    s_mov_b32 s27, 0x00020000
    s_mul_i32 s34, s30, 288
    s_lshl_b32 s32, s31, 6
    s_add_u32 s32, s32, 0
    v_add_u32 v4, s32, v1
    v_mul_u32_u24 v5, 1639, v4
    v_lshrrev_b32 v5, 15, v5
    v_mul_u32_u24 v6, 20, v5
    v_sub_u32 v6, v4, v6
    v_lshrrev_b32 v7, 1, v6
    v_bfe_u32 v8, v5, 3, 1
    v_xor_b32 v7, v7, v8
    v_and_b32 v6, 1, v6
    v_lshlrev_b32 v8, 5, v7
    v_lshl_add_u32 v8, v6, 4, v8
    v_mul_u32_u24 v5, 1152, v5
    v_add3_u32 v5, v5, v8, s34
    v_cmp_lt_u32 vcc, 8, v7
    v_mov_b32 v8, 0x80000000
    s_nop 1
    v_cndmask_b32 v9, v5, v8, vcc
    s_lshl_b32 s32, s31, 6
    s_add_u32 s32, s32, 256
    v_add_u32 v4, s32, v1
    v_mul_u32_u24 v5, 1639, v4
    v_lshrrev_b32 v5, 15, v5
    v_mul_u32_u24 v6, 20, v5
    v_sub_u32 v6, v4, v6
    v_lshrrev_b32 v7, 1, v6
    v_bfe_u32 v8, v5, 3, 1
    v_xor_b32 v7, v7, v8
    v_and_b32 v6, 1, v6
    v_lshlrev_b32 v8, 5, v7
    v_lshl_add_u32 v8, v6, 4, v8
    v_mul_u32_u24 v5, 1152, v5
    v_add3_u32 v5, v5, v8, s34
    v_cmp_lt_u32 vcc, 8, v7
    v_mov_b32 v8, 0x80000000
    s_nop 1
    v_cndmask_b32 v10, v5, v8, vcc
    s_lshl_b32 s32, s31, 6
    s_add_u32 s32, s32, 512
    v_add_u32 v4, s32, v1
    v_mul_u32_u24 v5, 1639, v4
    v_lshrrev_b32 v5, 15, v5
    v_mul_u32_u24 v6, 20, v5
    v_sub_u32 v6, v4, v6
    v_lshrrev_b32 v7, 1, v6
    v_bfe_u32 v8, v5, 3, 1
    v_xor_b32 v7, v7, v8
    v_and_b32 v6, 1, v6
    v_lshlrev_b32 v8, 5, v7
    v_lshl_add_u32 v8, v6, 4, v8
    v_mul_u32_u24 v5, 1152, v5
    v_add3_u32 v5, v5, v8, s34
    v_cmp_lt_u32 vcc, 8, v7
    v_mov_b32 v8, 0x80000000
    s_nop 1
    v_cndmask_b32 v11, v5, v8, vcc
    s_lshl_b32 s32, s31, 6
    s_add_u32 s32, s32, 768
    v_add_u32 v4, s32, v1
    v_mul_u32_u24 v5, 1639, v4
    v_lshrrev_b32 v5, 15, v5
    v_mul_u32_u24 v6, 20, v5
    v_sub_u32 v6, v4, v6
    v_lshrrev_b32 v7, 1, v6
    v_bfe_u32 v8, v5, 3, 1
    v_xor_b32 v7, v7, v8
    v_and_b32 v6, 1, v6
    v_lshlrev_b32 v8, 5, v7
    v_lshl_add_u32 v8, v6, 4, v8
    v_mul_u32_u24 v5, 1152, v5
    v_add3_u32 v5, v5, v8, s34
    v_cmp_lt_u32 vcc, 8, v7
    v_mov_b32 v8, 0x80000000
    s_nop 1
    v_cndmask_b32 v12, v5, v8, vcc
    s_lshl_b32 s32, s31, 6
    s_add_u32 s32, s32, 1024
    v_add_u32 v4, s32, v1
    v_mul_u32_u24 v5, 1639, v4
    v_lshrrev_b32 v5, 15, v5
    v_mul_u32_u24 v6, 20, v5
    v_sub_u32 v6, v4, v6
    v_lshrrev_b32 v7, 1, v6
    v_bfe_u32 v8, v5, 3, 1
    v_xor_b32 v7, v7, v8
    v_and_b32 v6, 1, v6
    v_lshlrev_b32 v8, 5, v7
    v_lshl_add_u32 v8, v6, 4, v8
    v_mul_u32_u24 v5, 1152, v5
    v_add3_u32 v5, v5, v8, s34
    v_cmp_lt_u32 vcc, 8, v7
    v_mov_b32 v8, 0x80000000
    s_nop 1
    v_cndmask_b32 v13, v5, v8, vcc
    v_lshrrev_b32 v4, 2, v3
    v_lshl_add_u32 v4, v2, 3, v4
    v_and_b32 v5, 3, v3
    v_and_b32 v6, 1, v2
    v_mul_u32_u24 v7, 320, v4
    v_lshl_add_u32 v7, v5, 3, v7
    v_lshlrev_b32 v8, 5, v6
    v_add_u32 v14, v7, v8
    v_sub_u32 v15, v7, v8
    v_add_u32 v16, 61440, v14
    v_add_u32 v17, 61440, v15
    s_lshl_b32 s32, s29, 3
    s_lshl_b32 s33, s31, 1
    s_add_u32 s32, s32, s33
    s_mul_i32 s32, s32, 165888
    v_lshlrev_b32 v18, 4, v1
    v_add_u32 v18, s32, v18
    s_lshl_b32 s32, s28, 11
    s_lshl_b32 s33, s29, 7
    s_add_u32 s32, s32, s33
    s_lshl_b32 s33, s31, 5
    s_add_u32 s32, s32, s33
    v_add_u32 v4, s32, v3
    v_mul_u32_u24 v4, 576, v4
    s_mul_i32 s33, s30, 144
    v_lshl_add_u32 v4, v2, 2, v4
    v_add_u32 v4, s33, v4
    v_lshlrev_b32 v19, 2, v4
    s_lshl_b32 s36, s31, 10
    s_cmp_eq_u32 s28, 0
    s_cbranch_scc0 L_k3_gemm2_kernel_v1
    s_mov_b32 s35, 0
    s_mov_b32 s34, 0
    s_add_u32 s33, s34, 0
    buffer_load_dwordx4 v[56:59], v18, s[20:23], s33 offen
    s_add_u32 s33, s34, 165888
    buffer_load_dwordx4 v[60:63], v18, s[20:23], s33 offen
    s_add_u32 s33, s34, 1024
    buffer_load_dwordx4 v[64:67], v18, s[20:23], s33 offen
    s_add_u32 s33, s34, 166912
    buffer_load_dwordx4 v[68:71], v18, s[20:23], s33 offen
    s_add_u32 s33, s34, 2048
    buffer_load_dwordx4 v[72:75], v18, s[20:23], s33 offen
    s_add_u32 s33, s34, 167936
    buffer_load_dwordx4 v[76:79], v18, s[20:23], s33 offen
    s_add_u32 s33, s34, 3072
    buffer_load_dwordx4 v[80:83], v18, s[20:23], s33 offen
    s_add_u32 s33, s34, 168960
    buffer_load_dwordx4 v[84:87], v18, s[20:23], s33 offen
    s_add_u32 s33, s34, 4096
    buffer_load_dwordx4 v[88:91], v18, s[20:23], s33 offen
    s_add_u32 s33, s34, 169984
    buffer_load_dwordx4 v[92:95], v18, s[20:23], s33 offen
    s_add_u32 s33, s34, 5120
    buffer_load_dwordx4 v[96:99], v18, s[20:23], s33 offen
    s_add_u32 s33, s34, 171008
    buffer_load_dwordx4 v[100:103], v18, s[20:23], s33 offen
    s_add_u32 m0, s36, 0
    s_mov_b32 s32, 0
    buffer_load_dwordx4 v9, s[12:15], s32 offen lds
    s_add_u32 m0, s36, 4096
    s_mov_b32 s32, 0
    buffer_load_dwordx4 v10, s[12:15], s32 offen lds
    s_add_u32 m0, s36, 8192
    s_mov_b32 s32, 0
    buffer_load_dwordx4 v11, s[12:15], s32 offen lds
    s_add_u32 m0, s36, 12288
    s_mov_b32 s32, 0
    buffer_load_dwordx4 v12, s[12:15], s32 offen lds
    s_add_u32 m0, s36, 16384
    s_mov_b32 s32, 0
    buffer_load_dwordx4 v13, s[12:15], s32 offen lds
    s_add_u32 m0, s36, 20480
    s_mov_b32 s32, 73728
    buffer_load_dwordx4 v9, s[12:15], s32 offen lds
    s_add_u32 m0, s36, 24576
    s_mov_b32 s32, 73728
    buffer_load_dwordx4 v10, s[12:15], s32 offen lds
    s_add_u32 m0, s36, 28672
    s_mov_b32 s32, 73728
    buffer_load_dwordx4 v11, s[12:15], s32 offen lds
    s_add_u32 m0, s36, 32768
    s_mov_b32 s32, 73728
    buffer_load_dwordx4 v12, s[12:15], s32 offen lds
    s_add_u32 m0, s36, 36864
    s_mov_b32 s32, 73728
    buffer_load_dwordx4 v13, s[12:15], s32 offen lds
    s_add_u32 m0, s36, 40960
    s_mov_b32 s32, 147456
    buffer_load_dwordx4 v9, s[12:15], s32 offen lds
    s_add_u32 m0, s36, 45056
    s_mov_b32 s32, 147456
    buffer_load_dwordx4 v10, s[12:15], s32 offen lds
    s_add_u32 m0, s36, 49152
    s_mov_b32 s32, 147456
    buffer_load_dwordx4 v11, s[12:15], s32 offen lds
    s_add_u32 m0, s36, 53248
    s_mov_b32 s32, 147456
    buffer_load_dwordx4 v12, s[12:15], s32 offen lds
    s_add_u32 m0, s36, 57344
    s_mov_b32 s32, 147456
    buffer_load_dwordx4 v13, s[12:15], s32 offen lds
    s_add_u32 m0, s36, 61440
    s_mov_b32 s32, 221184
    buffer_load_dwordx4 v9, s[12:15], s32 offen lds
    s_add_u32 m0, s36, 65536
    s_mov_b32 s32, 221184
    buffer_load_dwordx4 v10, s[12:15], s32 offen lds
    s_add_u32 m0, s36, 69632
    s_mov_b32 s32, 221184
    buffer_load_dwordx4 v11, s[12:15], s32 offen lds
    s_add_u32 m0, s36, 73728
    s_mov_b32 s32, 221184
    buffer_load_dwordx4 v12, s[12:15], s32 offen lds
    s_add_u32 m0, s36, 77824
    s_mov_b32 s32, 221184
    buffer_load_dwordx4 v13, s[12:15], s32 offen lds
    s_waitcnt vmcnt(15)
    s_barrier
    s_add_u32 m0, s36, 81920
    s_mov_b32 s32, 294912
    buffer_load_dwordx4 v9, s[12:15], s32 offen lds
    s_add_u32 m0, s36, 86016
    s_mov_b32 s32, 294912
    buffer_load_dwordx4 v10, s[12:15], s32 offen lds
    s_add_u32 m0, s36, 90112
    s_mov_b32 s32, 294912
    buffer_load_dwordx4 v11, s[12:15], s32 offen lds
    s_add_u32 m0, s36, 94208
    s_mov_b32 s32, 294912
    buffer_load_dwordx4 v12, s[12:15], s32 offen lds
    s_add_u32 m0, s36, 98304
    s_mov_b32 s32, 294912
    buffer_load_dwordx4 v13, s[12:15], s32 offen lds
    ds_read_b64_tr_b16 v[24:25], v14 offset:0
    ds_read_b64_tr_b16 v[26:27], v14 offset:1280
    ds_read_b64_tr_b16 v[28:29], v15 offset:32
    ds_read_b64_tr_b16 v[30:31], v15 offset:1312
    ds_read_b64_tr_b16 v[32:33], v14 offset:64
    ds_read_b64_tr_b16 v[34:35], v14 offset:1344
    ds_read_b64_tr_b16 v[36:37], v15 offset:96
    ds_read_b64_tr_b16 v[38:39], v15 offset:1376
    ds_read_b64_tr_b16 v[40:41], v14 offset:128
    ds_read_b64_tr_b16 v[42:43], v14 offset:1408
    ds_read_b64_tr_b16 v[44:45], v15 offset:160
    ds_read_b64_tr_b16 v[46:47], v15 offset:1440
    s_add_u32 s33, s34, 6144
    buffer_load_dwordx4 v[104:107], v18, s[20:23], s33 offen
    s_add_u32 s33, s34, 172032
    buffer_load_dwordx4 v[108:111], v18, s[20:23], s33 offen
    ds_read_b64_tr_b16 v[48:49], v14 offset:192
    ds_read_b64_tr_b16 v[50:51], v14 offset:1472
    s_waitcnt lgkmcnt(12)
    v_mfma_f32_16x16x32_bf16 a[0:3], v[24:27], v[56:59], 0
    v_mfma_f32_16x16x32_bf16 a[4:7], v[24:27], v[60:63], 0
    ds_read_b64_tr_b16 v[52:53], v15 offset:224
    ds_read_b64_tr_b16 v[54:55], v15 offset:1504
    s_waitcnt lgkmcnt(12)
    v_mfma_f32_16x16x32_bf16 a[8:11], v[28:31], v[56:59], 0
    v_mfma_f32_16x16x32_bf16 a[12:15], v[28:31], v[60:63], 0
    ds_read_b64_tr_b16 v[24:25], v14 offset:256
    ds_read_b64_tr_b16 v[26:27], v14 offset:1536
    s_waitcnt lgkmcnt(12)
    v_mfma_f32_16x16x32_bf16 a[16:19], v[32:35], v[56:59], 0
    v_mfma_f32_16x16x32_bf16 a[20:23], v[32:35], v[60:63], 0
    ds_read_b64_tr_b16 v[28:29], v14 offset:10240
    ds_read_b64_tr_b16 v[30:31], v14 offset:11520
    s_waitcnt lgkmcnt(12)
    v_mfma_f32_16x16x32_bf16 a[24:27], v[36:39], v[56:59], 0
    v_mfma_f32_16x16x32_bf16 a[28:31], v[36:39], v[60:63], 0
    ds_read_b64_tr_b16 v[32:33], v15 offset:10272
    ds_read_b64_tr_b16 v[34:35], v15 offset:11552
    s_waitcnt lgkmcnt(12)
    v_mfma_f32_16x16x32_bf16 a[32:35], v[40:43], v[56:59], 0
    v_mfma_f32_16x16x32_bf16 a[36:39], v[40:43], v[60:63], 0
    ds_read_b64_tr_b16 v[36:37], v14 offset:10304
    ds_read_b64_tr_b16 v[38:39], v14 offset:11584
    s_waitcnt lgkmcnt(12)
    v_mfma_f32_16x16x32_bf16 a[40:43], v[44:47], v[56:59], 0
    v_mfma_f32_16x16x32_bf16 a[44:47], v[44:47], v[60:63], 0
    ds_read_b64_tr_b16 v[40:41], v15 offset:10336
    ds_read_b64_tr_b16 v[42:43], v15 offset:11616
    s_waitcnt lgkmcnt(12)
    v_mfma_f32_16x16x32_bf16 a[48:51], v[48:51], v[56:59], 0
    v_mfma_f32_16x16x32_bf16 a[52:55], v[48:51], v[60:63], 0
    ds_read_b64_tr_b16 v[44:45], v14 offset:10368
    ds_read_b64_tr_b16 v[46:47], v14 offset:11648
    s_waitcnt lgkmcnt(12)
    v_mfma_f32_16x16x32_bf16 a[56:59], v[52:55], v[56:59], 0
    v_mfma_f32_16x16x32_bf16 a[60:63], v[52:55], v[60:63], 0
    ds_read_b64_tr_b16 v[48:49], v15 offset:10400
    ds_read_b64_tr_b16 v[50:51], v15 offset:11680
    s_waitcnt lgkmcnt(12)
    v_mfma_f32_16x16x32_bf16 a[64:67], v[24:27], v[56:59], 0
    v_mfma_f32_16x16x32_bf16 a[68:71], v[24:27], v[60:63], 0
    s_add_u32 s33, s34, 7168
    buffer_load_dwordx4 v[112:115], v18, s[20:23], s33 offen
    s_add_u32 s33, s34, 173056
    buffer_load_dwordx4 v[116:119], v18, s[20:23], s33 offen
    ds_read_b64_tr_b16 v[52:53], v14 offset:10432
    ds_read_b64_tr_b16 v[54:55], v14 offset:11712
    s_waitcnt lgkmcnt(12)
    v_mfma_f32_16x16x32_bf16 a[0:3], v[28:31], v[64:67], a[0:3]
    v_mfma_f32_16x16x32_bf16 a[4:7], v[28:31], v[68:71], a[4:7]
    ds_read_b64_tr_b16 v[24:25], v15 offset:10464
    ds_read_b64_tr_b16 v[26:27], v15 offset:11744
    s_waitcnt lgkmcnt(12)
    v_mfma_f32_16x16x32_bf16 a[8:11], v[32:35], v[64:67], a[8:11]
    v_mfma_f32_16x16x32_bf16 a[12:15], v[32:35], v[68:71], a[12:15]
    ds_read_b64_tr_b16 v[28:29], v14 offset:10496
    ds_read_b64_tr_b16 v[30:31], v14 offset:11776
    s_waitcnt lgkmcnt(12)
    v_mfma_f32_16x16x32_bf16 a[16:19], v[36:39], v[64:67], a[16:19]
    v_mfma_f32_16x16x32_bf16 a[20:23], v[36:39], v[68:71], a[20:23]
    s_waitcnt vmcnt(19)
    s_barrier
    s_add_u32 m0, s36, 102400
    s_mov_b32 s32, 368640
    buffer_load_dwordx4 v9, s[12:15], s32 offen lds
    s_add_u32 m0, s36, 106496
    s_mov_b32 s32, 368640
    buffer_load_dwordx4 v10, s[12:15], s32 offen lds
    s_add_u32 m0, s36, 110592
    s_mov_b32 s32, 368640
    buffer_load_dwordx4 v11, s[12:15], s32 offen lds
    s_add_u32 m0, s36, 114688
    s_mov_b32 s32, 368640
    buffer_load_dwordx4 v12, s[12:15], s32 offen lds
    s_add_u32 m0, s36, 118784
    s_mov_b32 s32, 368640
    buffer_load_dwordx4 v13, s[12:15], s32 offen lds
    ds_read_b64_tr_b16 v[32:33], v14 offset:20480
    ds_read_b64_tr_b16 v[34:35], v14 offset:21760
    s_waitcnt lgkmcnt(12)
    v_mfma_f32_16x16x32_bf16 a[24:27], v[40:43], v[64:67], a[24:27]
    v_mfma_f32_16x16x32_bf16 a[28:31], v[40:43], v[68:71], a[28:31]
    ds_read_b64_tr_b16 v[36:37], v15 offset:20512
    ds_read_b64_tr_b16 v[38:39], v15 offset:21792
    s_waitcnt lgkmcnt(12)
    v_mfma_f32_16x16x32_bf16 a[32:35], v[44:47], v[64:67], a[32:35]
    v_mfma_f32_16x16x32_bf16 a[36:39], v[44:47], v[68:71], a[36:39]
    ds_read_b64_tr_b16 v[40:41], v14 offset:20544
    ds_read_b64_tr_b16 v[42:43], v14 offset:21824
    s_waitcnt lgkmcnt(12)
    v_mfma_f32_16x16x32_bf16 a[40:43], v[48:51], v[64:67], a[40:43]
    v_mfma_f32_16x16x32_bf16 a[44:47], v[48:51], v[68:71], a[44:47]
    ds_read_b64_tr_b16 v[44:45], v15 offset:20576
    ds_read_b64_tr_b16 v[46:47], v15 offset:21856
    s_waitcnt lgkmcnt(12)
    v_mfma_f32_16x16x32_bf16 a[48:51], v[52:55], v[64:67], a[48:51]
    v_mfma_f32_16x16x32_bf16 a[52:55], v[52:55], v[68:71], a[52:55]
    ds_read_b64_tr_b16 v[48:49], v14 offset:20608
    ds_read_b64_tr_b16 v[50:51], v14 offset:21888
    s_waitcnt lgkmcnt(12)
    v_mfma_f32_16x16x32_bf16 a[56:59], v[24:27], v[64:67], a[56:59]
    v_mfma_f32_16x16x32_bf16 a[60:63], v[24:27], v[68:71], a[60:63]
    ds_read_b64_tr_b16 v[52:53], v15 offset:20640
    ds_read_b64_tr_b16 v[54:55], v15 offset:21920
    s_waitcnt lgkmcnt(12)
    v_mfma_f32_16x16x32_bf16 a[64:67], v[28:31], v[64:67], a[64:67]
    v_mfma_f32_16x16x32_bf16 a[68:71], v[28:31], v[68:71], a[68:71]
    s_add_u32 s33, s34, 8192
    buffer_load_dwordx4 v[56:59], v18, s[20:23], s33 offen
    s_add_u32 s33, s34, 174080
    buffer_load_dwordx4 v[60:63], v18, s[20:23], s33 offen
    ds_read_b64_tr_b16 v[24:25], v14 offset:20672
    ds_read_b64_tr_b16 v[26:27], v14 offset:21952
    s_waitcnt lgkmcnt(12)
    v_mfma_f32_16x16x32_bf16 a[0:3], v[32:35], v[72:75], a[0:3]
    v_mfma_f32_16x16x32_bf16 a[4:7], v[32:35], v[76:79], a[4:7]
    ds_read_b64_tr_b16 v[28:29], v15 offset:20704
    ds_read_b64_tr_b16 v[30:31], v15 offset:21984
    s_waitcnt lgkmcnt(12)
    v_mfma_f32_16x16x32_bf16 a[8:11], v[36:39], v[72:75], a[8:11]
    v_mfma_f32_16x16x32_bf16 a[12:15], v[36:39], v[76:79], a[12:15]
    ds_read_b64_tr_b16 v[32:33], v14 offset:20736
    ds_read_b64_tr_b16 v[34:35], v14 offset:22016
    s_waitcnt lgkmcnt(12)
    v_mfma_f32_16x16x32_bf16 a[16:19], v[40:43], v[72:75], a[16:19]
    v_mfma_f32_16x16x32_bf16 a[20:23], v[40:43], v[76:79], a[20:23]
    ds_read_b64_tr_b16 v[36:37], v14 offset:30720
    ds_read_b64_tr_b16 v[38:39], v14 offset:32000
    s_waitcnt lgkmcnt(12)
    v_mfma_f32_16x16x32_bf16 a[24:27], v[44:47], v[72:75], a[24:27]
    v_mfma_f32_16x16x32_bf16 a[28:31], v[44:47], v[76:79], a[28:31]
    ds_read_b64_tr_b16 v[40:41], v15 offset:30752
    ds_read_b64_tr_b16 v[42:43], v15 offset:32032
    s_waitcnt lgkmcnt(12)
    v_mfma_f32_16x16x32_bf16 a[32:35], v[48:51], v[72:75], a[32:35]
    v_mfma_f32_16x16x32_bf16 a[36:39], v[48:51], v[76:79], a[36:39]
    ds_read_b64_tr_b16 v[44:45], v14 offset:30784
    ds_read_b64_tr_b16 v[46:47], v14 offset:32064
    s_waitcnt lgkmcnt(12)
    v_mfma_f32_16x16x32_bf16 a[40:43], v[52:55], v[72:75], a[40:43]
    v_mfma_f32_16x16x32_bf16 a[44:47], v[52:55], v[76:79], a[44:47]
    ds_read_b64_tr_b16 v[48:49], v15 offset:30816
    ds_read_b64_tr_b16 v[50:51], v15 offset:32096
    s_waitcnt lgkmcnt(12)
    v_mfma_f32_16x16x32_bf16 a[48:51], v[24:27], v[72:75], a[48:51]
    v_mfma_f32_16x16x32_bf16 a[52:55], v[24:27], v[76:79], a[52:55]
    ds_read_b64_tr_b16 v[52:53], v14 offset:30848
    ds_read_b64_tr_b16 v[54:55], v14 offset:32128
    s_waitcnt lgkmcnt(12)
    v_mfma_f32_16x16x32_bf16 a[56:59], v[28:31], v[72:75], a[56:59]
    v_mfma_f32_16x16x32_bf16 a[60:63], v[28:31], v[76:79], a[60:63]
    ds_read_b64_tr_b16 v[24:25], v15 offset:30880
    ds_read_b64_tr_b16 v[26:27], v15 offset:32160
    s_waitcnt lgkmcnt(12)
    v_mfma_f32_16x16x32_bf16 a[64:67], v[32:35], v[72:75], a[64:67]
    v_mfma_f32_16x16x32_bf16 a[68:71], v[32:35], v[76:79], a[68:71]
    s_add_u32 s33, s34, 9216
    buffer_load_dwordx4 v[64:67], v18, s[20:23], s33 offen
    s_add_u32 s33, s34, 175104
    buffer_load_dwordx4 v[68:71], v18, s[20:23], s33 offen
    ds_read_b64_tr_b16 v[28:29], v14 offset:30912
    ds_read_b64_tr_b16 v[30:31], v14 offset:32192
    s_waitcnt lgkmcnt(12)
    v_mfma_f32_16x16x32_bf16 a[0:3], v[36:39], v[80:83], a[0:3]
    v_mfma_f32_16x16x32_bf16 a[4:7], v[36:39], v[84:87], a[4:7]
    ds_read_b64_tr_b16 v[32:33], v15 offset:30944
    ds_read_b64_tr_b16 v[34:35], v15 offset:32224
    s_waitcnt lgkmcnt(12)
    v_mfma_f32_16x16x32_bf16 a[8:11], v[40:43], v[80:83], a[8:11]
    v_mfma_f32_16x16x32_bf16 a[12:15], v[40:43], v[84:87], a[12:15]
    ds_read_b64_tr_b16 v[36:37], v14 offset:30976
    ds_read_b64_tr_b16 v[38:39], v14 offset:32256
    s_waitcnt lgkmcnt(12)
    v_mfma_f32_16x16x32_bf16 a[16:19], v[44:47], v[80:83], a[16:19]
    v_mfma_f32_16x16x32_bf16 a[20:23], v[44:47], v[84:87], a[20:23]
    s_waitcnt vmcnt(23)
    s_barrier
    s_add_u32 m0, s36, 0
    s_mov_b32 s32, 442368
    buffer_load_dwordx4 v9, s[12:15], s32 offen lds
    s_add_u32 m0, s36, 4096
    s_mov_b32 s32, 442368
    buffer_load_dwordx4 v10, s[12:15], s32 offen lds
    s_add_u32 m0, s36, 8192
    s_mov_b32 s32, 442368
    buffer_load_dwordx4 v11, s[12:15], s32 offen lds
    s_add_u32 m0, s36, 12288
    s_mov_b32 s32, 442368
    buffer_load_dwordx4 v12, s[12:15], s32 offen lds
    s_add_u32 m0, s36, 16384
    s_mov_b32 s32, 442368
    buffer_load_dwordx4 v13, s[12:15], s32 offen lds
    ds_read_b64_tr_b16 v[40:41], v14 offset:40960
    ds_read_b64_tr_b16 v[42:43], v14 offset:42240
    s_waitcnt lgkmcnt(12)
    v_mfma_f32_16x16x32_bf16 a[24:27], v[48:51], v[80:83], a[24:27]
    v_mfma_f32_16x16x32_bf16 a[28:31], v[48:51], v[84:87], a[28:31]
    ds_read_b64_tr_b16 v[44:45], v15 offset:40992
    ds_read_b64_tr_b16 v[46:47], v15 offset:42272
    s_waitcnt lgkmcnt(12)
    v_mfma_f32_16x16x32_bf16 a[32:35], v[52:55], v[80:83], a[32:35]
    v_mfma_f32_16x16x32_bf16 a[36:39], v[52:55], v[84:87], a[36:39]
    ds_read_b64_tr_b16 v[48:49], v14 offset:41024
    ds_read_b64_tr_b16 v[50:51], v14 offset:42304
    s_waitcnt lgkmcnt(12)
    v_mfma_f32_16x16x32_bf16 a[40:43], v[24:27], v[80:83], a[40:43]
    v_mfma_f32_16x16x32_bf16 a[44:47], v[24:27], v[84:87], a[44:47]
    ds_read_b64_tr_b16 v[52:53], v15 offset:41056
    ds_read_b64_tr_b16 v[54:55], v15 offset:42336
    s_waitcnt lgkmcnt(12)
    v_mfma_f32_16x16x32_bf16 a[48:51], v[28:31], v[80:83], a[48:51]
    v_mfma_f32_16x16x32_bf16 a[52:55], v[28:31], v[84:87], a[52:55]
    ds_read_b64_tr_b16 v[24:25], v14 offset:41088
    ds_read_b64_tr_b16 v[26:27], v14 offset:42368
    s_waitcnt lgkmcnt(12)
    v_mfma_f32_16x16x32_bf16 a[56:59], v[32:35], v[80:83], a[56:59]
    v_mfma_f32_16x16x32_bf16 a[60:63], v[32:35], v[84:87], a[60:63]
    ds_read_b64_tr_b16 v[28:29], v15 offset:41120
    ds_read_b64_tr_b16 v[30:31], v15 offset:42400
    s_waitcnt lgkmcnt(12)
    v_mfma_f32_16x16x32_bf16 a[64:67], v[36:39], v[80:83], a[64:67]
    v_mfma_f32_16x16x32_bf16 a[68:71], v[36:39], v[84:87], a[68:71]
    s_add_u32 s33, s34, 10240
    buffer_load_dwordx4 v[72:75], v18, s[20:23], s33 offen
    s_add_u32 s33, s34, 176128
    buffer_load_dwordx4 v[76:79], v18, s[20:23], s33 offen
    ds_read_b64_tr_b16 v[32:33], v14 offset:41152
    ds_read_b64_tr_b16 v[34:35], v14 offset:42432
    s_waitcnt lgkmcnt(12)
    v_mfma_f32_16x16x32_bf16 a[0:3], v[40:43], v[88:91], a[0:3]
    v_mfma_f32_16x16x32_bf16 a[4:7], v[40:43], v[92:95], a[4:7]
    ds_read_b64_tr_b16 v[36:37], v15 offset:41184
    ds_read_b64_tr_b16 v[38:39], v15 offset:42464
    s_waitcnt lgkmcnt(12)
    v_mfma_f32_16x16x32_bf16 a[8:11], v[44:47], v[88:91], a[8:11]
    v_mfma_f32_16x16x32_bf16 a[12:15], v[44:47], v[92:95], a[12:15]
    ds_read_b64_tr_b16 v[40:41], v14 offset:41216
    ds_read_b64_tr_b16 v[42:43], v14 offset:42496
    s_waitcnt lgkmcnt(12)
    v_mfma_f32_16x16x32_bf16 a[16:19], v[48:51], v[88:91], a[16:19]
    v_mfma_f32_16x16x32_bf16 a[20:23], v[48:51], v[92:95], a[20:23]
    ds_read_b64_tr_b16 v[44:45], v14 offset:51200
    ds_read_b64_tr_b16 v[46:47], v14 offset:52480
    s_waitcnt lgkmcnt(12)
    v_mfma_f32_16x16x32_bf16 a[24:27], v[52:55], v[88:91], a[24:27]
    v_mfma_f32_16x16x32_bf16 a[28:31], v[52:55], v[92:95], a[28:31]
    ds_read_b64_tr_b16 v[48:49], v15 offset:51232
    ds_read_b64_tr_b16 v[50:51], v15 offset:52512
    s_waitcnt lgkmcnt(12)
    v_mfma_f32_16x16x32_bf16 a[32:35], v[24:27], v[88:91], a[32:35]
    v_mfma_f32_16x16x32_bf16 a[36:39], v[24:27], v[92:95], a[36:39]
    ds_read_b64_tr_b16 v[52:53], v14 offset:51264
    ds_read_b64_tr_b16 v[54:55], v14 offset:52544
    s_waitcnt lgkmcnt(12)
    v_mfma_f32_16x16x32_bf16 a[40:43], v[28:31], v[88:91], a[40:43]
    v_mfma_f32_16x16x32_bf16 a[44:47], v[28:31], v[92:95], a[44:47]
    ds_read_b64_tr_b16 v[24:25], v15 offset:51296
    ds_read_b64_tr_b16 v[26:27], v15 offset:52576
    s_waitcnt lgkmcnt(12)
    v_mfma_f32_16x16x32_bf16 a[48:51], v[32:35], v[88:91], a[48:51]
    v_mfma_f32_16x16x32_bf16 a[52:55], v[32:35], v[92:95], a[52:55]
    ds_read_b64_tr_b16 v[28:29], v14 offset:51328
    ds_read_b64_tr_b16 v[30:31], v14 offset:52608
    s_waitcnt lgkmcnt(12)
    v_mfma_f32_16x16x32_bf16 a[56:59], v[36:39], v[88:91], a[56:59]
    v_mfma_f32_16x16x32_bf16 a[60:63], v[36:39], v[92:95], a[60:63]
    ds_read_b64_tr_b16 v[32:33], v15 offset:51360
    ds_read_b64_tr_b16 v[34:35], v15 offset:52640
    s_waitcnt lgkmcnt(12)
    v_mfma_f32_16x16x32_bf16 a[64:67], v[40:43], v[88:91], a[64:67]
    v_mfma_f32_16x16x32_bf16 a[68:71], v[40:43], v[92:95], a[68:71]
    s_add_u32 s33, s34, 11264
    buffer_load_dwordx4 v[80:83], v18, s[20:23], s33 offen
    s_add_u32 s33, s34, 177152
    buffer_load_dwordx4 v[84:87], v18, s[20:23], s33 offen
    ds_read_b64_tr_b16 v[36:37], v14 offset:51392
    ds_read_b64_tr_b16 v[38:39], v14 offset:52672
    s_waitcnt lgkmcnt(12)
    v_mfma_f32_16x16x32_bf16 a[0:3], v[44:47], v[96:99], a[0:3]
    v_mfma_f32_16x16x32_bf16 a[4:7], v[44:47], v[100:103], a[4:7]
    ds_read_b64_tr_b16 v[40:41], v15 offset:51424
    ds_read_b64_tr_b16 v[42:43], v15 offset:52704
    s_waitcnt lgkmcnt(12)
    v_mfma_f32_16x16x32_bf16 a[8:11], v[48:51], v[96:99], a[8:11]
    v_mfma_f32_16x16x32_bf16 a[12:15], v[48:51], v[100:103], a[12:15]
    ds_read_b64_tr_b16 v[44:45], v14 offset:51456
    ds_read_b64_tr_b16 v[46:47], v14 offset:52736
    s_waitcnt lgkmcnt(12)
    v_mfma_f32_16x16x32_bf16 a[16:19], v[52:55], v[96:99], a[16:19]
    v_mfma_f32_16x16x32_bf16 a[20:23], v[52:55], v[100:103], a[20:23]
    s_waitcnt vmcnt(27)
    s_barrier
    s_add_u32 m0, s36, 20480
    s_mov_b32 s32, 516096
    buffer_load_dwordx4 v9, s[12:15], s32 offen lds
    s_add_u32 m0, s36, 24576
    s_mov_b32 s32, 516096
    buffer_load_dwordx4 v10, s[12:15], s32 offen lds
    s_add_u32 m0, s36, 28672
    s_mov_b32 s32, 516096
    buffer_load_dwordx4 v11, s[12:15], s32 offen lds
    s_add_u32 m0, s36, 32768
    s_mov_b32 s32, 516096
    buffer_load_dwordx4 v12, s[12:15], s32 offen lds
    s_add_u32 m0, s36, 36864
    s_mov_b32 s32, 516096
    buffer_load_dwordx4 v13, s[12:15], s32 offen lds
    ds_read_b64_tr_b16 v[48:49], v16 offset:0
    ds_read_b64_tr_b16 v[50:51], v16 offset:1280
    s_waitcnt lgkmcnt(12)
    v_mfma_f32_16x16x32_bf16 a[24:27], v[24:27], v[96:99], a[24:27]
    v_mfma_f32_16x16x32_bf16 a[28:31], v[24:27], v[100:103], a[28:31]
    ds_read_b64_tr_b16 v[52:53], v17 offset:32
    ds_read_b64_tr_b16 v[54:55], v17 offset:1312
    s_waitcnt lgkmcnt(12)
    v_mfma_f32_16x16x32_bf16 a[32:35], v[28:31], v[96:99], a[32:35]
    v_mfma_f32_16x16x32_bf16 a[36:39], v[28:31], v[100:103], a[36:39]
    ds_read_b64_tr_b16 v[24:25], v16 offset:64
    ds_read_b64_tr_b16 v[26:27], v16 offset:1344
    s_waitcnt lgkmcnt(12)
    v_mfma_f32_16x16x32_bf16 a[40:43], v[32:35], v[96:99], a[40:43]
    v_mfma_f32_16x16x32_bf16 a[44:47], v[32:35], v[100:103], a[44:47]
    ds_read_b64_tr_b16 v[28:29], v17 offset:96
    ds_read_b64_tr_b16 v[30:31], v17 offset:1376
    s_waitcnt lgkmcnt(12)
    v_mfma_f32_16x16x32_bf16 a[48:51], v[36:39], v[96:99], a[48:51]
    v_mfma_f32_16x16x32_bf16 a[52:55], v[36:39], v[100:103], a[52:55]
    ds_read_b64_tr_b16 v[32:33], v16 offset:128
    ds_read_b64_tr_b16 v[34:35], v16 offset:1408
    s_waitcnt lgkmcnt(12)
    v_mfma_f32_16x16x32_bf16 a[56:59], v[40:43], v[96:99], a[56:59]
    v_mfma_f32_16x16x32_bf16 a[60:63], v[40:43], v[100:103], a[60:63]
    ds_read_b64_tr_b16 v[36:37], v17 offset:160
    ds_read_b64_tr_b16 v[38:39], v17 offset:1440
    s_waitcnt lgkmcnt(12)
    v_mfma_f32_16x16x32_bf16 a[64:67], v[44:47], v[96:99], a[64:67]
    v_mfma_f32_16x16x32_bf16 a[68:71], v[44:47], v[100:103], a[68:71]
    s_add_u32 s33, s34, 12288
    buffer_load_dwordx4 v[88:91], v18, s[20:23], s33 offen
    s_add_u32 s33, s34, 178176
    buffer_load_dwordx4 v[92:95], v18, s[20:23], s33 offen
    ds_read_b64_tr_b16 v[40:41], v16 offset:192
    ds_read_b64_tr_b16 v[42:43], v16 offset:1472
    s_waitcnt vmcnt(27)
    s_waitcnt lgkmcnt(12)
    v_mfma_f32_16x16x32_bf16 a[0:3], v[48:51], v[104:107], a[0:3]
    v_mfma_f32_16x16x32_bf16 a[4:7], v[48:51], v[108:111], a[4:7]
    ds_read_b64_tr_b16 v[44:45], v17 offset:224
    ds_read_b64_tr_b16 v[46:47], v17 offset:1504
    s_waitcnt lgkmcnt(12)
    v_mfma_f32_16x16x32_bf16 a[8:11], v[52:55], v[104:107], a[8:11]
    v_mfma_f32_16x16x32_bf16 a[12:15], v[52:55], v[108:111], a[12:15]
    ds_read_b64_tr_b16 v[48:49], v16 offset:256
    ds_read_b64_tr_b16 v[50:51], v16 offset:1536
    s_waitcnt lgkmcnt(12)
    v_mfma_f32_16x16x32_bf16 a[16:19], v[24:27], v[104:107], a[16:19]
    v_mfma_f32_16x16x32_bf16 a[20:23], v[24:27], v[108:111], a[20:23]
    ds_read_b64_tr_b16 v[52:53], v16 offset:10240
    ds_read_b64_tr_b16 v[54:55], v16 offset:11520
    s_waitcnt lgkmcnt(12)
    v_mfma_f32_16x16x32_bf16 a[24:27], v[28:31], v[104:107], a[24:27]
    v_mfma_f32_16x16x32_bf16 a[28:31], v[28:31], v[108:111], a[28:31]
    ds_read_b64_tr_b16 v[24:25], v17 offset:10272
    ds_read_b64_tr_b16 v[26:27], v17 offset:11552
    s_waitcnt lgkmcnt(12)
    v_mfma_f32_16x16x32_bf16 a[32:35], v[32:35], v[104:107], a[32:35]
    v_mfma_f32_16x16x32_bf16 a[36:39], v[32:35], v[108:111], a[36:39]
    ds_read_b64_tr_b16 v[28:29], v16 offset:10304
    ds_read_b64_tr_b16 v[30:31], v16 offset:11584
    s_waitcnt lgkmcnt(12)
    v_mfma_f32_16x16x32_bf16 a[40:43], v[36:39], v[104:107], a[40:43]
    v_mfma_f32_16x16x32_bf16 a[44:47], v[36:39], v[108:111], a[44:47]
    ds_read_b64_tr_b16 v[32:33], v17 offset:10336
    ds_read_b64_tr_b16 v[34:35], v17 offset:11616
    s_waitcnt lgkmcnt(12)
    v_mfma_f32_16x16x32_bf16 a[48:51], v[40:43], v[104:107], a[48:51]
    v_mfma_f32_16x16x32_bf16 a[52:55], v[40:43], v[108:111], a[52:55]
    ds_read_b64_tr_b16 v[36:37], v16 offset:10368
    ds_read_b64_tr_b16 v[38:39], v16 offset:11648
    s_waitcnt lgkmcnt(12)
    v_mfma_f32_16x16x32_bf16 a[56:59], v[44:47], v[104:107], a[56:59]
    v_mfma_f32_16x16x32_bf16 a[60:63], v[44:47], v[108:111], a[60:63]
    ds_read_b64_tr_b16 v[40:41], v17 offset:10400
    ds_read_b64_tr_b16 v[42:43], v17 offset:11680
    s_waitcnt lgkmcnt(12)
    v_mfma_f32_16x16x32_bf16 a[64:67], v[48:51], v[104:107], a[64:67]
    v_mfma_f32_16x16x32_bf16 a[68:71], v[48:51], v[108:111], a[68:71]
    s_add_u32 s33, s34, 13312
    buffer_load_dwordx4 v[96:99], v18, s[20:23], s33 offen
    s_add_u32 s33, s34, 179200
    buffer_load_dwordx4 v[100:103], v18, s[20:23], s33 offen
    ds_read_b64_tr_b16 v[44:45], v16 offset:10432
    ds_read_b64_tr_b16 v[46:47], v16 offset:11712
    s_waitcnt vmcnt(27)
    s_waitcnt lgkmcnt(12)
    v_mfma_f32_16x16x32_bf16 a[0:3], v[52:55], v[112:115], a[0:3]
    v_mfma_f32_16x16x32_bf16 a[4:7], v[52:55], v[116:119], a[4:7]
    ds_read_b64_tr_b16 v[48:49], v17 offset:10464
    ds_read_b64_tr_b16 v[50:51], v17 offset:11744
    s_waitcnt lgkmcnt(12)
    v_mfma_f32_16x16x32_bf16 a[8:11], v[24:27], v[112:115], a[8:11]
    v_mfma_f32_16x16x32_bf16 a[12:15], v[24:27], v[116:119], a[12:15]
    ds_read_b64_tr_b16 v[52:53], v16 offset:10496
    ds_read_b64_tr_b16 v[54:55], v16 offset:11776
    s_waitcnt lgkmcnt(12)
    v_mfma_f32_16x16x32_bf16 a[16:19], v[28:31], v[112:115], a[16:19]
    v_mfma_f32_16x16x32_bf16 a[20:23], v[28:31], v[116:119], a[20:23]
    s_barrier
    s_add_u32 m0, s36, 40960
    s_mov_b32 s32, 589824
    buffer_load_dwordx4 v9, s[12:15], s32 offen lds
    s_add_u32 m0, s36, 45056
    s_mov_b32 s32, 589824
    buffer_load_dwordx4 v10, s[12:15], s32 offen lds
    s_add_u32 m0, s36, 49152
    s_mov_b32 s32, 589824
    buffer_load_dwordx4 v11, s[12:15], s32 offen lds
    s_add_u32 m0, s36, 53248
    s_mov_b32 s32, 589824
    buffer_load_dwordx4 v12, s[12:15], s32 offen lds
    s_add_u32 m0, s36, 57344
    s_mov_b32 s32, 589824
    buffer_load_dwordx4 v13, s[12:15], s32 offen lds
    ds_read_b64_tr_b16 v[24:25], v16 offset:20480
    ds_read_b64_tr_b16 v[26:27], v16 offset:21760
    s_waitcnt lgkmcnt(12)
    v_mfma_f32_16x16x32_bf16 a[24:27], v[32:35], v[112:115], a[24:27]
    v_mfma_f32_16x16x32_bf16 a[28:31], v[32:35], v[116:119], a[28:31]
    ds_read_b64_tr_b16 v[28:29], v17 offset:20512
    ds_read_b64_tr_b16 v[30:31], v17 offset:21792
    s_waitcnt lgkmcnt(12)
    v_mfma_f32_16x16x32_bf16 a[32:35], v[36:39], v[112:115], a[32:35]
    v_mfma_f32_16x16x32_bf16 a[36:39], v[36:39], v[116:119], a[36:39]
    ds_read_b64_tr_b16 v[32:33], v16 offset:20544
    ds_read_b64_tr_b16 v[34:35], v16 offset:21824
    s_waitcnt lgkmcnt(12)
    v_mfma_f32_16x16x32_bf16 a[40:43], v[40:43], v[112:115], a[40:43]
    v_mfma_f32_16x16x32_bf16 a[44:47], v[40:43], v[116:119], a[44:47]
    ds_read_b64_tr_b16 v[36:37], v17 offset:20576
    ds_read_b64_tr_b16 v[38:39], v17 offset:21856
    s_waitcnt lgkmcnt(12)
    v_mfma_f32_16x16x32_bf16 a[48:51], v[44:47], v[112:115], a[48:51]
    v_mfma_f32_16x16x32_bf16 a[52:55], v[44:47], v[116:119], a[52:55]
    ds_read_b64_tr_b16 v[40:41], v16 offset:20608
    ds_read_b64_tr_b16 v[42:43], v16 offset:21888
    s_waitcnt lgkmcnt(12)
    v_mfma_f32_16x16x32_bf16 a[56:59], v[48:51], v[112:115], a[56:59]
    v_mfma_f32_16x16x32_bf16 a[60:63], v[48:51], v[116:119], a[60:63]
    ds_read_b64_tr_b16 v[44:45], v17 offset:20640
    ds_read_b64_tr_b16 v[46:47], v17 offset:21920
    s_waitcnt lgkmcnt(12)
    v_mfma_f32_16x16x32_bf16 a[64:67], v[52:55], v[112:115], a[64:67]
    v_mfma_f32_16x16x32_bf16 a[68:71], v[52:55], v[116:119], a[68:71]
    s_add_u32 s33, s34, 14336
    buffer_load_dwordx4 v[104:107], v18, s[20:23], s33 offen
    s_add_u32 s33, s34, 180224
    buffer_load_dwordx4 v[108:111], v18, s[20:23], s33 offen
    ds_read_b64_tr_b16 v[48:49], v16 offset:20672
    ds_read_b64_tr_b16 v[50:51], v16 offset:21952
    s_waitcnt vmcnt(27)
    s_waitcnt lgkmcnt(12)
    v_mfma_f32_16x16x32_bf16 a[0:3], v[24:27], v[56:59], a[0:3]
    v_mfma_f32_16x16x32_bf16 a[4:7], v[24:27], v[60:63], a[4:7]
    ds_read_b64_tr_b16 v[52:53], v17 offset:20704
    ds_read_b64_tr_b16 v[54:55], v17 offset:21984
    s_waitcnt lgkmcnt(12)
    v_mfma_f32_16x16x32_bf16 a[8:11], v[28:31], v[56:59], a[8:11]
    v_mfma_f32_16x16x32_bf16 a[12:15], v[28:31], v[60:63], a[12:15]
    ds_read_b64_tr_b16 v[24:25], v16 offset:20736
    ds_read_b64_tr_b16 v[26:27], v16 offset:22016
    s_waitcnt lgkmcnt(12)
    v_mfma_f32_16x16x32_bf16 a[16:19], v[32:35], v[56:59], a[16:19]
    v_mfma_f32_16x16x32_bf16 a[20:23], v[32:35], v[60:63], a[20:23]
    ds_read_b64_tr_b16 v[28:29], v16 offset:30720
    ds_read_b64_tr_b16 v[30:31], v16 offset:32000
    s_waitcnt lgkmcnt(12)
    v_mfma_f32_16x16x32_bf16 a[24:27], v[36:39], v[56:59], a[24:27]
    v_mfma_f32_16x16x32_bf16 a[28:31], v[36:39], v[60:63], a[28:31]
    ds_read_b64_tr_b16 v[32:33], v17 offset:30752
    ds_read_b64_tr_b16 v[34:35], v17 offset:32032
    s_waitcnt lgkmcnt(12)
    v_mfma_f32_16x16x32_bf16 a[32:35], v[40:43], v[56:59], a[32:35]
    v_mfma_f32_16x16x32_bf16 a[36:39], v[40:43], v[60:63], a[36:39]
    ds_read_b64_tr_b16 v[36:37], v16 offset:30784
    ds_read_b64_tr_b16 v[38:39], v16 offset:32064
    s_waitcnt lgkmcnt(12)
    v_mfma_f32_16x16x32_bf16 a[40:43], v[44:47], v[56:59], a[40:43]
    v_mfma_f32_16x16x32_bf16 a[44:47], v[44:47], v[60:63], a[44:47]
    ds_read_b64_tr_b16 v[40:41], v17 offset:30816
    ds_read_b64_tr_b16 v[42:43], v17 offset:32096
    s_waitcnt lgkmcnt(12)
    v_mfma_f32_16x16x32_bf16 a[48:51], v[48:51], v[56:59], a[48:51]
    v_mfma_f32_16x16x32_bf16 a[52:55], v[48:51], v[60:63], a[52:55]
    ds_read_b64_tr_b16 v[44:45], v16 offset:30848
    ds_read_b64_tr_b16 v[46:47], v16 offset:32128
    s_waitcnt lgkmcnt(12)
    v_mfma_f32_16x16x32_bf16 a[56:59], v[52:55], v[56:59], a[56:59]
    v_mfma_f32_16x16x32_bf16 a[60:63], v[52:55], v[60:63], a[60:63]
    ds_read_b64_tr_b16 v[48:49], v17 offset:30880
    ds_read_b64_tr_b16 v[50:51], v17 offset:32160
    s_waitcnt lgkmcnt(12)
    v_mfma_f32_16x16x32_bf16 a[64:67], v[24:27], v[56:59], a[64:67]
    v_mfma_f32_16x16x32_bf16 a[68:71], v[24:27], v[60:63], a[68:71]
    s_add_u32 s33, s34, 15360
    buffer_load_dwordx4 v[112:115], v18, s[20:23], s33 offen
    s_add_u32 s33, s34, 181248
    buffer_load_dwordx4 v[116:119], v18, s[20:23], s33 offen
    ds_read_b64_tr_b16 v[52:53], v16 offset:30912
    ds_read_b64_tr_b16 v[54:55], v16 offset:32192
    s_waitcnt vmcnt(27)
    s_waitcnt lgkmcnt(12)
    v_mfma_f32_16x16x32_bf16 a[0:3], v[28:31], v[64:67], a[0:3]
    v_mfma_f32_16x16x32_bf16 a[4:7], v[28:31], v[68:71], a[4:7]
    ds_read_b64_tr_b16 v[24:25], v17 offset:30944
    ds_read_b64_tr_b16 v[26:27], v17 offset:32224
    s_waitcnt lgkmcnt(12)
    v_mfma_f32_16x16x32_bf16 a[8:11], v[32:35], v[64:67], a[8:11]
    v_mfma_f32_16x16x32_bf16 a[12:15], v[32:35], v[68:71], a[12:15]
    ds_read_b64_tr_b16 v[28:29], v16 offset:30976
    ds_read_b64_tr_b16 v[30:31], v16 offset:32256
    s_waitcnt lgkmcnt(12)
    v_mfma_f32_16x16x32_bf16 a[16:19], v[36:39], v[64:67], a[16:19]
    v_mfma_f32_16x16x32_bf16 a[20:23], v[36:39], v[68:71], a[20:23]
    s_barrier
    s_add_u32 m0, s36, 61440
    buffer_load_dwordx4 v9, s[16:19], s35 offen lds
    s_add_u32 m0, s36, 65536
    buffer_load_dwordx4 v10, s[16:19], s35 offen lds
    s_add_u32 m0, s36, 69632
    buffer_load_dwordx4 v11, s[16:19], s35 offen lds
    s_add_u32 m0, s36, 73728
    buffer_load_dwordx4 v12, s[16:19], s35 offen lds
    s_add_u32 m0, s36, 77824
    buffer_load_dwordx4 v13, s[16:19], s35 offen lds
    s_add_u32 s35, s35, 73728
    ds_read_b64_tr_b16 v[32:33], v16 offset:40960
    ds_read_b64_tr_b16 v[34:35], v16 offset:42240
    s_waitcnt lgkmcnt(12)
    v_mfma_f32_16x16x32_bf16 a[24:27], v[40:43], v[64:67], a[24:27]
    v_mfma_f32_16x16x32_bf16 a[28:31], v[40:43], v[68:71], a[28:31]
    ds_read_b64_tr_b16 v[36:37], v17 offset:40992
    ds_read_b64_tr_b16 v[38:39], v17 offset:42272
    s_waitcnt lgkmcnt(12)
    v_mfma_f32_16x16x32_bf16 a[32:35], v[44:47], v[64:67], a[32:35]
    v_mfma_f32_16x16x32_bf16 a[36:39], v[44:47], v[68:71], a[36:39]
    ds_read_b64_tr_b16 v[40:41], v16 offset:41024
    ds_read_b64_tr_b16 v[42:43], v16 offset:42304
    s_waitcnt lgkmcnt(12)
    v_mfma_f32_16x16x32_bf16 a[40:43], v[48:51], v[64:67], a[40:43]
    v_mfma_f32_16x16x32_bf16 a[44:47], v[48:51], v[68:71], a[44:47]
    ds_read_b64_tr_b16 v[44:45], v17 offset:41056
    ds_read_b64_tr_b16 v[46:47], v17 offset:42336
    s_waitcnt lgkmcnt(12)
    v_mfma_f32_16x16x32_bf16 a[48:51], v[52:55], v[64:67], a[48:51]
    v_mfma_f32_16x16x32_bf16 a[52:55], v[52:55], v[68:71], a[52:55]
    ds_read_b64_tr_b16 v[48:49], v16 offset:41088
    ds_read_b64_tr_b16 v[50:51], v16 offset:42368
    s_waitcnt lgkmcnt(12)
    v_mfma_f32_16x16x32_bf16 a[56:59], v[24:27], v[64:67], a[56:59]
    v_mfma_f32_16x16x32_bf16 a[60:63], v[24:27], v[68:71], a[60:63]
    ds_read_b64_tr_b16 v[52:53], v17 offset:41120
    ds_read_b64_tr_b16 v[54:55], v17 offset:42400
    s_waitcnt lgkmcnt(12)
    v_mfma_f32_16x16x32_bf16 a[64:67], v[28:31], v[64:67], a[64:67]
    v_mfma_f32_16x16x32_bf16 a[68:71], v[28:31], v[68:71], a[68:71]
    s_add_u32 s33, s34, 16384
    buffer_load_dwordx4 v[56:59], v18, s[20:23], s33 offen
    s_add_u32 s33, s34, 182272
    buffer_load_dwordx4 v[60:63], v18, s[20:23], s33 offen
    ds_read_b64_tr_b16 v[24:25], v16 offset:41152
    ds_read_b64_tr_b16 v[26:27], v16 offset:42432
    s_waitcnt vmcnt(27)
    s_waitcnt lgkmcnt(12)
    v_mfma_f32_16x16x32_bf16 a[0:3], v[32:35], v[72:75], a[0:3]
    v_mfma_f32_16x16x32_bf16 a[4:7], v[32:35], v[76:79], a[4:7]
    ds_read_b64_tr_b16 v[28:29], v17 offset:41184
    ds_read_b64_tr_b16 v[30:31], v17 offset:42464
    s_waitcnt lgkmcnt(12)
    v_mfma_f32_16x16x32_bf16 a[8:11], v[36:39], v[72:75], a[8:11]
    v_mfma_f32_16x16x32_bf16 a[12:15], v[36:39], v[76:79], a[12:15]
    ds_read_b64_tr_b16 v[32:33], v16 offset:41216
    ds_read_b64_tr_b16 v[34:35], v16 offset:42496
    s_waitcnt lgkmcnt(12)
    v_mfma_f32_16x16x32_bf16 a[16:19], v[40:43], v[72:75], a[16:19]
    v_mfma_f32_16x16x32_bf16 a[20:23], v[40:43], v[76:79], a[20:23]
    ds_read_b64_tr_b16 v[36:37], v16 offset:51200
    ds_read_b64_tr_b16 v[38:39], v16 offset:52480
    s_waitcnt lgkmcnt(12)
    v_mfma_f32_16x16x32_bf16 a[24:27], v[44:47], v[72:75], a[24:27]
    v_mfma_f32_16x16x32_bf16 a[28:31], v[44:47], v[76:79], a[28:31]
    ds_read_b64_tr_b16 v[40:41], v17 offset:51232
    ds_read_b64_tr_b16 v[42:43], v17 offset:52512
    s_waitcnt lgkmcnt(12)
    v_mfma_f32_16x16x32_bf16 a[32:35], v[48:51], v[72:75], a[32:35]
    v_mfma_f32_16x16x32_bf16 a[36:39], v[48:51], v[76:79], a[36:39]
    ds_read_b64_tr_b16 v[44:45], v16 offset:51264
    ds_read_b64_tr_b16 v[46:47], v16 offset:52544
    s_waitcnt lgkmcnt(12)
    v_mfma_f32_16x16x32_bf16 a[40:43], v[52:55], v[72:75], a[40:43]
    v_mfma_f32_16x16x32_bf16 a[44:47], v[52:55], v[76:79], a[44:47]
    ds_read_b64_tr_b16 v[48:49], v17 offset:51296
    ds_read_b64_tr_b16 v[50:51], v17 offset:52576
    s_waitcnt lgkmcnt(12)
    v_mfma_f32_16x16x32_bf16 a[48:51], v[24:27], v[72:75], a[48:51]
    v_mfma_f32_16x16x32_bf16 a[52:55], v[24:27], v[76:79], a[52:55]
    ds_read_b64_tr_b16 v[52:53], v16 offset:51328
    ds_read_b64_tr_b16 v[54:55], v16 offset:52608
    s_waitcnt lgkmcnt(12)
    v_mfma_f32_16x16x32_bf16 a[56:59], v[28:31], v[72:75], a[56:59]
    v_mfma_f32_16x16x32_bf16 a[60:63], v[28:31], v[76:79], a[60:63]
    ds_read_b64_tr_b16 v[24:25], v17 offset:51360
    ds_read_b64_tr_b16 v[26:27], v17 offset:52640
    s_waitcnt lgkmcnt(12)
    v_mfma_f32_16x16x32_bf16 a[64:67], v[32:35], v[72:75], a[64:67]
    v_mfma_f32_16x16x32_bf16 a[68:71], v[32:35], v[76:79], a[68:71]
    s_add_u32 s33, s34, 17408
    buffer_load_dwordx4 v[64:67], v18, s[20:23], s33 offen
    s_add_u32 s33, s34, 183296
    buffer_load_dwordx4 v[68:71], v18, s[20:23], s33 offen
    ds_read_b64_tr_b16 v[28:29], v16 offset:51392
    ds_read_b64_tr_b16 v[30:31], v16 offset:52672
    s_waitcnt vmcnt(27)
    s_waitcnt lgkmcnt(12)
    v_mfma_f32_16x16x32_bf16 a[0:3], v[36:39], v[80:83], a[0:3]
    v_mfma_f32_16x16x32_bf16 a[4:7], v[36:39], v[84:87], a[4:7]
    ds_read_b64_tr_b16 v[32:33], v17 offset:51424
    ds_read_b64_tr_b16 v[34:35], v17 offset:52704
    s_waitcnt lgkmcnt(12)
    v_mfma_f32_16x16x32_bf16 a[8:11], v[40:43], v[80:83], a[8:11]
    v_mfma_f32_16x16x32_bf16 a[12:15], v[40:43], v[84:87], a[12:15]
    ds_read_b64_tr_b16 v[36:37], v16 offset:51456
    ds_read_b64_tr_b16 v[38:39], v16 offset:52736
    s_waitcnt lgkmcnt(12)
    v_mfma_f32_16x16x32_bf16 a[16:19], v[44:47], v[80:83], a[16:19]
    v_mfma_f32_16x16x32_bf16 a[20:23], v[44:47], v[84:87], a[20:23]
    s_barrier
    s_add_u32 m0, s36, 81920
    buffer_load_dwordx4 v9, s[16:19], s35 offen lds
    s_add_u32 m0, s36, 86016
    buffer_load_dwordx4 v10, s[16:19], s35 offen lds
    s_add_u32 m0, s36, 90112
    buffer_load_dwordx4 v11, s[16:19], s35 offen lds
    s_add_u32 m0, s36, 94208
    buffer_load_dwordx4 v12, s[16:19], s35 offen lds
    s_add_u32 m0, s36, 98304
    buffer_load_dwordx4 v13, s[16:19], s35 offen lds
    s_add_u32 s35, s35, 73728
    ds_read_b64_tr_b16 v[40:41], v14 offset:0
    ds_read_b64_tr_b16 v[42:43], v14 offset:1280
    s_waitcnt lgkmcnt(12)
    v_mfma_f32_16x16x32_bf16 a[24:27], v[48:51], v[80:83], a[24:27]
    v_mfma_f32_16x16x32_bf16 a[28:31], v[48:51], v[84:87], a[28:31]
    ds_read_b64_tr_b16 v[44:45], v15 offset:32
    ds_read_b64_tr_b16 v[46:47], v15 offset:1312
    s_waitcnt lgkmcnt(12)
    v_mfma_f32_16x16x32_bf16 a[32:35], v[52:55], v[80:83], a[32:35]
    v_mfma_f32_16x16x32_bf16 a[36:39], v[52:55], v[84:87], a[36:39]
    ds_read_b64_tr_b16 v[48:49], v14 offset:64
    ds_read_b64_tr_b16 v[50:51], v14 offset:1344
    s_waitcnt lgkmcnt(12)
    v_mfma_f32_16x16x32_bf16 a[40:43], v[24:27], v[80:83], a[40:43]
    v_mfma_f32_16x16x32_bf16 a[44:47], v[24:27], v[84:87], a[44:47]
    ds_read_b64_tr_b16 v[52:53], v15 offset:96
    ds_read_b64_tr_b16 v[54:55], v15 offset:1376
    s_waitcnt lgkmcnt(12)
    v_mfma_f32_16x16x32_bf16 a[48:51], v[28:31], v[80:83], a[48:51]
    v_mfma_f32_16x16x32_bf16 a[52:55], v[28:31], v[84:87], a[52:55]
    ds_read_b64_tr_b16 v[24:25], v14 offset:128
    ds_read_b64_tr_b16 v[26:27], v14 offset:1408
    s_waitcnt lgkmcnt(12)
    v_mfma_f32_16x16x32_bf16 a[56:59], v[32:35], v[80:83], a[56:59]
    v_mfma_f32_16x16x32_bf16 a[60:63], v[32:35], v[84:87], a[60:63]
    ds_read_b64_tr_b16 v[28:29], v15 offset:160
    ds_read_b64_tr_b16 v[30:31], v15 offset:1440
    s_waitcnt lgkmcnt(12)
    v_mfma_f32_16x16x32_bf16 a[64:67], v[36:39], v[80:83], a[64:67]
    v_mfma_f32_16x16x32_bf16 a[68:71], v[36:39], v[84:87], a[68:71]
    s_add_u32 s33, s34, 18432
    buffer_load_dwordx4 v[72:75], v18, s[20:23], s33 offen
    s_add_u32 s33, s34, 184320
    buffer_load_dwordx4 v[76:79], v18, s[20:23], s33 offen
    ds_read_b64_tr_b16 v[32:33], v14 offset:192
    ds_read_b64_tr_b16 v[34:35], v14 offset:1472
    s_waitcnt vmcnt(27)
    s_waitcnt lgkmcnt(12)
    v_mfma_f32_16x16x32_bf16 a[0:3], v[40:43], v[88:91], a[0:3]
    v_mfma_f32_16x16x32_bf16 a[4:7], v[40:43], v[92:95], a[4:7]
    ds_read_b64_tr_b16 v[36:37], v15 offset:224
    ds_read_b64_tr_b16 v[38:39], v15 offset:1504
    s_waitcnt lgkmcnt(12)
    v_mfma_f32_16x16x32_bf16 a[8:11], v[44:47], v[88:91], a[8:11]
    v_mfma_f32_16x16x32_bf16 a[12:15], v[44:47], v[92:95], a[12:15]
    ds_read_b64_tr_b16 v[40:41], v14 offset:256
    ds_read_b64_tr_b16 v[42:43], v14 offset:1536
    s_waitcnt lgkmcnt(12)
    v_mfma_f32_16x16x32_bf16 a[16:19], v[48:51], v[88:91], a[16:19]
    v_mfma_f32_16x16x32_bf16 a[20:23], v[48:51], v[92:95], a[20:23]
    ds_read_b64_tr_b16 v[44:45], v14 offset:10240
    ds_read_b64_tr_b16 v[46:47], v14 offset:11520
    s_waitcnt lgkmcnt(12)
    v_mfma_f32_16x16x32_bf16 a[24:27], v[52:55], v[88:91], a[24:27]
    v_mfma_f32_16x16x32_bf16 a[28:31], v[52:55], v[92:95], a[28:31]
    ds_read_b64_tr_b16 v[48:49], v15 offset:10272
    ds_read_b64_tr_b16 v[50:51], v15 offset:11552
    s_waitcnt lgkmcnt(12)
    v_mfma_f32_16x16x32_bf16 a[32:35], v[24:27], v[88:91], a[32:35]
    v_mfma_f32_16x16x32_bf16 a[36:39], v[24:27], v[92:95], a[36:39]
    ds_read_b64_tr_b16 v[52:53], v14 offset:10304
    ds_read_b64_tr_b16 v[54:55], v14 offset:11584
    s_waitcnt lgkmcnt(12)
    v_mfma_f32_16x16x32_bf16 a[40:43], v[28:31], v[88:91], a[40:43]
    v_mfma_f32_16x16x32_bf16 a[44:47], v[28:31], v[92:95], a[44:47]
    ds_read_b64_tr_b16 v[24:25], v15 offset:10336
    ds_read_b64_tr_b16 v[26:27], v15 offset:11616
    s_waitcnt lgkmcnt(12)
    v_mfma_f32_16x16x32_bf16 a[48:51], v[32:35], v[88:91], a[48:51]
    v_mfma_f32_16x16x32_bf16 a[52:55], v[32:35], v[92:95], a[52:55]
    ds_read_b64_tr_b16 v[28:29], v14 offset:10368
    ds_read_b64_tr_b16 v[30:31], v14 offset:11648
    s_waitcnt lgkmcnt(12)
    v_mfma_f32_16x16x32_bf16 a[56:59], v[36:39], v[88:91], a[56:59]
    v_mfma_f32_16x16x32_bf16 a[60:63], v[36:39], v[92:95], a[60:63]
    ds_read_b64_tr_b16 v[32:33], v15 offset:10400
    ds_read_b64_tr_b16 v[34:35], v15 offset:11680
    s_waitcnt lgkmcnt(12)
    v_mfma_f32_16x16x32_bf16 a[64:67], v[40:43], v[88:91], a[64:67]
    v_mfma_f32_16x16x32_bf16 a[68:71], v[40:43], v[92:95], a[68:71]
    s_add_u32 s33, s34, 19456
    buffer_load_dwordx4 v[80:83], v18, s[20:23], s33 offen
    s_add_u32 s33, s34, 185344
    buffer_load_dwordx4 v[84:87], v18, s[20:23], s33 offen
    ds_read_b64_tr_b16 v[36:37], v14 offset:10432
    ds_read_b64_tr_b16 v[38:39], v14 offset:11712
    s_waitcnt vmcnt(27)
    s_waitcnt lgkmcnt(12)
    v_mfma_f32_16x16x32_bf16 a[0:3], v[44:47], v[96:99], a[0:3]
    v_mfma_f32_16x16x32_bf16 a[4:7], v[44:47], v[100:103], a[4:7]
    ds_read_b64_tr_b16 v[40:41], v15 offset:10464
    ds_read_b64_tr_b16 v[42:43], v15 offset:11744
    s_waitcnt lgkmcnt(12)
    v_mfma_f32_16x16x32_bf16 a[8:11], v[48:51], v[96:99], a[8:11]
    v_mfma_f32_16x16x32_bf16 a[12:15], v[48:51], v[100:103], a[12:15]
    ds_read_b64_tr_b16 v[44:45], v14 offset:10496
    ds_read_b64_tr_b16 v[46:47], v14 offset:11776
    s_waitcnt lgkmcnt(12)
    v_mfma_f32_16x16x32_bf16 a[16:19], v[52:55], v[96:99], a[16:19]
    v_mfma_f32_16x16x32_bf16 a[20:23], v[52:55], v[100:103], a[20:23]
    s_barrier
    s_add_u32 m0, s36, 102400
    buffer_load_dwordx4 v9, s[16:19], s35 offen lds
    s_add_u32 m0, s36, 106496
    buffer_load_dwordx4 v10, s[16:19], s35 offen lds
    s_add_u32 m0, s36, 110592
    buffer_load_dwordx4 v11, s[16:19], s35 offen lds
    s_add_u32 m0, s36, 114688
    buffer_load_dwordx4 v12, s[16:19], s35 offen lds
    s_add_u32 m0, s36, 118784
    buffer_load_dwordx4 v13, s[16:19], s35 offen lds
    s_add_u32 s35, s35, 73728
    ds_read_b64_tr_b16 v[48:49], v14 offset:20480
    ds_read_b64_tr_b16 v[50:51], v14 offset:21760
    s_waitcnt lgkmcnt(12)
    v_mfma_f32_16x16x32_bf16 a[24:27], v[24:27], v[96:99], a[24:27]
    v_mfma_f32_16x16x32_bf16 a[28:31], v[24:27], v[100:103], a[28:31]
    ds_read_b64_tr_b16 v[52:53], v15 offset:20512
    ds_read_b64_tr_b16 v[54:55], v15 offset:21792
    s_waitcnt lgkmcnt(12)
    v_mfma_f32_16x16x32_bf16 a[32:35], v[28:31], v[96:99], a[32:35]
    v_mfma_f32_16x16x32_bf16 a[36:39], v[28:31], v[100:103], a[36:39]
    ds_read_b64_tr_b16 v[24:25], v14 offset:20544
    ds_read_b64_tr_b16 v[26:27], v14 offset:21824
    s_waitcnt lgkmcnt(12)
    v_mfma_f32_16x16x32_bf16 a[40:43], v[32:35], v[96:99], a[40:43]
    v_mfma_f32_16x16x32_bf16 a[44:47], v[32:35], v[100:103], a[44:47]
    ds_read_b64_tr_b16 v[28:29], v15 offset:20576
    ds_read_b64_tr_b16 v[30:31], v15 offset:21856
    s_waitcnt lgkmcnt(12)
    v_mfma_f32_16x16x32_bf16 a[48:51], v[36:39], v[96:99], a[48:51]
    v_mfma_f32_16x16x32_bf16 a[52:55], v[36:39], v[100:103], a[52:55]
    ds_read_b64_tr_b16 v[32:33], v14 offset:20608
    ds_read_b64_tr_b16 v[34:35], v14 offset:21888
    s_waitcnt lgkmcnt(12)
    v_mfma_f32_16x16x32_bf16 a[56:59], v[40:43], v[96:99], a[56:59]
    v_mfma_f32_16x16x32_bf16 a[60:63], v[40:43], v[100:103], a[60:63]
    ds_read_b64_tr_b16 v[36:37], v15 offset:20640
    ds_read_b64_tr_b16 v[38:39], v15 offset:21920
    s_waitcnt lgkmcnt(12)
    v_mfma_f32_16x16x32_bf16 a[64:67], v[44:47], v[96:99], a[64:67]
    v_mfma_f32_16x16x32_bf16 a[68:71], v[44:47], v[100:103], a[68:71]
    s_add_u32 s33, s34, 20480
    buffer_load_dwordx4 v[88:91], v18, s[20:23], s33 offen
    s_add_u32 s33, s34, 186368
    buffer_load_dwordx4 v[92:95], v18, s[20:23], s33 offen
    ds_read_b64_tr_b16 v[40:41], v14 offset:20672
    ds_read_b64_tr_b16 v[42:43], v14 offset:21952
    s_waitcnt vmcnt(27)
    s_waitcnt lgkmcnt(12)
    v_mfma_f32_16x16x32_bf16 a[0:3], v[48:51], v[104:107], a[0:3]
    v_mfma_f32_16x16x32_bf16 a[4:7], v[48:51], v[108:111], a[4:7]
    ds_read_b64_tr_b16 v[44:45], v15 offset:20704
    ds_read_b64_tr_b16 v[46:47], v15 offset:21984
    s_waitcnt lgkmcnt(12)
    v_mfma_f32_16x16x32_bf16 a[8:11], v[52:55], v[104:107], a[8:11]
    v_mfma_f32_16x16x32_bf16 a[12:15], v[52:55], v[108:111], a[12:15]
    ds_read_b64_tr_b16 v[48:49], v14 offset:20736
    ds_read_b64_tr_b16 v[50:51], v14 offset:22016
    s_waitcnt lgkmcnt(12)
    v_mfma_f32_16x16x32_bf16 a[16:19], v[24:27], v[104:107], a[16:19]
    v_mfma_f32_16x16x32_bf16 a[20:23], v[24:27], v[108:111], a[20:23]
    ds_read_b64_tr_b16 v[52:53], v14 offset:30720
    ds_read_b64_tr_b16 v[54:55], v14 offset:32000
    s_waitcnt lgkmcnt(12)
    v_mfma_f32_16x16x32_bf16 a[24:27], v[28:31], v[104:107], a[24:27]
    v_mfma_f32_16x16x32_bf16 a[28:31], v[28:31], v[108:111], a[28:31]
    ds_read_b64_tr_b16 v[24:25], v15 offset:30752
    ds_read_b64_tr_b16 v[26:27], v15 offset:32032
    s_waitcnt lgkmcnt(12)
    v_mfma_f32_16x16x32_bf16 a[32:35], v[32:35], v[104:107], a[32:35]
    v_mfma_f32_16x16x32_bf16 a[36:39], v[32:35], v[108:111], a[36:39]
    ds_read_b64_tr_b16 v[28:29], v14 offset:30784
    ds_read_b64_tr_b16 v[30:31], v14 offset:32064
    s_waitcnt lgkmcnt(12)
    v_mfma_f32_16x16x32_bf16 a[40:43], v[36:39], v[104:107], a[40:43]
    v_mfma_f32_16x16x32_bf16 a[44:47], v[36:39], v[108:111], a[44:47]
    ds_read_b64_tr_b16 v[32:33], v15 offset:30816
    ds_read_b64_tr_b16 v[34:35], v15 offset:32096
    s_waitcnt lgkmcnt(12)
    v_mfma_f32_16x16x32_bf16 a[48:51], v[40:43], v[104:107], a[48:51]
    v_mfma_f32_16x16x32_bf16 a[52:55], v[40:43], v[108:111], a[52:55]
    ds_read_b64_tr_b16 v[36:37], v14 offset:30848
    ds_read_b64_tr_b16 v[38:39], v14 offset:32128
    s_waitcnt lgkmcnt(12)
    v_mfma_f32_16x16x32_bf16 a[56:59], v[44:47], v[104:107], a[56:59]
    v_mfma_f32_16x16x32_bf16 a[60:63], v[44:47], v[108:111], a[60:63]
    ds_read_b64_tr_b16 v[40:41], v15 offset:30880
    ds_read_b64_tr_b16 v[42:43], v15 offset:32160
    s_waitcnt lgkmcnt(12)
    v_mfma_f32_16x16x32_bf16 a[64:67], v[48:51], v[104:107], a[64:67]
    v_mfma_f32_16x16x32_bf16 a[68:71], v[48:51], v[108:111], a[68:71]
    s_add_u32 s33, s34, 21504
    buffer_load_dwordx4 v[96:99], v18, s[20:23], s33 offen
    s_add_u32 s33, s34, 187392
    buffer_load_dwordx4 v[100:103], v18, s[20:23], s33 offen
    ds_read_b64_tr_b16 v[44:45], v14 offset:30912
    ds_read_b64_tr_b16 v[46:47], v14 offset:32192
    s_waitcnt vmcnt(27)
    s_waitcnt lgkmcnt(12)
    v_mfma_f32_16x16x32_bf16 a[0:3], v[52:55], v[112:115], a[0:3]
    v_mfma_f32_16x16x32_bf16 a[4:7], v[52:55], v[116:119], a[4:7]
    ds_read_b64_tr_b16 v[48:49], v15 offset:30944
    ds_read_b64_tr_b16 v[50:51], v15 offset:32224
    s_waitcnt lgkmcnt(12)
    v_mfma_f32_16x16x32_bf16 a[8:11], v[24:27], v[112:115], a[8:11]
    v_mfma_f32_16x16x32_bf16 a[12:15], v[24:27], v[116:119], a[12:15]
    ds_read_b64_tr_b16 v[52:53], v14 offset:30976
    ds_read_b64_tr_b16 v[54:55], v14 offset:32256
    s_waitcnt lgkmcnt(12)
    v_mfma_f32_16x16x32_bf16 a[16:19], v[28:31], v[112:115], a[16:19]
    v_mfma_f32_16x16x32_bf16 a[20:23], v[28:31], v[116:119], a[20:23]
    s_barrier
    s_add_u32 m0, s36, 0
    buffer_load_dwordx4 v9, s[16:19], s35 offen lds
    s_add_u32 m0, s36, 4096
    buffer_load_dwordx4 v10, s[16:19], s35 offen lds
    s_add_u32 m0, s36, 8192
    buffer_load_dwordx4 v11, s[16:19], s35 offen lds
    s_add_u32 m0, s36, 12288
    buffer_load_dwordx4 v12, s[16:19], s35 offen lds
    s_add_u32 m0, s36, 16384
    buffer_load_dwordx4 v13, s[16:19], s35 offen lds
    s_add_u32 s35, s35, 73728
    ds_read_b64_tr_b16 v[24:25], v14 offset:40960
    ds_read_b64_tr_b16 v[26:27], v14 offset:42240
    s_waitcnt lgkmcnt(12)
    v_mfma_f32_16x16x32_bf16 a[24:27], v[32:35], v[112:115], a[24:27]
    v_mfma_f32_16x16x32_bf16 a[28:31], v[32:35], v[116:119], a[28:31]
    ds_read_b64_tr_b16 v[28:29], v15 offset:40992
    ds_read_b64_tr_b16 v[30:31], v15 offset:42272
    s_waitcnt lgkmcnt(12)
    v_mfma_f32_16x16x32_bf16 a[32:35], v[36:39], v[112:115], a[32:35]
    v_mfma_f32_16x16x32_bf16 a[36:39], v[36:39], v[116:119], a[36:39]
    ds_read_b64_tr_b16 v[32:33], v14 offset:41024
    ds_read_b64_tr_b16 v[34:35], v14 offset:42304
    s_waitcnt lgkmcnt(12)
    v_mfma_f32_16x16x32_bf16 a[40:43], v[40:43], v[112:115], a[40:43]
    v_mfma_f32_16x16x32_bf16 a[44:47], v[40:43], v[116:119], a[44:47]
    ds_read_b64_tr_b16 v[36:37], v15 offset:41056
    ds_read_b64_tr_b16 v[38:39], v15 offset:42336
    s_waitcnt lgkmcnt(12)
    v_mfma_f32_16x16x32_bf16 a[48:51], v[44:47], v[112:115], a[48:51]
    v_mfma_f32_16x16x32_bf16 a[52:55], v[44:47], v[116:119], a[52:55]
    ds_read_b64_tr_b16 v[40:41], v14 offset:41088
    ds_read_b64_tr_b16 v[42:43], v14 offset:42368
    s_waitcnt lgkmcnt(12)
    v_mfma_f32_16x16x32_bf16 a[56:59], v[48:51], v[112:115], a[56:59]
    v_mfma_f32_16x16x32_bf16 a[60:63], v[48:51], v[116:119], a[60:63]
    ds_read_b64_tr_b16 v[44:45], v15 offset:41120
    ds_read_b64_tr_b16 v[46:47], v15 offset:42400
    s_waitcnt lgkmcnt(12)
    v_mfma_f32_16x16x32_bf16 a[64:67], v[52:55], v[112:115], a[64:67]
    v_mfma_f32_16x16x32_bf16 a[68:71], v[52:55], v[116:119], a[68:71]
    s_add_u32 s33, s34, 22528
    buffer_load_dwordx4 v[104:107], v18, s[20:23], s33 offen
    s_add_u32 s33, s34, 188416
    buffer_load_dwordx4 v[108:111], v18, s[20:23], s33 offen
    ds_read_b64_tr_b16 v[48:49], v14 offset:41152
    ds_read_b64_tr_b16 v[50:51], v14 offset:42432
    s_waitcnt vmcnt(27)
    s_waitcnt lgkmcnt(12)
    v_mfma_f32_16x16x32_bf16 a[0:3], v[24:27], v[56:59], a[0:3]
    v_mfma_f32_16x16x32_bf16 a[4:7], v[24:27], v[60:63], a[4:7]
    ds_read_b64_tr_b16 v[52:53], v15 offset:41184
    ds_read_b64_tr_b16 v[54:55], v15 offset:42464
    s_waitcnt lgkmcnt(12)
    v_mfma_f32_16x16x32_bf16 a[8:11], v[28:31], v[56:59], a[8:11]
    v_mfma_f32_16x16x32_bf16 a[12:15], v[28:31], v[60:63], a[12:15]
    ds_read_b64_tr_b16 v[24:25], v14 offset:41216
    ds_read_b64_tr_b16 v[26:27], v14 offset:42496
    s_waitcnt lgkmcnt(12)
    v_mfma_f32_16x16x32_bf16 a[16:19], v[32:35], v[56:59], a[16:19]
    v_mfma_f32_16x16x32_bf16 a[20:23], v[32:35], v[60:63], a[20:23]
    ds_read_b64_tr_b16 v[28:29], v14 offset:51200
    ds_read_b64_tr_b16 v[30:31], v14 offset:52480
    s_waitcnt lgkmcnt(12)
    v_mfma_f32_16x16x32_bf16 a[24:27], v[36:39], v[56:59], a[24:27]
    v_mfma_f32_16x16x32_bf16 a[28:31], v[36:39], v[60:63], a[28:31]
    ds_read_b64_tr_b16 v[32:33], v15 offset:51232
    ds_read_b64_tr_b16 v[34:35], v15 offset:52512
    s_waitcnt lgkmcnt(12)
    v_mfma_f32_16x16x32_bf16 a[32:35], v[40:43], v[56:59], a[32:35]
    v_mfma_f32_16x16x32_bf16 a[36:39], v[40:43], v[60:63], a[36:39]
    ds_read_b64_tr_b16 v[36:37], v14 offset:51264
    ds_read_b64_tr_b16 v[38:39], v14 offset:52544
    s_waitcnt lgkmcnt(12)
    v_mfma_f32_16x16x32_bf16 a[40:43], v[44:47], v[56:59], a[40:43]
    v_mfma_f32_16x16x32_bf16 a[44:47], v[44:47], v[60:63], a[44:47]
    ds_read_b64_tr_b16 v[40:41], v15 offset:51296
    ds_read_b64_tr_b16 v[42:43], v15 offset:52576
    s_waitcnt lgkmcnt(12)
    v_mfma_f32_16x16x32_bf16 a[48:51], v[48:51], v[56:59], a[48:51]
    v_mfma_f32_16x16x32_bf16 a[52:55], v[48:51], v[60:63], a[52:55]
    ds_read_b64_tr_b16 v[44:45], v14 offset:51328
    ds_read_b64_tr_b16 v[46:47], v14 offset:52608
    s_waitcnt lgkmcnt(12)
    v_mfma_f32_16x16x32_bf16 a[56:59], v[52:55], v[56:59], a[56:59]
    v_mfma_f32_16x16x32_bf16 a[60:63], v[52:55], v[60:63], a[60:63]
    ds_read_b64_tr_b16 v[48:49], v15 offset:51360
    ds_read_b64_tr_b16 v[50:51], v15 offset:52640
    s_waitcnt lgkmcnt(12)
    v_mfma_f32_16x16x32_bf16 a[64:67], v[24:27], v[56:59], a[64:67]
    v_mfma_f32_16x16x32_bf16 a[68:71], v[24:27], v[60:63], a[68:71]
    s_add_u32 s33, s34, 23552
    buffer_load_dwordx4 v[112:115], v18, s[20:23], s33 offen
    s_add_u32 s33, s34, 189440
    buffer_load_dwordx4 v[116:119], v18, s[20:23], s33 offen
    ds_read_b64_tr_b16 v[52:53], v14 offset:51392
    ds_read_b64_tr_b16 v[54:55], v14 offset:52672
    s_waitcnt vmcnt(27)
    s_waitcnt lgkmcnt(12)
    v_mfma_f32_16x16x32_bf16 a[0:3], v[28:31], v[64:67], a[0:3]
    v_mfma_f32_16x16x32_bf16 a[4:7], v[28:31], v[68:71], a[4:7]
    ds_read_b64_tr_b16 v[24:25], v15 offset:51424
    ds_read_b64_tr_b16 v[26:27], v15 offset:52704
    s_waitcnt lgkmcnt(12)
    v_mfma_f32_16x16x32_bf16 a[8:11], v[32:35], v[64:67], a[8:11]
    v_mfma_f32_16x16x32_bf16 a[12:15], v[32:35], v[68:71], a[12:15]
    ds_read_b64_tr_b16 v[28:29], v14 offset:51456
    ds_read_b64_tr_b16 v[30:31], v14 offset:52736
    s_waitcnt lgkmcnt(12)
    v_mfma_f32_16x16x32_bf16 a[16:19], v[36:39], v[64:67], a[16:19]
    v_mfma_f32_16x16x32_bf16 a[20:23], v[36:39], v[68:71], a[20:23]
    s_barrier
    s_add_u32 m0, s36, 20480
    buffer_load_dwordx4 v9, s[16:19], s35 offen lds
    s_add_u32 m0, s36, 24576
    buffer_load_dwordx4 v10, s[16:19], s35 offen lds
    s_add_u32 m0, s36, 28672
    buffer_load_dwordx4 v11, s[16:19], s35 offen lds
    s_add_u32 m0, s36, 32768
    buffer_load_dwordx4 v12, s[16:19], s35 offen lds
    s_add_u32 m0, s36, 36864
    buffer_load_dwordx4 v13, s[16:19], s35 offen lds
    s_add_u32 s35, s35, 73728
    ds_read_b64_tr_b16 v[32:33], v16 offset:0
    ds_read_b64_tr_b16 v[34:35], v16 offset:1280
    s_waitcnt lgkmcnt(12)
    v_mfma_f32_16x16x32_bf16 a[24:27], v[40:43], v[64:67], a[24:27]
    v_mfma_f32_16x16x32_bf16 a[28:31], v[40:43], v[68:71], a[28:31]
    ds_read_b64_tr_b16 v[36:37], v17 offset:32
    ds_read_b64_tr_b16 v[38:39], v17 offset:1312
    s_waitcnt lgkmcnt(12)
    v_mfma_f32_16x16x32_bf16 a[32:35], v[44:47], v[64:67], a[32:35]
    v_mfma_f32_16x16x32_bf16 a[36:39], v[44:47], v[68:71], a[36:39]
    ds_read_b64_tr_b16 v[40:41], v16 offset:64
    ds_read_b64_tr_b16 v[42:43], v16 offset:1344
    s_waitcnt lgkmcnt(12)
    v_mfma_f32_16x16x32_bf16 a[40:43], v[48:51], v[64:67], a[40:43]
    v_mfma_f32_16x16x32_bf16 a[44:47], v[48:51], v[68:71], a[44:47]
    ds_read_b64_tr_b16 v[44:45], v17 offset:96
    ds_read_b64_tr_b16 v[46:47], v17 offset:1376
    s_waitcnt lgkmcnt(12)
    v_mfma_f32_16x16x32_bf16 a[48:51], v[52:55], v[64:67], a[48:51]
    v_mfma_f32_16x16x32_bf16 a[52:55], v[52:55], v[68:71], a[52:55]
    ds_read_b64_tr_b16 v[48:49], v16 offset:128
    ds_read_b64_tr_b16 v[50:51], v16 offset:1408
    s_waitcnt lgkmcnt(12)
    v_mfma_f32_16x16x32_bf16 a[56:59], v[24:27], v[64:67], a[56:59]
    v_mfma_f32_16x16x32_bf16 a[60:63], v[24:27], v[68:71], a[60:63]
    ds_read_b64_tr_b16 v[52:53], v17 offset:160
    ds_read_b64_tr_b16 v[54:55], v17 offset:1440
    s_waitcnt lgkmcnt(12)
    v_mfma_f32_16x16x32_bf16 a[64:67], v[28:31], v[64:67], a[64:67]
    v_mfma_f32_16x16x32_bf16 a[68:71], v[28:31], v[68:71], a[68:71]
    s_add_u32 s33, s34, 24576
    buffer_load_dwordx4 v[56:59], v18, s[20:23], s33 offen
    s_add_u32 s33, s34, 190464
    buffer_load_dwordx4 v[60:63], v18, s[20:23], s33 offen
    ds_read_b64_tr_b16 v[24:25], v16 offset:192
    ds_read_b64_tr_b16 v[26:27], v16 offset:1472
    s_waitcnt vmcnt(27)
    s_waitcnt lgkmcnt(12)
    v_mfma_f32_16x16x32_bf16 a[0:3], v[32:35], v[72:75], a[0:3]
    v_mfma_f32_16x16x32_bf16 a[4:7], v[32:35], v[76:79], a[4:7]
    ds_read_b64_tr_b16 v[28:29], v17 offset:224
    ds_read_b64_tr_b16 v[30:31], v17 offset:1504
    s_waitcnt lgkmcnt(12)
    v_mfma_f32_16x16x32_bf16 a[8:11], v[36:39], v[72:75], a[8:11]
    v_mfma_f32_16x16x32_bf16 a[12:15], v[36:39], v[76:79], a[12:15]
    ds_read_b64_tr_b16 v[32:33], v16 offset:256
    ds_read_b64_tr_b16 v[34:35], v16 offset:1536
    s_waitcnt lgkmcnt(12)
    v_mfma_f32_16x16x32_bf16 a[16:19], v[40:43], v[72:75], a[16:19]
    v_mfma_f32_16x16x32_bf16 a[20:23], v[40:43], v[76:79], a[20:23]
    ds_read_b64_tr_b16 v[36:37], v16 offset:10240
    ds_read_b64_tr_b16 v[38:39], v16 offset:11520
    s_waitcnt lgkmcnt(12)
    v_mfma_f32_16x16x32_bf16 a[24:27], v[44:47], v[72:75], a[24:27]
    v_mfma_f32_16x16x32_bf16 a[28:31], v[44:47], v[76:79], a[28:31]
    ds_read_b64_tr_b16 v[40:41], v17 offset:10272
    ds_read_b64_tr_b16 v[42:43], v17 offset:11552
    s_waitcnt lgkmcnt(12)
    v_mfma_f32_16x16x32_bf16 a[32:35], v[48:51], v[72:75], a[32:35]
    v_mfma_f32_16x16x32_bf16 a[36:39], v[48:51], v[76:79], a[36:39]
    ds_read_b64_tr_b16 v[44:45], v16 offset:10304
    ds_read_b64_tr_b16 v[46:47], v16 offset:11584
    s_waitcnt lgkmcnt(12)
    v_mfma_f32_16x16x32_bf16 a[40:43], v[52:55], v[72:75], a[40:43]
    v_mfma_f32_16x16x32_bf16 a[44:47], v[52:55], v[76:79], a[44:47]
    ds_read_b64_tr_b16 v[48:49], v17 offset:10336
    ds_read_b64_tr_b16 v[50:51], v17 offset:11616
    s_waitcnt lgkmcnt(12)
    v_mfma_f32_16x16x32_bf16 a[48:51], v[24:27], v[72:75], a[48:51]
    v_mfma_f32_16x16x32_bf16 a[52:55], v[24:27], v[76:79], a[52:55]
    ds_read_b64_tr_b16 v[52:53], v16 offset:10368
    ds_read_b64_tr_b16 v[54:55], v16 offset:11648
    s_waitcnt lgkmcnt(12)
    v_mfma_f32_16x16x32_bf16 a[56:59], v[28:31], v[72:75], a[56:59]
    v_mfma_f32_16x16x32_bf16 a[60:63], v[28:31], v[76:79], a[60:63]
    ds_read_b64_tr_b16 v[24:25], v17 offset:10400
    ds_read_b64_tr_b16 v[26:27], v17 offset:11680
    s_waitcnt lgkmcnt(12)
    v_mfma_f32_16x16x32_bf16 a[64:67], v[32:35], v[72:75], a[64:67]
    v_mfma_f32_16x16x32_bf16 a[68:71], v[32:35], v[76:79], a[68:71]
    s_add_u32 s33, s34, 25600
    buffer_load_dwordx4 v[64:67], v18, s[20:23], s33 offen
    s_add_u32 s33, s34, 191488
    buffer_load_dwordx4 v[68:71], v18, s[20:23], s33 offen
    ds_read_b64_tr_b16 v[28:29], v16 offset:10432
    ds_read_b64_tr_b16 v[30:31], v16 offset:11712
    s_waitcnt vmcnt(27)
    s_waitcnt lgkmcnt(12)
    v_mfma_f32_16x16x32_bf16 a[0:3], v[36:39], v[80:83], a[0:3]
    v_mfma_f32_16x16x32_bf16 a[4:7], v[36:39], v[84:87], a[4:7]
    ds_read_b64_tr_b16 v[32:33], v17 offset:10464
    ds_read_b64_tr_b16 v[34:35], v17 offset:11744
    s_waitcnt lgkmcnt(12)
    v_mfma_f32_16x16x32_bf16 a[8:11], v[40:43], v[80:83], a[8:11]
    v_mfma_f32_16x16x32_bf16 a[12:15], v[40:43], v[84:87], a[12:15]
    ds_read_b64_tr_b16 v[36:37], v16 offset:10496
    ds_read_b64_tr_b16 v[38:39], v16 offset:11776
    s_waitcnt lgkmcnt(12)
    v_mfma_f32_16x16x32_bf16 a[16:19], v[44:47], v[80:83], a[16:19]
    v_mfma_f32_16x16x32_bf16 a[20:23], v[44:47], v[84:87], a[20:23]
    s_barrier
    s_add_u32 m0, s36, 40960
    buffer_load_dwordx4 v9, s[16:19], s35 offen lds
    s_add_u32 m0, s36, 45056
    buffer_load_dwordx4 v10, s[16:19], s35 offen lds
    s_add_u32 m0, s36, 49152
    buffer_load_dwordx4 v11, s[16:19], s35 offen lds
    s_add_u32 m0, s36, 53248
    buffer_load_dwordx4 v12, s[16:19], s35 offen lds
    s_add_u32 m0, s36, 57344
    buffer_load_dwordx4 v13, s[16:19], s35 offen lds
    s_add_u32 s35, s35, 73728
    ds_read_b64_tr_b16 v[40:41], v16 offset:20480
    ds_read_b64_tr_b16 v[42:43], v16 offset:21760
    s_waitcnt lgkmcnt(12)
    v_mfma_f32_16x16x32_bf16 a[24:27], v[48:51], v[80:83], a[24:27]
    v_mfma_f32_16x16x32_bf16 a[28:31], v[48:51], v[84:87], a[28:31]
    ds_read_b64_tr_b16 v[44:45], v17 offset:20512
    ds_read_b64_tr_b16 v[46:47], v17 offset:21792
    s_waitcnt lgkmcnt(12)
    v_mfma_f32_16x16x32_bf16 a[32:35], v[52:55], v[80:83], a[32:35]
    v_mfma_f32_16x16x32_bf16 a[36:39], v[52:55], v[84:87], a[36:39]
    ds_read_b64_tr_b16 v[48:49], v16 offset:20544
    ds_read_b64_tr_b16 v[50:51], v16 offset:21824
    s_waitcnt lgkmcnt(12)
    v_mfma_f32_16x16x32_bf16 a[40:43], v[24:27], v[80:83], a[40:43]
    v_mfma_f32_16x16x32_bf16 a[44:47], v[24:27], v[84:87], a[44:47]
    ds_read_b64_tr_b16 v[52:53], v17 offset:20576
    ds_read_b64_tr_b16 v[54:55], v17 offset:21856
    s_waitcnt lgkmcnt(12)
    v_mfma_f32_16x16x32_bf16 a[48:51], v[28:31], v[80:83], a[48:51]
    v_mfma_f32_16x16x32_bf16 a[52:55], v[28:31], v[84:87], a[52:55]
    ds_read_b64_tr_b16 v[24:25], v16 offset:20608
    ds_read_b64_tr_b16 v[26:27], v16 offset:21888
    s_waitcnt lgkmcnt(12)
    v_mfma_f32_16x16x32_bf16 a[56:59], v[32:35], v[80:83], a[56:59]
    v_mfma_f32_16x16x32_bf16 a[60:63], v[32:35], v[84:87], a[60:63]
    ds_read_b64_tr_b16 v[28:29], v17 offset:20640
    ds_read_b64_tr_b16 v[30:31], v17 offset:21920
    s_waitcnt lgkmcnt(12)
    v_mfma_f32_16x16x32_bf16 a[64:67], v[36:39], v[80:83], a[64:67]
    v_mfma_f32_16x16x32_bf16 a[68:71], v[36:39], v[84:87], a[68:71]
    s_add_u32 s33, s34, 26624
    buffer_load_dwordx4 v[72:75], v18, s[20:23], s33 offen
    s_add_u32 s33, s34, 192512
    buffer_load_dwordx4 v[76:79], v18, s[20:23], s33 offen
    ds_read_b64_tr_b16 v[32:33], v16 offset:20672
    ds_read_b64_tr_b16 v[34:35], v16 offset:21952
    s_waitcnt vmcnt(27)
    s_waitcnt lgkmcnt(12)
    v_mfma_f32_16x16x32_bf16 a[0:3], v[40:43], v[88:91], a[0:3]
    v_mfma_f32_16x16x32_bf16 a[4:7], v[40:43], v[92:95], a[4:7]
    ds_read_b64_tr_b16 v[36:37], v17 offset:20704
    ds_read_b64_tr_b16 v[38:39], v17 offset:21984
    s_waitcnt lgkmcnt(12)
    v_mfma_f32_16x16x32_bf16 a[8:11], v[44:47], v[88:91], a[8:11]
    v_mfma_f32_16x16x32_bf16 a[12:15], v[44:47], v[92:95], a[12:15]
    ds_read_b64_tr_b16 v[40:41], v16 offset:20736
    ds_read_b64_tr_b16 v[42:43], v16 offset:22016
    s_waitcnt lgkmcnt(12)
    v_mfma_f32_16x16x32_bf16 a[16:19], v[48:51], v[88:91], a[16:19]
    v_mfma_f32_16x16x32_bf16 a[20:23], v[48:51], v[92:95], a[20:23]
    ds_read_b64_tr_b16 v[44:45], v16 offset:30720
    ds_read_b64_tr_b16 v[46:47], v16 offset:32000
    s_waitcnt lgkmcnt(12)
    v_mfma_f32_16x16x32_bf16 a[24:27], v[52:55], v[88:91], a[24:27]
    v_mfma_f32_16x16x32_bf16 a[28:31], v[52:55], v[92:95], a[28:31]
    ds_read_b64_tr_b16 v[48:49], v17 offset:30752
    ds_read_b64_tr_b16 v[50:51], v17 offset:32032
    s_waitcnt lgkmcnt(12)
    v_mfma_f32_16x16x32_bf16 a[32:35], v[24:27], v[88:91], a[32:35]
    v_mfma_f32_16x16x32_bf16 a[36:39], v[24:27], v[92:95], a[36:39]
    ds_read_b64_tr_b16 v[52:53], v16 offset:30784
    ds_read_b64_tr_b16 v[54:55], v16 offset:32064
    s_waitcnt lgkmcnt(12)
    v_mfma_f32_16x16x32_bf16 a[40:43], v[28:31], v[88:91], a[40:43]
    v_mfma_f32_16x16x32_bf16 a[44:47], v[28:31], v[92:95], a[44:47]
    ds_read_b64_tr_b16 v[24:25], v17 offset:30816
    ds_read_b64_tr_b16 v[26:27], v17 offset:32096
    s_waitcnt lgkmcnt(12)
    v_mfma_f32_16x16x32_bf16 a[48:51], v[32:35], v[88:91], a[48:51]
    v_mfma_f32_16x16x32_bf16 a[52:55], v[32:35], v[92:95], a[52:55]
    ds_read_b64_tr_b16 v[28:29], v16 offset:30848
    ds_read_b64_tr_b16 v[30:31], v16 offset:32128
    s_waitcnt lgkmcnt(12)
    v_mfma_f32_16x16x32_bf16 a[56:59], v[36:39], v[88:91], a[56:59]
    v_mfma_f32_16x16x32_bf16 a[60:63], v[36:39], v[92:95], a[60:63]
    ds_read_b64_tr_b16 v[32:33], v17 offset:30880
    ds_read_b64_tr_b16 v[34:35], v17 offset:32160
    s_waitcnt lgkmcnt(12)
    v_mfma_f32_16x16x32_bf16 a[64:67], v[40:43], v[88:91], a[64:67]
    v_mfma_f32_16x16x32_bf16 a[68:71], v[40:43], v[92:95], a[68:71]
    s_add_u32 s33, s34, 27648
    buffer_load_dwordx4 v[80:83], v18, s[20:23], s33 offen
    s_add_u32 s33, s34, 193536
    buffer_load_dwordx4 v[84:87], v18, s[20:23], s33 offen
    ds_read_b64_tr_b16 v[36:37], v16 offset:30912
    ds_read_b64_tr_b16 v[38:39], v16 offset:32192
    s_waitcnt vmcnt(27)
    s_waitcnt lgkmcnt(12)
    v_mfma_f32_16x16x32_bf16 a[0:3], v[44:47], v[96:99], a[0:3]
    v_mfma_f32_16x16x32_bf16 a[4:7], v[44:47], v[100:103], a[4:7]
    ds_read_b64_tr_b16 v[40:41], v17 offset:30944
    ds_read_b64_tr_b16 v[42:43], v17 offset:32224
    s_waitcnt lgkmcnt(12)
    v_mfma_f32_16x16x32_bf16 a[8:11], v[48:51], v[96:99], a[8:11]
    v_mfma_f32_16x16x32_bf16 a[12:15], v[48:51], v[100:103], a[12:15]
    ds_read_b64_tr_b16 v[44:45], v16 offset:30976
    ds_read_b64_tr_b16 v[46:47], v16 offset:32256
    s_waitcnt lgkmcnt(12)
    v_mfma_f32_16x16x32_bf16 a[16:19], v[52:55], v[96:99], a[16:19]
    v_mfma_f32_16x16x32_bf16 a[20:23], v[52:55], v[100:103], a[20:23]
    s_barrier
    s_add_u32 m0, s36, 61440
    buffer_load_dwordx4 v9, s[16:19], s35 offen lds
    s_add_u32 m0, s36, 65536
    buffer_load_dwordx4 v10, s[16:19], s35 offen lds
    s_add_u32 m0, s36, 69632
    buffer_load_dwordx4 v11, s[16:19], s35 offen lds
    s_add_u32 m0, s36, 73728
    buffer_load_dwordx4 v12, s[16:19], s35 offen lds
    s_add_u32 m0, s36, 77824
    buffer_load_dwordx4 v13, s[16:19], s35 offen lds
    s_add_u32 s35, s35, 73728
    ds_read_b64_tr_b16 v[48:49], v16 offset:40960
    ds_read_b64_tr_b16 v[50:51], v16 offset:42240
    s_waitcnt lgkmcnt(12)
    v_mfma_f32_16x16x32_bf16 a[24:27], v[24:27], v[96:99], a[24:27]
    v_mfma_f32_16x16x32_bf16 a[28:31], v[24:27], v[100:103], a[28:31]
    ds_read_b64_tr_b16 v[52:53], v17 offset:40992
    ds_read_b64_tr_b16 v[54:55], v17 offset:42272
    s_waitcnt lgkmcnt(12)
    v_mfma_f32_16x16x32_bf16 a[32:35], v[28:31], v[96:99], a[32:35]
    v_mfma_f32_16x16x32_bf16 a[36:39], v[28:31], v[100:103], a[36:39]
    ds_read_b64_tr_b16 v[24:25], v16 offset:41024
    ds_read_b64_tr_b16 v[26:27], v16 offset:42304
    s_waitcnt lgkmcnt(12)
    v_mfma_f32_16x16x32_bf16 a[40:43], v[32:35], v[96:99], a[40:43]
    v_mfma_f32_16x16x32_bf16 a[44:47], v[32:35], v[100:103], a[44:47]
    ds_read_b64_tr_b16 v[28:29], v17 offset:41056
    ds_read_b64_tr_b16 v[30:31], v17 offset:42336
    s_waitcnt lgkmcnt(12)
    v_mfma_f32_16x16x32_bf16 a[48:51], v[36:39], v[96:99], a[48:51]
    v_mfma_f32_16x16x32_bf16 a[52:55], v[36:39], v[100:103], a[52:55]
    ds_read_b64_tr_b16 v[32:33], v16 offset:41088
    ds_read_b64_tr_b16 v[34:35], v16 offset:42368
    s_waitcnt lgkmcnt(12)
    v_mfma_f32_16x16x32_bf16 a[56:59], v[40:43], v[96:99], a[56:59]
    v_mfma_f32_16x16x32_bf16 a[60:63], v[40:43], v[100:103], a[60:63]
    ds_read_b64_tr_b16 v[36:37], v17 offset:41120
    ds_read_b64_tr_b16 v[38:39], v17 offset:42400
    s_waitcnt lgkmcnt(12)
    v_mfma_f32_16x16x32_bf16 a[64:67], v[44:47], v[96:99], a[64:67]
    v_mfma_f32_16x16x32_bf16 a[68:71], v[44:47], v[100:103], a[68:71]
    s_add_u32 s33, s34, 28672
    buffer_load_dwordx4 v[88:91], v18, s[20:23], s33 offen
    s_add_u32 s33, s34, 194560
    buffer_load_dwordx4 v[92:95], v18, s[20:23], s33 offen
    ds_read_b64_tr_b16 v[40:41], v16 offset:41152
    ds_read_b64_tr_b16 v[42:43], v16 offset:42432
    s_waitcnt vmcnt(27)
    s_waitcnt lgkmcnt(12)
    v_mfma_f32_16x16x32_bf16 a[0:3], v[48:51], v[104:107], a[0:3]
    v_mfma_f32_16x16x32_bf16 a[4:7], v[48:51], v[108:111], a[4:7]
    ds_read_b64_tr_b16 v[44:45], v17 offset:41184
    ds_read_b64_tr_b16 v[46:47], v17 offset:42464
    s_waitcnt lgkmcnt(12)
    v_mfma_f32_16x16x32_bf16 a[8:11], v[52:55], v[104:107], a[8:11]
    v_mfma_f32_16x16x32_bf16 a[12:15], v[52:55], v[108:111], a[12:15]
    ds_read_b64_tr_b16 v[48:49], v16 offset:41216
    ds_read_b64_tr_b16 v[50:51], v16 offset:42496
    s_waitcnt lgkmcnt(12)
    v_mfma_f32_16x16x32_bf16 a[16:19], v[24:27], v[104:107], a[16:19]
    v_mfma_f32_16x16x32_bf16 a[20:23], v[24:27], v[108:111], a[20:23]
    ds_read_b64_tr_b16 v[52:53], v16 offset:51200
    ds_read_b64_tr_b16 v[54:55], v16 offset:52480
    s_waitcnt lgkmcnt(12)
    v_mfma_f32_16x16x32_bf16 a[24:27], v[28:31], v[104:107], a[24:27]
    v_mfma_f32_16x16x32_bf16 a[28:31], v[28:31], v[108:111], a[28:31]
    ds_read_b64_tr_b16 v[24:25], v17 offset:51232
    ds_read_b64_tr_b16 v[26:27], v17 offset:52512
    s_waitcnt lgkmcnt(12)
    v_mfma_f32_16x16x32_bf16 a[32:35], v[32:35], v[104:107], a[32:35]
    v_mfma_f32_16x16x32_bf16 a[36:39], v[32:35], v[108:111], a[36:39]
    ds_read_b64_tr_b16 v[28:29], v16 offset:51264
    ds_read_b64_tr_b16 v[30:31], v16 offset:52544
    s_waitcnt lgkmcnt(12)
    v_mfma_f32_16x16x32_bf16 a[40:43], v[36:39], v[104:107], a[40:43]
    v_mfma_f32_16x16x32_bf16 a[44:47], v[36:39], v[108:111], a[44:47]
    ds_read_b64_tr_b16 v[32:33], v17 offset:51296
    ds_read_b64_tr_b16 v[34:35], v17 offset:52576
    s_waitcnt lgkmcnt(12)
    v_mfma_f32_16x16x32_bf16 a[48:51], v[40:43], v[104:107], a[48:51]
    v_mfma_f32_16x16x32_bf16 a[52:55], v[40:43], v[108:111], a[52:55]
    ds_read_b64_tr_b16 v[36:37], v16 offset:51328
    ds_read_b64_tr_b16 v[38:39], v16 offset:52608
    s_waitcnt lgkmcnt(12)
    v_mfma_f32_16x16x32_bf16 a[56:59], v[44:47], v[104:107], a[56:59]
    v_mfma_f32_16x16x32_bf16 a[60:63], v[44:47], v[108:111], a[60:63]
    ds_read_b64_tr_b16 v[40:41], v17 offset:51360
    ds_read_b64_tr_b16 v[42:43], v17 offset:52640
    s_waitcnt lgkmcnt(12)
    v_mfma_f32_16x16x32_bf16 a[64:67], v[48:51], v[104:107], a[64:67]
    v_mfma_f32_16x16x32_bf16 a[68:71], v[48:51], v[108:111], a[68:71]
    s_add_u32 s33, s34, 29696
    buffer_load_dwordx4 v[96:99], v18, s[20:23], s33 offen
    s_add_u32 s33, s34, 195584
    buffer_load_dwordx4 v[100:103], v18, s[20:23], s33 offen
    ds_read_b64_tr_b16 v[44:45], v16 offset:51392
    ds_read_b64_tr_b16 v[46:47], v16 offset:52672
    s_waitcnt vmcnt(27)
    s_waitcnt lgkmcnt(12)
    v_mfma_f32_16x16x32_bf16 a[0:3], v[52:55], v[112:115], a[0:3]
    v_mfma_f32_16x16x32_bf16 a[4:7], v[52:55], v[116:119], a[4:7]
    ds_read_b64_tr_b16 v[48:49], v17 offset:51424
    ds_read_b64_tr_b16 v[50:51], v17 offset:52704
    s_waitcnt lgkmcnt(12)
    v_mfma_f32_16x16x32_bf16 a[8:11], v[24:27], v[112:115], a[8:11]
    v_mfma_f32_16x16x32_bf16 a[12:15], v[24:27], v[116:119], a[12:15]
    ds_read_b64_tr_b16 v[52:53], v16 offset:51456
    ds_read_b64_tr_b16 v[54:55], v16 offset:52736
    s_waitcnt lgkmcnt(12)
    v_mfma_f32_16x16x32_bf16 a[16:19], v[28:31], v[112:115], a[16:19]
    v_mfma_f32_16x16x32_bf16 a[20:23], v[28:31], v[116:119], a[20:23]
    s_barrier
    s_add_u32 m0, s36, 81920
    buffer_load_dwordx4 v9, s[16:19], s35 offen lds
    s_add_u32 m0, s36, 86016
    buffer_load_dwordx4 v10, s[16:19], s35 offen lds
    s_add_u32 m0, s36, 90112
    buffer_load_dwordx4 v11, s[16:19], s35 offen lds
    s_add_u32 m0, s36, 94208
    buffer_load_dwordx4 v12, s[16:19], s35 offen lds
    s_add_u32 m0, s36, 98304
    buffer_load_dwordx4 v13, s[16:19], s35 offen lds
    s_add_u32 s35, s35, 73728
    ds_read_b64_tr_b16 v[24:25], v14 offset:0
    ds_read_b64_tr_b16 v[26:27], v14 offset:1280
    s_waitcnt lgkmcnt(12)
    v_mfma_f32_16x16x32_bf16 a[24:27], v[32:35], v[112:115], a[24:27]
    v_mfma_f32_16x16x32_bf16 a[28:31], v[32:35], v[116:119], a[28:31]
    ds_read_b64_tr_b16 v[28:29], v15 offset:32
    ds_read_b64_tr_b16 v[30:31], v15 offset:1312
    s_waitcnt lgkmcnt(12)
    v_mfma_f32_16x16x32_bf16 a[32:35], v[36:39], v[112:115], a[32:35]
    v_mfma_f32_16x16x32_bf16 a[36:39], v[36:39], v[116:119], a[36:39]
    ds_read_b64_tr_b16 v[32:33], v14 offset:64
    ds_read_b64_tr_b16 v[34:35], v14 offset:1344
    s_waitcnt lgkmcnt(12)
    v_mfma_f32_16x16x32_bf16 a[40:43], v[40:43], v[112:115], a[40:43]
    v_mfma_f32_16x16x32_bf16 a[44:47], v[40:43], v[116:119], a[44:47]
    ds_read_b64_tr_b16 v[36:37], v15 offset:96
    ds_read_b64_tr_b16 v[38:39], v15 offset:1376
    s_waitcnt lgkmcnt(12)
    v_mfma_f32_16x16x32_bf16 a[48:51], v[44:47], v[112:115], a[48:51]
    v_mfma_f32_16x16x32_bf16 a[52:55], v[44:47], v[116:119], a[52:55]
    ds_read_b64_tr_b16 v[40:41], v14 offset:128
    ds_read_b64_tr_b16 v[42:43], v14 offset:1408
    s_waitcnt lgkmcnt(12)
    v_mfma_f32_16x16x32_bf16 a[56:59], v[48:51], v[112:115], a[56:59]
    v_mfma_f32_16x16x32_bf16 a[60:63], v[48:51], v[116:119], a[60:63]
    ds_read_b64_tr_b16 v[44:45], v15 offset:160
    ds_read_b64_tr_b16 v[46:47], v15 offset:1440
    s_waitcnt lgkmcnt(12)
    v_mfma_f32_16x16x32_bf16 a[64:67], v[52:55], v[112:115], a[64:67]
    v_mfma_f32_16x16x32_bf16 a[68:71], v[52:55], v[116:119], a[68:71]
    s_add_u32 s33, s34, 30720
    buffer_load_dwordx4 v[104:107], v18, s[20:23], s33 offen
    s_add_u32 s33, s34, 196608
    buffer_load_dwordx4 v[108:111], v18, s[20:23], s33 offen
    ds_read_b64_tr_b16 v[48:49], v14 offset:192
    ds_read_b64_tr_b16 v[50:51], v14 offset:1472
    s_waitcnt vmcnt(27)
    s_waitcnt lgkmcnt(12)
    v_mfma_f32_16x16x32_bf16 a[0:3], v[24:27], v[56:59], a[0:3]
    v_mfma_f32_16x16x32_bf16 a[4:7], v[24:27], v[60:63], a[4:7]
    ds_read_b64_tr_b16 v[52:53], v15 offset:224
    ds_read_b64_tr_b16 v[54:55], v15 offset:1504
    s_waitcnt lgkmcnt(12)
    v_mfma_f32_16x16x32_bf16 a[8:11], v[28:31], v[56:59], a[8:11]
    v_mfma_f32_16x16x32_bf16 a[12:15], v[28:31], v[60:63], a[12:15]
    ds_read_b64_tr_b16 v[24:25], v14 offset:256
    ds_read_b64_tr_b16 v[26:27], v14 offset:1536
    s_waitcnt lgkmcnt(12)
    v_mfma_f32_16x16x32_bf16 a[16:19], v[32:35], v[56:59], a[16:19]
    v_mfma_f32_16x16x32_bf16 a[20:23], v[32:35], v[60:63], a[20:23]
    ds_read_b64_tr_b16 v[28:29], v14 offset:10240
    ds_read_b64_tr_b16 v[30:31], v14 offset:11520
    s_waitcnt lgkmcnt(12)
    v_mfma_f32_16x16x32_bf16 a[24:27], v[36:39], v[56:59], a[24:27]
    v_mfma_f32_16x16x32_bf16 a[28:31], v[36:39], v[60:63], a[28:31]
    ds_read_b64_tr_b16 v[32:33], v15 offset:10272
    ds_read_b64_tr_b16 v[34:35], v15 offset:11552
    s_waitcnt lgkmcnt(12)
    v_mfma_f32_16x16x32_bf16 a[32:35], v[40:43], v[56:59], a[32:35]
    v_mfma_f32_16x16x32_bf16 a[36:39], v[40:43], v[60:63], a[36:39]
    ds_read_b64_tr_b16 v[36:37], v14 offset:10304
    ds_read_b64_tr_b16 v[38:39], v14 offset:11584
    s_waitcnt lgkmcnt(12)
    v_mfma_f32_16x16x32_bf16 a[40:43], v[44:47], v[56:59], a[40:43]
    v_mfma_f32_16x16x32_bf16 a[44:47], v[44:47], v[60:63], a[44:47]
    ds_read_b64_tr_b16 v[40:41], v15 offset:10336
    ds_read_b64_tr_b16 v[42:43], v15 offset:11616
    s_waitcnt lgkmcnt(12)
    v_mfma_f32_16x16x32_bf16 a[48:51], v[48:51], v[56:59], a[48:51]
    v_mfma_f32_16x16x32_bf16 a[52:55], v[48:51], v[60:63], a[52:55]
    ds_read_b64_tr_b16 v[44:45], v14 offset:10368
    ds_read_b64_tr_b16 v[46:47], v14 offset:11648
    s_waitcnt lgkmcnt(12)
    v_mfma_f32_16x16x32_bf16 a[56:59], v[52:55], v[56:59], a[56:59]
    v_mfma_f32_16x16x32_bf16 a[60:63], v[52:55], v[60:63], a[60:63]
    ds_read_b64_tr_b16 v[48:49], v15 offset:10400
    ds_read_b64_tr_b16 v[50:51], v15 offset:11680
    s_waitcnt lgkmcnt(12)
    v_mfma_f32_16x16x32_bf16 a[64:67], v[24:27], v[56:59], a[64:67]
    v_mfma_f32_16x16x32_bf16 a[68:71], v[24:27], v[60:63], a[68:71]
    s_add_u32 s33, s34, 31744
    buffer_load_dwordx4 v[112:115], v18, s[20:23], s33 offen
    s_add_u32 s33, s34, 197632
    buffer_load_dwordx4 v[116:119], v18, s[20:23], s33 offen
    ds_read_b64_tr_b16 v[52:53], v14 offset:10432
    ds_read_b64_tr_b16 v[54:55], v14 offset:11712
    s_waitcnt vmcnt(27)
    s_waitcnt lgkmcnt(12)
    v_mfma_f32_16x16x32_bf16 a[0:3], v[28:31], v[64:67], a[0:3]
    v_mfma_f32_16x16x32_bf16 a[4:7], v[28:31], v[68:71], a[4:7]
    ds_read_b64_tr_b16 v[24:25], v15 offset:10464
    ds_read_b64_tr_b16 v[26:27], v15 offset:11744
    s_waitcnt lgkmcnt(12)
    v_mfma_f32_16x16x32_bf16 a[8:11], v[32:35], v[64:67], a[8:11]
    v_mfma_f32_16x16x32_bf16 a[12:15], v[32:35], v[68:71], a[12:15]
    ds_read_b64_tr_b16 v[28:29], v14 offset:10496
    ds_read_b64_tr_b16 v[30:31], v14 offset:11776
    s_waitcnt lgkmcnt(12)
    v_mfma_f32_16x16x32_bf16 a[16:19], v[36:39], v[64:67], a[16:19]
    v_mfma_f32_16x16x32_bf16 a[20:23], v[36:39], v[68:71], a[20:23]
    s_barrier
    s_add_u32 m0, s36, 102400
    buffer_load_dwordx4 v9, s[16:19], s35 offen lds
    s_add_u32 m0, s36, 106496
    buffer_load_dwordx4 v10, s[16:19], s35 offen lds
    s_add_u32 m0, s36, 110592
    buffer_load_dwordx4 v11, s[16:19], s35 offen lds
    s_add_u32 m0, s36, 114688
    buffer_load_dwordx4 v12, s[16:19], s35 offen lds
    s_add_u32 m0, s36, 118784
    buffer_load_dwordx4 v13, s[16:19], s35 offen lds
    s_add_u32 s35, s35, 73728
    ds_read_b64_tr_b16 v[32:33], v14 offset:20480
    ds_read_b64_tr_b16 v[34:35], v14 offset:21760
    s_waitcnt lgkmcnt(12)
    v_mfma_f32_16x16x32_bf16 a[24:27], v[40:43], v[64:67], a[24:27]
    v_mfma_f32_16x16x32_bf16 a[28:31], v[40:43], v[68:71], a[28:31]
    ds_read_b64_tr_b16 v[36:37], v15 offset:20512
    ds_read_b64_tr_b16 v[38:39], v15 offset:21792
    s_waitcnt lgkmcnt(12)
    v_mfma_f32_16x16x32_bf16 a[32:35], v[44:47], v[64:67], a[32:35]
    v_mfma_f32_16x16x32_bf16 a[36:39], v[44:47], v[68:71], a[36:39]
    ds_read_b64_tr_b16 v[40:41], v14 offset:20544
    ds_read_b64_tr_b16 v[42:43], v14 offset:21824
    s_waitcnt lgkmcnt(12)
    v_mfma_f32_16x16x32_bf16 a[40:43], v[48:51], v[64:67], a[40:43]
    v_mfma_f32_16x16x32_bf16 a[44:47], v[48:51], v[68:71], a[44:47]
    ds_read_b64_tr_b16 v[44:45], v15 offset:20576
    ds_read_b64_tr_b16 v[46:47], v15 offset:21856
    s_waitcnt lgkmcnt(12)
    v_mfma_f32_16x16x32_bf16 a[48:51], v[52:55], v[64:67], a[48:51]
    v_mfma_f32_16x16x32_bf16 a[52:55], v[52:55], v[68:71], a[52:55]
    ds_read_b64_tr_b16 v[48:49], v14 offset:20608
    ds_read_b64_tr_b16 v[50:51], v14 offset:21888
    s_waitcnt lgkmcnt(12)
    v_mfma_f32_16x16x32_bf16 a[56:59], v[24:27], v[64:67], a[56:59]
    v_mfma_f32_16x16x32_bf16 a[60:63], v[24:27], v[68:71], a[60:63]
    ds_read_b64_tr_b16 v[52:53], v15 offset:20640
    ds_read_b64_tr_b16 v[54:55], v15 offset:21920
    s_waitcnt lgkmcnt(12)
    v_mfma_f32_16x16x32_bf16 a[64:67], v[28:31], v[64:67], a[64:67]
    v_mfma_f32_16x16x32_bf16 a[68:71], v[28:31], v[68:71], a[68:71]
    s_add_u32 s33, s34, 32768
    buffer_load_dwordx4 v[56:59], v18, s[20:23], s33 offen
    s_add_u32 s33, s34, 198656
    buffer_load_dwordx4 v[60:63], v18, s[20:23], s33 offen
    ds_read_b64_tr_b16 v[24:25], v14 offset:20672
    ds_read_b64_tr_b16 v[26:27], v14 offset:21952
    s_waitcnt vmcnt(27)
    s_waitcnt lgkmcnt(12)
    v_mfma_f32_16x16x32_bf16 a[0:3], v[32:35], v[72:75], a[0:3]
    v_mfma_f32_16x16x32_bf16 a[4:7], v[32:35], v[76:79], a[4:7]
    ds_read_b64_tr_b16 v[28:29], v15 offset:20704
    ds_read_b64_tr_b16 v[30:31], v15 offset:21984
    s_waitcnt lgkmcnt(12)
    v_mfma_f32_16x16x32_bf16 a[8:11], v[36:39], v[72:75], a[8:11]
    v_mfma_f32_16x16x32_bf16 a[12:15], v[36:39], v[76:79], a[12:15]
    ds_read_b64_tr_b16 v[32:33], v14 offset:20736
    ds_read_b64_tr_b16 v[34:35], v14 offset:22016
    s_waitcnt lgkmcnt(12)
    v_mfma_f32_16x16x32_bf16 a[16:19], v[40:43], v[72:75], a[16:19]
    v_mfma_f32_16x16x32_bf16 a[20:23], v[40:43], v[76:79], a[20:23]
    ds_read_b64_tr_b16 v[36:37], v14 offset:30720
    ds_read_b64_tr_b16 v[38:39], v14 offset:32000
    s_waitcnt lgkmcnt(12)
    v_mfma_f32_16x16x32_bf16 a[24:27], v[44:47], v[72:75], a[24:27]
    v_mfma_f32_16x16x32_bf16 a[28:31], v[44:47], v[76:79], a[28:31]
    ds_read_b64_tr_b16 v[40:41], v15 offset:30752
    ds_read_b64_tr_b16 v[42:43], v15 offset:32032
    s_waitcnt lgkmcnt(12)
    v_mfma_f32_16x16x32_bf16 a[32:35], v[48:51], v[72:75], a[32:35]
    v_mfma_f32_16x16x32_bf16 a[36:39], v[48:51], v[76:79], a[36:39]
    ds_read_b64_tr_b16 v[44:45], v14 offset:30784
    ds_read_b64_tr_b16 v[46:47], v14 offset:32064
    s_waitcnt lgkmcnt(12)
    v_mfma_f32_16x16x32_bf16 a[40:43], v[52:55], v[72:75], a[40:43]
    v_mfma_f32_16x16x32_bf16 a[44:47], v[52:55], v[76:79], a[44:47]
    ds_read_b64_tr_b16 v[48:49], v15 offset:30816
    ds_read_b64_tr_b16 v[50:51], v15 offset:32096
    s_waitcnt lgkmcnt(12)
    v_mfma_f32_16x16x32_bf16 a[48:51], v[24:27], v[72:75], a[48:51]
    v_mfma_f32_16x16x32_bf16 a[52:55], v[24:27], v[76:79], a[52:55]
    ds_read_b64_tr_b16 v[52:53], v14 offset:30848
    ds_read_b64_tr_b16 v[54:55], v14 offset:32128
    s_waitcnt lgkmcnt(12)
    v_mfma_f32_16x16x32_bf16 a[56:59], v[28:31], v[72:75], a[56:59]
    v_mfma_f32_16x16x32_bf16 a[60:63], v[28:31], v[76:79], a[60:63]
    ds_read_b64_tr_b16 v[24:25], v15 offset:30880
    ds_read_b64_tr_b16 v[26:27], v15 offset:32160
    s_waitcnt lgkmcnt(12)
    v_mfma_f32_16x16x32_bf16 a[64:67], v[32:35], v[72:75], a[64:67]
    v_mfma_f32_16x16x32_bf16 a[68:71], v[32:35], v[76:79], a[68:71]
    s_add_u32 s33, s34, 33792
    buffer_load_dwordx4 v[64:67], v18, s[20:23], s33 offen
    s_add_u32 s33, s34, 199680
    buffer_load_dwordx4 v[68:71], v18, s[20:23], s33 offen
    ds_read_b64_tr_b16 v[28:29], v14 offset:30912
    ds_read_b64_tr_b16 v[30:31], v14 offset:32192
    s_waitcnt vmcnt(27)
    s_waitcnt lgkmcnt(12)
    v_mfma_f32_16x16x32_bf16 a[0:3], v[36:39], v[80:83], a[0:3]
    v_mfma_f32_16x16x32_bf16 a[4:7], v[36:39], v[84:87], a[4:7]
    ds_read_b64_tr_b16 v[32:33], v15 offset:30944
    ds_read_b64_tr_b16 v[34:35], v15 offset:32224
    s_waitcnt lgkmcnt(12)
    v_mfma_f32_16x16x32_bf16 a[8:11], v[40:43], v[80:83], a[8:11]
    v_mfma_f32_16x16x32_bf16 a[12:15], v[40:43], v[84:87], a[12:15]
    ds_read_b64_tr_b16 v[36:37], v14 offset:30976
    ds_read_b64_tr_b16 v[38:39], v14 offset:32256
    s_waitcnt lgkmcnt(12)
    v_mfma_f32_16x16x32_bf16 a[16:19], v[44:47], v[80:83], a[16:19]
    v_mfma_f32_16x16x32_bf16 a[20:23], v[44:47], v[84:87], a[20:23]
    s_barrier
    s_add_u32 m0, s36, 0
    buffer_load_dwordx4 v9, s[16:19], s35 offen lds
    s_add_u32 m0, s36, 4096
    buffer_load_dwordx4 v10, s[16:19], s35 offen lds
    s_add_u32 m0, s36, 8192
    buffer_load_dwordx4 v11, s[16:19], s35 offen lds
    s_add_u32 m0, s36, 12288
    buffer_load_dwordx4 v12, s[16:19], s35 offen lds
    s_add_u32 m0, s36, 16384
    buffer_load_dwordx4 v13, s[16:19], s35 offen lds
    s_add_u32 s35, s35, 73728
    ds_read_b64_tr_b16 v[40:41], v14 offset:40960
    ds_read_b64_tr_b16 v[42:43], v14 offset:42240
    s_waitcnt lgkmcnt(12)
    v_mfma_f32_16x16x32_bf16 a[24:27], v[48:51], v[80:83], a[24:27]
    v_mfma_f32_16x16x32_bf16 a[28:31], v[48:51], v[84:87], a[28:31]
    ds_read_b64_tr_b16 v[44:45], v15 offset:40992
    ds_read_b64_tr_b16 v[46:47], v15 offset:42272
    s_waitcnt lgkmcnt(12)
    v_mfma_f32_16x16x32_bf16 a[32:35], v[52:55], v[80:83], a[32:35]
    v_mfma_f32_16x16x32_bf16 a[36:39], v[52:55], v[84:87], a[36:39]
    ds_read_b64_tr_b16 v[48:49], v14 offset:41024
    ds_read_b64_tr_b16 v[50:51], v14 offset:42304
    s_waitcnt lgkmcnt(12)
    v_mfma_f32_16x16x32_bf16 a[40:43], v[24:27], v[80:83], a[40:43]
    v_mfma_f32_16x16x32_bf16 a[44:47], v[24:27], v[84:87], a[44:47]
    ds_read_b64_tr_b16 v[52:53], v15 offset:41056
    ds_read_b64_tr_b16 v[54:55], v15 offset:42336
    s_waitcnt lgkmcnt(12)
    v_mfma_f32_16x16x32_bf16 a[48:51], v[28:31], v[80:83], a[48:51]
    v_mfma_f32_16x16x32_bf16 a[52:55], v[28:31], v[84:87], a[52:55]
    ds_read_b64_tr_b16 v[24:25], v14 offset:41088
    ds_read_b64_tr_b16 v[26:27], v14 offset:42368
    s_waitcnt lgkmcnt(12)
    v_mfma_f32_16x16x32_bf16 a[56:59], v[32:35], v[80:83], a[56:59]
    v_mfma_f32_16x16x32_bf16 a[60:63], v[32:35], v[84:87], a[60:63]
    ds_read_b64_tr_b16 v[28:29], v15 offset:41120
    ds_read_b64_tr_b16 v[30:31], v15 offset:42400
    s_waitcnt lgkmcnt(12)
    v_mfma_f32_16x16x32_bf16 a[64:67], v[36:39], v[80:83], a[64:67]
    v_mfma_f32_16x16x32_bf16 a[68:71], v[36:39], v[84:87], a[68:71]
    s_add_u32 s33, s34, 34816
    buffer_load_dwordx4 v[72:75], v18, s[20:23], s33 offen
    s_add_u32 s33, s34, 200704
    buffer_load_dwordx4 v[76:79], v18, s[20:23], s33 offen
    ds_read_b64_tr_b16 v[32:33], v14 offset:41152
    ds_read_b64_tr_b16 v[34:35], v14 offset:42432
    s_waitcnt vmcnt(27)
    s_waitcnt lgkmcnt(12)
    v_mfma_f32_16x16x32_bf16 a[0:3], v[40:43], v[88:91], a[0:3]
    v_mfma_f32_16x16x32_bf16 a[4:7], v[40:43], v[92:95], a[4:7]
    ds_read_b64_tr_b16 v[36:37], v15 offset:41184
    ds_read_b64_tr_b16 v[38:39], v15 offset:42464
    s_waitcnt lgkmcnt(12)
    v_mfma_f32_16x16x32_bf16 a[8:11], v[44:47], v[88:91], a[8:11]
    v_mfma_f32_16x16x32_bf16 a[12:15], v[44:47], v[92:95], a[12:15]
    ds_read_b64_tr_b16 v[40:41], v14 offset:41216
    ds_read_b64_tr_b16 v[42:43], v14 offset:42496
    s_waitcnt lgkmcnt(12)
    v_mfma_f32_16x16x32_bf16 a[16:19], v[48:51], v[88:91], a[16:19]
    v_mfma_f32_16x16x32_bf16 a[20:23], v[48:51], v[92:95], a[20:23]
    ds_read_b64_tr_b16 v[44:45], v14 offset:51200
    ds_read_b64_tr_b16 v[46:47], v14 offset:52480
    s_waitcnt lgkmcnt(12)
    v_mfma_f32_16x16x32_bf16 a[24:27], v[52:55], v[88:91], a[24:27]
    v_mfma_f32_16x16x32_bf16 a[28:31], v[52:55], v[92:95], a[28:31]
    ds_read_b64_tr_b16 v[48:49], v15 offset:51232
    ds_read_b64_tr_b16 v[50:51], v15 offset:52512
    s_waitcnt lgkmcnt(12)
    v_mfma_f32_16x16x32_bf16 a[32:35], v[24:27], v[88:91], a[32:35]
    v_mfma_f32_16x16x32_bf16 a[36:39], v[24:27], v[92:95], a[36:39]
    ds_read_b64_tr_b16 v[52:53], v14 offset:51264
    ds_read_b64_tr_b16 v[54:55], v14 offset:52544
    s_waitcnt lgkmcnt(12)
    v_mfma_f32_16x16x32_bf16 a[40:43], v[28:31], v[88:91], a[40:43]
    v_mfma_f32_16x16x32_bf16 a[44:47], v[28:31], v[92:95], a[44:47]
    ds_read_b64_tr_b16 v[24:25], v15 offset:51296
    ds_read_b64_tr_b16 v[26:27], v15 offset:52576
    s_waitcnt lgkmcnt(12)
    v_mfma_f32_16x16x32_bf16 a[48:51], v[32:35], v[88:91], a[48:51]
    v_mfma_f32_16x16x32_bf16 a[52:55], v[32:35], v[92:95], a[52:55]
    ds_read_b64_tr_b16 v[28:29], v14 offset:51328
    ds_read_b64_tr_b16 v[30:31], v14 offset:52608
    s_waitcnt lgkmcnt(12)
    v_mfma_f32_16x16x32_bf16 a[56:59], v[36:39], v[88:91], a[56:59]
    v_mfma_f32_16x16x32_bf16 a[60:63], v[36:39], v[92:95], a[60:63]
    ds_read_b64_tr_b16 v[32:33], v15 offset:51360
    ds_read_b64_tr_b16 v[34:35], v15 offset:52640
    s_waitcnt lgkmcnt(12)
    v_mfma_f32_16x16x32_bf16 a[64:67], v[40:43], v[88:91], a[64:67]
    v_mfma_f32_16x16x32_bf16 a[68:71], v[40:43], v[92:95], a[68:71]
    s_add_u32 s33, s34, 35840
    buffer_load_dwordx4 v[80:83], v18, s[20:23], s33 offen
    s_add_u32 s33, s34, 201728
    buffer_load_dwordx4 v[84:87], v18, s[20:23], s33 offen
    ds_read_b64_tr_b16 v[36:37], v14 offset:51392
    ds_read_b64_tr_b16 v[38:39], v14 offset:52672
    s_waitcnt vmcnt(27)
    s_waitcnt lgkmcnt(12)
    v_mfma_f32_16x16x32_bf16 a[0:3], v[44:47], v[96:99], a[0:3]
    v_mfma_f32_16x16x32_bf16 a[4:7], v[44:47], v[100:103], a[4:7]
    ds_read_b64_tr_b16 v[40:41], v15 offset:51424
    ds_read_b64_tr_b16 v[42:43], v15 offset:52704
    s_waitcnt lgkmcnt(12)
    v_mfma_f32_16x16x32_bf16 a[8:11], v[48:51], v[96:99], a[8:11]
    v_mfma_f32_16x16x32_bf16 a[12:15], v[48:51], v[100:103], a[12:15]
    ds_read_b64_tr_b16 v[44:45], v14 offset:51456
    ds_read_b64_tr_b16 v[46:47], v14 offset:52736
    s_waitcnt lgkmcnt(12)
    v_mfma_f32_16x16x32_bf16 a[16:19], v[52:55], v[96:99], a[16:19]
    v_mfma_f32_16x16x32_bf16 a[20:23], v[52:55], v[100:103], a[20:23]
    s_barrier
    s_add_u32 m0, s36, 20480
    buffer_load_dwordx4 v9, s[16:19], s35 offen lds
    s_add_u32 m0, s36, 24576
    buffer_load_dwordx4 v10, s[16:19], s35 offen lds
    s_add_u32 m0, s36, 28672
    buffer_load_dwordx4 v11, s[16:19], s35 offen lds
    s_add_u32 m0, s36, 32768
    buffer_load_dwordx4 v12, s[16:19], s35 offen lds
    s_add_u32 m0, s36, 36864
    buffer_load_dwordx4 v13, s[16:19], s35 offen lds
    s_add_u32 s35, s35, 73728
    ds_read_b64_tr_b16 v[48:49], v16 offset:0
    ds_read_b64_tr_b16 v[50:51], v16 offset:1280
    s_waitcnt lgkmcnt(12)
    v_mfma_f32_16x16x32_bf16 a[24:27], v[24:27], v[96:99], a[24:27]
    v_mfma_f32_16x16x32_bf16 a[28:31], v[24:27], v[100:103], a[28:31]
    ds_read_b64_tr_b16 v[52:53], v17 offset:32
    ds_read_b64_tr_b16 v[54:55], v17 offset:1312
    s_waitcnt lgkmcnt(12)
    v_mfma_f32_16x16x32_bf16 a[32:35], v[28:31], v[96:99], a[32:35]
    v_mfma_f32_16x16x32_bf16 a[36:39], v[28:31], v[100:103], a[36:39]
    ds_read_b64_tr_b16 v[24:25], v16 offset:64
    ds_read_b64_tr_b16 v[26:27], v16 offset:1344
    s_waitcnt lgkmcnt(12)
    v_mfma_f32_16x16x32_bf16 a[40:43], v[32:35], v[96:99], a[40:43]
    v_mfma_f32_16x16x32_bf16 a[44:47], v[32:35], v[100:103], a[44:47]
    ds_read_b64_tr_b16 v[28:29], v17 offset:96
    ds_read_b64_tr_b16 v[30:31], v17 offset:1376
    s_waitcnt lgkmcnt(12)
    v_mfma_f32_16x16x32_bf16 a[48:51], v[36:39], v[96:99], a[48:51]
    v_mfma_f32_16x16x32_bf16 a[52:55], v[36:39], v[100:103], a[52:55]
    ds_read_b64_tr_b16 v[32:33], v16 offset:128
    ds_read_b64_tr_b16 v[34:35], v16 offset:1408
    s_waitcnt lgkmcnt(12)
    v_mfma_f32_16x16x32_bf16 a[56:59], v[40:43], v[96:99], a[56:59]
    v_mfma_f32_16x16x32_bf16 a[60:63], v[40:43], v[100:103], a[60:63]
    ds_read_b64_tr_b16 v[36:37], v17 offset:160
    ds_read_b64_tr_b16 v[38:39], v17 offset:1440
    s_waitcnt lgkmcnt(12)
    v_mfma_f32_16x16x32_bf16 a[64:67], v[44:47], v[96:99], a[64:67]
    v_mfma_f32_16x16x32_bf16 a[68:71], v[44:47], v[100:103], a[68:71]
    s_add_u32 s33, s34, 36864
    buffer_load_dwordx4 v[88:91], v18, s[20:23], s33 offen
    s_add_u32 s33, s34, 202752
    buffer_load_dwordx4 v[92:95], v18, s[20:23], s33 offen
    ds_read_b64_tr_b16 v[40:41], v16 offset:192
    ds_read_b64_tr_b16 v[42:43], v16 offset:1472
    s_waitcnt vmcnt(27)
    s_waitcnt lgkmcnt(12)
    v_mfma_f32_16x16x32_bf16 a[0:3], v[48:51], v[104:107], a[0:3]
    v_mfma_f32_16x16x32_bf16 a[4:7], v[48:51], v[108:111], a[4:7]
    ds_read_b64_tr_b16 v[44:45], v17 offset:224
    ds_read_b64_tr_b16 v[46:47], v17 offset:1504
    s_waitcnt lgkmcnt(12)
    v_mfma_f32_16x16x32_bf16 a[8:11], v[52:55], v[104:107], a[8:11]
    v_mfma_f32_16x16x32_bf16 a[12:15], v[52:55], v[108:111], a[12:15]
    ds_read_b64_tr_b16 v[48:49], v16 offset:256
    ds_read_b64_tr_b16 v[50:51], v16 offset:1536
    s_waitcnt lgkmcnt(12)
    v_mfma_f32_16x16x32_bf16 a[16:19], v[24:27], v[104:107], a[16:19]
    v_mfma_f32_16x16x32_bf16 a[20:23], v[24:27], v[108:111], a[20:23]
    ds_read_b64_tr_b16 v[52:53], v16 offset:10240
    ds_read_b64_tr_b16 v[54:55], v16 offset:11520
    s_waitcnt lgkmcnt(12)
    v_mfma_f32_16x16x32_bf16 a[24:27], v[28:31], v[104:107], a[24:27]
    v_mfma_f32_16x16x32_bf16 a[28:31], v[28:31], v[108:111], a[28:31]
    ds_read_b64_tr_b16 v[24:25], v17 offset:10272
    ds_read_b64_tr_b16 v[26:27], v17 offset:11552
    s_waitcnt lgkmcnt(12)
    v_mfma_f32_16x16x32_bf16 a[32:35], v[32:35], v[104:107], a[32:35]
    v_mfma_f32_16x16x32_bf16 a[36:39], v[32:35], v[108:111], a[36:39]
    ds_read_b64_tr_b16 v[28:29], v16 offset:10304
    ds_read_b64_tr_b16 v[30:31], v16 offset:11584
    s_waitcnt lgkmcnt(12)
    v_mfma_f32_16x16x32_bf16 a[40:43], v[36:39], v[104:107], a[40:43]
    v_mfma_f32_16x16x32_bf16 a[44:47], v[36:39], v[108:111], a[44:47]
    ds_read_b64_tr_b16 v[32:33], v17 offset:10336
    ds_read_b64_tr_b16 v[34:35], v17 offset:11616
    s_waitcnt lgkmcnt(12)
    v_mfma_f32_16x16x32_bf16 a[48:51], v[40:43], v[104:107], a[48:51]
    v_mfma_f32_16x16x32_bf16 a[52:55], v[40:43], v[108:111], a[52:55]
    ds_read_b64_tr_b16 v[36:37], v16 offset:10368
    ds_read_b64_tr_b16 v[38:39], v16 offset:11648
    s_waitcnt lgkmcnt(12)
    v_mfma_f32_16x16x32_bf16 a[56:59], v[44:47], v[104:107], a[56:59]
    v_mfma_f32_16x16x32_bf16 a[60:63], v[44:47], v[108:111], a[60:63]
    ds_read_b64_tr_b16 v[40:41], v17 offset:10400
    ds_read_b64_tr_b16 v[42:43], v17 offset:11680
    s_waitcnt lgkmcnt(12)
    v_mfma_f32_16x16x32_bf16 a[64:67], v[48:51], v[104:107], a[64:67]
    v_mfma_f32_16x16x32_bf16 a[68:71], v[48:51], v[108:111], a[68:71]
    s_add_u32 s33, s34, 37888
    buffer_load_dwordx4 v[96:99], v18, s[20:23], s33 offen
    s_add_u32 s33, s34, 203776
    buffer_load_dwordx4 v[100:103], v18, s[20:23], s33 offen
    ds_read_b64_tr_b16 v[44:45], v16 offset:10432
    ds_read_b64_tr_b16 v[46:47], v16 offset:11712
    s_waitcnt vmcnt(27)
    s_waitcnt lgkmcnt(12)
    v_mfma_f32_16x16x32_bf16 a[0:3], v[52:55], v[112:115], a[0:3]
    v_mfma_f32_16x16x32_bf16 a[4:7], v[52:55], v[116:119], a[4:7]
    ds_read_b64_tr_b16 v[48:49], v17 offset:10464
    ds_read_b64_tr_b16 v[50:51], v17 offset:11744
    s_waitcnt lgkmcnt(12)
    v_mfma_f32_16x16x32_bf16 a[8:11], v[24:27], v[112:115], a[8:11]
    v_mfma_f32_16x16x32_bf16 a[12:15], v[24:27], v[116:119], a[12:15]
    ds_read_b64_tr_b16 v[52:53], v16 offset:10496
    ds_read_b64_tr_b16 v[54:55], v16 offset:11776
    s_waitcnt lgkmcnt(12)
    v_mfma_f32_16x16x32_bf16 a[16:19], v[28:31], v[112:115], a[16:19]
    v_mfma_f32_16x16x32_bf16 a[20:23], v[28:31], v[116:119], a[20:23]
    s_barrier
    s_add_u32 m0, s36, 40960
    buffer_load_dwordx4 v9, s[16:19], s35 offen lds
    s_add_u32 m0, s36, 45056
    buffer_load_dwordx4 v10, s[16:19], s35 offen lds
    s_add_u32 m0, s36, 49152
    buffer_load_dwordx4 v11, s[16:19], s35 offen lds
    s_add_u32 m0, s36, 53248
    buffer_load_dwordx4 v12, s[16:19], s35 offen lds
    s_add_u32 m0, s36, 57344
    buffer_load_dwordx4 v13, s[16:19], s35 offen lds
    s_add_u32 s35, s35, 73728
    ds_read_b64_tr_b16 v[24:25], v16 offset:20480
    ds_read_b64_tr_b16 v[26:27], v16 offset:21760
    s_waitcnt lgkmcnt(12)
    v_mfma_f32_16x16x32_bf16 a[24:27], v[32:35], v[112:115], a[24:27]
    v_mfma_f32_16x16x32_bf16 a[28:31], v[32:35], v[116:119], a[28:31]
    ds_read_b64_tr_b16 v[28:29], v17 offset:20512
    ds_read_b64_tr_b16 v[30:31], v17 offset:21792
    s_waitcnt lgkmcnt(12)
    v_mfma_f32_16x16x32_bf16 a[32:35], v[36:39], v[112:115], a[32:35]
    v_mfma_f32_16x16x32_bf16 a[36:39], v[36:39], v[116:119], a[36:39]
    ds_read_b64_tr_b16 v[32:33], v16 offset:20544
    ds_read_b64_tr_b16 v[34:35], v16 offset:21824
    s_waitcnt lgkmcnt(12)
    v_mfma_f32_16x16x32_bf16 a[40:43], v[40:43], v[112:115], a[40:43]
    v_mfma_f32_16x16x32_bf16 a[44:47], v[40:43], v[116:119], a[44:47]
    ds_read_b64_tr_b16 v[36:37], v17 offset:20576
    ds_read_b64_tr_b16 v[38:39], v17 offset:21856
    s_waitcnt lgkmcnt(12)
    v_mfma_f32_16x16x32_bf16 a[48:51], v[44:47], v[112:115], a[48:51]
    v_mfma_f32_16x16x32_bf16 a[52:55], v[44:47], v[116:119], a[52:55]
    ds_read_b64_tr_b16 v[40:41], v16 offset:20608
    ds_read_b64_tr_b16 v[42:43], v16 offset:21888
    s_waitcnt lgkmcnt(12)
    v_mfma_f32_16x16x32_bf16 a[56:59], v[48:51], v[112:115], a[56:59]
    v_mfma_f32_16x16x32_bf16 a[60:63], v[48:51], v[116:119], a[60:63]
    ds_read_b64_tr_b16 v[44:45], v17 offset:20640
    ds_read_b64_tr_b16 v[46:47], v17 offset:21920
    s_waitcnt lgkmcnt(12)
    v_mfma_f32_16x16x32_bf16 a[64:67], v[52:55], v[112:115], a[64:67]
    v_mfma_f32_16x16x32_bf16 a[68:71], v[52:55], v[116:119], a[68:71]
    s_add_u32 s33, s34, 38912
    buffer_load_dwordx4 v[104:107], v18, s[20:23], s33 offen
    s_add_u32 s33, s34, 204800
    buffer_load_dwordx4 v[108:111], v18, s[20:23], s33 offen
    ds_read_b64_tr_b16 v[48:49], v16 offset:20672
    ds_read_b64_tr_b16 v[50:51], v16 offset:21952
    s_waitcnt vmcnt(27)
    s_waitcnt lgkmcnt(12)
    v_mfma_f32_16x16x32_bf16 a[0:3], v[24:27], v[56:59], a[0:3]
    v_mfma_f32_16x16x32_bf16 a[4:7], v[24:27], v[60:63], a[4:7]
    ds_read_b64_tr_b16 v[52:53], v17 offset:20704
    ds_read_b64_tr_b16 v[54:55], v17 offset:21984
    s_waitcnt lgkmcnt(12)
    v_mfma_f32_16x16x32_bf16 a[8:11], v[28:31], v[56:59], a[8:11]
    v_mfma_f32_16x16x32_bf16 a[12:15], v[28:31], v[60:63], a[12:15]
    ds_read_b64_tr_b16 v[24:25], v16 offset:20736
    ds_read_b64_tr_b16 v[26:27], v16 offset:22016
    s_waitcnt lgkmcnt(12)
    v_mfma_f32_16x16x32_bf16 a[16:19], v[32:35], v[56:59], a[16:19]
    v_mfma_f32_16x16x32_bf16 a[20:23], v[32:35], v[60:63], a[20:23]
    ds_read_b64_tr_b16 v[28:29], v16 offset:30720
    ds_read_b64_tr_b16 v[30:31], v16 offset:32000
    s_waitcnt lgkmcnt(12)
    v_mfma_f32_16x16x32_bf16 a[24:27], v[36:39], v[56:59], a[24:27]
    v_mfma_f32_16x16x32_bf16 a[28:31], v[36:39], v[60:63], a[28:31]
    ds_read_b64_tr_b16 v[32:33], v17 offset:30752
    ds_read_b64_tr_b16 v[34:35], v17 offset:32032
    s_waitcnt lgkmcnt(12)
    v_mfma_f32_16x16x32_bf16 a[32:35], v[40:43], v[56:59], a[32:35]
    v_mfma_f32_16x16x32_bf16 a[36:39], v[40:43], v[60:63], a[36:39]
    ds_read_b64_tr_b16 v[36:37], v16 offset:30784
    ds_read_b64_tr_b16 v[38:39], v16 offset:32064
    s_waitcnt lgkmcnt(12)
    v_mfma_f32_16x16x32_bf16 a[40:43], v[44:47], v[56:59], a[40:43]
    v_mfma_f32_16x16x32_bf16 a[44:47], v[44:47], v[60:63], a[44:47]
    ds_read_b64_tr_b16 v[40:41], v17 offset:30816
    ds_read_b64_tr_b16 v[42:43], v17 offset:32096
    s_waitcnt lgkmcnt(12)
    v_mfma_f32_16x16x32_bf16 a[48:51], v[48:51], v[56:59], a[48:51]
    v_mfma_f32_16x16x32_bf16 a[52:55], v[48:51], v[60:63], a[52:55]
    ds_read_b64_tr_b16 v[44:45], v16 offset:30848
    ds_read_b64_tr_b16 v[46:47], v16 offset:32128
    s_waitcnt lgkmcnt(12)
    v_mfma_f32_16x16x32_bf16 a[56:59], v[52:55], v[56:59], a[56:59]
    v_mfma_f32_16x16x32_bf16 a[60:63], v[52:55], v[60:63], a[60:63]
    ds_read_b64_tr_b16 v[48:49], v17 offset:30880
    ds_read_b64_tr_b16 v[50:51], v17 offset:32160
    s_waitcnt lgkmcnt(12)
    v_mfma_f32_16x16x32_bf16 a[64:67], v[24:27], v[56:59], a[64:67]
    v_mfma_f32_16x16x32_bf16 a[68:71], v[24:27], v[60:63], a[68:71]
    s_add_u32 s33, s34, 39936
    buffer_load_dwordx4 v[112:115], v18, s[20:23], s33 offen
    s_add_u32 s33, s34, 205824
    buffer_load_dwordx4 v[116:119], v18, s[20:23], s33 offen
    ds_read_b64_tr_b16 v[52:53], v16 offset:30912
    ds_read_b64_tr_b16 v[54:55], v16 offset:32192
    s_waitcnt vmcnt(27)
    s_waitcnt lgkmcnt(12)
    v_mfma_f32_16x16x32_bf16 a[0:3], v[28:31], v[64:67], a[0:3]
    v_mfma_f32_16x16x32_bf16 a[4:7], v[28:31], v[68:71], a[4:7]
    ds_read_b64_tr_b16 v[24:25], v17 offset:30944
    ds_read_b64_tr_b16 v[26:27], v17 offset:32224
    s_waitcnt lgkmcnt(12)
    v_mfma_f32_16x16x32_bf16 a[8:11], v[32:35], v[64:67], a[8:11]
    v_mfma_f32_16x16x32_bf16 a[12:15], v[32:35], v[68:71], a[12:15]
    ds_read_b64_tr_b16 v[28:29], v16 offset:30976
    ds_read_b64_tr_b16 v[30:31], v16 offset:32256
    s_waitcnt lgkmcnt(12)
    v_mfma_f32_16x16x32_bf16 a[16:19], v[36:39], v[64:67], a[16:19]
    v_mfma_f32_16x16x32_bf16 a[20:23], v[36:39], v[68:71], a[20:23]
    s_barrier
    ds_read_b64_tr_b16 v[32:33], v16 offset:40960
    ds_read_b64_tr_b16 v[34:35], v16 offset:42240
    s_waitcnt lgkmcnt(12)
    v_mfma_f32_16x16x32_bf16 a[24:27], v[40:43], v[64:67], a[24:27]
    v_mfma_f32_16x16x32_bf16 a[28:31], v[40:43], v[68:71], a[28:31]
    ds_read_b64_tr_b16 v[36:37], v17 offset:40992
    ds_read_b64_tr_b16 v[38:39], v17 offset:42272
    s_waitcnt lgkmcnt(12)
    v_mfma_f32_16x16x32_bf16 a[32:35], v[44:47], v[64:67], a[32:35]
    v_mfma_f32_16x16x32_bf16 a[36:39], v[44:47], v[68:71], a[36:39]
    ds_read_b64_tr_b16 v[40:41], v16 offset:41024
    ds_read_b64_tr_b16 v[42:43], v16 offset:42304
    s_waitcnt lgkmcnt(12)
    v_mfma_f32_16x16x32_bf16 a[40:43], v[48:51], v[64:67], a[40:43]
    v_mfma_f32_16x16x32_bf16 a[44:47], v[48:51], v[68:71], a[44:47]
    ds_read_b64_tr_b16 v[44:45], v17 offset:41056
    ds_read_b64_tr_b16 v[46:47], v17 offset:42336
    s_waitcnt lgkmcnt(12)
    v_mfma_f32_16x16x32_bf16 a[48:51], v[52:55], v[64:67], a[48:51]
    v_mfma_f32_16x16x32_bf16 a[52:55], v[52:55], v[68:71], a[52:55]
    ds_read_b64_tr_b16 v[48:49], v16 offset:41088
    ds_read_b64_tr_b16 v[50:51], v16 offset:42368
    s_waitcnt lgkmcnt(12)
    v_mfma_f32_16x16x32_bf16 a[56:59], v[24:27], v[64:67], a[56:59]
    v_mfma_f32_16x16x32_bf16 a[60:63], v[24:27], v[68:71], a[60:63]
    ds_read_b64_tr_b16 v[52:53], v17 offset:41120
    ds_read_b64_tr_b16 v[54:55], v17 offset:42400
    s_waitcnt lgkmcnt(12)
    v_mfma_f32_16x16x32_bf16 a[64:67], v[28:31], v[64:67], a[64:67]
    v_mfma_f32_16x16x32_bf16 a[68:71], v[28:31], v[68:71], a[68:71]
    s_add_u32 s33, s34, 40960
    buffer_load_dwordx4 v[56:59], v18, s[20:23], s33 offen
    s_add_u32 s33, s34, 206848
    buffer_load_dwordx4 v[60:63], v18, s[20:23], s33 offen
    ds_read_b64_tr_b16 v[24:25], v16 offset:41152
    ds_read_b64_tr_b16 v[26:27], v16 offset:42432
    s_waitcnt vmcnt(22)
    s_waitcnt lgkmcnt(12)
    v_mfma_f32_16x16x32_bf16 a[0:3], v[32:35], v[72:75], a[0:3]
    v_mfma_f32_16x16x32_bf16 a[4:7], v[32:35], v[76:79], a[4:7]
    ds_read_b64_tr_b16 v[28:29], v17 offset:41184
    ds_read_b64_tr_b16 v[30:31], v17 offset:42464
    s_waitcnt lgkmcnt(12)
    v_mfma_f32_16x16x32_bf16 a[8:11], v[36:39], v[72:75], a[8:11]
    v_mfma_f32_16x16x32_bf16 a[12:15], v[36:39], v[76:79], a[12:15]
    ds_read_b64_tr_b16 v[32:33], v16 offset:41216
    ds_read_b64_tr_b16 v[34:35], v16 offset:42496
    s_waitcnt lgkmcnt(12)
    v_mfma_f32_16x16x32_bf16 a[16:19], v[40:43], v[72:75], a[16:19]
    v_mfma_f32_16x16x32_bf16 a[20:23], v[40:43], v[76:79], a[20:23]
    ds_read_b64_tr_b16 v[36:37], v16 offset:51200
    ds_read_b64_tr_b16 v[38:39], v16 offset:52480
    s_waitcnt lgkmcnt(12)
    v_mfma_f32_16x16x32_bf16 a[24:27], v[44:47], v[72:75], a[24:27]
    v_mfma_f32_16x16x32_bf16 a[28:31], v[44:47], v[76:79], a[28:31]
    ds_read_b64_tr_b16 v[40:41], v17 offset:51232
    ds_read_b64_tr_b16 v[42:43], v17 offset:52512
    s_waitcnt lgkmcnt(12)
    v_mfma_f32_16x16x32_bf16 a[32:35], v[48:51], v[72:75], a[32:35]
    v_mfma_f32_16x16x32_bf16 a[36:39], v[48:51], v[76:79], a[36:39]
    ds_read_b64_tr_b16 v[44:45], v16 offset:51264
    ds_read_b64_tr_b16 v[46:47], v16 offset:52544
    s_waitcnt lgkmcnt(12)
    v_mfma_f32_16x16x32_bf16 a[40:43], v[52:55], v[72:75], a[40:43]
    v_mfma_f32_16x16x32_bf16 a[44:47], v[52:55], v[76:79], a[44:47]
    ds_read_b64_tr_b16 v[48:49], v17 offset:51296
    ds_read_b64_tr_b16 v[50:51], v17 offset:52576
    s_waitcnt lgkmcnt(12)
    v_mfma_f32_16x16x32_bf16 a[48:51], v[24:27], v[72:75], a[48:51]
    v_mfma_f32_16x16x32_bf16 a[52:55], v[24:27], v[76:79], a[52:55]
    ds_read_b64_tr_b16 v[52:53], v16 offset:51328
    ds_read_b64_tr_b16 v[54:55], v16 offset:52608
    s_waitcnt lgkmcnt(12)
    v_mfma_f32_16x16x32_bf16 a[56:59], v[28:31], v[72:75], a[56:59]
    v_mfma_f32_16x16x32_bf16 a[60:63], v[28:31], v[76:79], a[60:63]
    ds_read_b64_tr_b16 v[24:25], v17 offset:51360
    ds_read_b64_tr_b16 v[26:27], v17 offset:52640
    s_waitcnt lgkmcnt(12)
    v_mfma_f32_16x16x32_bf16 a[64:67], v[32:35], v[72:75], a[64:67]
    v_mfma_f32_16x16x32_bf16 a[68:71], v[32:35], v[76:79], a[68:71]
    s_add_u32 s33, s34, 41984
    buffer_load_dwordx4 v[64:67], v18, s[20:23], s33 offen
    s_add_u32 s33, s34, 207872
    buffer_load_dwordx4 v[68:71], v18, s[20:23], s33 offen
    ds_read_b64_tr_b16 v[28:29], v16 offset:51392
    ds_read_b64_tr_b16 v[30:31], v16 offset:52672
    s_waitcnt vmcnt(22)
    s_waitcnt lgkmcnt(12)
    v_mfma_f32_16x16x32_bf16 a[0:3], v[36:39], v[80:83], a[0:3]
    v_mfma_f32_16x16x32_bf16 a[4:7], v[36:39], v[84:87], a[4:7]
    ds_read_b64_tr_b16 v[32:33], v17 offset:51424
    ds_read_b64_tr_b16 v[34:35], v17 offset:52704
    s_waitcnt lgkmcnt(12)
    v_mfma_f32_16x16x32_bf16 a[8:11], v[40:43], v[80:83], a[8:11]
    v_mfma_f32_16x16x32_bf16 a[12:15], v[40:43], v[84:87], a[12:15]
    ds_read_b64_tr_b16 v[36:37], v16 offset:51456
    ds_read_b64_tr_b16 v[38:39], v16 offset:52736
    s_waitcnt lgkmcnt(12)
    v_mfma_f32_16x16x32_bf16 a[16:19], v[44:47], v[80:83], a[16:19]
    v_mfma_f32_16x16x32_bf16 a[20:23], v[44:47], v[84:87], a[20:23]
    s_barrier
    ds_read_b64_tr_b16 v[40:41], v14 offset:0
    ds_read_b64_tr_b16 v[42:43], v14 offset:1280
    s_waitcnt lgkmcnt(12)
    v_mfma_f32_16x16x32_bf16 a[24:27], v[48:51], v[80:83], a[24:27]
    v_mfma_f32_16x16x32_bf16 a[28:31], v[48:51], v[84:87], a[28:31]
    ds_read_b64_tr_b16 v[44:45], v15 offset:32
    ds_read_b64_tr_b16 v[46:47], v15 offset:1312
    s_waitcnt lgkmcnt(12)
    v_mfma_f32_16x16x32_bf16 a[32:35], v[52:55], v[80:83], a[32:35]
    v_mfma_f32_16x16x32_bf16 a[36:39], v[52:55], v[84:87], a[36:39]
    ds_read_b64_tr_b16 v[48:49], v14 offset:64
    ds_read_b64_tr_b16 v[50:51], v14 offset:1344
    s_waitcnt lgkmcnt(12)
    v_mfma_f32_16x16x32_bf16 a[40:43], v[24:27], v[80:83], a[40:43]
    v_mfma_f32_16x16x32_bf16 a[44:47], v[24:27], v[84:87], a[44:47]
    ds_read_b64_tr_b16 v[52:53], v15 offset:96
    ds_read_b64_tr_b16 v[54:55], v15 offset:1376
    s_waitcnt lgkmcnt(12)
    v_mfma_f32_16x16x32_bf16 a[48:51], v[28:31], v[80:83], a[48:51]
    v_mfma_f32_16x16x32_bf16 a[52:55], v[28:31], v[84:87], a[52:55]
    ds_read_b64_tr_b16 v[24:25], v14 offset:128
    ds_read_b64_tr_b16 v[26:27], v14 offset:1408
    s_waitcnt lgkmcnt(12)
    v_mfma_f32_16x16x32_bf16 a[56:59], v[32:35], v[80:83], a[56:59]
    v_mfma_f32_16x16x32_bf16 a[60:63], v[32:35], v[84:87], a[60:63]
    ds_read_b64_tr_b16 v[28:29], v15 offset:160
    ds_read_b64_tr_b16 v[30:31], v15 offset:1440
    s_waitcnt lgkmcnt(12)
    v_mfma_f32_16x16x32_bf16 a[64:67], v[36:39], v[80:83], a[64:67]
    v_mfma_f32_16x16x32_bf16 a[68:71], v[36:39], v[84:87], a[68:71]
    ds_read_b64_tr_b16 v[32:33], v14 offset:192
    ds_read_b64_tr_b16 v[34:35], v14 offset:1472
    s_waitcnt vmcnt(15)
    s_waitcnt lgkmcnt(12)
    v_mfma_f32_16x16x32_bf16 a[0:3], v[40:43], v[88:91], a[0:3]
    v_mfma_f32_16x16x32_bf16 a[4:7], v[40:43], v[92:95], a[4:7]
    ds_read_b64_tr_b16 v[36:37], v15 offset:224
    ds_read_b64_tr_b16 v[38:39], v15 offset:1504
    s_waitcnt lgkmcnt(12)
    v_mfma_f32_16x16x32_bf16 a[8:11], v[44:47], v[88:91], a[8:11]
    v_mfma_f32_16x16x32_bf16 a[12:15], v[44:47], v[92:95], a[12:15]
    ds_read_b64_tr_b16 v[40:41], v14 offset:256
    ds_read_b64_tr_b16 v[42:43], v14 offset:1536
    s_waitcnt lgkmcnt(12)
    v_mfma_f32_16x16x32_bf16 a[16:19], v[48:51], v[88:91], a[16:19]
    v_mfma_f32_16x16x32_bf16 a[20:23], v[48:51], v[92:95], a[20:23]
    ds_read_b64_tr_b16 v[44:45], v14 offset:10240
    ds_read_b64_tr_b16 v[46:47], v14 offset:11520
    s_waitcnt lgkmcnt(12)
    v_mfma_f32_16x16x32_bf16 a[24:27], v[52:55], v[88:91], a[24:27]
    v_mfma_f32_16x16x32_bf16 a[28:31], v[52:55], v[92:95], a[28:31]
    ds_read_b64_tr_b16 v[48:49], v15 offset:10272
    ds_read_b64_tr_b16 v[50:51], v15 offset:11552
    s_waitcnt lgkmcnt(12)
    v_mfma_f32_16x16x32_bf16 a[32:35], v[24:27], v[88:91], a[32:35]
    v_mfma_f32_16x16x32_bf16 a[36:39], v[24:27], v[92:95], a[36:39]
    ds_read_b64_tr_b16 v[52:53], v14 offset:10304
    ds_read_b64_tr_b16 v[54:55], v14 offset:11584
    s_waitcnt lgkmcnt(12)
    v_mfma_f32_16x16x32_bf16 a[40:43], v[28:31], v[88:91], a[40:43]
    v_mfma_f32_16x16x32_bf16 a[44:47], v[28:31], v[92:95], a[44:47]
    ds_read_b64_tr_b16 v[24:25], v15 offset:10336
    ds_read_b64_tr_b16 v[26:27], v15 offset:11616
    s_waitcnt lgkmcnt(12)
    v_mfma_f32_16x16x32_bf16 a[48:51], v[32:35], v[88:91], a[48:51]
    v_mfma_f32_16x16x32_bf16 a[52:55], v[32:35], v[92:95], a[52:55]
    ds_read_b64_tr_b16 v[28:29], v14 offset:10368
    ds_read_b64_tr_b16 v[30:31], v14 offset:11648
    s_waitcnt lgkmcnt(12)
    v_mfma_f32_16x16x32_bf16 a[56:59], v[36:39], v[88:91], a[56:59]
    v_mfma_f32_16x16x32_bf16 a[60:63], v[36:39], v[92:95], a[60:63]
    ds_read_b64_tr_b16 v[32:33], v15 offset:10400
    ds_read_b64_tr_b16 v[34:35], v15 offset:11680
    s_waitcnt lgkmcnt(12)
    v_mfma_f32_16x16x32_bf16 a[64:67], v[40:43], v[88:91], a[64:67]
    v_mfma_f32_16x16x32_bf16 a[68:71], v[40:43], v[92:95], a[68:71]
    ds_read_b64_tr_b16 v[36:37], v14 offset:10432
    ds_read_b64_tr_b16 v[38:39], v14 offset:11712
    s_waitcnt vmcnt(13)
    s_waitcnt lgkmcnt(12)
    v_mfma_f32_16x16x32_bf16 a[0:3], v[44:47], v[96:99], a[0:3]
    v_mfma_f32_16x16x32_bf16 a[4:7], v[44:47], v[100:103], a[4:7]
    ds_read_b64_tr_b16 v[40:41], v15 offset:10464
    ds_read_b64_tr_b16 v[42:43], v15 offset:11744
    s_waitcnt lgkmcnt(12)
    v_mfma_f32_16x16x32_bf16 a[8:11], v[48:51], v[96:99], a[8:11]
    v_mfma_f32_16x16x32_bf16 a[12:15], v[48:51], v[100:103], a[12:15]
    ds_read_b64_tr_b16 v[44:45], v14 offset:10496
    ds_read_b64_tr_b16 v[46:47], v14 offset:11776
    s_waitcnt lgkmcnt(12)
    v_mfma_f32_16x16x32_bf16 a[16:19], v[52:55], v[96:99], a[16:19]
    v_mfma_f32_16x16x32_bf16 a[20:23], v[52:55], v[100:103], a[20:23]
    s_barrier
    ds_read_b64_tr_b16 v[48:49], v14 offset:20480
    ds_read_b64_tr_b16 v[50:51], v14 offset:21760
    s_waitcnt lgkmcnt(12)
    v_mfma_f32_16x16x32_bf16 a[24:27], v[24:27], v[96:99], a[24:27]
    v_mfma_f32_16x16x32_bf16 a[28:31], v[24:27], v[100:103], a[28:31]
    ds_read_b64_tr_b16 v[52:53], v15 offset:20512
    ds_read_b64_tr_b16 v[54:55], v15 offset:21792
    s_waitcnt lgkmcnt(12)
    v_mfma_f32_16x16x32_bf16 a[32:35], v[28:31], v[96:99], a[32:35]
    v_mfma_f32_16x16x32_bf16 a[36:39], v[28:31], v[100:103], a[36:39]
    ds_read_b64_tr_b16 v[24:25], v14 offset:20544
    ds_read_b64_tr_b16 v[26:27], v14 offset:21824
    s_waitcnt lgkmcnt(12)
    v_mfma_f32_16x16x32_bf16 a[40:43], v[32:35], v[96:99], a[40:43]
    v_mfma_f32_16x16x32_bf16 a[44:47], v[32:35], v[100:103], a[44:47]
    ds_read_b64_tr_b16 v[28:29], v15 offset:20576
    ds_read_b64_tr_b16 v[30:31], v15 offset:21856
    s_waitcnt lgkmcnt(12)
    v_mfma_f32_16x16x32_bf16 a[48:51], v[36:39], v[96:99], a[48:51]
    v_mfma_f32_16x16x32_bf16 a[52:55], v[36:39], v[100:103], a[52:55]
    ds_read_b64_tr_b16 v[32:33], v14 offset:20608
    ds_read_b64_tr_b16 v[34:35], v14 offset:21888
    s_waitcnt lgkmcnt(12)
    v_mfma_f32_16x16x32_bf16 a[56:59], v[40:43], v[96:99], a[56:59]
    v_mfma_f32_16x16x32_bf16 a[60:63], v[40:43], v[100:103], a[60:63]
    ds_read_b64_tr_b16 v[36:37], v15 offset:20640
    ds_read_b64_tr_b16 v[38:39], v15 offset:21920
    s_waitcnt lgkmcnt(12)
    v_mfma_f32_16x16x32_bf16 a[64:67], v[44:47], v[96:99], a[64:67]
    v_mfma_f32_16x16x32_bf16 a[68:71], v[44:47], v[100:103], a[68:71]
    ds_read_b64_tr_b16 v[40:41], v14 offset:20672
    ds_read_b64_tr_b16 v[42:43], v14 offset:21952
    s_waitcnt vmcnt(6)
    s_waitcnt lgkmcnt(12)
    v_mfma_f32_16x16x32_bf16 a[0:3], v[48:51], v[104:107], a[0:3]
    v_mfma_f32_16x16x32_bf16 a[4:7], v[48:51], v[108:111], a[4:7]
    ds_read_b64_tr_b16 v[44:45], v15 offset:20704
    ds_read_b64_tr_b16 v[46:47], v15 offset:21984
    s_waitcnt lgkmcnt(12)
    v_mfma_f32_16x16x32_bf16 a[8:11], v[52:55], v[104:107], a[8:11]
    v_mfma_f32_16x16x32_bf16 a[12:15], v[52:55], v[108:111], a[12:15]
    ds_read_b64_tr_b16 v[48:49], v14 offset:20736
    ds_read_b64_tr_b16 v[50:51], v14 offset:22016
    s_waitcnt lgkmcnt(12)
    v_mfma_f32_16x16x32_bf16 a[16:19], v[24:27], v[104:107], a[16:19]
    v_mfma_f32_16x16x32_bf16 a[20:23], v[24:27], v[108:111], a[20:23]
    ds_read_b64_tr_b16 v[52:53], v14 offset:30720
    ds_read_b64_tr_b16 v[54:55], v14 offset:32000
    s_waitcnt lgkmcnt(12)
    v_mfma_f32_16x16x32_bf16 a[24:27], v[28:31], v[104:107], a[24:27]
    v_mfma_f32_16x16x32_bf16 a[28:31], v[28:31], v[108:111], a[28:31]
    ds_read_b64_tr_b16 v[24:25], v15 offset:30752
    ds_read_b64_tr_b16 v[26:27], v15 offset:32032
    s_waitcnt lgkmcnt(12)
    v_mfma_f32_16x16x32_bf16 a[32:35], v[32:35], v[104:107], a[32:35]
    v_mfma_f32_16x16x32_bf16 a[36:39], v[32:35], v[108:111], a[36:39]
    ds_read_b64_tr_b16 v[28:29], v14 offset:30784
    ds_read_b64_tr_b16 v[30:31], v14 offset:32064
    s_waitcnt lgkmcnt(12)
    v_mfma_f32_16x16x32_bf16 a[40:43], v[36:39], v[104:107], a[40:43]
    v_mfma_f32_16x16x32_bf16 a[44:47], v[36:39], v[108:111], a[44:47]
    ds_read_b64_tr_b16 v[32:33], v15 offset:30816
    ds_read_b64_tr_b16 v[34:35], v15 offset:32096
    s_waitcnt lgkmcnt(12)
    v_mfma_f32_16x16x32_bf16 a[48:51], v[40:43], v[104:107], a[48:51]
    v_mfma_f32_16x16x32_bf16 a[52:55], v[40:43], v[108:111], a[52:55]
    ds_read_b64_tr_b16 v[36:37], v14 offset:30848
    ds_read_b64_tr_b16 v[38:39], v14 offset:32128
    s_waitcnt lgkmcnt(12)
    v_mfma_f32_16x16x32_bf16 a[56:59], v[44:47], v[104:107], a[56:59]
    v_mfma_f32_16x16x32_bf16 a[60:63], v[44:47], v[108:111], a[60:63]
    ds_read_b64_tr_b16 v[40:41], v15 offset:30880
    ds_read_b64_tr_b16 v[42:43], v15 offset:32160
    s_waitcnt lgkmcnt(12)
    v_mfma_f32_16x16x32_bf16 a[64:67], v[48:51], v[104:107], a[64:67]
    v_mfma_f32_16x16x32_bf16 a[68:71], v[48:51], v[108:111], a[68:71]
    ds_read_b64_tr_b16 v[44:45], v14 offset:30912
    ds_read_b64_tr_b16 v[46:47], v14 offset:32192
    s_waitcnt vmcnt(4)
    s_waitcnt lgkmcnt(12)
    v_mfma_f32_16x16x32_bf16 a[0:3], v[52:55], v[112:115], a[0:3]
    v_mfma_f32_16x16x32_bf16 a[4:7], v[52:55], v[116:119], a[4:7]
    ds_read_b64_tr_b16 v[48:49], v15 offset:30944
    ds_read_b64_tr_b16 v[50:51], v15 offset:32224
    s_waitcnt lgkmcnt(12)
    v_mfma_f32_16x16x32_bf16 a[8:11], v[24:27], v[112:115], a[8:11]
    v_mfma_f32_16x16x32_bf16 a[12:15], v[24:27], v[116:119], a[12:15]
    ds_read_b64_tr_b16 v[52:53], v14 offset:30976
    ds_read_b64_tr_b16 v[54:55], v14 offset:32256
    s_waitcnt lgkmcnt(12)
    v_mfma_f32_16x16x32_bf16 a[16:19], v[28:31], v[112:115], a[16:19]
    v_mfma_f32_16x16x32_bf16 a[20:23], v[28:31], v[116:119], a[20:23]
    s_barrier
    ds_read_b64_tr_b16 v[24:25], v14 offset:40960
    ds_read_b64_tr_b16 v[26:27], v14 offset:42240
    s_waitcnt lgkmcnt(12)
    v_mfma_f32_16x16x32_bf16 a[24:27], v[32:35], v[112:115], a[24:27]
    v_mfma_f32_16x16x32_bf16 a[28:31], v[32:35], v[116:119], a[28:31]
    ds_read_b64_tr_b16 v[28:29], v15 offset:40992
    ds_read_b64_tr_b16 v[30:31], v15 offset:42272
    s_waitcnt lgkmcnt(12)
    v_mfma_f32_16x16x32_bf16 a[32:35], v[36:39], v[112:115], a[32:35]
    v_mfma_f32_16x16x32_bf16 a[36:39], v[36:39], v[116:119], a[36:39]
    ds_read_b64_tr_b16 v[32:33], v14 offset:41024
    ds_read_b64_tr_b16 v[34:35], v14 offset:42304
    s_waitcnt lgkmcnt(12)
    v_mfma_f32_16x16x32_bf16 a[40:43], v[40:43], v[112:115], a[40:43]
    v_mfma_f32_16x16x32_bf16 a[44:47], v[40:43], v[116:119], a[44:47]
    ds_read_b64_tr_b16 v[36:37], v15 offset:41056
    ds_read_b64_tr_b16 v[38:39], v15 offset:42336
    s_waitcnt lgkmcnt(12)
    v_mfma_f32_16x16x32_bf16 a[48:51], v[44:47], v[112:115], a[48:51]
    v_mfma_f32_16x16x32_bf16 a[52:55], v[44:47], v[116:119], a[52:55]
    ds_read_b64_tr_b16 v[40:41], v14 offset:41088
    ds_read_b64_tr_b16 v[42:43], v14 offset:42368
    s_waitcnt lgkmcnt(12)
    v_mfma_f32_16x16x32_bf16 a[56:59], v[48:51], v[112:115], a[56:59]
    v_mfma_f32_16x16x32_bf16 a[60:63], v[48:51], v[116:119], a[60:63]
    ds_read_b64_tr_b16 v[44:45], v15 offset:41120
    ds_read_b64_tr_b16 v[46:47], v15 offset:42400
    s_waitcnt lgkmcnt(12)
    v_mfma_f32_16x16x32_bf16 a[64:67], v[52:55], v[112:115], a[64:67]
    v_mfma_f32_16x16x32_bf16 a[68:71], v[52:55], v[116:119], a[68:71]
    ds_read_b64_tr_b16 v[48:49], v14 offset:41152
    ds_read_b64_tr_b16 v[50:51], v14 offset:42432
    s_waitcnt vmcnt(2)
    s_waitcnt lgkmcnt(12)
    v_mfma_f32_16x16x32_bf16 a[0:3], v[24:27], v[56:59], a[0:3]
    v_mfma_f32_16x16x32_bf16 a[4:7], v[24:27], v[60:63], a[4:7]
    ds_read_b64_tr_b16 v[52:53], v15 offset:41184
    ds_read_b64_tr_b16 v[54:55], v15 offset:42464
    s_waitcnt lgkmcnt(12)
    v_mfma_f32_16x16x32_bf16 a[8:11], v[28:31], v[56:59], a[8:11]
    v_mfma_f32_16x16x32_bf16 a[12:15], v[28:31], v[60:63], a[12:15]
    ds_read_b64_tr_b16 v[24:25], v14 offset:41216
    ds_read_b64_tr_b16 v[26:27], v14 offset:42496
    s_waitcnt lgkmcnt(12)
    v_mfma_f32_16x16x32_bf16 a[16:19], v[32:35], v[56:59], a[16:19]
    v_mfma_f32_16x16x32_bf16 a[20:23], v[32:35], v[60:63], a[20:23]
    ds_read_b64_tr_b16 v[28:29], v14 offset:51200
    ds_read_b64_tr_b16 v[30:31], v14 offset:52480
    s_waitcnt lgkmcnt(12)
    v_mfma_f32_16x16x32_bf16 a[24:27], v[36:39], v[56:59], a[24:27]
    v_mfma_f32_16x16x32_bf16 a[28:31], v[36:39], v[60:63], a[28:31]
    ds_read_b64_tr_b16 v[32:33], v15 offset:51232
    ds_read_b64_tr_b16 v[34:35], v15 offset:52512
    s_waitcnt lgkmcnt(12)
    v_mfma_f32_16x16x32_bf16 a[32:35], v[40:43], v[56:59], a[32:35]
    v_mfma_f32_16x16x32_bf16 a[36:39], v[40:43], v[60:63], a[36:39]
    ds_read_b64_tr_b16 v[36:37], v14 offset:51264
    ds_read_b64_tr_b16 v[38:39], v14 offset:52544
    s_waitcnt lgkmcnt(12)
    v_mfma_f32_16x16x32_bf16 a[40:43], v[44:47], v[56:59], a[40:43]
    v_mfma_f32_16x16x32_bf16 a[44:47], v[44:47], v[60:63], a[44:47]
    ds_read_b64_tr_b16 v[40:41], v15 offset:51296
    ds_read_b64_tr_b16 v[42:43], v15 offset:52576
    s_waitcnt lgkmcnt(12)
    v_mfma_f32_16x16x32_bf16 a[48:51], v[48:51], v[56:59], a[48:51]
    v_mfma_f32_16x16x32_bf16 a[52:55], v[48:51], v[60:63], a[52:55]
    ds_read_b64_tr_b16 v[44:45], v14 offset:51328
    ds_read_b64_tr_b16 v[46:47], v14 offset:52608
    s_waitcnt lgkmcnt(12)
    v_mfma_f32_16x16x32_bf16 a[56:59], v[52:55], v[56:59], a[56:59]
    v_mfma_f32_16x16x32_bf16 a[60:63], v[52:55], v[60:63], a[60:63]
    ds_read_b64_tr_b16 v[48:49], v15 offset:51360
    ds_read_b64_tr_b16 v[50:51], v15 offset:52640
    s_waitcnt lgkmcnt(12)
    v_mfma_f32_16x16x32_bf16 a[64:67], v[24:27], v[56:59], a[64:67]
    v_mfma_f32_16x16x32_bf16 a[68:71], v[24:27], v[60:63], a[68:71]
    ds_read_b64_tr_b16 v[52:53], v14 offset:51392
    ds_read_b64_tr_b16 v[54:55], v14 offset:52672
    s_waitcnt vmcnt(0)
    s_waitcnt lgkmcnt(12)
    v_mfma_f32_16x16x32_bf16 a[0:3], v[28:31], v[64:67], a[0:3]
    v_mfma_f32_16x16x32_bf16 a[4:7], v[28:31], v[68:71], a[4:7]
    ds_read_b64_tr_b16 v[24:25], v15 offset:51424
    ds_read_b64_tr_b16 v[26:27], v15 offset:52704
    s_waitcnt lgkmcnt(12)
    v_mfma_f32_16x16x32_bf16 a[8:11], v[32:35], v[64:67], a[8:11]
    v_mfma_f32_16x16x32_bf16 a[12:15], v[32:35], v[68:71], a[12:15]
    ds_read_b64_tr_b16 v[28:29], v14 offset:51456
    ds_read_b64_tr_b16 v[30:31], v14 offset:52736
    s_waitcnt lgkmcnt(12)
    v_mfma_f32_16x16x32_bf16 a[16:19], v[36:39], v[64:67], a[16:19]
    v_mfma_f32_16x16x32_bf16 a[20:23], v[36:39], v[68:71], a[20:23]
    s_waitcnt lgkmcnt(10)
    v_mfma_f32_16x16x32_bf16 a[24:27], v[40:43], v[64:67], a[24:27]
    v_mfma_f32_16x16x32_bf16 a[28:31], v[40:43], v[68:71], a[28:31]
    s_waitcnt lgkmcnt(8)
    v_mfma_f32_16x16x32_bf16 a[32:35], v[44:47], v[64:67], a[32:35]
    v_mfma_f32_16x16x32_bf16 a[36:39], v[44:47], v[68:71], a[36:39]
    s_waitcnt lgkmcnt(6)
    v_mfma_f32_16x16x32_bf16 a[40:43], v[48:51], v[64:67], a[40:43]
    v_mfma_f32_16x16x32_bf16 a[44:47], v[48:51], v[68:71], a[44:47]
    s_waitcnt lgkmcnt(4)
    v_mfma_f32_16x16x32_bf16 a[48:51], v[52:55], v[64:67], a[48:51]
    v_mfma_f32_16x16x32_bf16 a[52:55], v[52:55], v[68:71], a[52:55]
    s_waitcnt lgkmcnt(2)
    v_mfma_f32_16x16x32_bf16 a[56:59], v[24:27], v[64:67], a[56:59]
    v_mfma_f32_16x16x32_bf16 a[60:63], v[24:27], v[68:71], a[60:63]
    s_waitcnt lgkmcnt(0)
    v_mfma_f32_16x16x32_bf16 a[64:67], v[28:31], v[64:67], a[64:67]
    v_mfma_f32_16x16x32_bf16 a[68:71], v[28:31], v[68:71], a[68:71]
    s_branch L_k3_gemm2_kernel_epi
L_k3_gemm2_kernel_v1:
    s_mul_i32 s32, s28, 40
    s_add_u32 s32, s32, 2
    s_lshl_b32 s34, s32, 10
    s_sub_u32 s32, s32, 18
    s_mul_i32 s35, s32, 36864
    s_add_u32 s33, s34, 0
    buffer_load_dwordx4 v[56:59], v18, s[20:23], s33 offen
    s_add_u32 s33, s34, 165888
    buffer_load_dwordx4 v[60:63], v18, s[20:23], s33 offen
    s_add_u32 s33, s34, 1024
    buffer_load_dwordx4 v[64:67], v18, s[20:23], s33 offen
    s_add_u32 s33, s34, 166912
    buffer_load_dwordx4 v[68:71], v18, s[20:23], s33 offen
    s_add_u32 s33, s34, 2048
    buffer_load_dwordx4 v[72:75], v18, s[20:23], s33 offen
    s_add_u32 s33, s34, 167936
    buffer_load_dwordx4 v[76:79], v18, s[20:23], s33 offen
    s_add_u32 s33, s34, 3072
    buffer_load_dwordx4 v[80:83], v18, s[20:23], s33 offen
    s_add_u32 s33, s34, 168960
    buffer_load_dwordx4 v[84:87], v18, s[20:23], s33 offen
    s_add_u32 s33, s34, 4096
    buffer_load_dwordx4 v[88:91], v18, s[20:23], s33 offen
    s_add_u32 s33, s34, 169984
    buffer_load_dwordx4 v[92:95], v18, s[20:23], s33 offen
    s_add_u32 s33, s34, 5120
    buffer_load_dwordx4 v[96:99], v18, s[20:23], s33 offen
    s_add_u32 s33, s34, 171008
    buffer_load_dwordx4 v[100:103], v18, s[20:23], s33 offen
    s_add_u32 m0, s36, 0
    buffer_load_dwordx4 v9, s[16:19], s35 offen lds
    s_add_u32 m0, s36, 4096
    buffer_load_dwordx4 v10, s[16:19], s35 offen lds
    s_add_u32 m0, s36, 8192
    buffer_load_dwordx4 v11, s[16:19], s35 offen lds
    s_add_u32 m0, s36, 12288
    buffer_load_dwordx4 v12, s[16:19], s35 offen lds
    s_add_u32 m0, s36, 16384
    buffer_load_dwordx4 v13, s[16:19], s35 offen lds
    s_add_u32 s35, s35, 73728
    s_add_u32 m0, s36, 20480
    buffer_load_dwordx4 v9, s[16:19], s35 offen lds
    s_add_u32 m0, s36, 24576
    buffer_load_dwordx4 v10, s[16:19], s35 offen lds
    s_add_u32 m0, s36, 28672
    buffer_load_dwordx4 v11, s[16:19], s35 offen lds
    s_add_u32 m0, s36, 32768
    buffer_load_dwordx4 v12, s[16:19], s35 offen lds
    s_add_u32 m0, s36, 36864
    buffer_load_dwordx4 v13, s[16:19], s35 offen lds
    s_add_u32 s35, s35, 73728
    s_add_u32 m0, s36, 40960
    buffer_load_dwordx4 v9, s[16:19], s35 offen lds
    s_add_u32 m0, s36, 45056
    buffer_load_dwordx4 v10, s[16:19], s35 offen lds
    s_add_u32 m0, s36, 49152
    buffer_load_dwordx4 v11, s[16:19], s35 offen lds
    s_add_u32 m0, s36, 53248
    buffer_load_dwordx4 v12, s[16:19], s35 offen lds
    s_add_u32 m0, s36, 57344
    buffer_load_dwordx4 v13, s[16:19], s35 offen lds
    s_add_u32 s35, s35, 73728
    s_add_u32 m0, s36, 61440
    buffer_load_dwordx4 v9, s[16:19], s35 offen lds
    s_add_u32 m0, s36, 65536
    buffer_load_dwordx4 v10, s[16:19], s35 offen lds
    s_add_u32 m0, s36, 69632
    buffer_load_dwordx4 v11, s[16:19], s35 offen lds
    s_add_u32 m0, s36, 73728
    buffer_load_dwordx4 v12, s[16:19], s35 offen lds
    s_add_u32 m0, s36, 77824
    buffer_load_dwordx4 v13, s[16:19], s35 offen lds
    s_add_u32 s35, s35, 73728
    s_waitcnt vmcnt(15)
    s_barrier
    s_add_u32 m0, s36, 81920
    buffer_load_dwordx4 v9, s[16:19], s35 offen lds
    s_add_u32 m0, s36, 86016
    buffer_load_dwordx4 v10, s[16:19], s35 offen lds
    s_add_u32 m0, s36, 90112
    buffer_load_dwordx4 v11, s[16:19], s35 offen lds
    s_add_u32 m0, s36, 94208
    buffer_load_dwordx4 v12, s[16:19], s35 offen lds
    s_add_u32 m0, s36, 98304
    buffer_load_dwordx4 v13, s[16:19], s35 offen lds
    s_add_u32 s35, s35, 73728
    ds_read_b64_tr_b16 v[24:25], v14 offset:0
    ds_read_b64_tr_b16 v[26:27], v14 offset:1280
    ds_read_b64_tr_b16 v[28:29], v15 offset:32
    ds_read_b64_tr_b16 v[30:31], v15 offset:1312
    ds_read_b64_tr_b16 v[32:33], v14 offset:64
    ds_read_b64_tr_b16 v[34:35], v14 offset:1344
    ds_read_b64_tr_b16 v[36:37], v15 offset:96
    ds_read_b64_tr_b16 v[38:39], v15 offset:1376
    ds_read_b64_tr_b16 v[40:41], v14 offset:128
    ds_read_b64_tr_b16 v[42:43], v14 offset:1408
    ds_read_b64_tr_b16 v[44:45], v15 offset:160
    ds_read_b64_tr_b16 v[46:47], v15 offset:1440
    s_add_u32 s33, s34, 6144
    buffer_load_dwordx4 v[104:107], v18, s[20:23], s33 offen
    s_add_u32 s33, s34, 172032
    buffer_load_dwordx4 v[108:111], v18, s[20:23], s33 offen
    ds_read_b64_tr_b16 v[48:49], v14 offset:192
    ds_read_b64_tr_b16 v[50:51], v14 offset:1472
    s_waitcnt lgkmcnt(12)
    v_mfma_f32_16x16x32_bf16 a[0:3], v[24:27], v[56:59], 0
    v_mfma_f32_16x16x32_bf16 a[4:7], v[24:27], v[60:63], 0
    ds_read_b64_tr_b16 v[52:53], v15 offset:224
    ds_read_b64_tr_b16 v[54:55], v15 offset:1504
    s_waitcnt lgkmcnt(12)
    v_mfma_f32_16x16x32_bf16 a[8:11], v[28:31], v[56:59], 0
    v_mfma_f32_16x16x32_bf16 a[12:15], v[28:31], v[60:63], 0
    ds_read_b64_tr_b16 v[24:25], v14 offset:256
    ds_read_b64_tr_b16 v[26:27], v14 offset:1536
    s_waitcnt lgkmcnt(12)
    v_mfma_f32_16x16x32_bf16 a[16:19], v[32:35], v[56:59], 0
    v_mfma_f32_16x16x32_bf16 a[20:23], v[32:35], v[60:63], 0
    ds_read_b64_tr_b16 v[28:29], v14 offset:10240
    ds_read_b64_tr_b16 v[30:31], v14 offset:11520
    s_waitcnt lgkmcnt(12)
    v_mfma_f32_16x16x32_bf16 a[24:27], v[36:39], v[56:59], 0
    v_mfma_f32_16x16x32_bf16 a[28:31], v[36:39], v[60:63], 0
    ds_read_b64_tr_b16 v[32:33], v15 offset:10272
    ds_read_b64_tr_b16 v[34:35], v15 offset:11552
    s_waitcnt lgkmcnt(12)
    v_mfma_f32_16x16x32_bf16 a[32:35], v[40:43], v[56:59], 0
    v_mfma_f32_16x16x32_bf16 a[36:39], v[40:43], v[60:63], 0
    ds_read_b64_tr_b16 v[36:37], v14 offset:10304
    ds_read_b64_tr_b16 v[38:39], v14 offset:11584
    s_waitcnt lgkmcnt(12)
    v_mfma_f32_16x16x32_bf16 a[40:43], v[44:47], v[56:59], 0
    v_mfma_f32_16x16x32_bf16 a[44:47], v[44:47], v[60:63], 0
    ds_read_b64_tr_b16 v[40:41], v15 offset:10336
    ds_read_b64_tr_b16 v[42:43], v15 offset:11616
    s_waitcnt lgkmcnt(12)
    v_mfma_f32_16x16x32_bf16 a[48:51], v[48:51], v[56:59], 0
    v_mfma_f32_16x16x32_bf16 a[52:55], v[48:51], v[60:63], 0
    ds_read_b64_tr_b16 v[44:45], v14 offset:10368
    ds_read_b64_tr_b16 v[46:47], v14 offset:11648
    s_waitcnt lgkmcnt(12)
    v_mfma_f32_16x16x32_bf16 a[56:59], v[52:55], v[56:59], 0
    v_mfma_f32_16x16x32_bf16 a[60:63], v[52:55], v[60:63], 0
    ds_read_b64_tr_b16 v[48:49], v15 offset:10400
    ds_read_b64_tr_b16 v[50:51], v15 offset:11680
    s_waitcnt lgkmcnt(12)
    v_mfma_f32_16x16x32_bf16 a[64:67], v[24:27], v[56:59], 0
    v_mfma_f32_16x16x32_bf16 a[68:71], v[24:27], v[60:63], 0
    s_add_u32 s33, s34, 7168
    buffer_load_dwordx4 v[112:115], v18, s[20:23], s33 offen
    s_add_u32 s33, s34, 173056
    buffer_load_dwordx4 v[116:119], v18, s[20:23], s33 offen
    ds_read_b64_tr_b16 v[52:53], v14 offset:10432
    ds_read_b64_tr_b16 v[54:55], v14 offset:11712
    s_waitcnt lgkmcnt(12)
    v_mfma_f32_16x16x32_bf16 a[0:3], v[28:31], v[64:67], a[0:3]
    v_mfma_f32_16x16x32_bf16 a[4:7], v[28:31], v[68:71], a[4:7]
    ds_read_b64_tr_b16 v[24:25], v15 offset:10464
    ds_read_b64_tr_b16 v[26:27], v15 offset:11744
    s_waitcnt lgkmcnt(12)
    v_mfma_f32_16x16x32_bf16 a[8:11], v[32:35], v[64:67], a[8:11]
    v_mfma_f32_16x16x32_bf16 a[12:15], v[32:35], v[68:71], a[12:15]
    ds_read_b64_tr_b16 v[28:29], v14 offset:10496
    ds_read_b64_tr_b16 v[30:31], v14 offset:11776
    s_waitcnt lgkmcnt(12)
    v_mfma_f32_16x16x32_bf16 a[16:19], v[36:39], v[64:67], a[16:19]
    v_mfma_f32_16x16x32_bf16 a[20:23], v[36:39], v[68:71], a[20:23]
    s_waitcnt vmcnt(19)
    s_barrier
    s_add_u32 m0, s36, 102400
    buffer_load_dwordx4 v9, s[16:19], s35 offen lds
    s_add_u32 m0, s36, 106496
    buffer_load_dwordx4 v10, s[16:19], s35 offen lds
    s_add_u32 m0, s36, 110592
    buffer_load_dwordx4 v11, s[16:19], s35 offen lds
    s_add_u32 m0, s36, 114688
    buffer_load_dwordx4 v12, s[16:19], s35 offen lds
    s_add_u32 m0, s36, 118784
    buffer_load_dwordx4 v13, s[16:19], s35 offen lds
    s_add_u32 s35, s35, 73728
    ds_read_b64_tr_b16 v[32:33], v14 offset:20480
    ds_read_b64_tr_b16 v[34:35], v14 offset:21760
    s_waitcnt lgkmcnt(12)
    v_mfma_f32_16x16x32_bf16 a[24:27], v[40:43], v[64:67], a[24:27]
    v_mfma_f32_16x16x32_bf16 a[28:31], v[40:43], v[68:71], a[28:31]
    ds_read_b64_tr_b16 v[36:37], v15 offset:20512
    ds_read_b64_tr_b16 v[38:39], v15 offset:21792
    s_waitcnt lgkmcnt(12)
    v_mfma_f32_16x16x32_bf16 a[32:35], v[44:47], v[64:67], a[32:35]
    v_mfma_f32_16x16x32_bf16 a[36:39], v[44:47], v[68:71], a[36:39]
    ds_read_b64_tr_b16 v[40:41], v14 offset:20544
    ds_read_b64_tr_b16 v[42:43], v14 offset:21824
    s_waitcnt lgkmcnt(12)
    v_mfma_f32_16x16x32_bf16 a[40:43], v[48:51], v[64:67], a[40:43]
    v_mfma_f32_16x16x32_bf16 a[44:47], v[48:51], v[68:71], a[44:47]
    ds_read_b64_tr_b16 v[44:45], v15 offset:20576
    ds_read_b64_tr_b16 v[46:47], v15 offset:21856
    s_waitcnt lgkmcnt(12)
    v_mfma_f32_16x16x32_bf16 a[48:51], v[52:55], v[64:67], a[48:51]
    v_mfma_f32_16x16x32_bf16 a[52:55], v[52:55], v[68:71], a[52:55]
    ds_read_b64_tr_b16 v[48:49], v14 offset:20608
    ds_read_b64_tr_b16 v[50:51], v14 offset:21888
    s_waitcnt lgkmcnt(12)
    v_mfma_f32_16x16x32_bf16 a[56:59], v[24:27], v[64:67], a[56:59]
    v_mfma_f32_16x16x32_bf16 a[60:63], v[24:27], v[68:71], a[60:63]
    ds_read_b64_tr_b16 v[52:53], v15 offset:20640
    ds_read_b64_tr_b16 v[54:55], v15 offset:21920
    s_waitcnt lgkmcnt(12)
    v_mfma_f32_16x16x32_bf16 a[64:67], v[28:31], v[64:67], a[64:67]
    v_mfma_f32_16x16x32_bf16 a[68:71], v[28:31], v[68:71], a[68:71]
    s_add_u32 s33, s34, 8192
    buffer_load_dwordx4 v[56:59], v18, s[20:23], s33 offen
    s_add_u32 s33, s34, 174080
    buffer_load_dwordx4 v[60:63], v18, s[20:23], s33 offen
    ds_read_b64_tr_b16 v[24:25], v14 offset:20672
    ds_read_b64_tr_b16 v[26:27], v14 offset:21952
    s_waitcnt lgkmcnt(12)
    v_mfma_f32_16x16x32_bf16 a[0:3], v[32:35], v[72:75], a[0:3]
    v_mfma_f32_16x16x32_bf16 a[4:7], v[32:35], v[76:79], a[4:7]
    ds_read_b64_tr_b16 v[28:29], v15 offset:20704
    ds_read_b64_tr_b16 v[30:31], v15 offset:21984
    s_waitcnt lgkmcnt(12)
    v_mfma_f32_16x16x32_bf16 a[8:11], v[36:39], v[72:75], a[8:11]
    v_mfma_f32_16x16x32_bf16 a[12:15], v[36:39], v[76:79], a[12:15]
    ds_read_b64_tr_b16 v[32:33], v14 offset:20736
    ds_read_b64_tr_b16 v[34:35], v14 offset:22016
    s_waitcnt lgkmcnt(12)
    v_mfma_f32_16x16x32_bf16 a[16:19], v[40:43], v[72:75], a[16:19]
    v_mfma_f32_16x16x32_bf16 a[20:23], v[40:43], v[76:79], a[20:23]
    ds_read_b64_tr_b16 v[36:37], v14 offset:30720
    ds_read_b64_tr_b16 v[38:39], v14 offset:32000
    s_waitcnt lgkmcnt(12)
    v_mfma_f32_16x16x32_bf16 a[24:27], v[44:47], v[72:75], a[24:27]
    v_mfma_f32_16x16x32_bf16 a[28:31], v[44:47], v[76:79], a[28:31]
    ds_read_b64_tr_b16 v[40:41], v15 offset:30752
    ds_read_b64_tr_b16 v[42:43], v15 offset:32032
    s_waitcnt lgkmcnt(12)
    v_mfma_f32_16x16x32_bf16 a[32:35], v[48:51], v[72:75], a[32:35]
    v_mfma_f32_16x16x32_bf16 a[36:39], v[48:51], v[76:79], a[36:39]
    ds_read_b64_tr_b16 v[44:45], v14 offset:30784
    ds_read_b64_tr_b16 v[46:47], v14 offset:32064
    s_waitcnt lgkmcnt(12)
    v_mfma_f32_16x16x32_bf16 a[40:43], v[52:55], v[72:75], a[40:43]
    v_mfma_f32_16x16x32_bf16 a[44:47], v[52:55], v[76:79], a[44:47]
    ds_read_b64_tr_b16 v[48:49], v15 offset:30816
    ds_read_b64_tr_b16 v[50:51], v15 offset:32096
    s_waitcnt lgkmcnt(12)
    v_mfma_f32_16x16x32_bf16 a[48:51], v[24:27], v[72:75], a[48:51]
    v_mfma_f32_16x16x32_bf16 a[52:55], v[24:27], v[76:79], a[52:55]
    ds_read_b64_tr_b16 v[52:53], v14 offset:30848
    ds_read_b64_tr_b16 v[54:55], v14 offset:32128
    s_waitcnt lgkmcnt(12)
    v_mfma_f32_16x16x32_bf16 a[56:59], v[28:31], v[72:75], a[56:59]
    v_mfma_f32_16x16x32_bf16 a[60:63], v[28:31], v[76:79], a[60:63]
    ds_read_b64_tr_b16 v[24:25], v15 offset:30880
    ds_read_b64_tr_b16 v[26:27], v15 offset:32160
    s_waitcnt lgkmcnt(12)
    v_mfma_f32_16x16x32_bf16 a[64:67], v[32:35], v[72:75], a[64:67]
    v_mfma_f32_16x16x32_bf16 a[68:71], v[32:35], v[76:79], a[68:71]
    s_add_u32 s33, s34, 9216
    buffer_load_dwordx4 v[64:67], v18, s[20:23], s33 offen
    s_add_u32 s33, s34, 175104
    buffer_load_dwordx4 v[68:71], v18, s[20:23], s33 offen
    ds_read_b64_tr_b16 v[28:29], v14 offset:30912
    ds_read_b64_tr_b16 v[30:31], v14 offset:32192
    s_waitcnt lgkmcnt(12)
    v_mfma_f32_16x16x32_bf16 a[0:3], v[36:39], v[80:83], a[0:3]
    v_mfma_f32_16x16x32_bf16 a[4:7], v[36:39], v[84:87], a[4:7]
    ds_read_b64_tr_b16 v[32:33], v15 offset:30944
    ds_read_b64_tr_b16 v[34:35], v15 offset:32224
    s_waitcnt lgkmcnt(12)
    v_mfma_f32_16x16x32_bf16 a[8:11], v[40:43], v[80:83], a[8:11]
    v_mfma_f32_16x16x32_bf16 a[12:15], v[40:43], v[84:87], a[12:15]
    ds_read_b64_tr_b16 v[36:37], v14 offset:30976
    ds_read_b64_tr_b16 v[38:39], v14 offset:32256
    s_waitcnt lgkmcnt(12)
    v_mfma_f32_16x16x32_bf16 a[16:19], v[44:47], v[80:83], a[16:19]
    v_mfma_f32_16x16x32_bf16 a[20:23], v[44:47], v[84:87], a[20:23]
    s_waitcnt vmcnt(23)
    s_barrier
    s_add_u32 m0, s36, 0
    buffer_load_dwordx4 v9, s[16:19], s35 offen lds
    s_add_u32 m0, s36, 4096
    buffer_load_dwordx4 v10, s[16:19], s35 offen lds
    s_add_u32 m0, s36, 8192
    buffer_load_dwordx4 v11, s[16:19], s35 offen lds
    s_add_u32 m0, s36, 12288
    buffer_load_dwordx4 v12, s[16:19], s35 offen lds
    s_add_u32 m0, s36, 16384
    buffer_load_dwordx4 v13, s[16:19], s35 offen lds
    s_add_u32 s35, s35, 73728
    ds_read_b64_tr_b16 v[40:41], v14 offset:40960
    ds_read_b64_tr_b16 v[42:43], v14 offset:42240
    s_waitcnt lgkmcnt(12)
    v_mfma_f32_16x16x32_bf16 a[24:27], v[48:51], v[80:83], a[24:27]
    v_mfma_f32_16x16x32_bf16 a[28:31], v[48:51], v[84:87], a[28:31]
    ds_read_b64_tr_b16 v[44:45], v15 offset:40992
    ds_read_b64_tr_b16 v[46:47], v15 offset:42272
    s_waitcnt lgkmcnt(12)
    v_mfma_f32_16x16x32_bf16 a[32:35], v[52:55], v[80:83], a[32:35]
    v_mfma_f32_16x16x32_bf16 a[36:39], v[52:55], v[84:87], a[36:39]
    ds_read_b64_tr_b16 v[48:49], v14 offset:41024
    ds_read_b64_tr_b16 v[50:51], v14 offset:42304
    s_waitcnt lgkmcnt(12)
    v_mfma_f32_16x16x32_bf16 a[40:43], v[24:27], v[80:83], a[40:43]
    v_mfma_f32_16x16x32_bf16 a[44:47], v[24:27], v[84:87], a[44:47]
    ds_read_b64_tr_b16 v[52:53], v15 offset:41056
    ds_read_b64_tr_b16 v[54:55], v15 offset:42336
    s_waitcnt lgkmcnt(12)
    v_mfma_f32_16x16x32_bf16 a[48:51], v[28:31], v[80:83], a[48:51]
    v_mfma_f32_16x16x32_bf16 a[52:55], v[28:31], v[84:87], a[52:55]
    ds_read_b64_tr_b16 v[24:25], v14 offset:41088
    ds_read_b64_tr_b16 v[26:27], v14 offset:42368
    s_waitcnt lgkmcnt(12)
    v_mfma_f32_16x16x32_bf16 a[56:59], v[32:35], v[80:83], a[56:59]
    v_mfma_f32_16x16x32_bf16 a[60:63], v[32:35], v[84:87], a[60:63]
    ds_read_b64_tr_b16 v[28:29], v15 offset:41120
    ds_read_b64_tr_b16 v[30:31], v15 offset:42400
    s_waitcnt lgkmcnt(12)
    v_mfma_f32_16x16x32_bf16 a[64:67], v[36:39], v[80:83], a[64:67]
    v_mfma_f32_16x16x32_bf16 a[68:71], v[36:39], v[84:87], a[68:71]
    s_add_u32 s33, s34, 10240
    buffer_load_dwordx4 v[72:75], v18, s[20:23], s33 offen
    s_add_u32 s33, s34, 176128
    buffer_load_dwordx4 v[76:79], v18, s[20:23], s33 offen
    ds_read_b64_tr_b16 v[32:33], v14 offset:41152
    ds_read_b64_tr_b16 v[34:35], v14 offset:42432
    s_waitcnt lgkmcnt(12)
    v_mfma_f32_16x16x32_bf16 a[0:3], v[40:43], v[88:91], a[0:3]
    v_mfma_f32_16x16x32_bf16 a[4:7], v[40:43], v[92:95], a[4:7]
    ds_read_b64_tr_b16 v[36:37], v15 offset:41184
    ds_read_b64_tr_b16 v[38:39], v15 offset:42464
    s_waitcnt lgkmcnt(12)
    v_mfma_f32_16x16x32_bf16 a[8:11], v[44:47], v[88:91], a[8:11]
    v_mfma_f32_16x16x32_bf16 a[12:15], v[44:47], v[92:95], a[12:15]
    ds_read_b64_tr_b16 v[40:41], v14 offset:41216
    ds_read_b64_tr_b16 v[42:43], v14 offset:42496
    s_waitcnt lgkmcnt(12)
    v_mfma_f32_16x16x32_bf16 a[16:19], v[48:51], v[88:91], a[16:19]
    v_mfma_f32_16x16x32_bf16 a[20:23], v[48:51], v[92:95], a[20:23]
    ds_read_b64_tr_b16 v[44:45], v14 offset:51200
    ds_read_b64_tr_b16 v[46:47], v14 offset:52480
    s_waitcnt lgkmcnt(12)
    v_mfma_f32_16x16x32_bf16 a[24:27], v[52:55], v[88:91], a[24:27]
    v_mfma_f32_16x16x32_bf16 a[28:31], v[52:55], v[92:95], a[28:31]
    ds_read_b64_tr_b16 v[48:49], v15 offset:51232
    ds_read_b64_tr_b16 v[50:51], v15 offset:52512
    s_waitcnt lgkmcnt(12)
    v_mfma_f32_16x16x32_bf16 a[32:35], v[24:27], v[88:91], a[32:35]
    v_mfma_f32_16x16x32_bf16 a[36:39], v[24:27], v[92:95], a[36:39]
    ds_read_b64_tr_b16 v[52:53], v14 offset:51264
    ds_read_b64_tr_b16 v[54:55], v14 offset:52544
    s_waitcnt lgkmcnt(12)
    v_mfma_f32_16x16x32_bf16 a[40:43], v[28:31], v[88:91], a[40:43]
    v_mfma_f32_16x16x32_bf16 a[44:47], v[28:31], v[92:95], a[44:47]
    ds_read_b64_tr_b16 v[24:25], v15 offset:51296
    ds_read_b64_tr_b16 v[26:27], v15 offset:52576
    s_waitcnt lgkmcnt(12)
    v_mfma_f32_16x16x32_bf16 a[48:51], v[32:35], v[88:91], a[48:51]
    v_mfma_f32_16x16x32_bf16 a[52:55], v[32:35], v[92:95], a[52:55]
    ds_read_b64_tr_b16 v[28:29], v14 offset:51328
    ds_read_b64_tr_b16 v[30:31], v14 offset:52608
    s_waitcnt lgkmcnt(12)
    v_mfma_f32_16x16x32_bf16 a[56:59], v[36:39], v[88:91], a[56:59]
    v_mfma_f32_16x16x32_bf16 a[60:63], v[36:39], v[92:95], a[60:63]
    ds_read_b64_tr_b16 v[32:33], v15 offset:51360
    ds_read_b64_tr_b16 v[34:35], v15 offset:52640
    s_waitcnt lgkmcnt(12)
    v_mfma_f32_16x16x32_bf16 a[64:67], v[40:43], v[88:91], a[64:67]
    v_mfma_f32_16x16x32_bf16 a[68:71], v[40:43], v[92:95], a[68:71]
    s_add_u32 s33, s34, 11264
    buffer_load_dwordx4 v[80:83], v18, s[20:23], s33 offen
    s_add_u32 s33, s34, 177152
    buffer_load_dwordx4 v[84:87], v18, s[20:23], s33 offen
    ds_read_b64_tr_b16 v[36:37], v14 offset:51392
    ds_read_b64_tr_b16 v[38:39], v14 offset:52672
    s_waitcnt lgkmcnt(12)
    v_mfma_f32_16x16x32_bf16 a[0:3], v[44:47], v[96:99], a[0:3]
    v_mfma_f32_16x16x32_bf16 a[4:7], v[44:47], v[100:103], a[4:7]
    ds_read_b64_tr_b16 v[40:41], v15 offset:51424
    ds_read_b64_tr_b16 v[42:43], v15 offset:52704
    s_waitcnt lgkmcnt(12)
    v_mfma_f32_16x16x32_bf16 a[8:11], v[48:51], v[96:99], a[8:11]
    v_mfma_f32_16x16x32_bf16 a[12:15], v[48:51], v[100:103], a[12:15]
    ds_read_b64_tr_b16 v[44:45], v14 offset:51456
    ds_read_b64_tr_b16 v[46:47], v14 offset:52736
    s_waitcnt lgkmcnt(12)
    v_mfma_f32_16x16x32_bf16 a[16:19], v[52:55], v[96:99], a[16:19]
    v_mfma_f32_16x16x32_bf16 a[20:23], v[52:55], v[100:103], a[20:23]
    s_waitcnt vmcnt(27)
    s_barrier
    s_add_u32 m0, s36, 20480
    buffer_load_dwordx4 v9, s[16:19], s35 offen lds
    s_add_u32 m0, s36, 24576
    buffer_load_dwordx4 v10, s[16:19], s35 offen lds
    s_add_u32 m0, s36, 28672
    buffer_load_dwordx4 v11, s[16:19], s35 offen lds
    s_add_u32 m0, s36, 32768
    buffer_load_dwordx4 v12, s[16:19], s35 offen lds
    s_add_u32 m0, s36, 36864
    buffer_load_dwordx4 v13, s[16:19], s35 offen lds
    s_add_u32 s35, s35, 73728
    ds_read_b64_tr_b16 v[48:49], v16 offset:0
    ds_read_b64_tr_b16 v[50:51], v16 offset:1280
    s_waitcnt lgkmcnt(12)
    v_mfma_f32_16x16x32_bf16 a[24:27], v[24:27], v[96:99], a[24:27]
    v_mfma_f32_16x16x32_bf16 a[28:31], v[24:27], v[100:103], a[28:31]
    ds_read_b64_tr_b16 v[52:53], v17 offset:32
    ds_read_b64_tr_b16 v[54:55], v17 offset:1312
    s_waitcnt lgkmcnt(12)
    v_mfma_f32_16x16x32_bf16 a[32:35], v[28:31], v[96:99], a[32:35]
    v_mfma_f32_16x16x32_bf16 a[36:39], v[28:31], v[100:103], a[36:39]
    ds_read_b64_tr_b16 v[24:25], v16 offset:64
    ds_read_b64_tr_b16 v[26:27], v16 offset:1344
    s_waitcnt lgkmcnt(12)
    v_mfma_f32_16x16x32_bf16 a[40:43], v[32:35], v[96:99], a[40:43]
    v_mfma_f32_16x16x32_bf16 a[44:47], v[32:35], v[100:103], a[44:47]
    ds_read_b64_tr_b16 v[28:29], v17 offset:96
    ds_read_b64_tr_b16 v[30:31], v17 offset:1376
    s_waitcnt lgkmcnt(12)
    v_mfma_f32_16x16x32_bf16 a[48:51], v[36:39], v[96:99], a[48:51]
    v_mfma_f32_16x16x32_bf16 a[52:55], v[36:39], v[100:103], a[52:55]
    ds_read_b64_tr_b16 v[32:33], v16 offset:128
    ds_read_b64_tr_b16 v[34:35], v16 offset:1408
    s_waitcnt lgkmcnt(12)
    v_mfma_f32_16x16x32_bf16 a[56:59], v[40:43], v[96:99], a[56:59]
    v_mfma_f32_16x16x32_bf16 a[60:63], v[40:43], v[100:103], a[60:63]
    ds_read_b64_tr_b16 v[36:37], v17 offset:160
    ds_read_b64_tr_b16 v[38:39], v17 offset:1440
    s_waitcnt lgkmcnt(12)
    v_mfma_f32_16x16x32_bf16 a[64:67], v[44:47], v[96:99], a[64:67]
    v_mfma_f32_16x16x32_bf16 a[68:71], v[44:47], v[100:103], a[68:71]
    s_add_u32 s33, s34, 12288
    buffer_load_dwordx4 v[88:91], v18, s[20:23], s33 offen
    s_add_u32 s33, s34, 178176
    buffer_load_dwordx4 v[92:95], v18, s[20:23], s33 offen
    ds_read_b64_tr_b16 v[40:41], v16 offset:192
    ds_read_b64_tr_b16 v[42:43], v16 offset:1472
    s_waitcnt vmcnt(27)
    s_waitcnt lgkmcnt(12)
    v_mfma_f32_16x16x32_bf16 a[0:3], v[48:51], v[104:107], a[0:3]
    v_mfma_f32_16x16x32_bf16 a[4:7], v[48:51], v[108:111], a[4:7]
    ds_read_b64_tr_b16 v[44:45], v17 offset:224
    ds_read_b64_tr_b16 v[46:47], v17 offset:1504
    s_waitcnt lgkmcnt(12)
    v_mfma_f32_16x16x32_bf16 a[8:11], v[52:55], v[104:107], a[8:11]
    v_mfma_f32_16x16x32_bf16 a[12:15], v[52:55], v[108:111], a[12:15]
    ds_read_b64_tr_b16 v[48:49], v16 offset:256
    ds_read_b64_tr_b16 v[50:51], v16 offset:1536
    s_waitcnt lgkmcnt(12)
    v_mfma_f32_16x16x32_bf16 a[16:19], v[24:27], v[104:107], a[16:19]
    v_mfma_f32_16x16x32_bf16 a[20:23], v[24:27], v[108:111], a[20:23]
    ds_read_b64_tr_b16 v[52:53], v16 offset:10240
    ds_read_b64_tr_b16 v[54:55], v16 offset:11520
    s_waitcnt lgkmcnt(12)
    v_mfma_f32_16x16x32_bf16 a[24:27], v[28:31], v[104:107], a[24:27]
    v_mfma_f32_16x16x32_bf16 a[28:31], v[28:31], v[108:111], a[28:31]
    ds_read_b64_tr_b16 v[24:25], v17 offset:10272
    ds_read_b64_tr_b16 v[26:27], v17 offset:11552
    s_waitcnt lgkmcnt(12)
    v_mfma_f32_16x16x32_bf16 a[32:35], v[32:35], v[104:107], a[32:35]
    v_mfma_f32_16x16x32_bf16 a[36:39], v[32:35], v[108:111], a[36:39]
    ds_read_b64_tr_b16 v[28:29], v16 offset:10304
    ds_read_b64_tr_b16 v[30:31], v16 offset:11584
    s_waitcnt lgkmcnt(12)
    v_mfma_f32_16x16x32_bf16 a[40:43], v[36:39], v[104:107], a[40:43]
    v_mfma_f32_16x16x32_bf16 a[44:47], v[36:39], v[108:111], a[44:47]
    ds_read_b64_tr_b16 v[32:33], v17 offset:10336
    ds_read_b64_tr_b16 v[34:35], v17 offset:11616
    s_waitcnt lgkmcnt(12)
    v_mfma_f32_16x16x32_bf16 a[48:51], v[40:43], v[104:107], a[48:51]
    v_mfma_f32_16x16x32_bf16 a[52:55], v[40:43], v[108:111], a[52:55]
    ds_read_b64_tr_b16 v[36:37], v16 offset:10368
    ds_read_b64_tr_b16 v[38:39], v16 offset:11648
    s_waitcnt lgkmcnt(12)
    v_mfma_f32_16x16x32_bf16 a[56:59], v[44:47], v[104:107], a[56:59]
    v_mfma_f32_16x16x32_bf16 a[60:63], v[44:47], v[108:111], a[60:63]
    ds_read_b64_tr_b16 v[40:41], v17 offset:10400
    ds_read_b64_tr_b16 v[42:43], v17 offset:11680
    s_waitcnt lgkmcnt(12)
    v_mfma_f32_16x16x32_bf16 a[64:67], v[48:51], v[104:107], a[64:67]
    v_mfma_f32_16x16x32_bf16 a[68:71], v[48:51], v[108:111], a[68:71]
    s_add_u32 s33, s34, 13312
    buffer_load_dwordx4 v[96:99], v18, s[20:23], s33 offen
    s_add_u32 s33, s34, 179200
    buffer_load_dwordx4 v[100:103], v18, s[20:23], s33 offen
    ds_read_b64_tr_b16 v[44:45], v16 offset:10432
    ds_read_b64_tr_b16 v[46:47], v16 offset:11712
    s_waitcnt vmcnt(27)
    s_waitcnt lgkmcnt(12)
    v_mfma_f32_16x16x32_bf16 a[0:3], v[52:55], v[112:115], a[0:3]
    v_mfma_f32_16x16x32_bf16 a[4:7], v[52:55], v[116:119], a[4:7]
    ds_read_b64_tr_b16 v[48:49], v17 offset:10464
    ds_read_b64_tr_b16 v[50:51], v17 offset:11744
    s_waitcnt lgkmcnt(12)
    v_mfma_f32_16x16x32_bf16 a[8:11], v[24:27], v[112:115], a[8:11]
    v_mfma_f32_16x16x32_bf16 a[12:15], v[24:27], v[116:119], a[12:15]
    ds_read_b64_tr_b16 v[52:53], v16 offset:10496
    ds_read_b64_tr_b16 v[54:55], v16 offset:11776
    s_waitcnt lgkmcnt(12)
    v_mfma_f32_16x16x32_bf16 a[16:19], v[28:31], v[112:115], a[16:19]
    v_mfma_f32_16x16x32_bf16 a[20:23], v[28:31], v[116:119], a[20:23]
    s_barrier
    s_add_u32 m0, s36, 40960
    buffer_load_dwordx4 v9, s[16:19], s35 offen lds
    s_add_u32 m0, s36, 45056
    buffer_load_dwordx4 v10, s[16:19], s35 offen lds
    s_add_u32 m0, s36, 49152
    buffer_load_dwordx4 v11, s[16:19], s35 offen lds
    s_add_u32 m0, s36, 53248
    buffer_load_dwordx4 v12, s[16:19], s35 offen lds
    s_add_u32 m0, s36, 57344
    buffer_load_dwordx4 v13, s[16:19], s35 offen lds
    s_add_u32 s35, s35, 73728
    ds_read_b64_tr_b16 v[24:25], v16 offset:20480
    ds_read_b64_tr_b16 v[26:27], v16 offset:21760
    s_waitcnt lgkmcnt(12)
    v_mfma_f32_16x16x32_bf16 a[24:27], v[32:35], v[112:115], a[24:27]
    v_mfma_f32_16x16x32_bf16 a[28:31], v[32:35], v[116:119], a[28:31]
    ds_read_b64_tr_b16 v[28:29], v17 offset:20512
    ds_read_b64_tr_b16 v[30:31], v17 offset:21792
    s_waitcnt lgkmcnt(12)
    v_mfma_f32_16x16x32_bf16 a[32:35], v[36:39], v[112:115], a[32:35]
    v_mfma_f32_16x16x32_bf16 a[36:39], v[36:39], v[116:119], a[36:39]
    ds_read_b64_tr_b16 v[32:33], v16 offset:20544
    ds_read_b64_tr_b16 v[34:35], v16 offset:21824
    s_waitcnt lgkmcnt(12)
    v_mfma_f32_16x16x32_bf16 a[40:43], v[40:43], v[112:115], a[40:43]
    v_mfma_f32_16x16x32_bf16 a[44:47], v[40:43], v[116:119], a[44:47]
    ds_read_b64_tr_b16 v[36:37], v17 offset:20576
    ds_read_b64_tr_b16 v[38:39], v17 offset:21856
    s_waitcnt lgkmcnt(12)
    v_mfma_f32_16x16x32_bf16 a[48:51], v[44:47], v[112:115], a[48:51]
    v_mfma_f32_16x16x32_bf16 a[52:55], v[44:47], v[116:119], a[52:55]
    ds_read_b64_tr_b16 v[40:41], v16 offset:20608
    ds_read_b64_tr_b16 v[42:43], v16 offset:21888
    s_waitcnt lgkmcnt(12)
    v_mfma_f32_16x16x32_bf16 a[56:59], v[48:51], v[112:115], a[56:59]
    v_mfma_f32_16x16x32_bf16 a[60:63], v[48:51], v[116:119], a[60:63]
    ds_read_b64_tr_b16 v[44:45], v17 offset:20640
    ds_read_b64_tr_b16 v[46:47], v17 offset:21920
    s_waitcnt lgkmcnt(12)
    v_mfma_f32_16x16x32_bf16 a[64:67], v[52:55], v[112:115], a[64:67]
    v_mfma_f32_16x16x32_bf16 a[68:71], v[52:55], v[116:119], a[68:71]
    s_add_u32 s33, s34, 14336
    buffer_load_dwordx4 v[104:107], v18, s[20:23], s33 offen
    s_add_u32 s33, s34, 180224
    buffer_load_dwordx4 v[108:111], v18, s[20:23], s33 offen
    ds_read_b64_tr_b16 v[48:49], v16 offset:20672
    ds_read_b64_tr_b16 v[50:51], v16 offset:21952
    s_waitcnt vmcnt(27)
    s_waitcnt lgkmcnt(12)
    v_mfma_f32_16x16x32_bf16 a[0:3], v[24:27], v[56:59], a[0:3]
    v_mfma_f32_16x16x32_bf16 a[4:7], v[24:27], v[60:63], a[4:7]
    ds_read_b64_tr_b16 v[52:53], v17 offset:20704
    ds_read_b64_tr_b16 v[54:55], v17 offset:21984
    s_waitcnt lgkmcnt(12)
    v_mfma_f32_16x16x32_bf16 a[8:11], v[28:31], v[56:59], a[8:11]
    v_mfma_f32_16x16x32_bf16 a[12:15], v[28:31], v[60:63], a[12:15]
    ds_read_b64_tr_b16 v[24:25], v16 offset:20736
    ds_read_b64_tr_b16 v[26:27], v16 offset:22016
    s_waitcnt lgkmcnt(12)
    v_mfma_f32_16x16x32_bf16 a[16:19], v[32:35], v[56:59], a[16:19]
    v_mfma_f32_16x16x32_bf16 a[20:23], v[32:35], v[60:63], a[20:23]
    ds_read_b64_tr_b16 v[28:29], v16 offset:30720
    ds_read_b64_tr_b16 v[30:31], v16 offset:32000
    s_waitcnt lgkmcnt(12)
    v_mfma_f32_16x16x32_bf16 a[24:27], v[36:39], v[56:59], a[24:27]
    v_mfma_f32_16x16x32_bf16 a[28:31], v[36:39], v[60:63], a[28:31]
    ds_read_b64_tr_b16 v[32:33], v17 offset:30752
    ds_read_b64_tr_b16 v[34:35], v17 offset:32032
    s_waitcnt lgkmcnt(12)
    v_mfma_f32_16x16x32_bf16 a[32:35], v[40:43], v[56:59], a[32:35]
    v_mfma_f32_16x16x32_bf16 a[36:39], v[40:43], v[60:63], a[36:39]
    ds_read_b64_tr_b16 v[36:37], v16 offset:30784
    ds_read_b64_tr_b16 v[38:39], v16 offset:32064
    s_waitcnt lgkmcnt(12)
    v_mfma_f32_16x16x32_bf16 a[40:43], v[44:47], v[56:59], a[40:43]
    v_mfma_f32_16x16x32_bf16 a[44:47], v[44:47], v[60:63], a[44:47]
    ds_read_b64_tr_b16 v[40:41], v17 offset:30816
    ds_read_b64_tr_b16 v[42:43], v17 offset:32096
    s_waitcnt lgkmcnt(12)
    v_mfma_f32_16x16x32_bf16 a[48:51], v[48:51], v[56:59], a[48:51]
    v_mfma_f32_16x16x32_bf16 a[52:55], v[48:51], v[60:63], a[52:55]
    ds_read_b64_tr_b16 v[44:45], v16 offset:30848
    ds_read_b64_tr_b16 v[46:47], v16 offset:32128
    s_waitcnt lgkmcnt(12)
    v_mfma_f32_16x16x32_bf16 a[56:59], v[52:55], v[56:59], a[56:59]
    v_mfma_f32_16x16x32_bf16 a[60:63], v[52:55], v[60:63], a[60:63]
    ds_read_b64_tr_b16 v[48:49], v17 offset:30880
    ds_read_b64_tr_b16 v[50:51], v17 offset:32160
    s_waitcnt lgkmcnt(12)
    v_mfma_f32_16x16x32_bf16 a[64:67], v[24:27], v[56:59], a[64:67]
    v_mfma_f32_16x16x32_bf16 a[68:71], v[24:27], v[60:63], a[68:71]
    s_add_u32 s33, s34, 15360
    buffer_load_dwordx4 v[112:115], v18, s[20:23], s33 offen
    s_add_u32 s33, s34, 181248
    buffer_load_dwordx4 v[116:119], v18, s[20:23], s33 offen
    ds_read_b64_tr_b16 v[52:53], v16 offset:30912
    ds_read_b64_tr_b16 v[54:55], v16 offset:32192
    s_waitcnt vmcnt(27)
    s_waitcnt lgkmcnt(12)
    v_mfma_f32_16x16x32_bf16 a[0:3], v[28:31], v[64:67], a[0:3]
    v_mfma_f32_16x16x32_bf16 a[4:7], v[28:31], v[68:71], a[4:7]
    ds_read_b64_tr_b16 v[24:25], v17 offset:30944
    ds_read_b64_tr_b16 v[26:27], v17 offset:32224
    s_waitcnt lgkmcnt(12)
    v_mfma_f32_16x16x32_bf16 a[8:11], v[32:35], v[64:67], a[8:11]
    v_mfma_f32_16x16x32_bf16 a[12:15], v[32:35], v[68:71], a[12:15]
    ds_read_b64_tr_b16 v[28:29], v16 offset:30976
    ds_read_b64_tr_b16 v[30:31], v16 offset:32256
    s_waitcnt lgkmcnt(12)
    v_mfma_f32_16x16x32_bf16 a[16:19], v[36:39], v[64:67], a[16:19]
    v_mfma_f32_16x16x32_bf16 a[20:23], v[36:39], v[68:71], a[20:23]
    s_barrier
    s_add_u32 m0, s36, 61440
    buffer_load_dwordx4 v9, s[16:19], s35 offen lds
    s_add_u32 m0, s36, 65536
    buffer_load_dwordx4 v10, s[16:19], s35 offen lds
    s_add_u32 m0, s36, 69632
    buffer_load_dwordx4 v11, s[16:19], s35 offen lds
    s_add_u32 m0, s36, 73728
    buffer_load_dwordx4 v12, s[16:19], s35 offen lds
    s_add_u32 m0, s36, 77824
    buffer_load_dwordx4 v13, s[16:19], s35 offen lds
    s_add_u32 s35, s35, 73728
    ds_read_b64_tr_b16 v[32:33], v16 offset:40960
    ds_read_b64_tr_b16 v[34:35], v16 offset:42240
    s_waitcnt lgkmcnt(12)
    v_mfma_f32_16x16x32_bf16 a[24:27], v[40:43], v[64:67], a[24:27]
    v_mfma_f32_16x16x32_bf16 a[28:31], v[40:43], v[68:71], a[28:31]
    ds_read_b64_tr_b16 v[36:37], v17 offset:40992
    ds_read_b64_tr_b16 v[38:39], v17 offset:42272
    s_waitcnt lgkmcnt(12)
    v_mfma_f32_16x16x32_bf16 a[32:35], v[44:47], v[64:67], a[32:35]
    v_mfma_f32_16x16x32_bf16 a[36:39], v[44:47], v[68:71], a[36:39]
    ds_read_b64_tr_b16 v[40:41], v16 offset:41024
    ds_read_b64_tr_b16 v[42:43], v16 offset:42304
    s_waitcnt lgkmcnt(12)
    v_mfma_f32_16x16x32_bf16 a[40:43], v[48:51], v[64:67], a[40:43]
    v_mfma_f32_16x16x32_bf16 a[44:47], v[48:51], v[68:71], a[44:47]
    ds_read_b64_tr_b16 v[44:45], v17 offset:41056
    ds_read_b64_tr_b16 v[46:47], v17 offset:42336
    s_waitcnt lgkmcnt(12)
    v_mfma_f32_16x16x32_bf16 a[48:51], v[52:55], v[64:67], a[48:51]
    v_mfma_f32_16x16x32_bf16 a[52:55], v[52:55], v[68:71], a[52:55]
    ds_read_b64_tr_b16 v[48:49], v16 offset:41088
    ds_read_b64_tr_b16 v[50:51], v16 offset:42368
    s_waitcnt lgkmcnt(12)
    v_mfma_f32_16x16x32_bf16 a[56:59], v[24:27], v[64:67], a[56:59]
    v_mfma_f32_16x16x32_bf16 a[60:63], v[24:27], v[68:71], a[60:63]
    ds_read_b64_tr_b16 v[52:53], v17 offset:41120
    ds_read_b64_tr_b16 v[54:55], v17 offset:42400
    s_waitcnt lgkmcnt(12)
    v_mfma_f32_16x16x32_bf16 a[64:67], v[28:31], v[64:67], a[64:67]
    v_mfma_f32_16x16x32_bf16 a[68:71], v[28:31], v[68:71], a[68:71]
    s_add_u32 s33, s34, 16384
    buffer_load_dwordx4 v[56:59], v18, s[20:23], s33 offen
    s_add_u32 s33, s34, 182272
    buffer_load_dwordx4 v[60:63], v18, s[20:23], s33 offen
    ds_read_b64_tr_b16 v[24:25], v16 offset:41152
    ds_read_b64_tr_b16 v[26:27], v16 offset:42432
    s_waitcnt vmcnt(27)
    s_waitcnt lgkmcnt(12)
    v_mfma_f32_16x16x32_bf16 a[0:3], v[32:35], v[72:75], a[0:3]
    v_mfma_f32_16x16x32_bf16 a[4:7], v[32:35], v[76:79], a[4:7]
    ds_read_b64_tr_b16 v[28:29], v17 offset:41184
    ds_read_b64_tr_b16 v[30:31], v17 offset:42464
    s_waitcnt lgkmcnt(12)
    v_mfma_f32_16x16x32_bf16 a[8:11], v[36:39], v[72:75], a[8:11]
    v_mfma_f32_16x16x32_bf16 a[12:15], v[36:39], v[76:79], a[12:15]
    ds_read_b64_tr_b16 v[32:33], v16 offset:41216
    ds_read_b64_tr_b16 v[34:35], v16 offset:42496
    s_waitcnt lgkmcnt(12)
    v_mfma_f32_16x16x32_bf16 a[16:19], v[40:43], v[72:75], a[16:19]
    v_mfma_f32_16x16x32_bf16 a[20:23], v[40:43], v[76:79], a[20:23]
    ds_read_b64_tr_b16 v[36:37], v16 offset:51200
    ds_read_b64_tr_b16 v[38:39], v16 offset:52480
    s_waitcnt lgkmcnt(12)
    v_mfma_f32_16x16x32_bf16 a[24:27], v[44:47], v[72:75], a[24:27]
    v_mfma_f32_16x16x32_bf16 a[28:31], v[44:47], v[76:79], a[28:31]
    ds_read_b64_tr_b16 v[40:41], v17 offset:51232
    ds_read_b64_tr_b16 v[42:43], v17 offset:52512
    s_waitcnt lgkmcnt(12)
    v_mfma_f32_16x16x32_bf16 a[32:35], v[48:51], v[72:75], a[32:35]
    v_mfma_f32_16x16x32_bf16 a[36:39], v[48:51], v[76:79], a[36:39]
    ds_read_b64_tr_b16 v[44:45], v16 offset:51264
    ds_read_b64_tr_b16 v[46:47], v16 offset:52544
    s_waitcnt lgkmcnt(12)
    v_mfma_f32_16x16x32_bf16 a[40:43], v[52:55], v[72:75], a[40:43]
    v_mfma_f32_16x16x32_bf16 a[44:47], v[52:55], v[76:79], a[44:47]
    ds_read_b64_tr_b16 v[48:49], v17 offset:51296
    ds_read_b64_tr_b16 v[50:51], v17 offset:52576
    s_waitcnt lgkmcnt(12)
    v_mfma_f32_16x16x32_bf16 a[48:51], v[24:27], v[72:75], a[48:51]
    v_mfma_f32_16x16x32_bf16 a[52:55], v[24:27], v[76:79], a[52:55]
    ds_read_b64_tr_b16 v[52:53], v16 offset:51328
    ds_read_b64_tr_b16 v[54:55], v16 offset:52608
    s_waitcnt lgkmcnt(12)
    v_mfma_f32_16x16x32_bf16 a[56:59], v[28:31], v[72:75], a[56:59]
    v_mfma_f32_16x16x32_bf16 a[60:63], v[28:31], v[76:79], a[60:63]
    ds_read_b64_tr_b16 v[24:25], v17 offset:51360
    ds_read_b64_tr_b16 v[26:27], v17 offset:52640
    s_waitcnt lgkmcnt(12)
    v_mfma_f32_16x16x32_bf16 a[64:67], v[32:35], v[72:75], a[64:67]
    v_mfma_f32_16x16x32_bf16 a[68:71], v[32:35], v[76:79], a[68:71]
    s_add_u32 s33, s34, 17408
    buffer_load_dwordx4 v[64:67], v18, s[20:23], s33 offen
    s_add_u32 s33, s34, 183296
    buffer_load_dwordx4 v[68:71], v18, s[20:23], s33 offen
    ds_read_b64_tr_b16 v[28:29], v16 offset:51392
    ds_read_b64_tr_b16 v[30:31], v16 offset:52672
    s_waitcnt vmcnt(27)
    s_waitcnt lgkmcnt(12)
    v_mfma_f32_16x16x32_bf16 a[0:3], v[36:39], v[80:83], a[0:3]
    v_mfma_f32_16x16x32_bf16 a[4:7], v[36:39], v[84:87], a[4:7]
    ds_read_b64_tr_b16 v[32:33], v17 offset:51424
    ds_read_b64_tr_b16 v[34:35], v17 offset:52704
    s_waitcnt lgkmcnt(12)
    v_mfma_f32_16x16x32_bf16 a[8:11], v[40:43], v[80:83], a[8:11]
    v_mfma_f32_16x16x32_bf16 a[12:15], v[40:43], v[84:87], a[12:15]
    ds_read_b64_tr_b16 v[36:37], v16 offset:51456
    ds_read_b64_tr_b16 v[38:39], v16 offset:52736
    s_waitcnt lgkmcnt(12)
    v_mfma_f32_16x16x32_bf16 a[16:19], v[44:47], v[80:83], a[16:19]
    v_mfma_f32_16x16x32_bf16 a[20:23], v[44:47], v[84:87], a[20:23]
    s_barrier
    s_add_u32 m0, s36, 81920
    buffer_load_dwordx4 v9, s[16:19], s35 offen lds
    s_add_u32 m0, s36, 86016
    buffer_load_dwordx4 v10, s[16:19], s35 offen lds
    s_add_u32 m0, s36, 90112
    buffer_load_dwordx4 v11, s[16:19], s35 offen lds
    s_add_u32 m0, s36, 94208
    buffer_load_dwordx4 v12, s[16:19], s35 offen lds
    s_add_u32 m0, s36, 98304
    buffer_load_dwordx4 v13, s[16:19], s35 offen lds
    s_add_u32 s35, s35, 73728
    ds_read_b64_tr_b16 v[40:41], v14 offset:0
    ds_read_b64_tr_b16 v[42:43], v14 offset:1280
    s_waitcnt lgkmcnt(12)
    v_mfma_f32_16x16x32_bf16 a[24:27], v[48:51], v[80:83], a[24:27]
    v_mfma_f32_16x16x32_bf16 a[28:31], v[48:51], v[84:87], a[28:31]
    ds_read_b64_tr_b16 v[44:45], v15 offset:32
    ds_read_b64_tr_b16 v[46:47], v15 offset:1312
    s_waitcnt lgkmcnt(12)
    v_mfma_f32_16x16x32_bf16 a[32:35], v[52:55], v[80:83], a[32:35]
    v_mfma_f32_16x16x32_bf16 a[36:39], v[52:55], v[84:87], a[36:39]
    ds_read_b64_tr_b16 v[48:49], v14 offset:64
    ds_read_b64_tr_b16 v[50:51], v14 offset:1344
    s_waitcnt lgkmcnt(12)
    v_mfma_f32_16x16x32_bf16 a[40:43], v[24:27], v[80:83], a[40:43]
    v_mfma_f32_16x16x32_bf16 a[44:47], v[24:27], v[84:87], a[44:47]
    ds_read_b64_tr_b16 v[52:53], v15 offset:96
    ds_read_b64_tr_b16 v[54:55], v15 offset:1376
    s_waitcnt lgkmcnt(12)
    v_mfma_f32_16x16x32_bf16 a[48:51], v[28:31], v[80:83], a[48:51]
    v_mfma_f32_16x16x32_bf16 a[52:55], v[28:31], v[84:87], a[52:55]
    ds_read_b64_tr_b16 v[24:25], v14 offset:128
    ds_read_b64_tr_b16 v[26:27], v14 offset:1408
    s_waitcnt lgkmcnt(12)
    v_mfma_f32_16x16x32_bf16 a[56:59], v[32:35], v[80:83], a[56:59]
    v_mfma_f32_16x16x32_bf16 a[60:63], v[32:35], v[84:87], a[60:63]
    ds_read_b64_tr_b16 v[28:29], v15 offset:160
    ds_read_b64_tr_b16 v[30:31], v15 offset:1440
    s_waitcnt lgkmcnt(12)
    v_mfma_f32_16x16x32_bf16 a[64:67], v[36:39], v[80:83], a[64:67]
    v_mfma_f32_16x16x32_bf16 a[68:71], v[36:39], v[84:87], a[68:71]
    s_add_u32 s33, s34, 18432
    buffer_load_dwordx4 v[72:75], v18, s[20:23], s33 offen
    s_add_u32 s33, s34, 184320
    buffer_load_dwordx4 v[76:79], v18, s[20:23], s33 offen
    ds_read_b64_tr_b16 v[32:33], v14 offset:192
    ds_read_b64_tr_b16 v[34:35], v14 offset:1472
    s_waitcnt vmcnt(27)
    s_waitcnt lgkmcnt(12)
    v_mfma_f32_16x16x32_bf16 a[0:3], v[40:43], v[88:91], a[0:3]
    v_mfma_f32_16x16x32_bf16 a[4:7], v[40:43], v[92:95], a[4:7]
    ds_read_b64_tr_b16 v[36:37], v15 offset:224
    ds_read_b64_tr_b16 v[38:39], v15 offset:1504
    s_waitcnt lgkmcnt(12)
    v_mfma_f32_16x16x32_bf16 a[8:11], v[44:47], v[88:91], a[8:11]
    v_mfma_f32_16x16x32_bf16 a[12:15], v[44:47], v[92:95], a[12:15]
    ds_read_b64_tr_b16 v[40:41], v14 offset:256
    ds_read_b64_tr_b16 v[42:43], v14 offset:1536
    s_waitcnt lgkmcnt(12)
    v_mfma_f32_16x16x32_bf16 a[16:19], v[48:51], v[88:91], a[16:19]
    v_mfma_f32_16x16x32_bf16 a[20:23], v[48:51], v[92:95], a[20:23]
    ds_read_b64_tr_b16 v[44:45], v14 offset:10240
    ds_read_b64_tr_b16 v[46:47], v14 offset:11520
    s_waitcnt lgkmcnt(12)
    v_mfma_f32_16x16x32_bf16 a[24:27], v[52:55], v[88:91], a[24:27]
    v_mfma_f32_16x16x32_bf16 a[28:31], v[52:55], v[92:95], a[28:31]
    ds_read_b64_tr_b16 v[48:49], v15 offset:10272
    ds_read_b64_tr_b16 v[50:51], v15 offset:11552
    s_waitcnt lgkmcnt(12)
    v_mfma_f32_16x16x32_bf16 a[32:35], v[24:27], v[88:91], a[32:35]
    v_mfma_f32_16x16x32_bf16 a[36:39], v[24:27], v[92:95], a[36:39]
    ds_read_b64_tr_b16 v[52:53], v14 offset:10304
    ds_read_b64_tr_b16 v[54:55], v14 offset:11584
    s_waitcnt lgkmcnt(12)
    v_mfma_f32_16x16x32_bf16 a[40:43], v[28:31], v[88:91], a[40:43]
    v_mfma_f32_16x16x32_bf16 a[44:47], v[28:31], v[92:95], a[44:47]
    ds_read_b64_tr_b16 v[24:25], v15 offset:10336
    ds_read_b64_tr_b16 v[26:27], v15 offset:11616
    s_waitcnt lgkmcnt(12)
    v_mfma_f32_16x16x32_bf16 a[48:51], v[32:35], v[88:91], a[48:51]
    v_mfma_f32_16x16x32_bf16 a[52:55], v[32:35], v[92:95], a[52:55]
    ds_read_b64_tr_b16 v[28:29], v14 offset:10368
    ds_read_b64_tr_b16 v[30:31], v14 offset:11648
    s_waitcnt lgkmcnt(12)
    v_mfma_f32_16x16x32_bf16 a[56:59], v[36:39], v[88:91], a[56:59]
    v_mfma_f32_16x16x32_bf16 a[60:63], v[36:39], v[92:95], a[60:63]
    ds_read_b64_tr_b16 v[32:33], v15 offset:10400
    ds_read_b64_tr_b16 v[34:35], v15 offset:11680
    s_waitcnt lgkmcnt(12)
    v_mfma_f32_16x16x32_bf16 a[64:67], v[40:43], v[88:91], a[64:67]
    v_mfma_f32_16x16x32_bf16 a[68:71], v[40:43], v[92:95], a[68:71]
    s_add_u32 s33, s34, 19456
    buffer_load_dwordx4 v[80:83], v18, s[20:23], s33 offen
    s_add_u32 s33, s34, 185344
    buffer_load_dwordx4 v[84:87], v18, s[20:23], s33 offen
    ds_read_b64_tr_b16 v[36:37], v14 offset:10432
    ds_read_b64_tr_b16 v[38:39], v14 offset:11712
    s_waitcnt vmcnt(27)
    s_waitcnt lgkmcnt(12)
    v_mfma_f32_16x16x32_bf16 a[0:3], v[44:47], v[96:99], a[0:3]
    v_mfma_f32_16x16x32_bf16 a[4:7], v[44:47], v[100:103], a[4:7]
    ds_read_b64_tr_b16 v[40:41], v15 offset:10464
    ds_read_b64_tr_b16 v[42:43], v15 offset:11744
    s_waitcnt lgkmcnt(12)
    v_mfma_f32_16x16x32_bf16 a[8:11], v[48:51], v[96:99], a[8:11]
    v_mfma_f32_16x16x32_bf16 a[12:15], v[48:51], v[100:103], a[12:15]
    ds_read_b64_tr_b16 v[44:45], v14 offset:10496
    ds_read_b64_tr_b16 v[46:47], v14 offset:11776
    s_waitcnt lgkmcnt(12)
    v_mfma_f32_16x16x32_bf16 a[16:19], v[52:55], v[96:99], a[16:19]
    v_mfma_f32_16x16x32_bf16 a[20:23], v[52:55], v[100:103], a[20:23]
    s_barrier
    s_add_u32 m0, s36, 102400
    buffer_load_dwordx4 v9, s[16:19], s35 offen lds
    s_add_u32 m0, s36, 106496
    buffer_load_dwordx4 v10, s[16:19], s35 offen lds
    s_add_u32 m0, s36, 110592
    buffer_load_dwordx4 v11, s[16:19], s35 offen lds
    s_add_u32 m0, s36, 114688
    buffer_load_dwordx4 v12, s[16:19], s35 offen lds
    s_add_u32 m0, s36, 118784
    buffer_load_dwordx4 v13, s[16:19], s35 offen lds
    s_add_u32 s35, s35, 73728
    ds_read_b64_tr_b16 v[48:49], v14 offset:20480
    ds_read_b64_tr_b16 v[50:51], v14 offset:21760
    s_waitcnt lgkmcnt(12)
    v_mfma_f32_16x16x32_bf16 a[24:27], v[24:27], v[96:99], a[24:27]
    v_mfma_f32_16x16x32_bf16 a[28:31], v[24:27], v[100:103], a[28:31]
    ds_read_b64_tr_b16 v[52:53], v15 offset:20512
    ds_read_b64_tr_b16 v[54:55], v15 offset:21792
    s_waitcnt lgkmcnt(12)
    v_mfma_f32_16x16x32_bf16 a[32:35], v[28:31], v[96:99], a[32:35]
    v_mfma_f32_16x16x32_bf16 a[36:39], v[28:31], v[100:103], a[36:39]
    ds_read_b64_tr_b16 v[24:25], v14 offset:20544
    ds_read_b64_tr_b16 v[26:27], v14 offset:21824
    s_waitcnt lgkmcnt(12)
    v_mfma_f32_16x16x32_bf16 a[40:43], v[32:35], v[96:99], a[40:43]
    v_mfma_f32_16x16x32_bf16 a[44:47], v[32:35], v[100:103], a[44:47]
    ds_read_b64_tr_b16 v[28:29], v15 offset:20576
    ds_read_b64_tr_b16 v[30:31], v15 offset:21856
    s_waitcnt lgkmcnt(12)
    v_mfma_f32_16x16x32_bf16 a[48:51], v[36:39], v[96:99], a[48:51]
    v_mfma_f32_16x16x32_bf16 a[52:55], v[36:39], v[100:103], a[52:55]
    ds_read_b64_tr_b16 v[32:33], v14 offset:20608
    ds_read_b64_tr_b16 v[34:35], v14 offset:21888
    s_waitcnt lgkmcnt(12)
    v_mfma_f32_16x16x32_bf16 a[56:59], v[40:43], v[96:99], a[56:59]
    v_mfma_f32_16x16x32_bf16 a[60:63], v[40:43], v[100:103], a[60:63]
    ds_read_b64_tr_b16 v[36:37], v15 offset:20640
    ds_read_b64_tr_b16 v[38:39], v15 offset:21920
    s_waitcnt lgkmcnt(12)
    v_mfma_f32_16x16x32_bf16 a[64:67], v[44:47], v[96:99], a[64:67]
    v_mfma_f32_16x16x32_bf16 a[68:71], v[44:47], v[100:103], a[68:71]
    s_add_u32 s33, s34, 20480
    buffer_load_dwordx4 v[88:91], v18, s[20:23], s33 offen
    s_add_u32 s33, s34, 186368
    buffer_load_dwordx4 v[92:95], v18, s[20:23], s33 offen
    ds_read_b64_tr_b16 v[40:41], v14 offset:20672
    ds_read_b64_tr_b16 v[42:43], v14 offset:21952
    s_waitcnt vmcnt(27)
    s_waitcnt lgkmcnt(12)
    v_mfma_f32_16x16x32_bf16 a[0:3], v[48:51], v[104:107], a[0:3]
    v_mfma_f32_16x16x32_bf16 a[4:7], v[48:51], v[108:111], a[4:7]
    ds_read_b64_tr_b16 v[44:45], v15 offset:20704
    ds_read_b64_tr_b16 v[46:47], v15 offset:21984
    s_waitcnt lgkmcnt(12)
    v_mfma_f32_16x16x32_bf16 a[8:11], v[52:55], v[104:107], a[8:11]
    v_mfma_f32_16x16x32_bf16 a[12:15], v[52:55], v[108:111], a[12:15]
    ds_read_b64_tr_b16 v[48:49], v14 offset:20736
    ds_read_b64_tr_b16 v[50:51], v14 offset:22016
    s_waitcnt lgkmcnt(12)
    v_mfma_f32_16x16x32_bf16 a[16:19], v[24:27], v[104:107], a[16:19]
    v_mfma_f32_16x16x32_bf16 a[20:23], v[24:27], v[108:111], a[20:23]
    ds_read_b64_tr_b16 v[52:53], v14 offset:30720
    ds_read_b64_tr_b16 v[54:55], v14 offset:32000
    s_waitcnt lgkmcnt(12)
    v_mfma_f32_16x16x32_bf16 a[24:27], v[28:31], v[104:107], a[24:27]
    v_mfma_f32_16x16x32_bf16 a[28:31], v[28:31], v[108:111], a[28:31]
    ds_read_b64_tr_b16 v[24:25], v15 offset:30752
    ds_read_b64_tr_b16 v[26:27], v15 offset:32032
    s_waitcnt lgkmcnt(12)
    v_mfma_f32_16x16x32_bf16 a[32:35], v[32:35], v[104:107], a[32:35]
    v_mfma_f32_16x16x32_bf16 a[36:39], v[32:35], v[108:111], a[36:39]
    ds_read_b64_tr_b16 v[28:29], v14 offset:30784
    ds_read_b64_tr_b16 v[30:31], v14 offset:32064
    s_waitcnt lgkmcnt(12)
    v_mfma_f32_16x16x32_bf16 a[40:43], v[36:39], v[104:107], a[40:43]
    v_mfma_f32_16x16x32_bf16 a[44:47], v[36:39], v[108:111], a[44:47]
    ds_read_b64_tr_b16 v[32:33], v15 offset:30816
    ds_read_b64_tr_b16 v[34:35], v15 offset:32096
    s_waitcnt lgkmcnt(12)
    v_mfma_f32_16x16x32_bf16 a[48:51], v[40:43], v[104:107], a[48:51]
    v_mfma_f32_16x16x32_bf16 a[52:55], v[40:43], v[108:111], a[52:55]
    ds_read_b64_tr_b16 v[36:37], v14 offset:30848
    ds_read_b64_tr_b16 v[38:39], v14 offset:32128
    s_waitcnt lgkmcnt(12)
    v_mfma_f32_16x16x32_bf16 a[56:59], v[44:47], v[104:107], a[56:59]
    v_mfma_f32_16x16x32_bf16 a[60:63], v[44:47], v[108:111], a[60:63]
    ds_read_b64_tr_b16 v[40:41], v15 offset:30880
    ds_read_b64_tr_b16 v[42:43], v15 offset:32160
    s_waitcnt lgkmcnt(12)
    v_mfma_f32_16x16x32_bf16 a[64:67], v[48:51], v[104:107], a[64:67]
    v_mfma_f32_16x16x32_bf16 a[68:71], v[48:51], v[108:111], a[68:71]
    s_add_u32 s33, s34, 21504
    buffer_load_dwordx4 v[96:99], v18, s[20:23], s33 offen
    s_add_u32 s33, s34, 187392
    buffer_load_dwordx4 v[100:103], v18, s[20:23], s33 offen
    ds_read_b64_tr_b16 v[44:45], v14 offset:30912
    ds_read_b64_tr_b16 v[46:47], v14 offset:32192
    s_waitcnt vmcnt(27)
    s_waitcnt lgkmcnt(12)
    v_mfma_f32_16x16x32_bf16 a[0:3], v[52:55], v[112:115], a[0:3]
    v_mfma_f32_16x16x32_bf16 a[4:7], v[52:55], v[116:119], a[4:7]
    ds_read_b64_tr_b16 v[48:49], v15 offset:30944
    ds_read_b64_tr_b16 v[50:51], v15 offset:32224
    s_waitcnt lgkmcnt(12)
    v_mfma_f32_16x16x32_bf16 a[8:11], v[24:27], v[112:115], a[8:11]
    v_mfma_f32_16x16x32_bf16 a[12:15], v[24:27], v[116:119], a[12:15]
    ds_read_b64_tr_b16 v[52:53], v14 offset:30976
    ds_read_b64_tr_b16 v[54:55], v14 offset:32256
    s_waitcnt lgkmcnt(12)
    v_mfma_f32_16x16x32_bf16 a[16:19], v[28:31], v[112:115], a[16:19]
    v_mfma_f32_16x16x32_bf16 a[20:23], v[28:31], v[116:119], a[20:23]
    s_barrier
    s_add_u32 m0, s36, 0
    buffer_load_dwordx4 v9, s[16:19], s35 offen lds
    s_add_u32 m0, s36, 4096
    buffer_load_dwordx4 v10, s[16:19], s35 offen lds
    s_add_u32 m0, s36, 8192
    buffer_load_dwordx4 v11, s[16:19], s35 offen lds
    s_add_u32 m0, s36, 12288
    buffer_load_dwordx4 v12, s[16:19], s35 offen lds
    s_add_u32 m0, s36, 16384
    buffer_load_dwordx4 v13, s[16:19], s35 offen lds
    s_add_u32 s35, s35, 73728
    ds_read_b64_tr_b16 v[24:25], v14 offset:40960
    ds_read_b64_tr_b16 v[26:27], v14 offset:42240
    s_waitcnt lgkmcnt(12)
    v_mfma_f32_16x16x32_bf16 a[24:27], v[32:35], v[112:115], a[24:27]
    v_mfma_f32_16x16x32_bf16 a[28:31], v[32:35], v[116:119], a[28:31]
    ds_read_b64_tr_b16 v[28:29], v15 offset:40992
    ds_read_b64_tr_b16 v[30:31], v15 offset:42272
    s_waitcnt lgkmcnt(12)
    v_mfma_f32_16x16x32_bf16 a[32:35], v[36:39], v[112:115], a[32:35]
    v_mfma_f32_16x16x32_bf16 a[36:39], v[36:39], v[116:119], a[36:39]
    ds_read_b64_tr_b16 v[32:33], v14 offset:41024
    ds_read_b64_tr_b16 v[34:35], v14 offset:42304
    s_waitcnt lgkmcnt(12)
    v_mfma_f32_16x16x32_bf16 a[40:43], v[40:43], v[112:115], a[40:43]
    v_mfma_f32_16x16x32_bf16 a[44:47], v[40:43], v[116:119], a[44:47]
    ds_read_b64_tr_b16 v[36:37], v15 offset:41056
    ds_read_b64_tr_b16 v[38:39], v15 offset:42336
    s_waitcnt lgkmcnt(12)
    v_mfma_f32_16x16x32_bf16 a[48:51], v[44:47], v[112:115], a[48:51]
    v_mfma_f32_16x16x32_bf16 a[52:55], v[44:47], v[116:119], a[52:55]
    ds_read_b64_tr_b16 v[40:41], v14 offset:41088
    ds_read_b64_tr_b16 v[42:43], v14 offset:42368
    s_waitcnt lgkmcnt(12)
    v_mfma_f32_16x16x32_bf16 a[56:59], v[48:51], v[112:115], a[56:59]
    v_mfma_f32_16x16x32_bf16 a[60:63], v[48:51], v[116:119], a[60:63]
    ds_read_b64_tr_b16 v[44:45], v15 offset:41120
    ds_read_b64_tr_b16 v[46:47], v15 offset:42400
    s_waitcnt lgkmcnt(12)
    v_mfma_f32_16x16x32_bf16 a[64:67], v[52:55], v[112:115], a[64:67]
    v_mfma_f32_16x16x32_bf16 a[68:71], v[52:55], v[116:119], a[68:71]
    s_add_u32 s33, s34, 22528
    buffer_load_dwordx4 v[104:107], v18, s[20:23], s33 offen
    s_add_u32 s33, s34, 188416
    buffer_load_dwordx4 v[108:111], v18, s[20:23], s33 offen
    ds_read_b64_tr_b16 v[48:49], v14 offset:41152
    ds_read_b64_tr_b16 v[50:51], v14 offset:42432
    s_waitcnt vmcnt(27)
    s_waitcnt lgkmcnt(12)
    v_mfma_f32_16x16x32_bf16 a[0:3], v[24:27], v[56:59], a[0:3]
    v_mfma_f32_16x16x32_bf16 a[4:7], v[24:27], v[60:63], a[4:7]
    ds_read_b64_tr_b16 v[52:53], v15 offset:41184
    ds_read_b64_tr_b16 v[54:55], v15 offset:42464
    s_waitcnt lgkmcnt(12)
    v_mfma_f32_16x16x32_bf16 a[8:11], v[28:31], v[56:59], a[8:11]
    v_mfma_f32_16x16x32_bf16 a[12:15], v[28:31], v[60:63], a[12:15]
    ds_read_b64_tr_b16 v[24:25], v14 offset:41216
    ds_read_b64_tr_b16 v[26:27], v14 offset:42496
    s_waitcnt lgkmcnt(12)
    v_mfma_f32_16x16x32_bf16 a[16:19], v[32:35], v[56:59], a[16:19]
    v_mfma_f32_16x16x32_bf16 a[20:23], v[32:35], v[60:63], a[20:23]
    ds_read_b64_tr_b16 v[28:29], v14 offset:51200
    ds_read_b64_tr_b16 v[30:31], v14 offset:52480
    s_waitcnt lgkmcnt(12)
    v_mfma_f32_16x16x32_bf16 a[24:27], v[36:39], v[56:59], a[24:27]
    v_mfma_f32_16x16x32_bf16 a[28:31], v[36:39], v[60:63], a[28:31]
    ds_read_b64_tr_b16 v[32:33], v15 offset:51232
    ds_read_b64_tr_b16 v[34:35], v15 offset:52512
    s_waitcnt lgkmcnt(12)
    v_mfma_f32_16x16x32_bf16 a[32:35], v[40:43], v[56:59], a[32:35]
    v_mfma_f32_16x16x32_bf16 a[36:39], v[40:43], v[60:63], a[36:39]
    ds_read_b64_tr_b16 v[36:37], v14 offset:51264
    ds_read_b64_tr_b16 v[38:39], v14 offset:52544
    s_waitcnt lgkmcnt(12)
    v_mfma_f32_16x16x32_bf16 a[40:43], v[44:47], v[56:59], a[40:43]
    v_mfma_f32_16x16x32_bf16 a[44:47], v[44:47], v[60:63], a[44:47]
    ds_read_b64_tr_b16 v[40:41], v15 offset:51296
    ds_read_b64_tr_b16 v[42:43], v15 offset:52576
    s_waitcnt lgkmcnt(12)
    v_mfma_f32_16x16x32_bf16 a[48:51], v[48:51], v[56:59], a[48:51]
    v_mfma_f32_16x16x32_bf16 a[52:55], v[48:51], v[60:63], a[52:55]
    ds_read_b64_tr_b16 v[44:45], v14 offset:51328
    ds_read_b64_tr_b16 v[46:47], v14 offset:52608
    s_waitcnt lgkmcnt(12)
    v_mfma_f32_16x16x32_bf16 a[56:59], v[52:55], v[56:59], a[56:59]
    v_mfma_f32_16x16x32_bf16 a[60:63], v[52:55], v[60:63], a[60:63]
    ds_read_b64_tr_b16 v[48:49], v15 offset:51360
    ds_read_b64_tr_b16 v[50:51], v15 offset:52640
    s_waitcnt lgkmcnt(12)
    v_mfma_f32_16x16x32_bf16 a[64:67], v[24:27], v[56:59], a[64:67]
    v_mfma_f32_16x16x32_bf16 a[68:71], v[24:27], v[60:63], a[68:71]
    s_add_u32 s33, s34, 23552
    buffer_load_dwordx4 v[112:115], v18, s[20:23], s33 offen
    s_add_u32 s33, s34, 189440
    buffer_load_dwordx4 v[116:119], v18, s[20:23], s33 offen
    ds_read_b64_tr_b16 v[52:53], v14 offset:51392
    ds_read_b64_tr_b16 v[54:55], v14 offset:52672
    s_waitcnt vmcnt(27)
    s_waitcnt lgkmcnt(12)
    v_mfma_f32_16x16x32_bf16 a[0:3], v[28:31], v[64:67], a[0:3]
    v_mfma_f32_16x16x32_bf16 a[4:7], v[28:31], v[68:71], a[4:7]
    ds_read_b64_tr_b16 v[24:25], v15 offset:51424
    ds_read_b64_tr_b16 v[26:27], v15 offset:52704
    s_waitcnt lgkmcnt(12)
    v_mfma_f32_16x16x32_bf16 a[8:11], v[32:35], v[64:67], a[8:11]
    v_mfma_f32_16x16x32_bf16 a[12:15], v[32:35], v[68:71], a[12:15]
    ds_read_b64_tr_b16 v[28:29], v14 offset:51456
    ds_read_b64_tr_b16 v[30:31], v14 offset:52736
    s_waitcnt lgkmcnt(12)
    v_mfma_f32_16x16x32_bf16 a[16:19], v[36:39], v[64:67], a[16:19]
    v_mfma_f32_16x16x32_bf16 a[20:23], v[36:39], v[68:71], a[20:23]
    s_barrier
    s_add_u32 m0, s36, 20480
    buffer_load_dwordx4 v9, s[16:19], s35 offen lds
    s_add_u32 m0, s36, 24576
    buffer_load_dwordx4 v10, s[16:19], s35 offen lds
    s_add_u32 m0, s36, 28672
    buffer_load_dwordx4 v11, s[16:19], s35 offen lds
    s_add_u32 m0, s36, 32768
    buffer_load_dwordx4 v12, s[16:19], s35 offen lds
    s_add_u32 m0, s36, 36864
    buffer_load_dwordx4 v13, s[16:19], s35 offen lds
    s_add_u32 s35, s35, 73728
    ds_read_b64_tr_b16 v[32:33], v16 offset:0
    ds_read_b64_tr_b16 v[34:35], v16 offset:1280
    s_waitcnt lgkmcnt(12)
    v_mfma_f32_16x16x32_bf16 a[24:27], v[40:43], v[64:67], a[24:27]
    v_mfma_f32_16x16x32_bf16 a[28:31], v[40:43], v[68:71], a[28:31]
    ds_read_b64_tr_b16 v[36:37], v17 offset:32
    ds_read_b64_tr_b16 v[38:39], v17 offset:1312
    s_waitcnt lgkmcnt(12)
    v_mfma_f32_16x16x32_bf16 a[32:35], v[44:47], v[64:67], a[32:35]
    v_mfma_f32_16x16x32_bf16 a[36:39], v[44:47], v[68:71], a[36:39]
    ds_read_b64_tr_b16 v[40:41], v16 offset:64
    ds_read_b64_tr_b16 v[42:43], v16 offset:1344
    s_waitcnt lgkmcnt(12)
    v_mfma_f32_16x16x32_bf16 a[40:43], v[48:51], v[64:67], a[40:43]
    v_mfma_f32_16x16x32_bf16 a[44:47], v[48:51], v[68:71], a[44:47]
    ds_read_b64_tr_b16 v[44:45], v17 offset:96
    ds_read_b64_tr_b16 v[46:47], v17 offset:1376
    s_waitcnt lgkmcnt(12)
    v_mfma_f32_16x16x32_bf16 a[48:51], v[52:55], v[64:67], a[48:51]
    v_mfma_f32_16x16x32_bf16 a[52:55], v[52:55], v[68:71], a[52:55]
    ds_read_b64_tr_b16 v[48:49], v16 offset:128
    ds_read_b64_tr_b16 v[50:51], v16 offset:1408
    s_waitcnt lgkmcnt(12)
    v_mfma_f32_16x16x32_bf16 a[56:59], v[24:27], v[64:67], a[56:59]
    v_mfma_f32_16x16x32_bf16 a[60:63], v[24:27], v[68:71], a[60:63]
    ds_read_b64_tr_b16 v[52:53], v17 offset:160
    ds_read_b64_tr_b16 v[54:55], v17 offset:1440
    s_waitcnt lgkmcnt(12)
    v_mfma_f32_16x16x32_bf16 a[64:67], v[28:31], v[64:67], a[64:67]
    v_mfma_f32_16x16x32_bf16 a[68:71], v[28:31], v[68:71], a[68:71]
    s_add_u32 s33, s34, 24576
    buffer_load_dwordx4 v[56:59], v18, s[20:23], s33 offen
    s_add_u32 s33, s34, 190464
    buffer_load_dwordx4 v[60:63], v18, s[20:23], s33 offen
    ds_read_b64_tr_b16 v[24:25], v16 offset:192
    ds_read_b64_tr_b16 v[26:27], v16 offset:1472
    s_waitcnt vmcnt(27)
    s_waitcnt lgkmcnt(12)
    v_mfma_f32_16x16x32_bf16 a[0:3], v[32:35], v[72:75], a[0:3]
    v_mfma_f32_16x16x32_bf16 a[4:7], v[32:35], v[76:79], a[4:7]
    ds_read_b64_tr_b16 v[28:29], v17 offset:224
    ds_read_b64_tr_b16 v[30:31], v17 offset:1504
    s_waitcnt lgkmcnt(12)
    v_mfma_f32_16x16x32_bf16 a[8:11], v[36:39], v[72:75], a[8:11]
    v_mfma_f32_16x16x32_bf16 a[12:15], v[36:39], v[76:79], a[12:15]
    ds_read_b64_tr_b16 v[32:33], v16 offset:256
    ds_read_b64_tr_b16 v[34:35], v16 offset:1536
    s_waitcnt lgkmcnt(12)
    v_mfma_f32_16x16x32_bf16 a[16:19], v[40:43], v[72:75], a[16:19]
    v_mfma_f32_16x16x32_bf16 a[20:23], v[40:43], v[76:79], a[20:23]
    ds_read_b64_tr_b16 v[36:37], v16 offset:10240
    ds_read_b64_tr_b16 v[38:39], v16 offset:11520
    s_waitcnt lgkmcnt(12)
    v_mfma_f32_16x16x32_bf16 a[24:27], v[44:47], v[72:75], a[24:27]
    v_mfma_f32_16x16x32_bf16 a[28:31], v[44:47], v[76:79], a[28:31]
    ds_read_b64_tr_b16 v[40:41], v17 offset:10272
    ds_read_b64_tr_b16 v[42:43], v17 offset:11552
    s_waitcnt lgkmcnt(12)
    v_mfma_f32_16x16x32_bf16 a[32:35], v[48:51], v[72:75], a[32:35]
    v_mfma_f32_16x16x32_bf16 a[36:39], v[48:51], v[76:79], a[36:39]
    ds_read_b64_tr_b16 v[44:45], v16 offset:10304
    ds_read_b64_tr_b16 v[46:47], v16 offset:11584
    s_waitcnt lgkmcnt(12)
    v_mfma_f32_16x16x32_bf16 a[40:43], v[52:55], v[72:75], a[40:43]
    v_mfma_f32_16x16x32_bf16 a[44:47], v[52:55], v[76:79], a[44:47]
    ds_read_b64_tr_b16 v[48:49], v17 offset:10336
    ds_read_b64_tr_b16 v[50:51], v17 offset:11616
    s_waitcnt lgkmcnt(12)
    v_mfma_f32_16x16x32_bf16 a[48:51], v[24:27], v[72:75], a[48:51]
    v_mfma_f32_16x16x32_bf16 a[52:55], v[24:27], v[76:79], a[52:55]
    ds_read_b64_tr_b16 v[52:53], v16 offset:10368
    ds_read_b64_tr_b16 v[54:55], v16 offset:11648
    s_waitcnt lgkmcnt(12)
    v_mfma_f32_16x16x32_bf16 a[56:59], v[28:31], v[72:75], a[56:59]
    v_mfma_f32_16x16x32_bf16 a[60:63], v[28:31], v[76:79], a[60:63]
    ds_read_b64_tr_b16 v[24:25], v17 offset:10400
    ds_read_b64_tr_b16 v[26:27], v17 offset:11680
    s_waitcnt lgkmcnt(12)
    v_mfma_f32_16x16x32_bf16 a[64:67], v[32:35], v[72:75], a[64:67]
    v_mfma_f32_16x16x32_bf16 a[68:71], v[32:35], v[76:79], a[68:71]
    s_add_u32 s33, s34, 25600
    buffer_load_dwordx4 v[64:67], v18, s[20:23], s33 offen
    s_add_u32 s33, s34, 191488
    buffer_load_dwordx4 v[68:71], v18, s[20:23], s33 offen
    ds_read_b64_tr_b16 v[28:29], v16 offset:10432
    ds_read_b64_tr_b16 v[30:31], v16 offset:11712
    s_waitcnt vmcnt(27)
    s_waitcnt lgkmcnt(12)
    v_mfma_f32_16x16x32_bf16 a[0:3], v[36:39], v[80:83], a[0:3]
    v_mfma_f32_16x16x32_bf16 a[4:7], v[36:39], v[84:87], a[4:7]
    ds_read_b64_tr_b16 v[32:33], v17 offset:10464
    ds_read_b64_tr_b16 v[34:35], v17 offset:11744
    s_waitcnt lgkmcnt(12)
    v_mfma_f32_16x16x32_bf16 a[8:11], v[40:43], v[80:83], a[8:11]
    v_mfma_f32_16x16x32_bf16 a[12:15], v[40:43], v[84:87], a[12:15]
    ds_read_b64_tr_b16 v[36:37], v16 offset:10496
    ds_read_b64_tr_b16 v[38:39], v16 offset:11776
    s_waitcnt lgkmcnt(12)
    v_mfma_f32_16x16x32_bf16 a[16:19], v[44:47], v[80:83], a[16:19]
    v_mfma_f32_16x16x32_bf16 a[20:23], v[44:47], v[84:87], a[20:23]
    s_barrier
    s_add_u32 m0, s36, 40960
    buffer_load_dwordx4 v9, s[16:19], s35 offen lds
    s_add_u32 m0, s36, 45056
    buffer_load_dwordx4 v10, s[16:19], s35 offen lds
    s_add_u32 m0, s36, 49152
    buffer_load_dwordx4 v11, s[16:19], s35 offen lds
    s_add_u32 m0, s36, 53248
    buffer_load_dwordx4 v12, s[16:19], s35 offen lds
    s_add_u32 m0, s36, 57344
    buffer_load_dwordx4 v13, s[16:19], s35 offen lds
    s_add_u32 s35, s35, 73728
    ds_read_b64_tr_b16 v[40:41], v16 offset:20480
    ds_read_b64_tr_b16 v[42:43], v16 offset:21760
    s_waitcnt lgkmcnt(12)
    v_mfma_f32_16x16x32_bf16 a[24:27], v[48:51], v[80:83], a[24:27]
    v_mfma_f32_16x16x32_bf16 a[28:31], v[48:51], v[84:87], a[28:31]
    ds_read_b64_tr_b16 v[44:45], v17 offset:20512
    ds_read_b64_tr_b16 v[46:47], v17 offset:21792
    s_waitcnt lgkmcnt(12)
    v_mfma_f32_16x16x32_bf16 a[32:35], v[52:55], v[80:83], a[32:35]
    v_mfma_f32_16x16x32_bf16 a[36:39], v[52:55], v[84:87], a[36:39]
    ds_read_b64_tr_b16 v[48:49], v16 offset:20544
    ds_read_b64_tr_b16 v[50:51], v16 offset:21824
    s_waitcnt lgkmcnt(12)
    v_mfma_f32_16x16x32_bf16 a[40:43], v[24:27], v[80:83], a[40:43]
    v_mfma_f32_16x16x32_bf16 a[44:47], v[24:27], v[84:87], a[44:47]
    ds_read_b64_tr_b16 v[52:53], v17 offset:20576
    ds_read_b64_tr_b16 v[54:55], v17 offset:21856
    s_waitcnt lgkmcnt(12)
    v_mfma_f32_16x16x32_bf16 a[48:51], v[28:31], v[80:83], a[48:51]
    v_mfma_f32_16x16x32_bf16 a[52:55], v[28:31], v[84:87], a[52:55]
    ds_read_b64_tr_b16 v[24:25], v16 offset:20608
    ds_read_b64_tr_b16 v[26:27], v16 offset:21888
    s_waitcnt lgkmcnt(12)
    v_mfma_f32_16x16x32_bf16 a[56:59], v[32:35], v[80:83], a[56:59]
    v_mfma_f32_16x16x32_bf16 a[60:63], v[32:35], v[84:87], a[60:63]
    ds_read_b64_tr_b16 v[28:29], v17 offset:20640
    ds_read_b64_tr_b16 v[30:31], v17 offset:21920
    s_waitcnt lgkmcnt(12)
    v_mfma_f32_16x16x32_bf16 a[64:67], v[36:39], v[80:83], a[64:67]
    v_mfma_f32_16x16x32_bf16 a[68:71], v[36:39], v[84:87], a[68:71]
    s_add_u32 s33, s34, 26624
    buffer_load_dwordx4 v[72:75], v18, s[20:23], s33 offen
    s_add_u32 s33, s34, 192512
    buffer_load_dwordx4 v[76:79], v18, s[20:23], s33 offen
    ds_read_b64_tr_b16 v[32:33], v16 offset:20672
    ds_read_b64_tr_b16 v[34:35], v16 offset:21952
    s_waitcnt vmcnt(27)
    s_waitcnt lgkmcnt(12)
    v_mfma_f32_16x16x32_bf16 a[0:3], v[40:43], v[88:91], a[0:3]
    v_mfma_f32_16x16x32_bf16 a[4:7], v[40:43], v[92:95], a[4:7]
    ds_read_b64_tr_b16 v[36:37], v17 offset:20704
    ds_read_b64_tr_b16 v[38:39], v17 offset:21984
    s_waitcnt lgkmcnt(12)
    v_mfma_f32_16x16x32_bf16 a[8:11], v[44:47], v[88:91], a[8:11]
    v_mfma_f32_16x16x32_bf16 a[12:15], v[44:47], v[92:95], a[12:15]
    ds_read_b64_tr_b16 v[40:41], v16 offset:20736
    ds_read_b64_tr_b16 v[42:43], v16 offset:22016
    s_waitcnt lgkmcnt(12)
    v_mfma_f32_16x16x32_bf16 a[16:19], v[48:51], v[88:91], a[16:19]
    v_mfma_f32_16x16x32_bf16 a[20:23], v[48:51], v[92:95], a[20:23]
    ds_read_b64_tr_b16 v[44:45], v16 offset:30720
    ds_read_b64_tr_b16 v[46:47], v16 offset:32000
    s_waitcnt lgkmcnt(12)
    v_mfma_f32_16x16x32_bf16 a[24:27], v[52:55], v[88:91], a[24:27]
    v_mfma_f32_16x16x32_bf16 a[28:31], v[52:55], v[92:95], a[28:31]
    ds_read_b64_tr_b16 v[48:49], v17 offset:30752
    ds_read_b64_tr_b16 v[50:51], v17 offset:32032
    s_waitcnt lgkmcnt(12)
    v_mfma_f32_16x16x32_bf16 a[32:35], v[24:27], v[88:91], a[32:35]
    v_mfma_f32_16x16x32_bf16 a[36:39], v[24:27], v[92:95], a[36:39]
    ds_read_b64_tr_b16 v[52:53], v16 offset:30784
    ds_read_b64_tr_b16 v[54:55], v16 offset:32064
    s_waitcnt lgkmcnt(12)
    v_mfma_f32_16x16x32_bf16 a[40:43], v[28:31], v[88:91], a[40:43]
    v_mfma_f32_16x16x32_bf16 a[44:47], v[28:31], v[92:95], a[44:47]
    ds_read_b64_tr_b16 v[24:25], v17 offset:30816
    ds_read_b64_tr_b16 v[26:27], v17 offset:32096
    s_waitcnt lgkmcnt(12)
    v_mfma_f32_16x16x32_bf16 a[48:51], v[32:35], v[88:91], a[48:51]
    v_mfma_f32_16x16x32_bf16 a[52:55], v[32:35], v[92:95], a[52:55]
    ds_read_b64_tr_b16 v[28:29], v16 offset:30848
    ds_read_b64_tr_b16 v[30:31], v16 offset:32128
    s_waitcnt lgkmcnt(12)
    v_mfma_f32_16x16x32_bf16 a[56:59], v[36:39], v[88:91], a[56:59]
    v_mfma_f32_16x16x32_bf16 a[60:63], v[36:39], v[92:95], a[60:63]
    ds_read_b64_tr_b16 v[32:33], v17 offset:30880
    ds_read_b64_tr_b16 v[34:35], v17 offset:32160
    s_waitcnt lgkmcnt(12)
    v_mfma_f32_16x16x32_bf16 a[64:67], v[40:43], v[88:91], a[64:67]
    v_mfma_f32_16x16x32_bf16 a[68:71], v[40:43], v[92:95], a[68:71]
    s_add_u32 s33, s34, 27648
    buffer_load_dwordx4 v[80:83], v18, s[20:23], s33 offen
    s_add_u32 s33, s34, 193536
    buffer_load_dwordx4 v[84:87], v18, s[20:23], s33 offen
    ds_read_b64_tr_b16 v[36:37], v16 offset:30912
    ds_read_b64_tr_b16 v[38:39], v16 offset:32192
    s_waitcnt vmcnt(27)
    s_waitcnt lgkmcnt(12)
    v_mfma_f32_16x16x32_bf16 a[0:3], v[44:47], v[96:99], a[0:3]
    v_mfma_f32_16x16x32_bf16 a[4:7], v[44:47], v[100:103], a[4:7]
    ds_read_b64_tr_b16 v[40:41], v17 offset:30944
    ds_read_b64_tr_b16 v[42:43], v17 offset:32224
    s_waitcnt lgkmcnt(12)
    v_mfma_f32_16x16x32_bf16 a[8:11], v[48:51], v[96:99], a[8:11]
    v_mfma_f32_16x16x32_bf16 a[12:15], v[48:51], v[100:103], a[12:15]
    ds_read_b64_tr_b16 v[44:45], v16 offset:30976
    ds_read_b64_tr_b16 v[46:47], v16 offset:32256
    s_waitcnt lgkmcnt(12)
    v_mfma_f32_16x16x32_bf16 a[16:19], v[52:55], v[96:99], a[16:19]
    v_mfma_f32_16x16x32_bf16 a[20:23], v[52:55], v[100:103], a[20:23]
    s_barrier
    s_add_u32 m0, s36, 61440
    buffer_load_dwordx4 v9, s[16:19], s35 offen lds
    s_add_u32 m0, s36, 65536
    buffer_load_dwordx4 v10, s[16:19], s35 offen lds
    s_add_u32 m0, s36, 69632
    buffer_load_dwordx4 v11, s[16:19], s35 offen lds
    s_add_u32 m0, s36, 73728
    buffer_load_dwordx4 v12, s[16:19], s35 offen lds
    s_add_u32 m0, s36, 77824
    buffer_load_dwordx4 v13, s[16:19], s35 offen lds
    s_add_u32 s35, s35, 73728
    ds_read_b64_tr_b16 v[48:49], v16 offset:40960
    ds_read_b64_tr_b16 v[50:51], v16 offset:42240
    s_waitcnt lgkmcnt(12)
    v_mfma_f32_16x16x32_bf16 a[24:27], v[24:27], v[96:99], a[24:27]
    v_mfma_f32_16x16x32_bf16 a[28:31], v[24:27], v[100:103], a[28:31]
    ds_read_b64_tr_b16 v[52:53], v17 offset:40992
    ds_read_b64_tr_b16 v[54:55], v17 offset:42272
    s_waitcnt lgkmcnt(12)
    v_mfma_f32_16x16x32_bf16 a[32:35], v[28:31], v[96:99], a[32:35]
    v_mfma_f32_16x16x32_bf16 a[36:39], v[28:31], v[100:103], a[36:39]
    ds_read_b64_tr_b16 v[24:25], v16 offset:41024
    ds_read_b64_tr_b16 v[26:27], v16 offset:42304
    s_waitcnt lgkmcnt(12)
    v_mfma_f32_16x16x32_bf16 a[40:43], v[32:35], v[96:99], a[40:43]
    v_mfma_f32_16x16x32_bf16 a[44:47], v[32:35], v[100:103], a[44:47]
    ds_read_b64_tr_b16 v[28:29], v17 offset:41056
    ds_read_b64_tr_b16 v[30:31], v17 offset:42336
    s_waitcnt lgkmcnt(12)
    v_mfma_f32_16x16x32_bf16 a[48:51], v[36:39], v[96:99], a[48:51]
    v_mfma_f32_16x16x32_bf16 a[52:55], v[36:39], v[100:103], a[52:55]
    ds_read_b64_tr_b16 v[32:33], v16 offset:41088
    ds_read_b64_tr_b16 v[34:35], v16 offset:42368
    s_waitcnt lgkmcnt(12)
    v_mfma_f32_16x16x32_bf16 a[56:59], v[40:43], v[96:99], a[56:59]
    v_mfma_f32_16x16x32_bf16 a[60:63], v[40:43], v[100:103], a[60:63]
    ds_read_b64_tr_b16 v[36:37], v17 offset:41120
    ds_read_b64_tr_b16 v[38:39], v17 offset:42400
    s_waitcnt lgkmcnt(12)
    v_mfma_f32_16x16x32_bf16 a[64:67], v[44:47], v[96:99], a[64:67]
    v_mfma_f32_16x16x32_bf16 a[68:71], v[44:47], v[100:103], a[68:71]
    s_add_u32 s33, s34, 28672
    buffer_load_dwordx4 v[88:91], v18, s[20:23], s33 offen
    s_add_u32 s33, s34, 194560
    buffer_load_dwordx4 v[92:95], v18, s[20:23], s33 offen
    ds_read_b64_tr_b16 v[40:41], v16 offset:41152
    ds_read_b64_tr_b16 v[42:43], v16 offset:42432
    s_waitcnt vmcnt(27)
    s_waitcnt lgkmcnt(12)
    v_mfma_f32_16x16x32_bf16 a[0:3], v[48:51], v[104:107], a[0:3]
    v_mfma_f32_16x16x32_bf16 a[4:7], v[48:51], v[108:111], a[4:7]
    ds_read_b64_tr_b16 v[44:45], v17 offset:41184
    ds_read_b64_tr_b16 v[46:47], v17 offset:42464
    s_waitcnt lgkmcnt(12)
    v_mfma_f32_16x16x32_bf16 a[8:11], v[52:55], v[104:107], a[8:11]
    v_mfma_f32_16x16x32_bf16 a[12:15], v[52:55], v[108:111], a[12:15]
    ds_read_b64_tr_b16 v[48:49], v16 offset:41216
    ds_read_b64_tr_b16 v[50:51], v16 offset:42496
    s_waitcnt lgkmcnt(12)
    v_mfma_f32_16x16x32_bf16 a[16:19], v[24:27], v[104:107], a[16:19]
    v_mfma_f32_16x16x32_bf16 a[20:23], v[24:27], v[108:111], a[20:23]
    ds_read_b64_tr_b16 v[52:53], v16 offset:51200
    ds_read_b64_tr_b16 v[54:55], v16 offset:52480
    s_waitcnt lgkmcnt(12)
    v_mfma_f32_16x16x32_bf16 a[24:27], v[28:31], v[104:107], a[24:27]
    v_mfma_f32_16x16x32_bf16 a[28:31], v[28:31], v[108:111], a[28:31]
    ds_read_b64_tr_b16 v[24:25], v17 offset:51232
    ds_read_b64_tr_b16 v[26:27], v17 offset:52512
    s_waitcnt lgkmcnt(12)
    v_mfma_f32_16x16x32_bf16 a[32:35], v[32:35], v[104:107], a[32:35]
    v_mfma_f32_16x16x32_bf16 a[36:39], v[32:35], v[108:111], a[36:39]
    ds_read_b64_tr_b16 v[28:29], v16 offset:51264
    ds_read_b64_tr_b16 v[30:31], v16 offset:52544
    s_waitcnt lgkmcnt(12)
    v_mfma_f32_16x16x32_bf16 a[40:43], v[36:39], v[104:107], a[40:43]
    v_mfma_f32_16x16x32_bf16 a[44:47], v[36:39], v[108:111], a[44:47]
    ds_read_b64_tr_b16 v[32:33], v17 offset:51296
    ds_read_b64_tr_b16 v[34:35], v17 offset:52576
    s_waitcnt lgkmcnt(12)
    v_mfma_f32_16x16x32_bf16 a[48:51], v[40:43], v[104:107], a[48:51]
    v_mfma_f32_16x16x32_bf16 a[52:55], v[40:43], v[108:111], a[52:55]
    ds_read_b64_tr_b16 v[36:37], v16 offset:51328
    ds_read_b64_tr_b16 v[38:39], v16 offset:52608
    s_waitcnt lgkmcnt(12)
    v_mfma_f32_16x16x32_bf16 a[56:59], v[44:47], v[104:107], a[56:59]
    v_mfma_f32_16x16x32_bf16 a[60:63], v[44:47], v[108:111], a[60:63]
    ds_read_b64_tr_b16 v[40:41], v17 offset:51360
    ds_read_b64_tr_b16 v[42:43], v17 offset:52640
    s_waitcnt lgkmcnt(12)
    v_mfma_f32_16x16x32_bf16 a[64:67], v[48:51], v[104:107], a[64:67]
    v_mfma_f32_16x16x32_bf16 a[68:71], v[48:51], v[108:111], a[68:71]
    s_add_u32 s33, s34, 29696
    buffer_load_dwordx4 v[96:99], v18, s[20:23], s33 offen
    s_add_u32 s33, s34, 195584
    buffer_load_dwordx4 v[100:103], v18, s[20:23], s33 offen
    ds_read_b64_tr_b16 v[44:45], v16 offset:51392
    ds_read_b64_tr_b16 v[46:47], v16 offset:52672
    s_waitcnt vmcnt(27)
    s_waitcnt lgkmcnt(12)
    v_mfma_f32_16x16x32_bf16 a[0:3], v[52:55], v[112:115], a[0:3]
    v_mfma_f32_16x16x32_bf16 a[4:7], v[52:55], v[116:119], a[4:7]
    ds_read_b64_tr_b16 v[48:49], v17 offset:51424
    ds_read_b64_tr_b16 v[50:51], v17 offset:52704
    s_waitcnt lgkmcnt(12)
    v_mfma_f32_16x16x32_bf16 a[8:11], v[24:27], v[112:115], a[8:11]
    v_mfma_f32_16x16x32_bf16 a[12:15], v[24:27], v[116:119], a[12:15]
    ds_read_b64_tr_b16 v[52:53], v16 offset:51456
    ds_read_b64_tr_b16 v[54:55], v16 offset:52736
    s_waitcnt lgkmcnt(12)
    v_mfma_f32_16x16x32_bf16 a[16:19], v[28:31], v[112:115], a[16:19]
    v_mfma_f32_16x16x32_bf16 a[20:23], v[28:31], v[116:119], a[20:23]
    s_barrier
    s_add_u32 m0, s36, 81920
    buffer_load_dwordx4 v9, s[16:19], s35 offen lds
    s_add_u32 m0, s36, 86016
    buffer_load_dwordx4 v10, s[16:19], s35 offen lds
    s_add_u32 m0, s36, 90112
    buffer_load_dwordx4 v11, s[16:19], s35 offen lds
    s_add_u32 m0, s36, 94208
    buffer_load_dwordx4 v12, s[16:19], s35 offen lds
    s_add_u32 m0, s36, 98304
    buffer_load_dwordx4 v13, s[16:19], s35 offen lds
    s_add_u32 s35, s35, 73728
    ds_read_b64_tr_b16 v[24:25], v14 offset:0
    ds_read_b64_tr_b16 v[26:27], v14 offset:1280
    s_waitcnt lgkmcnt(12)
    v_mfma_f32_16x16x32_bf16 a[24:27], v[32:35], v[112:115], a[24:27]
    v_mfma_f32_16x16x32_bf16 a[28:31], v[32:35], v[116:119], a[28:31]
    ds_read_b64_tr_b16 v[28:29], v15 offset:32
    ds_read_b64_tr_b16 v[30:31], v15 offset:1312
    s_waitcnt lgkmcnt(12)
    v_mfma_f32_16x16x32_bf16 a[32:35], v[36:39], v[112:115], a[32:35]
    v_mfma_f32_16x16x32_bf16 a[36:39], v[36:39], v[116:119], a[36:39]
    ds_read_b64_tr_b16 v[32:33], v14 offset:64
    ds_read_b64_tr_b16 v[34:35], v14 offset:1344
    s_waitcnt lgkmcnt(12)
    v_mfma_f32_16x16x32_bf16 a[40:43], v[40:43], v[112:115], a[40:43]
    v_mfma_f32_16x16x32_bf16 a[44:47], v[40:43], v[116:119], a[44:47]
    ds_read_b64_tr_b16 v[36:37], v15 offset:96
    ds_read_b64_tr_b16 v[38:39], v15 offset:1376
    s_waitcnt lgkmcnt(12)
    v_mfma_f32_16x16x32_bf16 a[48:51], v[44:47], v[112:115], a[48:51]
    v_mfma_f32_16x16x32_bf16 a[52:55], v[44:47], v[116:119], a[52:55]
    ds_read_b64_tr_b16 v[40:41], v14 offset:128
    ds_read_b64_tr_b16 v[42:43], v14 offset:1408
    s_waitcnt lgkmcnt(12)
    v_mfma_f32_16x16x32_bf16 a[56:59], v[48:51], v[112:115], a[56:59]
    v_mfma_f32_16x16x32_bf16 a[60:63], v[48:51], v[116:119], a[60:63]
    ds_read_b64_tr_b16 v[44:45], v15 offset:160
    ds_read_b64_tr_b16 v[46:47], v15 offset:1440
    s_waitcnt lgkmcnt(12)
    v_mfma_f32_16x16x32_bf16 a[64:67], v[52:55], v[112:115], a[64:67]
    v_mfma_f32_16x16x32_bf16 a[68:71], v[52:55], v[116:119], a[68:71]
    s_add_u32 s33, s34, 30720
    buffer_load_dwordx4 v[104:107], v18, s[20:23], s33 offen
    s_add_u32 s33, s34, 196608
    buffer_load_dwordx4 v[108:111], v18, s[20:23], s33 offen
    ds_read_b64_tr_b16 v[48:49], v14 offset:192
    ds_read_b64_tr_b16 v[50:51], v14 offset:1472
    s_waitcnt vmcnt(27)
    s_waitcnt lgkmcnt(12)
    v_mfma_f32_16x16x32_bf16 a[0:3], v[24:27], v[56:59], a[0:3]
    v_mfma_f32_16x16x32_bf16 a[4:7], v[24:27], v[60:63], a[4:7]
    ds_read_b64_tr_b16 v[52:53], v15 offset:224
    ds_read_b64_tr_b16 v[54:55], v15 offset:1504
    s_waitcnt lgkmcnt(12)
    v_mfma_f32_16x16x32_bf16 a[8:11], v[28:31], v[56:59], a[8:11]
    v_mfma_f32_16x16x32_bf16 a[12:15], v[28:31], v[60:63], a[12:15]
    ds_read_b64_tr_b16 v[24:25], v14 offset:256
    ds_read_b64_tr_b16 v[26:27], v14 offset:1536
    s_waitcnt lgkmcnt(12)
    v_mfma_f32_16x16x32_bf16 a[16:19], v[32:35], v[56:59], a[16:19]
    v_mfma_f32_16x16x32_bf16 a[20:23], v[32:35], v[60:63], a[20:23]
    ds_read_b64_tr_b16 v[28:29], v14 offset:10240
    ds_read_b64_tr_b16 v[30:31], v14 offset:11520
    s_waitcnt lgkmcnt(12)
    v_mfma_f32_16x16x32_bf16 a[24:27], v[36:39], v[56:59], a[24:27]
    v_mfma_f32_16x16x32_bf16 a[28:31], v[36:39], v[60:63], a[28:31]
    ds_read_b64_tr_b16 v[32:33], v15 offset:10272
    ds_read_b64_tr_b16 v[34:35], v15 offset:11552
    s_waitcnt lgkmcnt(12)
    v_mfma_f32_16x16x32_bf16 a[32:35], v[40:43], v[56:59], a[32:35]
    v_mfma_f32_16x16x32_bf16 a[36:39], v[40:43], v[60:63], a[36:39]
    ds_read_b64_tr_b16 v[36:37], v14 offset:10304
    ds_read_b64_tr_b16 v[38:39], v14 offset:11584
    s_waitcnt lgkmcnt(12)
    v_mfma_f32_16x16x32_bf16 a[40:43], v[44:47], v[56:59], a[40:43]
    v_mfma_f32_16x16x32_bf16 a[44:47], v[44:47], v[60:63], a[44:47]
    ds_read_b64_tr_b16 v[40:41], v15 offset:10336
    ds_read_b64_tr_b16 v[42:43], v15 offset:11616
    s_waitcnt lgkmcnt(12)
    v_mfma_f32_16x16x32_bf16 a[48:51], v[48:51], v[56:59], a[48:51]
    v_mfma_f32_16x16x32_bf16 a[52:55], v[48:51], v[60:63], a[52:55]
    ds_read_b64_tr_b16 v[44:45], v14 offset:10368
    ds_read_b64_tr_b16 v[46:47], v14 offset:11648
    s_waitcnt lgkmcnt(12)
    v_mfma_f32_16x16x32_bf16 a[56:59], v[52:55], v[56:59], a[56:59]
    v_mfma_f32_16x16x32_bf16 a[60:63], v[52:55], v[60:63], a[60:63]
    ds_read_b64_tr_b16 v[48:49], v15 offset:10400
    ds_read_b64_tr_b16 v[50:51], v15 offset:11680
    s_waitcnt lgkmcnt(12)
    v_mfma_f32_16x16x32_bf16 a[64:67], v[24:27], v[56:59], a[64:67]
    v_mfma_f32_16x16x32_bf16 a[68:71], v[24:27], v[60:63], a[68:71]
    s_add_u32 s33, s34, 31744
    buffer_load_dwordx4 v[112:115], v18, s[20:23], s33 offen
    s_add_u32 s33, s34, 197632
    buffer_load_dwordx4 v[116:119], v18, s[20:23], s33 offen
    ds_read_b64_tr_b16 v[52:53], v14 offset:10432
    ds_read_b64_tr_b16 v[54:55], v14 offset:11712
    s_waitcnt vmcnt(27)
    s_waitcnt lgkmcnt(12)
    v_mfma_f32_16x16x32_bf16 a[0:3], v[28:31], v[64:67], a[0:3]
    v_mfma_f32_16x16x32_bf16 a[4:7], v[28:31], v[68:71], a[4:7]
    ds_read_b64_tr_b16 v[24:25], v15 offset:10464
    ds_read_b64_tr_b16 v[26:27], v15 offset:11744
    s_waitcnt lgkmcnt(12)
    v_mfma_f32_16x16x32_bf16 a[8:11], v[32:35], v[64:67], a[8:11]
    v_mfma_f32_16x16x32_bf16 a[12:15], v[32:35], v[68:71], a[12:15]
    ds_read_b64_tr_b16 v[28:29], v14 offset:10496
    ds_read_b64_tr_b16 v[30:31], v14 offset:11776
    s_waitcnt lgkmcnt(12)
    v_mfma_f32_16x16x32_bf16 a[16:19], v[36:39], v[64:67], a[16:19]
    v_mfma_f32_16x16x32_bf16 a[20:23], v[36:39], v[68:71], a[20:23]
    s_barrier
    s_add_u32 m0, s36, 102400
    buffer_load_dwordx4 v9, s[16:19], s35 offen lds
    s_add_u32 m0, s36, 106496
    buffer_load_dwordx4 v10, s[16:19], s35 offen lds
    s_add_u32 m0, s36, 110592
    buffer_load_dwordx4 v11, s[16:19], s35 offen lds
    s_add_u32 m0, s36, 114688
    buffer_load_dwordx4 v12, s[16:19], s35 offen lds
    s_add_u32 m0, s36, 118784
    buffer_load_dwordx4 v13, s[16:19], s35 offen lds
    s_add_u32 s35, s35, 73728
    ds_read_b64_tr_b16 v[32:33], v14 offset:20480
    ds_read_b64_tr_b16 v[34:35], v14 offset:21760
    s_waitcnt lgkmcnt(12)
    v_mfma_f32_16x16x32_bf16 a[24:27], v[40:43], v[64:67], a[24:27]
    v_mfma_f32_16x16x32_bf16 a[28:31], v[40:43], v[68:71], a[28:31]
    ds_read_b64_tr_b16 v[36:37], v15 offset:20512
    ds_read_b64_tr_b16 v[38:39], v15 offset:21792
    s_waitcnt lgkmcnt(12)
    v_mfma_f32_16x16x32_bf16 a[32:35], v[44:47], v[64:67], a[32:35]
    v_mfma_f32_16x16x32_bf16 a[36:39], v[44:47], v[68:71], a[36:39]
    ds_read_b64_tr_b16 v[40:41], v14 offset:20544
    ds_read_b64_tr_b16 v[42:43], v14 offset:21824
    s_waitcnt lgkmcnt(12)
    v_mfma_f32_16x16x32_bf16 a[40:43], v[48:51], v[64:67], a[40:43]
    v_mfma_f32_16x16x32_bf16 a[44:47], v[48:51], v[68:71], a[44:47]
    ds_read_b64_tr_b16 v[44:45], v15 offset:20576
    ds_read_b64_tr_b16 v[46:47], v15 offset:21856
    s_waitcnt lgkmcnt(12)
    v_mfma_f32_16x16x32_bf16 a[48:51], v[52:55], v[64:67], a[48:51]
    v_mfma_f32_16x16x32_bf16 a[52:55], v[52:55], v[68:71], a[52:55]
    ds_read_b64_tr_b16 v[48:49], v14 offset:20608
    ds_read_b64_tr_b16 v[50:51], v14 offset:21888
    s_waitcnt lgkmcnt(12)
    v_mfma_f32_16x16x32_bf16 a[56:59], v[24:27], v[64:67], a[56:59]
    v_mfma_f32_16x16x32_bf16 a[60:63], v[24:27], v[68:71], a[60:63]
    ds_read_b64_tr_b16 v[52:53], v15 offset:20640
    ds_read_b64_tr_b16 v[54:55], v15 offset:21920
    s_waitcnt lgkmcnt(12)
    v_mfma_f32_16x16x32_bf16 a[64:67], v[28:31], v[64:67], a[64:67]
    v_mfma_f32_16x16x32_bf16 a[68:71], v[28:31], v[68:71], a[68:71]
    s_add_u32 s33, s34, 32768
    buffer_load_dwordx4 v[56:59], v18, s[20:23], s33 offen
    s_add_u32 s33, s34, 198656
    buffer_load_dwordx4 v[60:63], v18, s[20:23], s33 offen
    ds_read_b64_tr_b16 v[24:25], v14 offset:20672
    ds_read_b64_tr_b16 v[26:27], v14 offset:21952
    s_waitcnt vmcnt(27)
    s_waitcnt lgkmcnt(12)
    v_mfma_f32_16x16x32_bf16 a[0:3], v[32:35], v[72:75], a[0:3]
    v_mfma_f32_16x16x32_bf16 a[4:7], v[32:35], v[76:79], a[4:7]
    ds_read_b64_tr_b16 v[28:29], v15 offset:20704
    ds_read_b64_tr_b16 v[30:31], v15 offset:21984
    s_waitcnt lgkmcnt(12)
    v_mfma_f32_16x16x32_bf16 a[8:11], v[36:39], v[72:75], a[8:11]
    v_mfma_f32_16x16x32_bf16 a[12:15], v[36:39], v[76:79], a[12:15]
    ds_read_b64_tr_b16 v[32:33], v14 offset:20736
    ds_read_b64_tr_b16 v[34:35], v14 offset:22016
    s_waitcnt lgkmcnt(12)
    v_mfma_f32_16x16x32_bf16 a[16:19], v[40:43], v[72:75], a[16:19]
    v_mfma_f32_16x16x32_bf16 a[20:23], v[40:43], v[76:79], a[20:23]
    ds_read_b64_tr_b16 v[36:37], v14 offset:30720
    ds_read_b64_tr_b16 v[38:39], v14 offset:32000
    s_waitcnt lgkmcnt(12)
    v_mfma_f32_16x16x32_bf16 a[24:27], v[44:47], v[72:75], a[24:27]
    v_mfma_f32_16x16x32_bf16 a[28:31], v[44:47], v[76:79], a[28:31]
    ds_read_b64_tr_b16 v[40:41], v15 offset:30752
    ds_read_b64_tr_b16 v[42:43], v15 offset:32032
    s_waitcnt lgkmcnt(12)
    v_mfma_f32_16x16x32_bf16 a[32:35], v[48:51], v[72:75], a[32:35]
    v_mfma_f32_16x16x32_bf16 a[36:39], v[48:51], v[76:79], a[36:39]
    ds_read_b64_tr_b16 v[44:45], v14 offset:30784
    ds_read_b64_tr_b16 v[46:47], v14 offset:32064
    s_waitcnt lgkmcnt(12)
    v_mfma_f32_16x16x32_bf16 a[40:43], v[52:55], v[72:75], a[40:43]
    v_mfma_f32_16x16x32_bf16 a[44:47], v[52:55], v[76:79], a[44:47]
    ds_read_b64_tr_b16 v[48:49], v15 offset:30816
    ds_read_b64_tr_b16 v[50:51], v15 offset:32096
    s_waitcnt lgkmcnt(12)
    v_mfma_f32_16x16x32_bf16 a[48:51], v[24:27], v[72:75], a[48:51]
    v_mfma_f32_16x16x32_bf16 a[52:55], v[24:27], v[76:79], a[52:55]
    ds_read_b64_tr_b16 v[52:53], v14 offset:30848
    ds_read_b64_tr_b16 v[54:55], v14 offset:32128
    s_waitcnt lgkmcnt(12)
    v_mfma_f32_16x16x32_bf16 a[56:59], v[28:31], v[72:75], a[56:59]
    v_mfma_f32_16x16x32_bf16 a[60:63], v[28:31], v[76:79], a[60:63]
    ds_read_b64_tr_b16 v[24:25], v15 offset:30880
    ds_read_b64_tr_b16 v[26:27], v15 offset:32160
    s_waitcnt lgkmcnt(12)
    v_mfma_f32_16x16x32_bf16 a[64:67], v[32:35], v[72:75], a[64:67]
    v_mfma_f32_16x16x32_bf16 a[68:71], v[32:35], v[76:79], a[68:71]
    s_add_u32 s33, s34, 33792
    buffer_load_dwordx4 v[64:67], v18, s[20:23], s33 offen
    s_add_u32 s33, s34, 199680
    buffer_load_dwordx4 v[68:71], v18, s[20:23], s33 offen
    ds_read_b64_tr_b16 v[28:29], v14 offset:30912
    ds_read_b64_tr_b16 v[30:31], v14 offset:32192
    s_waitcnt vmcnt(27)
    s_waitcnt lgkmcnt(12)
    v_mfma_f32_16x16x32_bf16 a[0:3], v[36:39], v[80:83], a[0:3]
    v_mfma_f32_16x16x32_bf16 a[4:7], v[36:39], v[84:87], a[4:7]
    ds_read_b64_tr_b16 v[32:33], v15 offset:30944
    ds_read_b64_tr_b16 v[34:35], v15 offset:32224
    s_waitcnt lgkmcnt(12)
    v_mfma_f32_16x16x32_bf16 a[8:11], v[40:43], v[80:83], a[8:11]
    v_mfma_f32_16x16x32_bf16 a[12:15], v[40:43], v[84:87], a[12:15]
    ds_read_b64_tr_b16 v[36:37], v14 offset:30976
    ds_read_b64_tr_b16 v[38:39], v14 offset:32256
    s_waitcnt lgkmcnt(12)
    v_mfma_f32_16x16x32_bf16 a[16:19], v[44:47], v[80:83], a[16:19]
    v_mfma_f32_16x16x32_bf16 a[20:23], v[44:47], v[84:87], a[20:23]
    s_barrier
    s_add_u32 m0, s36, 0
    buffer_load_dwordx4 v9, s[16:19], s35 offen lds
    s_add_u32 m0, s36, 4096
    buffer_load_dwordx4 v10, s[16:19], s35 offen lds
    s_add_u32 m0, s36, 8192
    buffer_load_dwordx4 v11, s[16:19], s35 offen lds
    s_add_u32 m0, s36, 12288
    buffer_load_dwordx4 v12, s[16:19], s35 offen lds
    s_add_u32 m0, s36, 16384
    buffer_load_dwordx4 v13, s[16:19], s35 offen lds
    s_add_u32 s35, s35, 73728
    ds_read_b64_tr_b16 v[40:41], v14 offset:40960
    ds_read_b64_tr_b16 v[42:43], v14 offset:42240
    s_waitcnt lgkmcnt(12)
    v_mfma_f32_16x16x32_bf16 a[24:27], v[48:51], v[80:83], a[24:27]
    v_mfma_f32_16x16x32_bf16 a[28:31], v[48:51], v[84:87], a[28:31]
    ds_read_b64_tr_b16 v[44:45], v15 offset:40992
    ds_read_b64_tr_b16 v[46:47], v15 offset:42272
    s_waitcnt lgkmcnt(12)
    v_mfma_f32_16x16x32_bf16 a[32:35], v[52:55], v[80:83], a[32:35]
    v_mfma_f32_16x16x32_bf16 a[36:39], v[52:55], v[84:87], a[36:39]
    ds_read_b64_tr_b16 v[48:49], v14 offset:41024
    ds_read_b64_tr_b16 v[50:51], v14 offset:42304
    s_waitcnt lgkmcnt(12)
    v_mfma_f32_16x16x32_bf16 a[40:43], v[24:27], v[80:83], a[40:43]
    v_mfma_f32_16x16x32_bf16 a[44:47], v[24:27], v[84:87], a[44:47]
    ds_read_b64_tr_b16 v[52:53], v15 offset:41056
    ds_read_b64_tr_b16 v[54:55], v15 offset:42336
    s_waitcnt lgkmcnt(12)
    v_mfma_f32_16x16x32_bf16 a[48:51], v[28:31], v[80:83], a[48:51]
    v_mfma_f32_16x16x32_bf16 a[52:55], v[28:31], v[84:87], a[52:55]
    ds_read_b64_tr_b16 v[24:25], v14 offset:41088
    ds_read_b64_tr_b16 v[26:27], v14 offset:42368
    s_waitcnt lgkmcnt(12)
    v_mfma_f32_16x16x32_bf16 a[56:59], v[32:35], v[80:83], a[56:59]
    v_mfma_f32_16x16x32_bf16 a[60:63], v[32:35], v[84:87], a[60:63]
    ds_read_b64_tr_b16 v[28:29], v15 offset:41120
    ds_read_b64_tr_b16 v[30:31], v15 offset:42400
    s_waitcnt lgkmcnt(12)
    v_mfma_f32_16x16x32_bf16 a[64:67], v[36:39], v[80:83], a[64:67]
    v_mfma_f32_16x16x32_bf16 a[68:71], v[36:39], v[84:87], a[68:71]
    s_add_u32 s33, s34, 34816
    buffer_load_dwordx4 v[72:75], v18, s[20:23], s33 offen
    s_add_u32 s33, s34, 200704
    buffer_load_dwordx4 v[76:79], v18, s[20:23], s33 offen
    ds_read_b64_tr_b16 v[32:33], v14 offset:41152
    ds_read_b64_tr_b16 v[34:35], v14 offset:42432
    s_waitcnt vmcnt(27)
    s_waitcnt lgkmcnt(12)
    v_mfma_f32_16x16x32_bf16 a[0:3], v[40:43], v[88:91], a[0:3]
    v_mfma_f32_16x16x32_bf16 a[4:7], v[40:43], v[92:95], a[4:7]
    ds_read_b64_tr_b16 v[36:37], v15 offset:41184
    ds_read_b64_tr_b16 v[38:39], v15 offset:42464
    s_waitcnt lgkmcnt(12)
    v_mfma_f32_16x16x32_bf16 a[8:11], v[44:47], v[88:91], a[8:11]
    v_mfma_f32_16x16x32_bf16 a[12:15], v[44:47], v[92:95], a[12:15]
    ds_read_b64_tr_b16 v[40:41], v14 offset:41216
    ds_read_b64_tr_b16 v[42:43], v14 offset:42496
    s_waitcnt lgkmcnt(12)
    v_mfma_f32_16x16x32_bf16 a[16:19], v[48:51], v[88:91], a[16:19]
    v_mfma_f32_16x16x32_bf16 a[20:23], v[48:51], v[92:95], a[20:23]
    ds_read_b64_tr_b16 v[44:45], v14 offset:51200
    ds_read_b64_tr_b16 v[46:47], v14 offset:52480
    s_waitcnt lgkmcnt(12)
    v_mfma_f32_16x16x32_bf16 a[24:27], v[52:55], v[88:91], a[24:27]
    v_mfma_f32_16x16x32_bf16 a[28:31], v[52:55], v[92:95], a[28:31]
    ds_read_b64_tr_b16 v[48:49], v15 offset:51232
    ds_read_b64_tr_b16 v[50:51], v15 offset:52512
    s_waitcnt lgkmcnt(12)
    v_mfma_f32_16x16x32_bf16 a[32:35], v[24:27], v[88:91], a[32:35]
    v_mfma_f32_16x16x32_bf16 a[36:39], v[24:27], v[92:95], a[36:39]
    ds_read_b64_tr_b16 v[52:53], v14 offset:51264
    ds_read_b64_tr_b16 v[54:55], v14 offset:52544
    s_waitcnt lgkmcnt(12)
    v_mfma_f32_16x16x32_bf16 a[40:43], v[28:31], v[88:91], a[40:43]
    v_mfma_f32_16x16x32_bf16 a[44:47], v[28:31], v[92:95], a[44:47]
    ds_read_b64_tr_b16 v[24:25], v15 offset:51296
    ds_read_b64_tr_b16 v[26:27], v15 offset:52576
    s_waitcnt lgkmcnt(12)
    v_mfma_f32_16x16x32_bf16 a[48:51], v[32:35], v[88:91], a[48:51]
    v_mfma_f32_16x16x32_bf16 a[52:55], v[32:35], v[92:95], a[52:55]
    ds_read_b64_tr_b16 v[28:29], v14 offset:51328
    ds_read_b64_tr_b16 v[30:31], v14 offset:52608
    s_waitcnt lgkmcnt(12)
    v_mfma_f32_16x16x32_bf16 a[56:59], v[36:39], v[88:91], a[56:59]
    v_mfma_f32_16x16x32_bf16 a[60:63], v[36:39], v[92:95], a[60:63]
    ds_read_b64_tr_b16 v[32:33], v15 offset:51360
    ds_read_b64_tr_b16 v[34:35], v15 offset:52640
    s_waitcnt lgkmcnt(12)
    v_mfma_f32_16x16x32_bf16 a[64:67], v[40:43], v[88:91], a[64:67]
    v_mfma_f32_16x16x32_bf16 a[68:71], v[40:43], v[92:95], a[68:71]
    s_add_u32 s33, s34, 35840
    buffer_load_dwordx4 v[80:83], v18, s[20:23], s33 offen
    s_add_u32 s33, s34, 201728
    buffer_load_dwordx4 v[84:87], v18, s[20:23], s33 offen
    ds_read_b64_tr_b16 v[36:37], v14 offset:51392
    ds_read_b64_tr_b16 v[38:39], v14 offset:52672
    s_waitcnt vmcnt(27)
    s_waitcnt lgkmcnt(12)
    v_mfma_f32_16x16x32_bf16 a[0:3], v[44:47], v[96:99], a[0:3]
    v_mfma_f32_16x16x32_bf16 a[4:7], v[44:47], v[100:103], a[4:7]
    ds_read_b64_tr_b16 v[40:41], v15 offset:51424
    ds_read_b64_tr_b16 v[42:43], v15 offset:52704
    s_waitcnt lgkmcnt(12)
    v_mfma_f32_16x16x32_bf16 a[8:11], v[48:51], v[96:99], a[8:11]
    v_mfma_f32_16x16x32_bf16 a[12:15], v[48:51], v[100:103], a[12:15]
    ds_read_b64_tr_b16 v[44:45], v14 offset:51456
    ds_read_b64_tr_b16 v[46:47], v14 offset:52736
    s_waitcnt lgkmcnt(12)
    v_mfma_f32_16x16x32_bf16 a[16:19], v[52:55], v[96:99], a[16:19]
    v_mfma_f32_16x16x32_bf16 a[20:23], v[52:55], v[100:103], a[20:23]
    s_barrier
    s_add_u32 m0, s36, 20480
    buffer_load_dwordx4 v9, s[16:19], s35 offen lds
    s_add_u32 m0, s36, 24576
    buffer_load_dwordx4 v10, s[16:19], s35 offen lds
    s_add_u32 m0, s36, 28672
    buffer_load_dwordx4 v11, s[16:19], s35 offen lds
    s_add_u32 m0, s36, 32768
    buffer_load_dwordx4 v12, s[16:19], s35 offen lds
    s_add_u32 m0, s36, 36864
    buffer_load_dwordx4 v13, s[16:19], s35 offen lds
    s_add_u32 s35, s35, 73728
    ds_read_b64_tr_b16 v[48:49], v16 offset:0
    ds_read_b64_tr_b16 v[50:51], v16 offset:1280
    s_waitcnt lgkmcnt(12)
    v_mfma_f32_16x16x32_bf16 a[24:27], v[24:27], v[96:99], a[24:27]
    v_mfma_f32_16x16x32_bf16 a[28:31], v[24:27], v[100:103], a[28:31]
    ds_read_b64_tr_b16 v[52:53], v17 offset:32
    ds_read_b64_tr_b16 v[54:55], v17 offset:1312
    s_waitcnt lgkmcnt(12)
    v_mfma_f32_16x16x32_bf16 a[32:35], v[28:31], v[96:99], a[32:35]
    v_mfma_f32_16x16x32_bf16 a[36:39], v[28:31], v[100:103], a[36:39]
    ds_read_b64_tr_b16 v[24:25], v16 offset:64
    ds_read_b64_tr_b16 v[26:27], v16 offset:1344
    s_waitcnt lgkmcnt(12)
    v_mfma_f32_16x16x32_bf16 a[40:43], v[32:35], v[96:99], a[40:43]
    v_mfma_f32_16x16x32_bf16 a[44:47], v[32:35], v[100:103], a[44:47]
    ds_read_b64_tr_b16 v[28:29], v17 offset:96
    ds_read_b64_tr_b16 v[30:31], v17 offset:1376
    s_waitcnt lgkmcnt(12)
    v_mfma_f32_16x16x32_bf16 a[48:51], v[36:39], v[96:99], a[48:51]
    v_mfma_f32_16x16x32_bf16 a[52:55], v[36:39], v[100:103], a[52:55]
    ds_read_b64_tr_b16 v[32:33], v16 offset:128
    ds_read_b64_tr_b16 v[34:35], v16 offset:1408
    s_waitcnt lgkmcnt(12)
    v_mfma_f32_16x16x32_bf16 a[56:59], v[40:43], v[96:99], a[56:59]
    v_mfma_f32_16x16x32_bf16 a[60:63], v[40:43], v[100:103], a[60:63]
    ds_read_b64_tr_b16 v[36:37], v17 offset:160
    ds_read_b64_tr_b16 v[38:39], v17 offset:1440
    s_waitcnt lgkmcnt(12)
    v_mfma_f32_16x16x32_bf16 a[64:67], v[44:47], v[96:99], a[64:67]
    v_mfma_f32_16x16x32_bf16 a[68:71], v[44:47], v[100:103], a[68:71]
    s_add_u32 s33, s34, 36864
    buffer_load_dwordx4 v[88:91], v18, s[20:23], s33 offen
    s_add_u32 s33, s34, 202752
    buffer_load_dwordx4 v[92:95], v18, s[20:23], s33 offen
    ds_read_b64_tr_b16 v[40:41], v16 offset:192
    ds_read_b64_tr_b16 v[42:43], v16 offset:1472
    s_waitcnt vmcnt(27)
    s_waitcnt lgkmcnt(12)
    v_mfma_f32_16x16x32_bf16 a[0:3], v[48:51], v[104:107], a[0:3]
    v_mfma_f32_16x16x32_bf16 a[4:7], v[48:51], v[108:111], a[4:7]
    ds_read_b64_tr_b16 v[44:45], v17 offset:224
    ds_read_b64_tr_b16 v[46:47], v17 offset:1504
    s_waitcnt lgkmcnt(12)
    v_mfma_f32_16x16x32_bf16 a[8:11], v[52:55], v[104:107], a[8:11]
    v_mfma_f32_16x16x32_bf16 a[12:15], v[52:55], v[108:111], a[12:15]
    ds_read_b64_tr_b16 v[48:49], v16 offset:256
    ds_read_b64_tr_b16 v[50:51], v16 offset:1536
    s_waitcnt lgkmcnt(12)
    v_mfma_f32_16x16x32_bf16 a[16:19], v[24:27], v[104:107], a[16:19]
    v_mfma_f32_16x16x32_bf16 a[20:23], v[24:27], v[108:111], a[20:23]
    ds_read_b64_tr_b16 v[52:53], v16 offset:10240
    ds_read_b64_tr_b16 v[54:55], v16 offset:11520
    s_waitcnt lgkmcnt(12)
    v_mfma_f32_16x16x32_bf16 a[24:27], v[28:31], v[104:107], a[24:27]
    v_mfma_f32_16x16x32_bf16 a[28:31], v[28:31], v[108:111], a[28:31]
    ds_read_b64_tr_b16 v[24:25], v17 offset:10272
    ds_read_b64_tr_b16 v[26:27], v17 offset:11552
    s_waitcnt lgkmcnt(12)
    v_mfma_f32_16x16x32_bf16 a[32:35], v[32:35], v[104:107], a[32:35]
    v_mfma_f32_16x16x32_bf16 a[36:39], v[32:35], v[108:111], a[36:39]
    ds_read_b64_tr_b16 v[28:29], v16 offset:10304
    ds_read_b64_tr_b16 v[30:31], v16 offset:11584
    s_waitcnt lgkmcnt(12)
    v_mfma_f32_16x16x32_bf16 a[40:43], v[36:39], v[104:107], a[40:43]
    v_mfma_f32_16x16x32_bf16 a[44:47], v[36:39], v[108:111], a[44:47]
    ds_read_b64_tr_b16 v[32:33], v17 offset:10336
    ds_read_b64_tr_b16 v[34:35], v17 offset:11616
    s_waitcnt lgkmcnt(12)
    v_mfma_f32_16x16x32_bf16 a[48:51], v[40:43], v[104:107], a[48:51]
    v_mfma_f32_16x16x32_bf16 a[52:55], v[40:43], v[108:111], a[52:55]
    ds_read_b64_tr_b16 v[36:37], v16 offset:10368
    ds_read_b64_tr_b16 v[38:39], v16 offset:11648
    s_waitcnt lgkmcnt(12)
    v_mfma_f32_16x16x32_bf16 a[56:59], v[44:47], v[104:107], a[56:59]
    v_mfma_f32_16x16x32_bf16 a[60:63], v[44:47], v[108:111], a[60:63]
    ds_read_b64_tr_b16 v[40:41], v17 offset:10400
    ds_read_b64_tr_b16 v[42:43], v17 offset:11680
    s_waitcnt lgkmcnt(12)
    v_mfma_f32_16x16x32_bf16 a[64:67], v[48:51], v[104:107], a[64:67]
    v_mfma_f32_16x16x32_bf16 a[68:71], v[48:51], v[108:111], a[68:71]
    s_add_u32 s33, s34, 37888
    buffer_load_dwordx4 v[96:99], v18, s[20:23], s33 offen
    s_add_u32 s33, s34, 203776
    buffer_load_dwordx4 v[100:103], v18, s[20:23], s33 offen
    ds_read_b64_tr_b16 v[44:45], v16 offset:10432
    ds_read_b64_tr_b16 v[46:47], v16 offset:11712
    s_waitcnt vmcnt(27)
    s_waitcnt lgkmcnt(12)
    v_mfma_f32_16x16x32_bf16 a[0:3], v[52:55], v[112:115], a[0:3]
    v_mfma_f32_16x16x32_bf16 a[4:7], v[52:55], v[116:119], a[4:7]
    ds_read_b64_tr_b16 v[48:49], v17 offset:10464
    ds_read_b64_tr_b16 v[50:51], v17 offset:11744
    s_waitcnt lgkmcnt(12)
    v_mfma_f32_16x16x32_bf16 a[8:11], v[24:27], v[112:115], a[8:11]
    v_mfma_f32_16x16x32_bf16 a[12:15], v[24:27], v[116:119], a[12:15]
    ds_read_b64_tr_b16 v[52:53], v16 offset:10496
    ds_read_b64_tr_b16 v[54:55], v16 offset:11776
    s_waitcnt lgkmcnt(12)
    v_mfma_f32_16x16x32_bf16 a[16:19], v[28:31], v[112:115], a[16:19]
    v_mfma_f32_16x16x32_bf16 a[20:23], v[28:31], v[116:119], a[20:23]
    s_barrier
    ds_read_b64_tr_b16 v[24:25], v16 offset:20480
    ds_read_b64_tr_b16 v[26:27], v16 offset:21760
    s_waitcnt lgkmcnt(12)
    v_mfma_f32_16x16x32_bf16 a[24:27], v[32:35], v[112:115], a[24:27]
    v_mfma_f32_16x16x32_bf16 a[28:31], v[32:35], v[116:119], a[28:31]
    ds_read_b64_tr_b16 v[28:29], v17 offset:20512
    ds_read_b64_tr_b16 v[30:31], v17 offset:21792
    s_waitcnt lgkmcnt(12)
    v_mfma_f32_16x16x32_bf16 a[32:35], v[36:39], v[112:115], a[32:35]
    v_mfma_f32_16x16x32_bf16 a[36:39], v[36:39], v[116:119], a[36:39]
    ds_read_b64_tr_b16 v[32:33], v16 offset:20544
    ds_read_b64_tr_b16 v[34:35], v16 offset:21824
    s_waitcnt lgkmcnt(12)
    v_mfma_f32_16x16x32_bf16 a[40:43], v[40:43], v[112:115], a[40:43]
    v_mfma_f32_16x16x32_bf16 a[44:47], v[40:43], v[116:119], a[44:47]
    ds_read_b64_tr_b16 v[36:37], v17 offset:20576
    ds_read_b64_tr_b16 v[38:39], v17 offset:21856
    s_waitcnt lgkmcnt(12)
    v_mfma_f32_16x16x32_bf16 a[48:51], v[44:47], v[112:115], a[48:51]
    v_mfma_f32_16x16x32_bf16 a[52:55], v[44:47], v[116:119], a[52:55]
    ds_read_b64_tr_b16 v[40:41], v16 offset:20608
    ds_read_b64_tr_b16 v[42:43], v16 offset:21888
    s_waitcnt lgkmcnt(12)
    v_mfma_f32_16x16x32_bf16 a[56:59], v[48:51], v[112:115], a[56:59]
    v_mfma_f32_16x16x32_bf16 a[60:63], v[48:51], v[116:119], a[60:63]
    ds_read_b64_tr_b16 v[44:45], v17 offset:20640
    ds_read_b64_tr_b16 v[46:47], v17 offset:21920
    s_waitcnt lgkmcnt(12)
    v_mfma_f32_16x16x32_bf16 a[64:67], v[52:55], v[112:115], a[64:67]
    v_mfma_f32_16x16x32_bf16 a[68:71], v[52:55], v[116:119], a[68:71]
    s_add_u32 s33, s34, 38912
    buffer_load_dwordx4 v[104:107], v18, s[20:23], s33 offen
    s_add_u32 s33, s34, 204800
    buffer_load_dwordx4 v[108:111], v18, s[20:23], s33 offen
    ds_read_b64_tr_b16 v[48:49], v16 offset:20672
    ds_read_b64_tr_b16 v[50:51], v16 offset:21952
    s_waitcnt vmcnt(22)
    s_waitcnt lgkmcnt(12)
    v_mfma_f32_16x16x32_bf16 a[0:3], v[24:27], v[56:59], a[0:3]
    v_mfma_f32_16x16x32_bf16 a[4:7], v[24:27], v[60:63], a[4:7]
    ds_read_b64_tr_b16 v[52:53], v17 offset:20704
    ds_read_b64_tr_b16 v[54:55], v17 offset:21984
    s_waitcnt lgkmcnt(12)
    v_mfma_f32_16x16x32_bf16 a[8:11], v[28:31], v[56:59], a[8:11]
    v_mfma_f32_16x16x32_bf16 a[12:15], v[28:31], v[60:63], a[12:15]
    ds_read_b64_tr_b16 v[24:25], v16 offset:20736
    ds_read_b64_tr_b16 v[26:27], v16 offset:22016
    s_waitcnt lgkmcnt(12)
    v_mfma_f32_16x16x32_bf16 a[16:19], v[32:35], v[56:59], a[16:19]
    v_mfma_f32_16x16x32_bf16 a[20:23], v[32:35], v[60:63], a[20:23]
    ds_read_b64_tr_b16 v[28:29], v16 offset:30720
    ds_read_b64_tr_b16 v[30:31], v16 offset:32000
    s_waitcnt lgkmcnt(12)
    v_mfma_f32_16x16x32_bf16 a[24:27], v[36:39], v[56:59], a[24:27]
    v_mfma_f32_16x16x32_bf16 a[28:31], v[36:39], v[60:63], a[28:31]
    ds_read_b64_tr_b16 v[32:33], v17 offset:30752
    ds_read_b64_tr_b16 v[34:35], v17 offset:32032
    s_waitcnt lgkmcnt(12)
    v_mfma_f32_16x16x32_bf16 a[32:35], v[40:43], v[56:59], a[32:35]
    v_mfma_f32_16x16x32_bf16 a[36:39], v[40:43], v[60:63], a[36:39]
    ds_read_b64_tr_b16 v[36:37], v16 offset:30784
    ds_read_b64_tr_b16 v[38:39], v16 offset:32064
    s_waitcnt lgkmcnt(12)
    v_mfma_f32_16x16x32_bf16 a[40:43], v[44:47], v[56:59], a[40:43]
    v_mfma_f32_16x16x32_bf16 a[44:47], v[44:47], v[60:63], a[44:47]
    ds_read_b64_tr_b16 v[40:41], v17 offset:30816
    ds_read_b64_tr_b16 v[42:43], v17 offset:32096
    s_waitcnt lgkmcnt(12)
    v_mfma_f32_16x16x32_bf16 a[48:51], v[48:51], v[56:59], a[48:51]
    v_mfma_f32_16x16x32_bf16 a[52:55], v[48:51], v[60:63], a[52:55]
    ds_read_b64_tr_b16 v[44:45], v16 offset:30848
    ds_read_b64_tr_b16 v[46:47], v16 offset:32128
    s_waitcnt lgkmcnt(12)
    v_mfma_f32_16x16x32_bf16 a[56:59], v[52:55], v[56:59], a[56:59]
    v_mfma_f32_16x16x32_bf16 a[60:63], v[52:55], v[60:63], a[60:63]
    ds_read_b64_tr_b16 v[48:49], v17 offset:30880
    ds_read_b64_tr_b16 v[50:51], v17 offset:32160
    s_waitcnt lgkmcnt(12)
    v_mfma_f32_16x16x32_bf16 a[64:67], v[24:27], v[56:59], a[64:67]
    v_mfma_f32_16x16x32_bf16 a[68:71], v[24:27], v[60:63], a[68:71]
    s_add_u32 s33, s34, 39936
    buffer_load_dwordx4 v[112:115], v18, s[20:23], s33 offen
    s_add_u32 s33, s34, 205824
    buffer_load_dwordx4 v[116:119], v18, s[20:23], s33 offen
    ds_read_b64_tr_b16 v[52:53], v16 offset:30912
    ds_read_b64_tr_b16 v[54:55], v16 offset:32192
    s_waitcnt vmcnt(22)
    s_waitcnt lgkmcnt(12)
    v_mfma_f32_16x16x32_bf16 a[0:3], v[28:31], v[64:67], a[0:3]
    v_mfma_f32_16x16x32_bf16 a[4:7], v[28:31], v[68:71], a[4:7]
    ds_read_b64_tr_b16 v[24:25], v17 offset:30944
    ds_read_b64_tr_b16 v[26:27], v17 offset:32224
    s_waitcnt lgkmcnt(12)
    v_mfma_f32_16x16x32_bf16 a[8:11], v[32:35], v[64:67], a[8:11]
    v_mfma_f32_16x16x32_bf16 a[12:15], v[32:35], v[68:71], a[12:15]
    ds_read_b64_tr_b16 v[28:29], v16 offset:30976
    ds_read_b64_tr_b16 v[30:31], v16 offset:32256
    s_waitcnt lgkmcnt(12)
    v_mfma_f32_16x16x32_bf16 a[16:19], v[36:39], v[64:67], a[16:19]
    v_mfma_f32_16x16x32_bf16 a[20:23], v[36:39], v[68:71], a[20:23]
    s_barrier
    ds_read_b64_tr_b16 v[32:33], v16 offset:40960
    ds_read_b64_tr_b16 v[34:35], v16 offset:42240
    s_waitcnt lgkmcnt(12)
    v_mfma_f32_16x16x32_bf16 a[24:27], v[40:43], v[64:67], a[24:27]
    v_mfma_f32_16x16x32_bf16 a[28:31], v[40:43], v[68:71], a[28:31]
    ds_read_b64_tr_b16 v[36:37], v17 offset:40992
    ds_read_b64_tr_b16 v[38:39], v17 offset:42272
    s_waitcnt lgkmcnt(12)
    v_mfma_f32_16x16x32_bf16 a[32:35], v[44:47], v[64:67], a[32:35]
    v_mfma_f32_16x16x32_bf16 a[36:39], v[44:47], v[68:71], a[36:39]
    ds_read_b64_tr_b16 v[40:41], v16 offset:41024
    ds_read_b64_tr_b16 v[42:43], v16 offset:42304
    s_waitcnt lgkmcnt(12)
    v_mfma_f32_16x16x32_bf16 a[40:43], v[48:51], v[64:67], a[40:43]
    v_mfma_f32_16x16x32_bf16 a[44:47], v[48:51], v[68:71], a[44:47]
    ds_read_b64_tr_b16 v[44:45], v17 offset:41056
    ds_read_b64_tr_b16 v[46:47], v17 offset:42336
    s_waitcnt lgkmcnt(12)
    v_mfma_f32_16x16x32_bf16 a[48:51], v[52:55], v[64:67], a[48:51]
    v_mfma_f32_16x16x32_bf16 a[52:55], v[52:55], v[68:71], a[52:55]
    ds_read_b64_tr_b16 v[48:49], v16 offset:41088
    ds_read_b64_tr_b16 v[50:51], v16 offset:42368
    s_waitcnt lgkmcnt(12)
    v_mfma_f32_16x16x32_bf16 a[56:59], v[24:27], v[64:67], a[56:59]
    v_mfma_f32_16x16x32_bf16 a[60:63], v[24:27], v[68:71], a[60:63]
    ds_read_b64_tr_b16 v[52:53], v17 offset:41120
    ds_read_b64_tr_b16 v[54:55], v17 offset:42400
    s_waitcnt lgkmcnt(12)
    v_mfma_f32_16x16x32_bf16 a[64:67], v[28:31], v[64:67], a[64:67]
    v_mfma_f32_16x16x32_bf16 a[68:71], v[28:31], v[68:71], a[68:71]
    ds_read_b64_tr_b16 v[24:25], v16 offset:41152
    ds_read_b64_tr_b16 v[26:27], v16 offset:42432
    s_waitcnt vmcnt(15)
    s_waitcnt lgkmcnt(12)
    v_mfma_f32_16x16x32_bf16 a[0:3], v[32:35], v[72:75], a[0:3]
    v_mfma_f32_16x16x32_bf16 a[4:7], v[32:35], v[76:79], a[4:7]
    ds_read_b64_tr_b16 v[28:29], v17 offset:41184
    ds_read_b64_tr_b16 v[30:31], v17 offset:42464
    s_waitcnt lgkmcnt(12)
    v_mfma_f32_16x16x32_bf16 a[8:11], v[36:39], v[72:75], a[8:11]
    v_mfma_f32_16x16x32_bf16 a[12:15], v[36:39], v[76:79], a[12:15]
    ds_read_b64_tr_b16 v[32:33], v16 offset:41216
    ds_read_b64_tr_b16 v[34:35], v16 offset:42496
    s_waitcnt lgkmcnt(12)
    v_mfma_f32_16x16x32_bf16 a[16:19], v[40:43], v[72:75], a[16:19]
    v_mfma_f32_16x16x32_bf16 a[20:23], v[40:43], v[76:79], a[20:23]
    ds_read_b64_tr_b16 v[36:37], v16 offset:51200
    ds_read_b64_tr_b16 v[38:39], v16 offset:52480
    s_waitcnt lgkmcnt(12)
    v_mfma_f32_16x16x32_bf16 a[24:27], v[44:47], v[72:75], a[24:27]
    v_mfma_f32_16x16x32_bf16 a[28:31], v[44:47], v[76:79], a[28:31]
    ds_read_b64_tr_b16 v[40:41], v17 offset:51232
    ds_read_b64_tr_b16 v[42:43], v17 offset:52512
    s_waitcnt lgkmcnt(12)
    v_mfma_f32_16x16x32_bf16 a[32:35], v[48:51], v[72:75], a[32:35]
    v_mfma_f32_16x16x32_bf16 a[36:39], v[48:51], v[76:79], a[36:39]
    ds_read_b64_tr_b16 v[44:45], v16 offset:51264
    ds_read_b64_tr_b16 v[46:47], v16 offset:52544
    s_waitcnt lgkmcnt(12)
    v_mfma_f32_16x16x32_bf16 a[40:43], v[52:55], v[72:75], a[40:43]
    v_mfma_f32_16x16x32_bf16 a[44:47], v[52:55], v[76:79], a[44:47]
    ds_read_b64_tr_b16 v[48:49], v17 offset:51296
    ds_read_b64_tr_b16 v[50:51], v17 offset:52576
    s_waitcnt lgkmcnt(12)
    v_mfma_f32_16x16x32_bf16 a[48:51], v[24:27], v[72:75], a[48:51]
    v_mfma_f32_16x16x32_bf16 a[52:55], v[24:27], v[76:79], a[52:55]
    ds_read_b64_tr_b16 v[52:53], v16 offset:51328
    ds_read_b64_tr_b16 v[54:55], v16 offset:52608
    s_waitcnt lgkmcnt(12)
    v_mfma_f32_16x16x32_bf16 a[56:59], v[28:31], v[72:75], a[56:59]
    v_mfma_f32_16x16x32_bf16 a[60:63], v[28:31], v[76:79], a[60:63]
    ds_read_b64_tr_b16 v[24:25], v17 offset:51360
    ds_read_b64_tr_b16 v[26:27], v17 offset:52640
    s_waitcnt lgkmcnt(12)
    v_mfma_f32_16x16x32_bf16 a[64:67], v[32:35], v[72:75], a[64:67]
    v_mfma_f32_16x16x32_bf16 a[68:71], v[32:35], v[76:79], a[68:71]
    ds_read_b64_tr_b16 v[28:29], v16 offset:51392
    ds_read_b64_tr_b16 v[30:31], v16 offset:52672
    s_waitcnt vmcnt(13)
    s_waitcnt lgkmcnt(12)
    v_mfma_f32_16x16x32_bf16 a[0:3], v[36:39], v[80:83], a[0:3]
    v_mfma_f32_16x16x32_bf16 a[4:7], v[36:39], v[84:87], a[4:7]
    ds_read_b64_tr_b16 v[32:33], v17 offset:51424
    ds_read_b64_tr_b16 v[34:35], v17 offset:52704
    s_waitcnt lgkmcnt(12)
    v_mfma_f32_16x16x32_bf16 a[8:11], v[40:43], v[80:83], a[8:11]
    v_mfma_f32_16x16x32_bf16 a[12:15], v[40:43], v[84:87], a[12:15]
    ds_read_b64_tr_b16 v[36:37], v16 offset:51456
    ds_read_b64_tr_b16 v[38:39], v16 offset:52736
    s_waitcnt lgkmcnt(12)
    v_mfma_f32_16x16x32_bf16 a[16:19], v[44:47], v[80:83], a[16:19]
    v_mfma_f32_16x16x32_bf16 a[20:23], v[44:47], v[84:87], a[20:23]
    s_barrier
    ds_read_b64_tr_b16 v[40:41], v14 offset:0
    ds_read_b64_tr_b16 v[42:43], v14 offset:1280
    s_waitcnt lgkmcnt(12)
    v_mfma_f32_16x16x32_bf16 a[24:27], v[48:51], v[80:83], a[24:27]
    v_mfma_f32_16x16x32_bf16 a[28:31], v[48:51], v[84:87], a[28:31]
    ds_read_b64_tr_b16 v[44:45], v15 offset:32
    ds_read_b64_tr_b16 v[46:47], v15 offset:1312
    s_waitcnt lgkmcnt(12)
    v_mfma_f32_16x16x32_bf16 a[32:35], v[52:55], v[80:83], a[32:35]
    v_mfma_f32_16x16x32_bf16 a[36:39], v[52:55], v[84:87], a[36:39]
    ds_read_b64_tr_b16 v[48:49], v14 offset:64
    ds_read_b64_tr_b16 v[50:51], v14 offset:1344
    s_waitcnt lgkmcnt(12)
    v_mfma_f32_16x16x32_bf16 a[40:43], v[24:27], v[80:83], a[40:43]
    v_mfma_f32_16x16x32_bf16 a[44:47], v[24:27], v[84:87], a[44:47]
    ds_read_b64_tr_b16 v[52:53], v15 offset:96
    ds_read_b64_tr_b16 v[54:55], v15 offset:1376
    s_waitcnt lgkmcnt(12)
    v_mfma_f32_16x16x32_bf16 a[48:51], v[28:31], v[80:83], a[48:51]
    v_mfma_f32_16x16x32_bf16 a[52:55], v[28:31], v[84:87], a[52:55]
    ds_read_b64_tr_b16 v[24:25], v14 offset:128
    ds_read_b64_tr_b16 v[26:27], v14 offset:1408
    s_waitcnt lgkmcnt(12)
    v_mfma_f32_16x16x32_bf16 a[56:59], v[32:35], v[80:83], a[56:59]
    v_mfma_f32_16x16x32_bf16 a[60:63], v[32:35], v[84:87], a[60:63]
    ds_read_b64_tr_b16 v[28:29], v15 offset:160
    ds_read_b64_tr_b16 v[30:31], v15 offset:1440
    s_waitcnt lgkmcnt(12)
    v_mfma_f32_16x16x32_bf16 a[64:67], v[36:39], v[80:83], a[64:67]
    v_mfma_f32_16x16x32_bf16 a[68:71], v[36:39], v[84:87], a[68:71]
    ds_read_b64_tr_b16 v[32:33], v14 offset:192
    ds_read_b64_tr_b16 v[34:35], v14 offset:1472
    s_waitcnt vmcnt(6)
    s_waitcnt lgkmcnt(12)
    v_mfma_f32_16x16x32_bf16 a[0:3], v[40:43], v[88:91], a[0:3]
    v_mfma_f32_16x16x32_bf16 a[4:7], v[40:43], v[92:95], a[4:7]
    ds_read_b64_tr_b16 v[36:37], v15 offset:224
    ds_read_b64_tr_b16 v[38:39], v15 offset:1504
    s_waitcnt lgkmcnt(12)
    v_mfma_f32_16x16x32_bf16 a[8:11], v[44:47], v[88:91], a[8:11]
    v_mfma_f32_16x16x32_bf16 a[12:15], v[44:47], v[92:95], a[12:15]
    ds_read_b64_tr_b16 v[40:41], v14 offset:256
    ds_read_b64_tr_b16 v[42:43], v14 offset:1536
    s_waitcnt lgkmcnt(12)
    v_mfma_f32_16x16x32_bf16 a[16:19], v[48:51], v[88:91], a[16:19]
    v_mfma_f32_16x16x32_bf16 a[20:23], v[48:51], v[92:95], a[20:23]
    ds_read_b64_tr_b16 v[44:45], v14 offset:10240
    ds_read_b64_tr_b16 v[46:47], v14 offset:11520
    s_waitcnt lgkmcnt(12)
    v_mfma_f32_16x16x32_bf16 a[24:27], v[52:55], v[88:91], a[24:27]
    v_mfma_f32_16x16x32_bf16 a[28:31], v[52:55], v[92:95], a[28:31]
    ds_read_b64_tr_b16 v[48:49], v15 offset:10272
    ds_read_b64_tr_b16 v[50:51], v15 offset:11552
    s_waitcnt lgkmcnt(12)
    v_mfma_f32_16x16x32_bf16 a[32:35], v[24:27], v[88:91], a[32:35]
    v_mfma_f32_16x16x32_bf16 a[36:39], v[24:27], v[92:95], a[36:39]
    ds_read_b64_tr_b16 v[52:53], v14 offset:10304
    ds_read_b64_tr_b16 v[54:55], v14 offset:11584
    s_waitcnt lgkmcnt(12)
    v_mfma_f32_16x16x32_bf16 a[40:43], v[28:31], v[88:91], a[40:43]
    v_mfma_f32_16x16x32_bf16 a[44:47], v[28:31], v[92:95], a[44:47]
    ds_read_b64_tr_b16 v[24:25], v15 offset:10336
    ds_read_b64_tr_b16 v[26:27], v15 offset:11616
    s_waitcnt lgkmcnt(12)
    v_mfma_f32_16x16x32_bf16 a[48:51], v[32:35], v[88:91], a[48:51]
    v_mfma_f32_16x16x32_bf16 a[52:55], v[32:35], v[92:95], a[52:55]
    ds_read_b64_tr_b16 v[28:29], v14 offset:10368
    ds_read_b64_tr_b16 v[30:31], v14 offset:11648
    s_waitcnt lgkmcnt(12)
    v_mfma_f32_16x16x32_bf16 a[56:59], v[36:39], v[88:91], a[56:59]
    v_mfma_f32_16x16x32_bf16 a[60:63], v[36:39], v[92:95], a[60:63]
    ds_read_b64_tr_b16 v[32:33], v15 offset:10400
    ds_read_b64_tr_b16 v[34:35], v15 offset:11680
    s_waitcnt lgkmcnt(12)
    v_mfma_f32_16x16x32_bf16 a[64:67], v[40:43], v[88:91], a[64:67]
    v_mfma_f32_16x16x32_bf16 a[68:71], v[40:43], v[92:95], a[68:71]
    ds_read_b64_tr_b16 v[36:37], v14 offset:10432
    ds_read_b64_tr_b16 v[38:39], v14 offset:11712
    s_waitcnt vmcnt(4)
    s_waitcnt lgkmcnt(12)
    v_mfma_f32_16x16x32_bf16 a[0:3], v[44:47], v[96:99], a[0:3]
    v_mfma_f32_16x16x32_bf16 a[4:7], v[44:47], v[100:103], a[4:7]
    ds_read_b64_tr_b16 v[40:41], v15 offset:10464
    ds_read_b64_tr_b16 v[42:43], v15 offset:11744
    s_waitcnt lgkmcnt(12)
    v_mfma_f32_16x16x32_bf16 a[8:11], v[48:51], v[96:99], a[8:11]
    v_mfma_f32_16x16x32_bf16 a[12:15], v[48:51], v[100:103], a[12:15]
    ds_read_b64_tr_b16 v[44:45], v14 offset:10496
    ds_read_b64_tr_b16 v[46:47], v14 offset:11776
    s_waitcnt lgkmcnt(12)
    v_mfma_f32_16x16x32_bf16 a[16:19], v[52:55], v[96:99], a[16:19]
    v_mfma_f32_16x16x32_bf16 a[20:23], v[52:55], v[100:103], a[20:23]
    s_barrier
    ds_read_b64_tr_b16 v[48:49], v14 offset:20480
    ds_read_b64_tr_b16 v[50:51], v14 offset:21760
    s_waitcnt lgkmcnt(12)
    v_mfma_f32_16x16x32_bf16 a[24:27], v[24:27], v[96:99], a[24:27]
    v_mfma_f32_16x16x32_bf16 a[28:31], v[24:27], v[100:103], a[28:31]
    ds_read_b64_tr_b16 v[52:53], v15 offset:20512
    ds_read_b64_tr_b16 v[54:55], v15 offset:21792
    s_waitcnt lgkmcnt(12)
    v_mfma_f32_16x16x32_bf16 a[32:35], v[28:31], v[96:99], a[32:35]
    v_mfma_f32_16x16x32_bf16 a[36:39], v[28:31], v[100:103], a[36:39]
    ds_read_b64_tr_b16 v[24:25], v14 offset:20544
    ds_read_b64_tr_b16 v[26:27], v14 offset:21824
    s_waitcnt lgkmcnt(12)
    v_mfma_f32_16x16x32_bf16 a[40:43], v[32:35], v[96:99], a[40:43]
    v_mfma_f32_16x16x32_bf16 a[44:47], v[32:35], v[100:103], a[44:47]
    ds_read_b64_tr_b16 v[28:29], v15 offset:20576
    ds_read_b64_tr_b16 v[30:31], v15 offset:21856
    s_waitcnt lgkmcnt(12)
    v_mfma_f32_16x16x32_bf16 a[48:51], v[36:39], v[96:99], a[48:51]
    v_mfma_f32_16x16x32_bf16 a[52:55], v[36:39], v[100:103], a[52:55]
    ds_read_b64_tr_b16 v[32:33], v14 offset:20608
    ds_read_b64_tr_b16 v[34:35], v14 offset:21888
    s_waitcnt lgkmcnt(12)
    v_mfma_f32_16x16x32_bf16 a[56:59], v[40:43], v[96:99], a[56:59]
    v_mfma_f32_16x16x32_bf16 a[60:63], v[40:43], v[100:103], a[60:63]
    ds_read_b64_tr_b16 v[36:37], v15 offset:20640
    ds_read_b64_tr_b16 v[38:39], v15 offset:21920
    s_waitcnt lgkmcnt(12)
    v_mfma_f32_16x16x32_bf16 a[64:67], v[44:47], v[96:99], a[64:67]
    v_mfma_f32_16x16x32_bf16 a[68:71], v[44:47], v[100:103], a[68:71]
    ds_read_b64_tr_b16 v[40:41], v14 offset:20672
    ds_read_b64_tr_b16 v[42:43], v14 offset:21952
    s_waitcnt vmcnt(2)
    s_waitcnt lgkmcnt(12)
    v_mfma_f32_16x16x32_bf16 a[0:3], v[48:51], v[104:107], a[0:3]
    v_mfma_f32_16x16x32_bf16 a[4:7], v[48:51], v[108:111], a[4:7]
    ds_read_b64_tr_b16 v[44:45], v15 offset:20704
    ds_read_b64_tr_b16 v[46:47], v15 offset:21984
    s_waitcnt lgkmcnt(12)
    v_mfma_f32_16x16x32_bf16 a[8:11], v[52:55], v[104:107], a[8:11]
    v_mfma_f32_16x16x32_bf16 a[12:15], v[52:55], v[108:111], a[12:15]
    ds_read_b64_tr_b16 v[48:49], v14 offset:20736
    ds_read_b64_tr_b16 v[50:51], v14 offset:22016
    s_waitcnt lgkmcnt(12)
    v_mfma_f32_16x16x32_bf16 a[16:19], v[24:27], v[104:107], a[16:19]
    v_mfma_f32_16x16x32_bf16 a[20:23], v[24:27], v[108:111], a[20:23]
    ds_read_b64_tr_b16 v[52:53], v14 offset:30720
    ds_read_b64_tr_b16 v[54:55], v14 offset:32000
    s_waitcnt lgkmcnt(12)
    v_mfma_f32_16x16x32_bf16 a[24:27], v[28:31], v[104:107], a[24:27]
    v_mfma_f32_16x16x32_bf16 a[28:31], v[28:31], v[108:111], a[28:31]
    ds_read_b64_tr_b16 v[24:25], v15 offset:30752
    ds_read_b64_tr_b16 v[26:27], v15 offset:32032
    s_waitcnt lgkmcnt(12)
    v_mfma_f32_16x16x32_bf16 a[32:35], v[32:35], v[104:107], a[32:35]
    v_mfma_f32_16x16x32_bf16 a[36:39], v[32:35], v[108:111], a[36:39]
    ds_read_b64_tr_b16 v[28:29], v14 offset:30784
    ds_read_b64_tr_b16 v[30:31], v14 offset:32064
    s_waitcnt lgkmcnt(12)
    v_mfma_f32_16x16x32_bf16 a[40:43], v[36:39], v[104:107], a[40:43]
    v_mfma_f32_16x16x32_bf16 a[44:47], v[36:39], v[108:111], a[44:47]
    ds_read_b64_tr_b16 v[32:33], v15 offset:30816
    ds_read_b64_tr_b16 v[34:35], v15 offset:32096
    s_waitcnt lgkmcnt(12)
    v_mfma_f32_16x16x32_bf16 a[48:51], v[40:43], v[104:107], a[48:51]
    v_mfma_f32_16x16x32_bf16 a[52:55], v[40:43], v[108:111], a[52:55]
    ds_read_b64_tr_b16 v[36:37], v14 offset:30848
    ds_read_b64_tr_b16 v[38:39], v14 offset:32128
    s_waitcnt lgkmcnt(12)
    v_mfma_f32_16x16x32_bf16 a[56:59], v[44:47], v[104:107], a[56:59]
    v_mfma_f32_16x16x32_bf16 a[60:63], v[44:47], v[108:111], a[60:63]
    ds_read_b64_tr_b16 v[40:41], v15 offset:30880
    ds_read_b64_tr_b16 v[42:43], v15 offset:32160
    s_waitcnt lgkmcnt(12)
    v_mfma_f32_16x16x32_bf16 a[64:67], v[48:51], v[104:107], a[64:67]
    v_mfma_f32_16x16x32_bf16 a[68:71], v[48:51], v[108:111], a[68:71]
    ds_read_b64_tr_b16 v[44:45], v14 offset:30912
    ds_read_b64_tr_b16 v[46:47], v14 offset:32192
    s_waitcnt vmcnt(0)
    s_waitcnt lgkmcnt(12)
    v_mfma_f32_16x16x32_bf16 a[0:3], v[52:55], v[112:115], a[0:3]
    v_mfma_f32_16x16x32_bf16 a[4:7], v[52:55], v[116:119], a[4:7]
    ds_read_b64_tr_b16 v[48:49], v15 offset:30944
    ds_read_b64_tr_b16 v[50:51], v15 offset:32224
    s_waitcnt lgkmcnt(12)
    v_mfma_f32_16x16x32_bf16 a[8:11], v[24:27], v[112:115], a[8:11]
    v_mfma_f32_16x16x32_bf16 a[12:15], v[24:27], v[116:119], a[12:15]
    ds_read_b64_tr_b16 v[52:53], v14 offset:30976
    ds_read_b64_tr_b16 v[54:55], v14 offset:32256
    s_waitcnt lgkmcnt(12)
    v_mfma_f32_16x16x32_bf16 a[16:19], v[28:31], v[112:115], a[16:19]
    v_mfma_f32_16x16x32_bf16 a[20:23], v[28:31], v[116:119], a[20:23]
    s_waitcnt lgkmcnt(10)
    v_mfma_f32_16x16x32_bf16 a[24:27], v[32:35], v[112:115], a[24:27]
    v_mfma_f32_16x16x32_bf16 a[28:31], v[32:35], v[116:119], a[28:31]
    s_waitcnt lgkmcnt(8)
    v_mfma_f32_16x16x32_bf16 a[32:35], v[36:39], v[112:115], a[32:35]
    v_mfma_f32_16x16x32_bf16 a[36:39], v[36:39], v[116:119], a[36:39]
    s_waitcnt lgkmcnt(6)
    v_mfma_f32_16x16x32_bf16 a[40:43], v[40:43], v[112:115], a[40:43]
    v_mfma_f32_16x16x32_bf16 a[44:47], v[40:43], v[116:119], a[44:47]
    s_waitcnt lgkmcnt(4)
    v_mfma_f32_16x16x32_bf16 a[48:51], v[44:47], v[112:115], a[48:51]
    v_mfma_f32_16x16x32_bf16 a[52:55], v[44:47], v[116:119], a[52:55]
    s_waitcnt lgkmcnt(2)
    v_mfma_f32_16x16x32_bf16 a[56:59], v[48:51], v[112:115], a[56:59]
    v_mfma_f32_16x16x32_bf16 a[60:63], v[48:51], v[116:119], a[60:63]
    s_waitcnt lgkmcnt(0)
    v_mfma_f32_16x16x32_bf16 a[64:67], v[52:55], v[112:115], a[64:67]
    v_mfma_f32_16x16x32_bf16 a[68:71], v[52:55], v[116:119], a[68:71]
    s_branch L_k3_gemm2_kernel_epi
L_k3_gemm2_kernel_epi:
    s_nop 9
    s_mov_b32 s32, 0
    buffer_store_dwordx4 a[0:3], v19, s[24:27], s32 offen
    s_mov_b32 s32, 36864
    buffer_store_dwordx4 a[4:7], v19, s[24:27], s32 offen
    s_mov_b32 s32, 64
    buffer_store_dwordx4 a[8:11], v19, s[24:27], s32 offen
    s_mov_b32 s32, 36928
    buffer_store_dwordx4 a[12:15], v19, s[24:27], s32 offen
    s_mov_b32 s32, 128
    buffer_store_dwordx4 a[16:19], v19, s[24:27], s32 offen
    s_mov_b32 s32, 36992
    buffer_store_dwordx4 a[20:23], v19, s[24:27], s32 offen
    s_mov_b32 s32, 192
    buffer_store_dwordx4 a[24:27], v19, s[24:27], s32 offen
    s_mov_b32 s32, 37056
    buffer_store_dwordx4 a[28:31], v19, s[24:27], s32 offen
    s_mov_b32 s32, 256
    buffer_store_dwordx4 a[32:35], v19, s[24:27], s32 offen
    s_mov_b32 s32, 37120
    buffer_store_dwordx4 a[36:39], v19, s[24:27], s32 offen
    s_mov_b32 s32, 320
    buffer_store_dwordx4 a[40:43], v19, s[24:27], s32 offen
    s_mov_b32 s32, 37184
    buffer_store_dwordx4 a[44:47], v19, s[24:27], s32 offen
    s_mov_b32 s32, 384
    buffer_store_dwordx4 a[48:51], v19, s[24:27], s32 offen
    s_mov_b32 s32, 37248
    buffer_store_dwordx4 a[52:55], v19, s[24:27], s32 offen
    s_mov_b32 s32, 448
    buffer_store_dwordx4 a[56:59], v19, s[24:27], s32 offen
    s_mov_b32 s32, 37312
    buffer_store_dwordx4 a[60:63], v19, s[24:27], s32 offen
    s_mov_b32 s32, 512
    buffer_store_dwordx4 a[64:67], v19, s[24:27], s32 offen
    s_mov_b32 s32, 37376
    buffer_store_dwordx4 a[68:71], v19, s[24:27], s32 offen
    s_waitcnt vmcnt(0)
L_k3_gemm2_kernel_end:
    s_endpgm
.text
.globl k4_reduce_kernel
.p2align 8
.type k4_reduce_kernel,@function
k4_reduce_kernel:
    s_load_dwordx2 s[4:5], s[0:1], 0
    s_load_dwordx2 s[6:7], s[0:1], 56
    s_load_dwordx2 s[8:9], s[0:1], 72
    s_cmp_ge_u32 s2, 576
    s_cbranch_scc1 L_k4_reduce_kernel_end
    s_waitcnt lgkmcnt(0)
    s_mov_b32 s12, s4
    s_mov_b32 s13, s5
    s_mov_b32 s14, 2359296
    s_mov_b32 s15, 0x00020000
    s_mov_b32 s16, s6
    s_mov_b32 s17, s7
    s_mov_b32 s18, 2359296
    s_mov_b32 s19, 0x00020000
    s_add_u32 s20, s8, 50331648
    s_addc_u32 s21, s9, 0
    s_mov_b32 s22, 18874368
    s_mov_b32 s23, 0x00020000
    s_lshl_b32 s24, s2, 8
    v_add_u32 v1, s24, v0
    v_lshlrev_b32 v2, 4, v1
    v_lshlrev_b32 v3, 5, v1
    buffer_load_dwordx4 v[4:7], v2, s[12:15], 0 offen
    s_mov_b32 s25, 0
    buffer_load_dwordx4 v[8:11], v3, s[20:23], s25 offen
    buffer_load_dwordx4 v[12:15], v3, s[20:23], s25 offen offset:16
    s_mov_b32 s25, 4718592
    buffer_load_dwordx4 v[16:19], v3, s[20:23], s25 offen
    buffer_load_dwordx4 v[20:23], v3, s[20:23], s25 offen offset:16
    s_mov_b32 s25, 9437184
    buffer_load_dwordx4 v[24:27], v3, s[20:23], s25 offen
    buffer_load_dwordx4 v[28:31], v3, s[20:23], s25 offen offset:16
    s_mov_b32 s25, 14155776
    buffer_load_dwordx4 v[32:35], v3, s[20:23], s25 offen
    buffer_load_dwordx4 v[36:39], v3, s[20:23], s25 offen offset:16
    s_waitcnt vmcnt(8)
    v_lshlrev_b32 v40, 16, v4
    v_and_b32 v41, 0xffff0000, v4
    v_lshlrev_b32 v42, 16, v5
    v_and_b32 v43, 0xffff0000, v5
    v_lshlrev_b32 v44, 16, v6
    v_and_b32 v45, 0xffff0000, v6
    v_lshlrev_b32 v46, 16, v7
    v_and_b32 v47, 0xffff0000, v7
    s_waitcnt vmcnt(6)
    v_add_f32 v40, v40, v8
    v_add_f32 v41, v41, v9
    v_add_f32 v42, v42, v10
    v_add_f32 v43, v43, v11
    v_add_f32 v44, v44, v12
    v_add_f32 v45, v45, v13
    v_add_f32 v46, v46, v14
    v_add_f32 v47, v47, v15
    s_waitcnt vmcnt(4)
    v_add_f32 v40, v40, v16
    v_add_f32 v41, v41, v17
    v_add_f32 v42, v42, v18
    v_add_f32 v43, v43, v19
    v_add_f32 v44, v44, v20
    v_add_f32 v45, v45, v21
    v_add_f32 v46, v46, v22
    v_add_f32 v47, v47, v23
    s_waitcnt vmcnt(2)
    v_add_f32 v40, v40, v24
    v_add_f32 v41, v41, v25
    v_add_f32 v42, v42, v26
    v_add_f32 v43, v43, v27
    v_add_f32 v44, v44, v28
    v_add_f32 v45, v45, v29
    v_add_f32 v46, v46, v30
    v_add_f32 v47, v47, v31
    s_waitcnt vmcnt(0)
    v_add_f32 v40, v40, v32
    v_add_f32 v41, v41, v33
    v_add_f32 v42, v42, v34
    v_add_f32 v43, v43, v35
    v_add_f32 v44, v44, v36
    v_add_f32 v45, v45, v37
    v_add_f32 v46, v46, v38
    v_add_f32 v47, v47, v39
    v_cvt_pk_bf16_f32 v48, v40, v41
    v_cvt_pk_bf16_f32 v49, v42, v43
    v_cvt_pk_bf16_f32 v50, v44, v45
    v_cvt_pk_bf16_f32 v51, v46, v47
    buffer_store_dwordx4 v[48:51], v2, s[16:19], 0 offen
L_k4_reduce_kernel_end:
    s_endpgm
.section .rodata,"a"
.p2align 6
.p2align 6
.amdhsa_kernel k1_ln_gemm1_kernel
  .amdhsa_next_free_vgpr 496
  .amdhsa_next_free_sgpr 102
  .amdhsa_accum_offset 256
  .amdhsa_group_segment_fixed_size 0
  .amdhsa_kernarg_size 80
  .amdhsa_user_sgpr_count 2
  .amdhsa_user_sgpr_kernarg_segment_ptr 1
  .amdhsa_system_sgpr_workgroup_id_x 1
.end_amdhsa_kernel
.p2align 6
.amdhsa_kernel k2_attn_out_kernel
  .amdhsa_next_free_vgpr 128
  .amdhsa_next_free_sgpr 102
  .amdhsa_accum_offset 128
  .amdhsa_group_segment_fixed_size 0
  .amdhsa_kernarg_size 80
  .amdhsa_user_sgpr_count 2
  .amdhsa_user_sgpr_kernarg_segment_ptr 1
  .amdhsa_system_sgpr_workgroup_id_x 1
.end_amdhsa_kernel
.p2align 6
.amdhsa_kernel k3_gemm2_kernel
  .amdhsa_next_free_vgpr 192
  .amdhsa_next_free_sgpr 102
  .amdhsa_accum_offset 120
  .amdhsa_group_segment_fixed_size 0
  .amdhsa_kernarg_size 80
  .amdhsa_user_sgpr_count 2
  .amdhsa_user_sgpr_kernarg_segment_ptr 1
  .amdhsa_system_sgpr_workgroup_id_x 1
.end_amdhsa_kernel
.p2align 6
.amdhsa_kernel k4_reduce_kernel
  .amdhsa_next_free_vgpr 56
  .amdhsa_next_free_sgpr 102
  .amdhsa_accum_offset 56
  .amdhsa_group_segment_fixed_size 0
  .amdhsa_kernarg_size 80
  .amdhsa_user_sgpr_count 2
  .amdhsa_user_sgpr_kernarg_segment_ptr 1
  .amdhsa_system_sgpr_workgroup_id_x 1
.end_amdhsa_kernel
```
